```python
import torch

def _softmax(x, axis=-1):
    return torch.softmax(x, dim=axis)
def _gelu(x):
    return torch.nn.functional.gelu(x, approximate="tanh")
def _silu(x):
    return torch.nn.functional.silu(x)
def _sigmoid(x):
    return torch.sigmoid(x)
def _layernorm(x, axis=-1, eps=1e-5):
    m = x.mean(dim=axis, keepdim=True)
    v = x.var(dim=axis, keepdim=True, unbiased=False)
    return (x - m) / torch.sqrt(v + eps)
def _scatter_add(tgt, idx, src, axis=0):
    return tgt.clone().index_add_(axis, idx, src)
def _segment_sum(src, seg, n):
    out = torch.zeros((n,) + src.shape[1:], dtype=src.dtype)
    return out.index_add_(0, seg, src)
def _pad(x, pw):
    flat = tuple(v for pair in reversed(pw) for v in pair)
    return torch.nn.functional.pad(x, flat)

kernel_name = 'sequential_preLN__compressed_kv_cla__mixer_token_mlp__prompt'

def setup_inputs():

    _w = (lambda a: (lambda t: t.to(torch.bfloat16) if t.is_floating_point() else t)(torch.as_tensor(a)))
    def _A_setup():
        B, H, Sq, Sk, D, M = 1, 16, 2048, 2048, 256, 448
        Dc = 4 * D
        return {
            "x": _w((lambda *s: torch.randn(*s, dtype=torch.bfloat16) * 0.05)(B, Sq, M)),
            "c_kv": _w((lambda *s: torch.randn(*s, dtype=torch.bfloat16) * 0.2)(B, Sk, Dc)),
            "w_q": _w((lambda *s: torch.randn(*s, dtype=torch.bfloat16) * 3.2)(M, H, D) * (M ** -0.5)),
            "w_uk": _w((lambda *s: torch.randn(*s, dtype=torch.bfloat16) * 6.4)(Dc, H, D) * (Dc ** -0.5)),
            "w_uv": _w((lambda *s: torch.randn(*s, dtype=torch.bfloat16) * 0.2)(Dc, H, D) * (Dc ** -0.5)),
            "w_o": _w((lambda *s: torch.randn(*s, dtype=torch.bfloat16) * 0.2)(H, D, M) * ((H * D) ** -0.5)),
        }
    _A_in = _A_setup()

    def _B_setup():
        B, S, D, F = 1, 2048, 448, 1792
        return {
            "x": _w((lambda *s: torch.randn(*s, dtype=torch.bfloat16) * 0.05)(B, S, D)),
            "w1": _w((lambda *s: torch.randn(*s, dtype=torch.bfloat16) * 0.4)(S, F) * (S ** -0.5)),
            "b1": _w((lambda *s: torch.randn(*s, dtype=torch.bfloat16) * 3.2)(F) * 0.02),
            "w2": _w((lambda *s: torch.randn(*s, dtype=torch.bfloat16) * 0.2)(F, S) * (F ** -0.5)),
            "b2": _w((lambda *s: torch.randn(*s, dtype=torch.bfloat16) * 0.8)(S) * 0.02),
        }
    _B_in = _B_setup()

    return {
        "A_x": _A_in["x"],
        "A_c_kv": _A_in["c_kv"],
        "A_w_q": _A_in["w_q"],
        "A_w_uk": _A_in["w_uk"],
        "A_w_uv": _A_in["w_uv"],
        "A_w_o": _A_in["w_o"],
        "B_x": _B_in["x"],
        "B_w1": _B_in["w1"],
        "B_b1": _B_in["b1"],
        "B_w2": _B_in["w2"],
        "B_b2": _B_in["b2"],
    }

def reference(A_x, A_c_kv, A_w_q, A_w_uk, A_w_uv, A_w_o, B_x, B_w1, B_b1, B_w2, B_b2):
    def _A_ref(x, c_kv, w_q, w_uk, w_uv, w_o):
        B, Sq, M = x.shape[0], x.shape[1], x.shape[2]
        Sk = c_kv.shape[1]
        H, D = w_q.shape[1], w_q.shape[2]
        q = torch.einsum("bqm,mhd->bhqd", x, w_q)
        k = torch.einsum("bkc,chd->bhkd", c_kv, w_uk)
        v = torch.einsum("bkc,chd->bhkd", c_kv, w_uv)
        scores = torch.einsum("bhqd,bhkd->bhqk", q, k) * (D ** -0.5)
        off = Sk - Sq
        qi = torch.arange(Sq)[:, None]
        kj = torch.arange(Sk)[None, :]
        cmask = kj <= (qi + off)
        scores = torch.where(cmask[None, None], scores, -1e9)
        p = _softmax(scores, axis=-1)
        ctx = torch.einsum("bhqk,bhkd->bhqd", p, v)
        return torch.einsum("bhqd,hdm->bqm", ctx, w_o)

    def _B_ref(x, w1, b1, w2, b2):
        B, S, D = x.shape
        h = _layernorm(x, axis=-1)
        u = torch.einsum("bsd,sf->bdf", h, w1) + b1
        u = _gelu(u)
        y = torch.einsum("bdf,fs->bds", u, w2) + b2
        return (lambda x, *d: x.permute(*d))(y, 0, 2, 1)

    x = A_x
    h = x + _A_ref(_layernorm(x, axis=-1), A_c_kv, A_w_q, A_w_uk, A_w_uv, A_w_o)
    h2 = h + _B_ref(_layernorm(h, axis=-1), B_w1, B_b1, B_w2, B_b2)
    return h2
```

```asm
; @launch kernel=fused_kernel grid=(256,1,1) block=(256,1,1) lds=163840
.amdgcn_target "amdgcn-amd-amdhsa--gfx950"
.text
.globl fused_kernel
.p2align 8
.type fused_kernel,@function
fused_kernel:
  s_cmp_ge_u32 s2, 256
  s_cbranch_scc1 L_k1_exit
  s_load_dwordx4 s[28:31], s[0:1], 0
  s_load_dwordx4 s[32:35], s[0:1], 16
  s_load_dwordx4 s[36:39], s[0:1], 32
  s_load_dwordx4 s[40:43], s[0:1], 96
  s_load_dwordx2 s[62:63], s[0:1], 56
  s_load_dwordx2 s[64:65], s[0:1], 72
  s_getpc_b64 s[4:5]
L_k1_pc:
  v_lshlrev_b32_e64 v1, 7, v0
  v_min_u32 v1, L_k1_codeend-L_k1_pc-4, v1
  global_load_dword v64, v1, s[4:5]
  v_lshrrev_b32 v1, 6, v0
  v_and_b32 v0, 63, v0
  v_readfirstlane_b32 s44, v1
  s_and_b32 s3, s2, 7
  s_lshr_b32 s4, s2, 3
  s_and_b32 s46, s4, 7
  s_lshr_b32 s60, s4, 3
  s_and_b32 s47, s60, 1
  s_lshr_b32 s5, s60, 1
  s_lshl_b32 s3, s3, 1
  s_add_u32 s45, s3, s5
  s_and_b32 s4, s4, 15
  s_sub_u32 s5, 7, s4
  s_cmp_ge_u32 s4, 8
  s_cselect_b32 s49, s4, s5
  v_lshrrev_b32 v1, 5, v0
  v_and_b32 v2, 31, v0
  v_lshlrev_b32 v3, 1, v1
  v_xor_b32 v2, v2, v3
  s_lshl_b32 s3, s44, 4
  v_add_u32 v1, s3, v1
  v_lshlrev_b32 v1, 13, v1
  v_xor_b32_e64 v3, 0, v2
  v_lshl_add_u32 v3, v3, 4, v1
  v_add_u32 v11, 0, v3
  v_xor_b32 v3, 4, v2
  v_lshl_add_u32 v3, v3, 4, v1
  v_add_u32 v12, 15360, v3
  v_xor_b32_e64 v3, 0, v2
  v_lshl_add_u32 v3, v3, 4, v1
  v_add_u32 v13, 30720, v3
  v_xor_b32_e64 v3, 4, v2
  v_lshl_add_u32 v3, v3, 4, v1
  v_add_u32 v14, 46080, v3
  v_xor_b32_e64 v3, 8, v2
  v_lshl_add_u32 v3, v3, 4, v1
  v_add_u32 v15, 65536, v3
  v_xor_b32_e64 v3, 12, v2
  v_lshl_add_u32 v3, v3, 4, v1
  v_add_u32 v16, 80896, v3
  v_xor_b32_e64 v3, 8, v2
  v_lshl_add_u32 v3, v3, 4, v1
  v_add_u32 v17, 96256, v3
  v_xor_b32_e64 v3, 12, v2
  v_lshl_add_u32 v3, v3, 4, v1
  v_add_u32 v18, 111616, v3
  s_lshl_b32 s52, s44, 13
  s_lshl_b32 s51, s45, 9
  v_lshrrev_b32 v1, 3, v0
  s_lshl_b32 s3, s46, 8
  s_lshl_b32 s4, s44, 6
  s_add_u32 s4, s3, s4
  v_add_u32 v1, s4, v1
  v_lshlrev_b32 v1, 11, v1
  v_and_b32 v2, 7, v0
  v_lshrrev_b32 v3, 4, v0
  v_xor_b32 v2, v2, v3
  v_xor_b32 v3, 0, v2
  v_lshl_add_u32 v3, v3, 4, v1
  v_add_u32 v19, 0, v3
  v_xor_b32 v3, 4, v2
  v_lshl_add_u32 v3, v3, 4, v1
  v_add_u32 v20, 15360, v3
  v_xor_b32_e64 v3, 0, v2
  v_lshl_add_u32 v3, v3, 4, v1
  v_add_u32 v21, 30720, v3
  v_xor_b32_e64 v3, 4, v2
  v_lshl_add_u32 v3, v3, 4, v1
  v_add_u32 v22, 46080, v3
  v_xor_b32_e64 v3, 0, v2
  v_lshl_add_u32 v3, v3, 4, v1
  v_add_u32 v23, 65536, v3
  v_xor_b32_e64 v3, 4, v2
  v_lshl_add_u32 v3, v3, 4, v1
  v_add_u32 v24, 80896, v3
  v_xor_b32_e64 v3, 0, v2
  v_lshl_add_u32 v3, v3, 4, v1
  v_add_u32 v25, 96256, v3
  v_xor_b32_e64 v3, 4, v2
  v_lshl_add_u32 v3, v3, 4, v1
  v_add_u32 v26, 111616, v3
  s_mov_b32 s50, 0
  s_cmp_eq_u32 s47, 0
  s_waitcnt lgkmcnt(0)
  s_cselect_b32 s12, s34, s36
  s_cselect_b32 s13, s35, s37
  s_mov_b32 s14, 8388608
  s_mov_b32 s15, 0x20000
  s_mov_b32 s8, s30
  s_mov_b32 s9, s31
  s_mov_b32 s10, 4194304
  s_mov_b32 s11, 0x20000
  s_add_u32 m0, s52, 65536
  s_nop 0
  buffer_load_dwordx4 v11, s[12:15], s51 offen offset:0  lds
  s_mov_b32 s24, s28
  s_mov_b32 s25, s29
  s_mov_b32 s26, 1835008
  s_mov_b32 s27, 0x20000
  s_lshl_b32 s4, s2, 3
  s_lshl_b32 s5, s44, 1
  s_add_u32 s4, s4, s5
  s_mul_i32 s6, s4, 896
  buffer_load_dwordx4 v12, s[12:15], s51 offen offset:1024  lds
  v_lshlrev_b32 v30, 4, v0
  v_mov_b32_e64 v4, 1073741824
  v_cmp_gt_u32 vcc, 56, v0
  s_nop 1
  v_cndmask_b32 v30, v4, v30, vcc
  s_lshl_b32 s4, s60, 6
  s_add_u32 s3, s3, s4
  s_lshl_b32 s4, s44, 4
  buffer_load_dwordx4 v13, s[12:15], s51 offen offset:2048  lds
  s_add_u32 s3, s3, s4
  v_add_u32 v1, s3, v0
  v_lshlrev_b32 v1, 11, v1
  v_cmp_gt_u32 vcc, 16, v0
  s_lshl_b32 s3, s46, 3
  s_lshl_b32 s4, s44, 1
  s_add_u32 s3, s3, s4
  v_cndmask_b32 v27, v4, v1, vcc
  buffer_load_dwordx4 v14, s[12:15], s51 offen offset:3072  lds
  v_lshrrev_b32 v1, 2, v0
  v_add_u32 v1, s3, v1
  v_lshlrev_b32 v1, 13, v1
  v_cmp_gt_u32 vcc, 8, v0
  v_and_b32_e64 v2, 3, v0
  v_lshl_add_u32 v1, v2, 7, v1
  v_cndmask_b32 v28, v4, v1, vcc
  s_bitcmp1_b32 s44, 0
  s_cselect_b32 s62, s64, s62
  s_cselect_b32 s63, s65, s63
  s_cselect_b32 s64, s38, s32
  s_cselect_b32 s65, s39, s33
  s_mov_b32 s30, 7340032
  s_add_u32 m0, s52, 69632
  s_nop 0
  buffer_load_dwordx4 v15, s[12:15], s51 offen offset:0  lds
  s_cmp_lt_u32 s44, 2
  s_cselect_b32 s28, s62, s64
  s_cselect_b32 s29, s63, s65
  s_cselect_b32 s30, s30, 3670016
  s_mov_b32 s31, 0x20000
  s_mul_i32 s36, s2, 2432
  v_lshlrev_b32 v1, 7, v0
  v_cmp_gt_u32 vcc, 19, v0
  buffer_load_dwordx4 v16, s[12:15], s51 offen offset:1024  lds
  s_nop 1
  v_cndmask_b32 v62, v4, v1, vcc
  s_mov_b32 s16, s32
  s_mov_b32 s17, s33
  s_mov_b32 s18, 3670016
  s_mov_b32 s19, 0x20000
  s_mov_b32 s33, s6
  s_mov_b32 s20, s42
  buffer_load_dwordx4 v17, s[12:15], s51 offen offset:2048  lds
  s_mov_b32 s21, s43
  s_mov_b32 s22, 268435456
  s_mov_b32 s23, 0x20000
  v_mov_b32 v68, 0
  v_mov_b32 v69, 0
  v_mov_b32 v70, 0
  v_mov_b32 v71, 0
  s_lshl_b32 s3, s2, 1
  buffer_load_dwordx4 v18, s[12:15], s51 offen offset:3072  lds
  s_and_b32 s4, s44, 1
  s_add_u32 s3, s3, s4
  s_mul_i32 s3, s3, 17408
  s_add_u32 s48, s3, 8404992
  s_lshl_b32 s3, s2, 2
  s_add_u32 s3, s3, s44
  s_lshl_b32 s3, s3, 10
  s_add_u32 s3, s3, 8192000
  s_add_u32 s51, s51, 524288
  s_add_u32 m0, s52, 0
  s_nop 0
  buffer_load_dwordx4 v19, s[8:11], s50 offen offset:0 lds
  s_cmp_lt_u32 s2, 48
  s_cselect_b32 s53, s3, 0x80000000
  v_and_b32 v36, 15, v0
  v_lshrrev_b32 v37, 4, v0
  s_lshr_b32 s3, s44, 1
  s_and_b32 s4, s44, 1
  s_lshl_b32 s5, s3, 14
  v_lshrrev_b32 v38, 1, v36
  buffer_load_dwordx4 v20, s[8:11], s50 offen offset:1024 lds
  v_xor_b32 v38, v38, v37
  v_lshlrev_b32 v39, 7, v36
  v_add_u32_e64 v39, s5, v39
  v_lshl_add_u32 v9, v38, 4, v39
  v_xor_b32_e64 v38, 4, v38
  v_lshl_add_u32 v10, v38, 4, v39
  v_lshrrev_b32_e64 v38, 2, v36
  v_lshl_add_u32 v39, v37, 3, v38
  buffer_load_dwordx4 v21, s[8:11], s50 offen offset:2048 lds
  v_lshlrev_b32 v39, 9, v39
  v_and_b32 v40, 3, v0
  v_lshl_add_u32 v39, v40, 3, v39
  s_lshl_b32 s7, s4, 8
  s_add_u32 s5, s7, 65536
  v_add_u32 v39, s5, v39
  v_and_b32_e64 v40, 1, v37
  v_lshl_add_u32 v38, v40, 2, v38
  buffer_load_dwordx4 v22, s[8:11], s50 offen offset:3072 lds
  v_xor_b32_e64 v40, 0, v38
  v_lshl_add_u32 v1, v40, 5, v39
  v_xor_b32_e64 v40, 1, v38
  v_lshl_add_u32 v2, v40, 5, v39
  v_xor_b32_e64 v40, 2, v38
  v_lshl_add_u32 v3, v40, 5, v39
  v_xor_b32_e64 v40, 3, v38
  v_lshl_add_u32 v4, v40, 5, v39
  s_add_u32 m0, s52, 4096
  s_nop 0
  buffer_load_dwordx4 v23, s[8:11], s50 offen offset:0 lds
  v_xor_b32 v40, 4, v38
  v_lshl_add_u32 v5, v40, 5, v39
  v_xor_b32_e64 v40, 5, v38
  v_lshl_add_u32 v6, v40, 5, v39
  v_xor_b32_e64 v40, 6, v38
  v_lshl_add_u32 v7, v40, 5, v39
  v_xor_b32_e64 v40, 7, v38
  v_lshl_add_u32 v8, v40, 5, v39
  buffer_load_dwordx4 v24, s[8:11], s50 offen offset:1024 lds
  s_lshl_b32 s5, s49, 3
  s_add_u32 s58, s5, s44
  s_sub_u32 s59, s5, s44
  s_add_u32 s59, s59, 7
  s_lshl_b32 s5, s49, 4
  v_lshlrev_b32 v31, 4, v36
  s_bfe_u32 s5, s2, 0x20003
  s_lshl_b32 s61, 2, s5
  buffer_load_dwordx4 v25, s[8:11], s50 offen offset:2048 lds
  s_or_b32 s61, s61, 32
  s_mul_i32 s34, s58, 14336
  s_mul_i32 s35, s59, 14336
  s_lshl_b32 s5, s45, 4
  s_add_u32 s5, s5, s49
  s_lshl_b32 s5, s5, 2
  s_add_u32 s5, s5, s44
  s_lshl_b32 s5, s5, 14
  buffer_load_dwordx4 v26, s[8:11], s50 offen offset:3072 lds
  s_add_u32 s58, s5, 54525952
  s_cmp_ge_u32 s49, 8
  s_cselect_b32 s58, s58, 0x80000000
  s_add_u32 s59, s58, 8192
  s_lshl_b32 s5, s46, 17
  s_lshl_b32 s3, s3, 16
  s_add_u32 s5, s5, s3
  s_add_u32 s3, s47, 12
  s_add_u32 s50, s50, 128
  s_add_u32 m0, s52, 98304
  s_nop 0
  buffer_load_dwordx4 v11, s[12:15], s51 offen offset:0  lds
  s_lshl_b32 s4, s4, s3
  s_add_u32 s5, s5, s4
  s_lshl_b32 s3, s45, 20
  s_add_u32 s5, s5, s3
  s_cmp_eq_u32 s47, 0
  s_mov_b32 s3, 37748736
  s_cselect_b32 s3, 20971520, s3
  s_movk_i32 s56, 4096
  s_movk_i32 s57, 12288
  s_cselect_b32 s56, 8192, s56
  s_cselect_b32 s57, 8192, s57
  buffer_load_dwordx4 v12, s[12:15], s51 offen offset:1024  lds
  s_add_u32 s55, s5, s3
  v_lshlrev_b32_e64 v0, 4, v0
  s_lshl_b32 s3, s44, 5
  s_add_u32 s3, s3, 131072
  v_mul_u32_u24 v59, 9, v0
  v_add_u32 v59, s3, v59
  s_lshl_b32 s3, s44, 10
  v_add_u32 v57, s3, v0
  buffer_load_dwordx4 v13, s[12:15], s51 offen offset:2048  lds
  v_lshrrev_b32_e64 v56, 7, v57
  v_lshl_add_u32 v56, v56, 4, v57
  v_add_u32 v56, 131072, v56
  v_and_b32 v58, 0x70, v57
  v_and_b32 v57, 0xf80, v57
  v_lshl_add_u32 v57, v57, 1, v58
  s_lshr_b32 s3, s2, 1
  s_mul_i32 s6, s3, 14336
  buffer_load_dwordx4 v14, s[12:15], s51 offen offset:3072  lds
  s_and_b32 s3, s2, 1
  s_lshl_b32 s3, s3, 7
  s_add_u32 s6, s6, s3
  s_add_u32 s3, s6, 8192
  s_cmp_eq_u32 s44, 3
  s_cselect_b32 s37, 0x80000000, s3
  s_mov_b32 s54, 1
  s_add_u32 m0, s52, 102400
  s_nop 0
  buffer_load_dwordx4 v15, s[12:15], s51 offen offset:0  lds
  buffer_load_dwordx4 v16, s[12:15], s51 offen offset:1024  lds
  buffer_load_dwordx4 v17, s[12:15], s51 offen offset:2048  lds
  buffer_load_dwordx4 v18, s[12:15], s51 offen offset:3072  lds
  s_add_u32 s51, s51, 524288
  buffer_load_dwordx4 v[48:51], v30, s[24:27], s33 offen
  buffer_load_dwordx4 v[52:55], v30, s[24:27], s33 offen offset:896
  s_cmp_eq_u32 s47, 0
  s_waitcnt vmcnt(10) lgkmcnt(0)
  s_barrier
  ds_read_b128 v[32:35], v9 offset:0
  ds_read_b128 v[36:39], v10 offset:0
  ds_read_b64_tr_b16 v[128:129], v1 offset:0
  ds_read_b64_tr_b16 v[130:131], v1 offset:2048
  ds_read_b64_tr_b16 v[132:133], v1 offset:16384
  ds_read_b64_tr_b16 v[134:135], v1 offset:18432
  ds_read_b64_tr_b16 v[136:137], v2 offset:0
  ds_read_b64_tr_b16 v[138:139], v2 offset:2048
  ds_read_b64_tr_b16 v[140:141], v2 offset:16384
  ds_read_b64_tr_b16 v[142:143], v2 offset:18432
  ds_read_b64_tr_b16 v[144:145], v3 offset:0
  ds_read_b64_tr_b16 v[146:147], v3 offset:2048
  ds_read_b64_tr_b16 v[148:149], v3 offset:16384
  ds_read_b64_tr_b16 v[150:151], v3 offset:18432
  s_cbranch_scc0 L_k1_V
  s_waitcnt lgkmcnt(8)
  v_mfma_f32_16x16x32_bf16 a[0:3], v[128:131], v[32:35], 0
  ds_read_b64_tr_b16 v[152:153], v4 offset:0
  ds_read_b64_tr_b16 v[154:155], v4 offset:2048
  v_mfma_f32_16x16x32_bf16 a[0:3], v[132:135], v[36:39], a[0:3]
  ds_read_b64_tr_b16 v[156:157], v4 offset:16384
  ds_read_b64_tr_b16 v[158:159], v4 offset:18432
  s_waitcnt lgkmcnt(8)
  v_mfma_f32_16x16x32_bf16 a[4:7], v[136:139], v[32:35], 0
  ds_read_b64_tr_b16 v[160:161], v5 offset:0
  ds_read_b64_tr_b16 v[162:163], v5 offset:2048
  v_mfma_f32_16x16x32_bf16 a[4:7], v[140:143], v[36:39], a[4:7]
  ds_read_b64_tr_b16 v[164:165], v5 offset:16384
  ds_read_b64_tr_b16 v[166:167], v5 offset:18432
  s_waitcnt lgkmcnt(8)
  v_mfma_f32_16x16x32_bf16 a[8:11], v[144:147], v[32:35], 0
  ds_read_b128 v[40:43], v9 offset:2048
  ds_read_b128 v[44:47], v10 offset:2048
  v_mfma_f32_16x16x32_bf16 a[8:11], v[148:151], v[36:39], a[8:11]
  ds_read_b64_tr_b16 v[168:169], v6 offset:0
  ds_read_b64_tr_b16 v[170:171], v6 offset:2048
  s_waitcnt lgkmcnt(8)
  v_mfma_f32_16x16x32_bf16 a[12:15], v[152:155], v[32:35], 0
  ds_read_b64_tr_b16 v[172:173], v6 offset:16384
  ds_read_b64_tr_b16 v[174:175], v6 offset:18432
  v_mfma_f32_16x16x32_bf16 a[12:15], v[156:159], v[36:39], a[12:15]
  ds_read_b64_tr_b16 v[176:177], v7 offset:0
  ds_read_b64_tr_b16 v[178:179], v7 offset:2048
  s_waitcnt lgkmcnt(8)
  v_mfma_f32_16x16x32_bf16 a[16:19], v[160:163], v[32:35], 0
  ds_read_b64_tr_b16 v[180:181], v7 offset:16384
  ds_read_b64_tr_b16 v[182:183], v7 offset:18432
  v_mfma_f32_16x16x32_bf16 a[16:19], v[164:167], v[36:39], a[16:19]
  ds_read_b64_tr_b16 v[184:185], v8 offset:0
  ds_read_b64_tr_b16 v[186:187], v8 offset:2048
  s_waitcnt lgkmcnt(6)
  v_mfma_f32_16x16x32_bf16 a[20:23], v[168:171], v[32:35], 0
  ds_read_b64_tr_b16 v[188:189], v8 offset:16384
  ds_read_b64_tr_b16 v[190:191], v8 offset:18432
  v_mfma_f32_16x16x32_bf16 a[20:23], v[172:175], v[36:39], a[20:23]
  s_waitcnt lgkmcnt(4)
  s_add_u32 m0, s52, 32768
  v_mfma_f32_16x16x32_bf16 a[24:27], v[176:179], v[32:35], 0
  buffer_load_dwordx4 v19, s[8:11], s50 offen offset:0 lds
  v_mfma_f32_16x16x32_bf16 a[24:27], v[180:183], v[36:39], a[24:27]
  s_waitcnt lgkmcnt(0)
  s_nop 0
  v_mfma_f32_16x16x32_bf16 a[28:31], v[184:187], v[32:35], 0
  v_mfma_f32_16x16x32_bf16 a[28:31], v[188:191], v[36:39], a[28:31]
  v_mfma_f32_16x16x32_bf16 a[32:35], v[128:131], v[40:43], 0
  ds_read_b128 v[32:35], v9 offset:4096
  buffer_load_dwordx4 v20, s[8:11], s50 offen offset:1024 lds
  v_mfma_f32_16x16x32_bf16 a[32:35], v[132:135], v[44:47], a[32:35]
  ds_read_b128 v[36:39], v10 offset:4096
  v_mfma_f32_16x16x32_bf16 a[36:39], v[136:139], v[40:43], 0
  v_mfma_f32_16x16x32_bf16 a[36:39], v[140:143], v[44:47], a[36:39]
  v_mfma_f32_16x16x32_bf16 a[40:43], v[144:147], v[40:43], 0
  s_waitcnt vmcnt(4)
  s_barrier
  v_mfma_f32_16x16x32_bf16 a[40:43], v[148:151], v[44:47], a[40:43]
  buffer_load_dwordx4 v21, s[8:11], s50 offen offset:2048 lds
  ds_read_b64_tr_b16 v[192:193], v1 offset:32768
  v_mfma_f32_16x16x32_bf16 a[44:47], v[152:155], v[40:43], 0
  v_mfma_f32_16x16x32_bf16 a[44:47], v[156:159], v[44:47], a[44:47]
  ds_read_b64_tr_b16 v[194:195], v1 offset:34816
  v_mfma_f32_16x16x32_bf16 a[48:51], v[160:163], v[40:43], 0
  v_mfma_f32_16x16x32_bf16 a[48:51], v[164:167], v[44:47], a[48:51]
  buffer_load_dwordx4 v22, s[8:11], s50 offen offset:3072 lds
  v_mfma_f32_16x16x32_bf16 a[52:55], v[168:171], v[40:43], 0
  ds_read_b64_tr_b16 v[196:197], v1 offset:49152
  v_mfma_f32_16x16x32_bf16 a[52:55], v[172:175], v[44:47], a[52:55]
  v_mfma_f32_16x16x32_bf16 a[56:59], v[176:179], v[40:43], 0
  s_add_u32 m0, s52, 36864
  ds_read_b64_tr_b16 v[198:199], v1 offset:51200
  v_mfma_f32_16x16x32_bf16 a[56:59], v[180:183], v[44:47], a[56:59]
  buffer_load_dwordx4 v23, s[8:11], s50 offen offset:0 lds
  v_mfma_f32_16x16x32_bf16 a[60:63], v[184:187], v[40:43], 0
  v_mfma_f32_16x16x32_bf16 a[60:63], v[188:191], v[44:47], a[60:63]
  s_waitcnt lgkmcnt(4)
  ds_read_b64_tr_b16 v[200:201], v2 offset:32768
  v_mfma_f32_16x16x32_bf16 a[64:67], v[128:131], v[32:35], 0
  s_nop 0
  ds_read_b128 v[40:43], v9 offset:6144
  v_mfma_f32_16x16x32_bf16 a[64:67], v[132:135], v[36:39], a[64:67]
  ds_read_b128 v[44:47], v10 offset:6144
  buffer_load_dwordx4 v24, s[8:11], s50 offen offset:1024 lds
  v_mfma_f32_16x16x32_bf16 a[68:71], v[136:139], v[32:35], 0
  ds_read_b64_tr_b16 v[202:203], v2 offset:34816
  v_mfma_f32_16x16x32_bf16 a[68:71], v[140:143], v[36:39], a[68:71]
  v_mfma_f32_16x16x32_bf16 a[72:75], v[144:147], v[32:35], 0
  ds_read_b64_tr_b16 v[204:205], v2 offset:49152
  v_mfma_f32_16x16x32_bf16 a[72:75], v[148:151], v[36:39], a[72:75]
  buffer_load_dwordx4 v25, s[8:11], s50 offen offset:2048 lds
  v_mfma_f32_16x16x32_bf16 a[76:79], v[152:155], v[32:35], 0
  ds_read_b64_tr_b16 v[206:207], v2 offset:51200
  v_mfma_f32_16x16x32_bf16 a[76:79], v[156:159], v[36:39], a[76:79]
  v_mfma_f32_16x16x32_bf16 a[80:83], v[160:163], v[32:35], 0
  v_mfma_f32_16x16x32_bf16 a[80:83], v[164:167], v[36:39], a[80:83]
  buffer_load_dwordx4 v26, s[8:11], s50 offen offset:3072 lds
  ds_read_b64_tr_b16 v[208:209], v3 offset:32768
  v_mfma_f32_16x16x32_bf16 a[84:87], v[168:171], v[32:35], 0
  v_mfma_f32_16x16x32_bf16 a[84:87], v[172:175], v[36:39], a[84:87]
  ds_read_b64_tr_b16 v[210:211], v3 offset:34816
  v_mfma_f32_16x16x32_bf16 a[88:91], v[176:179], v[32:35], 0
  s_add_u32 s50, s50, 128
  v_mfma_f32_16x16x32_bf16 a[88:91], v[180:183], v[36:39], a[88:91]
  s_add_u32 m0, s52, 65536
  v_mfma_f32_16x16x32_bf16 a[92:95], v[184:187], v[32:35], 0
  buffer_load_dwordx4 v11, s[12:15], s51 offen offset:0  lds
  ds_read_b64_tr_b16 v[212:213], v3 offset:49152
  v_mfma_f32_16x16x32_bf16 a[92:95], v[188:191], v[36:39], a[92:95]
  s_waitcnt lgkmcnt(6)
  s_nop 0
  v_mfma_f32_16x16x32_bf16 a[96:99], v[128:131], v[40:43], 0
  ds_read_b128 v[32:35], v9 offset:8192
  v_mfma_f32_16x16x32_bf16 a[96:99], v[132:135], v[44:47], a[96:99]
  ds_read_b128 v[36:39], v10 offset:8192
  ds_read_b64_tr_b16 v[214:215], v3 offset:51200
  v_mfma_f32_16x16x32_bf16 a[100:103], v[136:139], v[40:43], 0
  buffer_load_dwordx4 v12, s[12:15], s51 offen offset:1024  lds
  v_mfma_f32_16x16x32_bf16 a[100:103], v[140:143], v[44:47], a[100:103]
  ds_read_b64_tr_b16 v[216:217], v4 offset:32768
  v_mfma_f32_16x16x32_bf16 a[104:107], v[144:147], v[40:43], 0
  v_mfma_f32_16x16x32_bf16 a[104:107], v[148:151], v[44:47], a[104:107]
  v_mfma_f32_16x16x32_bf16 a[108:111], v[152:155], v[40:43], 0
  buffer_load_dwordx4 v13, s[12:15], s51 offen offset:2048  lds
  ds_read_b64_tr_b16 v[218:219], v4 offset:34816
  v_mfma_f32_16x16x32_bf16 a[108:111], v[156:159], v[44:47], a[108:111]
  v_mfma_f32_16x16x32_bf16 a[112:115], v[160:163], v[40:43], 0
  ds_read_b64_tr_b16 v[220:221], v4 offset:49152
  s_waitcnt vmcnt(11)
  v_mfma_f32_16x16x32_bf16 a[112:115], v[164:167], v[44:47], a[112:115]
  v_lshlrev_b32 v72, 16, v48
  v_mfma_f32_16x16x32_bf16 a[116:119], v[168:171], v[40:43], 0
  buffer_load_dwordx4 v14, s[12:15], s51 offen offset:3072  lds
  v_and_b32 v73, 0xffff0000, v48
  v_mfma_f32_16x16x32_bf16 a[116:119], v[172:175], v[44:47], a[116:119]
  ds_read_b64_tr_b16 v[222:223], v4 offset:51200
  v_lshlrev_b32_e64 v74, 16, v49
  v_mfma_f32_16x16x32_bf16 a[120:123], v[176:179], v[40:43], 0
  v_and_b32 v75, 0xffff0000, v49
  v_mfma_f32_16x16x32_bf16 a[120:123], v[180:183], v[44:47], a[120:123]
  s_add_u32 m0, s52, 69632
  ds_read_b64_tr_b16 v[224:225], v5 offset:32768
  v_mfma_f32_16x16x32_bf16 a[124:127], v[184:187], v[40:43], 0
  buffer_load_dwordx4 v15, s[12:15], s51 offen offset:0  lds
  v_lshlrev_b32_e64 v76, 16, v50
  v_mfma_f32_16x16x32_bf16 a[124:127], v[188:191], v[44:47], a[124:127]
  s_waitcnt lgkmcnt(6)
  v_and_b32 v77, 0xffff0000, v50
  v_mfma_f32_16x16x32_bf16 a[128:131], v[128:131], v[32:35], 0
  ds_read_b128 v[40:43], v9 offset:10240
  ds_read_b64_tr_b16 v[226:227], v5 offset:34816
  v_mfma_f32_16x16x32_bf16 a[128:131], v[132:135], v[36:39], a[128:131]
  ds_read_b128 v[44:47], v10 offset:10240
  v_lshlrev_b32 v78, 16, v51
  v_mfma_f32_16x16x32_bf16 a[132:135], v[136:139], v[32:35], 0
  buffer_load_dwordx4 v16, s[12:15], s51 offen offset:1024  lds
  ds_read_b64_tr_b16 v[228:229], v5 offset:49152
  v_mfma_f32_16x16x32_bf16 a[132:135], v[140:143], v[36:39], a[132:135]
  v_and_b32 v79, 0xffff0000, v51
  v_lshlrev_b32_e64 v80, 16, v52
  v_mfma_f32_16x16x32_bf16 a[136:139], v[144:147], v[32:35], 0
  v_and_b32 v81, 0xffff0000, v52
  v_lshlrev_b32_e64 v82, 16, v53
  v_mfma_f32_16x16x32_bf16 a[136:139], v[148:151], v[36:39], a[136:139]
  ds_read_b64_tr_b16 v[230:231], v5 offset:51200
  v_and_b32 v83, 0xffff0000, v53
  v_mfma_f32_16x16x32_bf16 a[140:143], v[152:155], v[32:35], 0
  buffer_load_dwordx4 v17, s[12:15], s51 offen offset:2048  lds
  v_lshlrev_b32_e64 v84, 16, v54
  v_mfma_f32_16x16x32_bf16 a[140:143], v[156:159], v[36:39], a[140:143]
  ds_read_b64_tr_b16 v[232:233], v6 offset:32768
  v_and_b32 v85, 0xffff0000, v54
  v_mfma_f32_16x16x32_bf16 a[144:147], v[160:163], v[32:35], 0
  v_lshlrev_b32_e64 v86, 16, v55
  v_and_b32 v87, 0xffff0000, v55
  v_mfma_f32_16x16x32_bf16 a[144:147], v[164:167], v[36:39], a[144:147]
  v_add_f32_e64 v88, v72, v73
  v_mfma_f32_16x16x32_bf16 a[148:151], v[168:171], v[32:35], 0
  buffer_load_dwordx4 v18, s[12:15], s51 offen offset:3072  lds
  ds_read_b64_tr_b16 v[234:235], v6 offset:34816
  v_mfma_f32_16x16x32_bf16 a[148:151], v[172:175], v[36:39], a[148:151]
  v_mul_f32 v90, v72, v72
  v_add_f32 v89, v80, v81
  v_mfma_f32_16x16x32_bf16 a[152:155], v[176:179], v[32:35], 0
  v_mul_f32_e64 v91, v80, v80
  v_mfma_f32_16x16x32_bf16 a[152:155], v[180:183], v[36:39], a[152:155]
  s_add_u32 s51, s51, 524288
  ds_read_b64_tr_b16 v[236:237], v6 offset:49152
  v_mfma_f32_16x16x32_bf16 a[156:159], v[184:187], v[32:35], 0
  buffer_load_dword v29, v27, s[8:11], s50 offen offset:0
  v_fmac_f32_e64 v90, v73, v73
  v_mfma_f32_16x16x32_bf16 a[156:159], v[188:191], v[36:39], a[156:159]
  s_waitcnt lgkmcnt(5)
  ds_read_b64_tr_b16 v[238:239], v6 offset:51200
  v_mfma_f32_16x16x32_bf16 a[160:163], v[128:131], v[40:43], 0
  ds_read_b128 v[32:35], v9 offset:12288
  v_fmac_f32 v91, v81, v81
  v_mfma_f32_16x16x32_bf16 a[160:163], v[132:135], v[44:47], a[160:163]
  ds_read_b128 v[36:39], v10 offset:12288
  buffer_load_dword v29, v28, s[12:15], s51 offen
  v_mfma_f32_16x16x32_bf16 a[164:167], v[136:139], v[40:43], 0
  ds_read_b64_tr_b16 v[240:241], v7 offset:32768
  v_add_f32_e64 v88, v88, v74
  v_mfma_f32_16x16x32_bf16 a[164:167], v[140:143], v[44:47], a[164:167]
  v_fmac_f32 v90, v74, v74
  v_add_f32 v89, v89, v82
  v_mfma_f32_16x16x32_bf16 a[168:171], v[144:147], v[40:43], 0
  ds_read_b64_tr_b16 v[242:243], v7 offset:34816
  v_fmac_f32_e64 v91, v82, v82
  v_mfma_f32_16x16x32_bf16 a[168:171], v[148:151], v[44:47], a[168:171]
  v_add_f32 v88, v88, v75
  v_fmac_f32 v90, v75, v75
  v_mfma_f32_16x16x32_bf16 a[172:175], v[152:155], v[40:43], 0
  v_add_f32 v89, v89, v83
  v_fmac_f32 v91, v83, v83
  v_mfma_f32_16x16x32_bf16 a[172:175], v[156:159], v[44:47], a[172:175]
  ds_read_b64_tr_b16 v[244:245], v7 offset:49152
  v_add_f32_e64 v88, v88, v76
  v_mfma_f32_16x16x32_bf16 a[176:179], v[160:163], v[40:43], 0
  v_fmac_f32_e64 v90, v76, v76
  v_mfma_f32_16x16x32_bf16 a[176:179], v[164:167], v[44:47], a[176:179]
  ds_read_b64_tr_b16 v[246:247], v7 offset:51200
  v_add_f32_e64 v89, v89, v84
  v_mfma_f32_16x16x32_bf16 a[180:183], v[168:171], v[40:43], 0
  v_fmac_f32_e64 v91, v84, v84
  v_mfma_f32_16x16x32_bf16 a[180:183], v[172:175], v[44:47], a[180:183]
  v_add_f32_e64 v88, v88, v77
  v_mfma_f32_16x16x32_bf16 a[184:187], v[176:179], v[40:43], 0
  ds_read_b64_tr_b16 v[248:249], v8 offset:32768
  v_fmac_f32_e64 v90, v77, v77
  v_mfma_f32_16x16x32_bf16 a[184:187], v[180:183], v[44:47], a[184:187]
  v_add_f32_e64 v89, v89, v85
  v_mfma_f32_16x16x32_bf16 a[188:191], v[184:187], v[40:43], 0
  ds_read_b64_tr_b16 v[250:251], v8 offset:34816
  v_fmac_f32_e64 v91, v85, v85
  v_mfma_f32_16x16x32_bf16 a[188:191], v[188:191], v[44:47], a[188:191]
  s_waitcnt lgkmcnt(6)
  v_add_f32 v88, v88, v78
  v_mfma_f32_16x16x32_bf16 a[192:195], v[128:131], v[32:35], 0
  ds_read_b128 v[40:43], v9 offset:14336
  v_fmac_f32_e64 v90, v78, v78
  v_mfma_f32_16x16x32_bf16 a[192:195], v[132:135], v[36:39], a[192:195]
  ds_read_b128 v[44:47], v10 offset:14336
  ds_read_b64_tr_b16 v[252:253], v8 offset:49152
  v_mfma_f32_16x16x32_bf16 a[196:199], v[136:139], v[32:35], 0
  v_add_f32 v89, v89, v86
  v_fmac_f32 v91, v86, v86
  v_mfma_f32_16x16x32_bf16 a[196:199], v[140:143], v[36:39], a[196:199]
  v_add_f32_e64 v88, v88, v79
  v_mfma_f32_16x16x32_bf16 a[200:203], v[144:147], v[32:35], 0
  ds_read_b64_tr_b16 v[254:255], v8 offset:51200
  v_fmac_f32_e64 v90, v79, v79
  v_mfma_f32_16x16x32_bf16 a[200:203], v[148:151], v[36:39], a[200:203]
  v_add_f32_e64 v89, v89, v87
  v_mfma_f32_16x16x32_bf16 a[204:207], v[152:155], v[32:35], 0
  v_fmac_f32_e64 v91, v87, v87
  v_mfma_f32_16x16x32_bf16 a[204:207], v[156:159], v[36:39], a[204:207]
  s_nop 1
  v_mfma_f32_16x16x32_bf16 a[208:211], v[160:163], v[32:35], 0
  s_nop 0
  v_add_f32_dpp v88, v88, v88 row_shr:1 row_mask:0xf bank_mask:0xf bound_ctrl:1
  v_mfma_f32_16x16x32_bf16 a[208:211], v[164:167], v[36:39], a[208:211]
  v_add_f32_dpp v89, v89, v89 row_shr:1 row_mask:0xf bank_mask:0xf bound_ctrl:1
  v_mfma_f32_16x16x32_bf16 a[212:215], v[168:171], v[32:35], 0
  v_add_f32_dpp v90, v90, v90 row_shr:1 row_mask:0xf bank_mask:0xf bound_ctrl:1
  v_mfma_f32_16x16x32_bf16 a[212:215], v[172:175], v[36:39], a[212:215]
  v_add_f32_dpp v91, v91, v91 row_shr:1 row_mask:0xf bank_mask:0xf bound_ctrl:1
  v_mfma_f32_16x16x32_bf16 a[216:219], v[176:179], v[32:35], 0
  v_add_f32_dpp v88, v88, v88 row_shr:2 row_mask:0xf bank_mask:0xf bound_ctrl:1
  v_mfma_f32_16x16x32_bf16 a[216:219], v[180:183], v[36:39], a[216:219]
  s_waitcnt vmcnt(10) lgkmcnt(0)
  s_barrier
  v_mfma_f32_16x16x32_bf16 a[220:223], v[184:187], v[32:35], 0
  s_add_u32 m0, s52, 0
  v_add_f32_dpp v89, v89, v89 row_shr:2 row_mask:0xf bank_mask:0xf bound_ctrl:1
  v_mfma_f32_16x16x32_bf16 a[220:223], v[188:191], v[36:39], a[220:223]
  buffer_load_dwordx4 v19, s[8:11], s50 offen offset:0 lds
  v_add_f32_dpp v90, v90, v90 row_shr:2 row_mask:0xf bank_mask:0xf bound_ctrl:1
  v_mfma_f32_16x16x32_bf16 a[224:227], v[128:131], v[40:43], 0
  ds_read_b128 v[32:35], v9 offset:32768
  v_add_f32_dpp v91, v91, v91 row_shr:2 row_mask:0xf bank_mask:0xf bound_ctrl:1
  v_mfma_f32_16x16x32_bf16 a[224:227], v[132:135], v[44:47], a[224:227]
  ds_read_b128 v[36:39], v10 offset:32768
  v_add_f32_dpp v88, v88, v88 row_shr:4 row_mask:0xf bank_mask:0xf bound_ctrl:1
  v_mfma_f32_16x16x32_bf16 a[228:231], v[136:139], v[40:43], 0
  v_add_f32_dpp v89, v89, v89 row_shr:4 row_mask:0xf bank_mask:0xf bound_ctrl:1
  v_add_f32_dpp v90, v90, v90 row_shr:4 row_mask:0xf bank_mask:0xf bound_ctrl:1
  v_mfma_f32_16x16x32_bf16 a[228:231], v[140:143], v[44:47], a[228:231]
  buffer_load_dwordx4 v20, s[8:11], s50 offen offset:1024 lds
  v_add_f32_dpp v91, v91, v91 row_shr:4 row_mask:0xf bank_mask:0xf bound_ctrl:1
  v_mfma_f32_16x16x32_bf16 a[232:235], v[144:147], v[40:43], 0
  s_nop 0
  v_add_f32_dpp v88, v88, v88 row_shr:8 row_mask:0xf bank_mask:0xf bound_ctrl:1
  v_mfma_f32_16x16x32_bf16 a[232:235], v[148:151], v[44:47], a[232:235]
  v_mfma_f32_16x16x32_bf16 a[236:239], v[152:155], v[40:43], 0
  v_mfma_f32_16x16x32_bf16 a[236:239], v[156:159], v[44:47], a[236:239]
  buffer_load_dwordx4 v21, s[8:11], s50 offen offset:2048 lds
  v_mfma_f32_16x16x32_bf16 a[240:243], v[160:163], v[40:43], 0
  v_mfma_f32_16x16x32_bf16 a[240:243], v[164:167], v[44:47], a[240:243]
  v_mfma_f32_16x16x32_bf16 a[244:247], v[168:171], v[40:43], 0
  v_mfma_f32_16x16x32_bf16 a[244:247], v[172:175], v[44:47], a[244:247]
  buffer_load_dwordx4 v22, s[8:11], s50 offen offset:3072 lds
  v_mfma_f32_16x16x32_bf16 a[248:251], v[176:179], v[40:43], 0
  v_mfma_f32_16x16x32_bf16 a[248:251], v[180:183], v[44:47], a[248:251]
  v_mfma_f32_16x16x32_bf16 a[252:255], v[184:187], v[40:43], 0
  s_add_u32 m0, s52, 4096
  v_mfma_f32_16x16x32_bf16 a[252:255], v[188:191], v[44:47], a[252:255]
  s_waitcnt lgkmcnt(0)
  s_nop 0
  v_mfma_f32_16x16x32_bf16 a[0:3], v[192:195], v[32:35], a[0:3]
  ds_read_b128 v[40:43], v9 offset:34816
  v_add_f32_dpp v89, v89, v89 row_shr:8 row_mask:0xf bank_mask:0xf bound_ctrl:1
  v_mfma_f32_16x16x32_bf16 a[0:3], v[196:199], v[36:39], a[0:3]
  ds_read_b128 v[44:47], v10 offset:34816
  buffer_load_dwordx4 v23, s[8:11], s50 offen offset:0 lds
  v_mfma_f32_16x16x32_bf16 a[4:7], v[200:203], v[32:35], a[4:7]
  v_add_f32_dpp v90, v90, v90 row_shr:8 row_mask:0xf bank_mask:0xf bound_ctrl:1
  v_add_f32_dpp v91, v91, v91 row_shr:8 row_mask:0xf bank_mask:0xf bound_ctrl:1
  v_mfma_f32_16x16x32_bf16 a[4:7], v[204:207], v[36:39], a[4:7]
  v_add_f32_dpp v88, v88, v88 row_bcast:15 row_mask:0xa bank_mask:0xf
  v_mfma_f32_16x16x32_bf16 a[8:11], v[208:211], v[32:35], a[8:11]
  v_add_f32_dpp v89, v89, v89 row_bcast:15 row_mask:0xa bank_mask:0xf
  v_mfma_f32_16x16x32_bf16 a[8:11], v[212:215], v[36:39], a[8:11]
  v_add_f32_dpp v90, v90, v90 row_bcast:15 row_mask:0xa bank_mask:0xf
  v_mfma_f32_16x16x32_bf16 a[12:15], v[216:219], v[32:35], a[12:15]
  buffer_load_dwordx4 v24, s[8:11], s50 offen offset:1024 lds
  v_add_f32_dpp v91, v91, v91 row_bcast:15 row_mask:0xa bank_mask:0xf
  v_mfma_f32_16x16x32_bf16 a[12:15], v[220:223], v[36:39], a[12:15]
  v_add_f32_dpp v88, v88, v88 row_bcast:31 row_mask:0xc bank_mask:0xf
  v_mfma_f32_16x16x32_bf16 a[16:19], v[224:227], v[32:35], a[16:19]
  v_add_f32_dpp v89, v89, v89 row_bcast:31 row_mask:0xc bank_mask:0xf
  v_mfma_f32_16x16x32_bf16 a[16:19], v[228:231], v[36:39], a[16:19]
  v_add_f32_dpp v90, v90, v90 row_bcast:31 row_mask:0xc bank_mask:0xf
  v_mfma_f32_16x16x32_bf16 a[20:23], v[232:235], v[32:35], a[20:23]
  v_add_f32_dpp v91, v91, v91 row_bcast:31 row_mask:0xc bank_mask:0xf
  v_mfma_f32_16x16x32_bf16 a[20:23], v[236:239], v[36:39], a[20:23]
  buffer_load_dwordx4 v25, s[8:11], s50 offen offset:2048 lds
  v_mul_f32 v88, 0x3b124925, v88
  v_mfma_f32_16x16x32_bf16 a[24:27], v[240:243], v[32:35], a[24:27]
  v_mul_f32 v89, 0x3b124925, v89
  v_mfma_f32_16x16x32_bf16 a[24:27], v[244:247], v[36:39], a[24:27]
  v_mul_f32 v90, 0x3b124925, v90
  v_mfma_f32_16x16x32_bf16 a[28:31], v[248:251], v[32:35], a[28:31]
  v_mul_f32 v91, 0x3b124925, v91
  v_mfma_f32_16x16x32_bf16 a[28:31], v[252:255], v[36:39], a[28:31]
  s_waitcnt lgkmcnt(0)
  v_fma_f32 v90, -v88, v88, v90
  v_mfma_f32_16x16x32_bf16 a[32:35], v[192:195], v[40:43], a[32:35]
  ds_read_b128 v[32:35], v9 offset:36864
  s_waitcnt vmcnt(9)
  s_barrier
  v_mfma_f32_16x16x32_bf16 a[32:35], v[196:199], v[44:47], a[32:35]
  ds_read_b128 v[36:39], v10 offset:36864
  buffer_load_dwordx4 v26, s[8:11], s50 offen offset:3072 lds
  v_mfma_f32_16x16x32_bf16 a[36:39], v[200:203], v[40:43], a[36:39]
  ds_read_b64_tr_b16 v[128:129], v1 offset:0
  v_fma_f32 v91, -v89, v89, v91
  v_mfma_f32_16x16x32_bf16 a[36:39], v[204:207], v[44:47], a[36:39]
  ds_read_b64_tr_b16 v[130:131], v1 offset:2048
  v_max_f32 v90, 0, v90
  v_mfma_f32_16x16x32_bf16 a[40:43], v[208:211], v[40:43], a[40:43]
  v_max_f32_e64 v91, 0, v91
  v_add_f32 v90, 0x3727c5ac, v90
  v_mfma_f32_16x16x32_bf16 a[40:43], v[212:215], v[44:47], a[40:43]
  s_add_u32 s50, s50, 128
  s_add_u32 m0, s52, 98304
  v_mfma_f32_16x16x32_bf16 a[44:47], v[216:219], v[40:43], a[44:47]
  buffer_load_dwordx4 v11, s[12:15], s51 offen offset:0  lds
  ds_read_b64_tr_b16 v[132:133], v1 offset:16384
  v_mfma_f32_16x16x32_bf16 a[44:47], v[220:223], v[44:47], a[44:47]
  v_add_f32 v91, 0x3727c5ac, v91
  v_mfma_f32_16x16x32_bf16 a[48:51], v[224:227], v[40:43], a[48:51]
  v_rsq_f32 v90, v90
  v_mfma_f32_16x16x32_bf16 a[48:51], v[228:231], v[44:47], a[48:51]
  s_nop 0
  ds_read_b64_tr_b16 v[134:135], v1 offset:18432
  v_mfma_f32_16x16x32_bf16 a[52:55], v[232:235], v[40:43], a[52:55]
  v_rsq_f32 v91, v91
  v_mfma_f32_16x16x32_bf16 a[52:55], v[236:239], v[44:47], a[52:55]
  buffer_load_dwordx4 v12, s[12:15], s51 offen offset:1024  lds
  ds_read_b64_tr_b16 v[136:137], v2 offset:0
  v_mfma_f32_16x16x32_bf16 a[56:59], v[240:243], v[40:43], a[56:59]
  s_nop 0
  v_mul_f32 v90, 0x3db8aa3b, v90
  v_mfma_f32_16x16x32_bf16 a[56:59], v[244:247], v[44:47], a[56:59]
  v_mul_f32 v91, 0x3db8aa3b, v91
  v_mul_f32_e64 v88, v88, v90
  v_mfma_f32_16x16x32_bf16 a[60:63], v[248:251], v[40:43], a[60:63]
  ds_read_b64_tr_b16 v[138:139], v2 offset:2048
  v_mul_f32_e64 v89, v89, v91
  v_mfma_f32_16x16x32_bf16 a[60:63], v[252:255], v[44:47], a[60:63]
  s_waitcnt lgkmcnt(6)
  s_nop 0
  v_mfma_f32_16x16x32_bf16 a[64:67], v[192:195], v[32:35], a[64:67]
  ds_read_b128 v[40:43], v9 offset:38912
  buffer_load_dwordx4 v13, s[12:15], s51 offen offset:2048  lds
  v_mfma_f32_16x16x32_bf16 a[64:67], v[196:199], v[36:39], a[64:67]
  ds_read_b128 v[44:47], v10 offset:38912
  ds_read_b64_tr_b16 v[140:141], v2 offset:16384
  v_mfma_f32_16x16x32_bf16 a[68:71], v[200:203], v[32:35], a[68:71]
  v_readlane_b32 s62, v88, 63
  v_readlane_b32 s63, v89, 63
  v_mfma_f32_16x16x32_bf16 a[68:71], v[204:207], v[36:39], a[68:71]
  ds_read_b64_tr_b16 v[142:143], v2 offset:18432
  v_readlane_b32 s64, v90, 63
  v_mfma_f32_16x16x32_bf16 a[72:75], v[208:211], v[32:35], a[72:75]
  v_readlane_b32 s65, v91, 63
  v_mfma_f32_16x16x32_bf16 a[72:75], v[212:215], v[36:39], a[72:75]
  buffer_load_dwordx4 v14, s[12:15], s51 offen offset:3072  lds
  v_mfma_f32_16x16x32_bf16 a[76:79], v[216:219], v[32:35], a[76:79]
  ds_read_b64_tr_b16 v[144:145], v3 offset:0
  v_mfma_f32_16x16x32_bf16 a[76:79], v[220:223], v[36:39], a[76:79]
  s_nop 1
  v_mfma_f32_16x16x32_bf16 a[80:83], v[224:227], v[32:35], a[80:83]
  v_mov_b32 v88, s62
  v_mov_b32_e64 v89, s63
  v_mfma_f32_16x16x32_bf16 a[80:83], v[228:231], v[36:39], a[80:83]
  s_add_u32 m0, s52, 102400
  ds_read_b64_tr_b16 v[146:147], v3 offset:2048
  v_mfma_f32_16x16x32_bf16 a[84:87], v[232:235], v[32:35], a[84:87]
  buffer_load_dwordx4 v15, s[12:15], s51 offen offset:0  lds
  v_fma_f32 v72, v72, s64, -v88
  v_mfma_f32_16x16x32_bf16 a[84:87], v[236:239], v[36:39], a[84:87]
  ds_read_b64_tr_b16 v[148:149], v3 offset:16384
  v_fma_f32 v80, v80, s65, -v89
  v_mfma_f32_16x16x32_bf16 a[88:91], v[240:243], v[32:35], a[88:91]
  v_fma_f32 v73, v73, s64, -v88
  v_fma_f32 v81, v81, s65, -v89
  v_mfma_f32_16x16x32_bf16 a[88:91], v[244:247], v[36:39], a[88:91]
  v_fma_f32 v74, v74, s64, -v88
  v_fma_f32 v82, v82, s65, -v89
  v_mfma_f32_16x16x32_bf16 a[92:95], v[248:251], v[32:35], a[92:95]
  ds_read_b64_tr_b16 v[150:151], v3 offset:18432
  v_fma_f32 v75, v75, s64, -v88
  v_mfma_f32_16x16x32_bf16 a[92:95], v[252:255], v[36:39], a[92:95]
  s_waitcnt lgkmcnt(6)
  buffer_load_dwordx4 v16, s[12:15], s51 offen offset:1024  lds
  v_mfma_f32_16x16x32_bf16 a[96:99], v[192:195], v[40:43], a[96:99]
  ds_read_b128 v[32:35], v9 offset:40960
  v_fma_f32 v83, v83, s65, -v89
  v_mfma_f32_16x16x32_bf16 a[96:99], v[196:199], v[44:47], a[96:99]
  ds_read_b128 v[36:39], v10 offset:40960
  ds_read_b64_tr_b16 v[152:153], v4 offset:0
  v_mfma_f32_16x16x32_bf16 a[100:103], v[200:203], v[40:43], a[100:103]
  v_fma_f32 v76, v76, s64, -v88
  v_fma_f32 v84, v84, s65, -v89
  v_mfma_f32_16x16x32_bf16 a[100:103], v[204:207], v[44:47], a[100:103]
  ds_read_b64_tr_b16 v[154:155], v4 offset:2048
  v_fma_f32 v77, v77, s64, -v88
  v_mfma_f32_16x16x32_bf16 a[104:107], v[208:211], v[40:43], a[104:107]
  buffer_load_dwordx4 v17, s[12:15], s51 offen offset:2048  lds
  v_fma_f32 v85, v85, s65, -v89
  v_mfma_f32_16x16x32_bf16 a[104:107], v[212:215], v[44:47], a[104:107]
  v_fma_f32 v78, v78, s64, -v88
  v_fma_f32 v86, v86, s65, -v89
  v_mfma_f32_16x16x32_bf16 a[108:111], v[216:219], v[40:43], a[108:111]
  ds_read_b64_tr_b16 v[156:157], v4 offset:16384
  v_fma_f32 v79, v79, s64, -v88
  v_mfma_f32_16x16x32_bf16 a[108:111], v[220:223], v[44:47], a[108:111]
  v_fma_f32 v87, v87, s65, -v89
  v_cvt_pk_bf16_f32 v48, v72, v73
  v_mfma_f32_16x16x32_bf16 a[112:115], v[224:227], v[40:43], a[112:115]
  v_cvt_pk_bf16_f32 v52, v80, v81
  v_cvt_pk_bf16_f32 v49, v74, v75
  v_mfma_f32_16x16x32_bf16 a[112:115], v[228:231], v[44:47], a[112:115]
  buffer_load_dwordx4 v18, s[12:15], s51 offen offset:3072  lds
  ds_read_b64_tr_b16 v[158:159], v4 offset:18432
  v_mfma_f32_16x16x32_bf16 a[116:119], v[232:235], v[40:43], a[116:119]
  v_cvt_pk_bf16_f32 v53, v82, v83
  v_cvt_pk_bf16_f32 v50, v76, v77
  v_mfma_f32_16x16x32_bf16 a[116:119], v[236:239], v[44:47], a[116:119]
  ds_read_b64_tr_b16 v[160:161], v5 offset:0
  v_cvt_pk_bf16_f32 v54, v84, v85
  v_mfma_f32_16x16x32_bf16 a[120:123], v[240:243], v[40:43], a[120:123]
  v_cvt_pk_bf16_f32 v51, v78, v79
  v_cvt_pk_bf16_f32 v55, v86, v87
  v_mfma_f32_16x16x32_bf16 a[120:123], v[244:247], v[44:47], a[120:123]
  s_add_u32 s51, s51, 524288
  ds_write_b128 v59, v[48:51]
  v_mfma_f32_16x16x32_bf16 a[124:127], v[248:251], v[40:43], a[124:127]
  buffer_load_dword v29, v27, s[8:11], s50 offen offset:0
  ds_read_b64_tr_b16 v[162:163], v5 offset:2048
  v_mfma_f32_16x16x32_bf16 a[124:127], v[252:255], v[44:47], a[124:127]
  s_waitcnt lgkmcnt(7)
  ds_write_b128 v59, v[52:55] offset:16
  v_mfma_f32_16x16x32_bf16 a[128:131], v[192:195], v[32:35], a[128:131]
  ds_read_b128 v[40:43], v9 offset:43008
  v_mfma_f32_16x16x32_bf16 a[128:131], v[196:199], v[36:39], a[128:131]
  ds_read_b128 v[44:47], v10 offset:43008
  buffer_load_dword v29, v28, s[12:15], s51 offen
  v_mfma_f32_16x16x32_bf16 a[132:135], v[200:203], v[32:35], a[132:135]
  ds_read_b64_tr_b16 v[164:165], v5 offset:16384
  v_mfma_f32_16x16x32_bf16 a[132:135], v[204:207], v[36:39], a[132:135]
  ds_read_b64_tr_b16 v[166:167], v5 offset:18432
  v_mfma_f32_16x16x32_bf16 a[136:139], v[208:211], v[32:35], a[136:139]
  buffer_load_dword v29, v27, s[8:11], s50 offen offset:128
  v_mfma_f32_16x16x32_bf16 a[136:139], v[212:215], v[36:39], a[136:139]
  v_mfma_f32_16x16x32_bf16 a[140:143], v[216:219], v[32:35], a[140:143]
  ds_read_b64_tr_b16 v[168:169], v6 offset:0
  v_mfma_f32_16x16x32_bf16 a[140:143], v[220:223], v[36:39], a[140:143]
  buffer_store_dwordx4 v[68:71], v0, s[20:23], s48 offen sc1
  v_mfma_f32_16x16x32_bf16 a[144:147], v[224:227], v[32:35], a[144:147]
  v_mfma_f32_16x16x32_bf16 a[144:147], v[228:231], v[36:39], a[144:147]
  ds_read_b64_tr_b16 v[170:171], v6 offset:2048
  v_mfma_f32_16x16x32_bf16 a[148:151], v[232:235], v[32:35], a[148:151]
  buffer_store_dwordx4 v[68:71], v0, s[20:23], s53 offen sc1
  v_mfma_f32_16x16x32_bf16 a[148:151], v[236:239], v[36:39], a[148:151]
  ds_read_b64_tr_b16 v[172:173], v6 offset:16384
  v_mfma_f32_16x16x32_bf16 a[152:155], v[240:243], v[32:35], a[152:155]
  v_mfma_f32_16x16x32_bf16 a[152:155], v[244:247], v[36:39], a[152:155]
  v_mfma_f32_16x16x32_bf16 a[156:159], v[248:251], v[32:35], a[156:159]
  ds_read_b64_tr_b16 v[174:175], v6 offset:18432
  v_mfma_f32_16x16x32_bf16 a[156:159], v[252:255], v[36:39], a[156:159]
  s_waitcnt lgkmcnt(6)
  s_nop 0
  v_mfma_f32_16x16x32_bf16 a[160:163], v[192:195], v[40:43], a[160:163]
  ds_read_b128 v[32:35], v9 offset:45056
  v_mfma_f32_16x16x32_bf16 a[160:163], v[196:199], v[44:47], a[160:163]
  ds_read_b128 v[36:39], v10 offset:45056
  ds_read_b64_tr_b16 v[176:177], v7 offset:0
  v_mfma_f32_16x16x32_bf16 a[164:167], v[200:203], v[40:43], a[164:167]
  v_mfma_f32_16x16x32_bf16 a[164:167], v[204:207], v[44:47], a[164:167]
  ds_read_b64_tr_b16 v[178:179], v7 offset:2048
  v_mfma_f32_16x16x32_bf16 a[168:171], v[208:211], v[40:43], a[168:171]
  v_mfma_f32_16x16x32_bf16 a[168:171], v[212:215], v[44:47], a[168:171]
  v_mfma_f32_16x16x32_bf16 a[172:175], v[216:219], v[40:43], a[172:175]
  ds_read_b64_tr_b16 v[180:181], v7 offset:16384
  v_mfma_f32_16x16x32_bf16 a[172:175], v[220:223], v[44:47], a[172:175]
  v_mfma_f32_16x16x32_bf16 a[176:179], v[224:227], v[40:43], a[176:179]
  v_mfma_f32_16x16x32_bf16 a[176:179], v[228:231], v[44:47], a[176:179]
  ds_read_b64_tr_b16 v[182:183], v7 offset:18432
  v_mfma_f32_16x16x32_bf16 a[180:183], v[232:235], v[40:43], a[180:183]
  v_mfma_f32_16x16x32_bf16 a[180:183], v[236:239], v[44:47], a[180:183]
  ds_read_b64_tr_b16 v[184:185], v8 offset:0
  v_mfma_f32_16x16x32_bf16 a[184:187], v[240:243], v[40:43], a[184:187]
  v_mfma_f32_16x16x32_bf16 a[184:187], v[244:247], v[44:47], a[184:187]
  v_mfma_f32_16x16x32_bf16 a[188:191], v[248:251], v[40:43], a[188:191]
  ds_read_b64_tr_b16 v[186:187], v8 offset:2048
  v_mfma_f32_16x16x32_bf16 a[188:191], v[252:255], v[44:47], a[188:191]
  s_waitcnt lgkmcnt(6)
  s_nop 0
  v_mfma_f32_16x16x32_bf16 a[192:195], v[192:195], v[32:35], a[192:195]
  ds_read_b128 v[40:43], v9 offset:47104
  v_mfma_f32_16x16x32_bf16 a[192:195], v[196:199], v[36:39], a[192:195]
  ds_read_b128 v[44:47], v10 offset:47104
  ds_read_b64_tr_b16 v[188:189], v8 offset:16384
  v_mfma_f32_16x16x32_bf16 a[196:199], v[200:203], v[32:35], a[196:199]
  v_mfma_f32_16x16x32_bf16 a[196:199], v[204:207], v[36:39], a[196:199]
  v_mfma_f32_16x16x32_bf16 a[200:203], v[208:211], v[32:35], a[200:203]
  ds_read_b64_tr_b16 v[190:191], v8 offset:18432
  v_mfma_f32_16x16x32_bf16 a[200:203], v[212:215], v[36:39], a[200:203]
  v_mfma_f32_16x16x32_bf16 a[204:207], v[216:219], v[32:35], a[204:207]
  v_mfma_f32_16x16x32_bf16 a[204:207], v[220:223], v[36:39], a[204:207]
  v_mfma_f32_16x16x32_bf16 a[208:211], v[224:227], v[32:35], a[208:211]
  v_mfma_f32_16x16x32_bf16 a[208:211], v[228:231], v[36:39], a[208:211]
  v_mfma_f32_16x16x32_bf16 a[212:215], v[232:235], v[32:35], a[212:215]
  v_mfma_f32_16x16x32_bf16 a[212:215], v[236:239], v[36:39], a[212:215]
  v_mfma_f32_16x16x32_bf16 a[216:219], v[240:243], v[32:35], a[216:219]
  v_mfma_f32_16x16x32_bf16 a[216:219], v[244:247], v[36:39], a[216:219]
  s_waitcnt vmcnt(5) lgkmcnt(0)
  s_barrier
  v_mfma_f32_16x16x32_bf16 a[220:223], v[248:251], v[32:35], a[220:223]
  ds_read_b128 v[48:51], v56
  s_add_u32 m0, s52, 32768
  v_mfma_f32_16x16x32_bf16 a[220:223], v[252:255], v[36:39], a[220:223]
  ds_read_b128 v[52:55], v56 offset:4608
  buffer_load_dwordx4 v19, s[8:11], s50 offen offset:0 lds
  v_mfma_f32_16x16x32_bf16 a[224:227], v[192:195], v[40:43], a[224:227]
  ds_read_b128 v[32:35], v9 offset:0
  v_mfma_f32_16x16x32_bf16 a[224:227], v[196:199], v[44:47], a[224:227]
  ds_read_b128 v[36:39], v10 offset:0
  v_mfma_f32_16x16x32_bf16 a[228:231], v[200:203], v[40:43], a[228:231]
  v_mfma_f32_16x16x32_bf16 a[228:231], v[204:207], v[44:47], a[228:231]
  buffer_load_dwordx4 v20, s[8:11], s50 offen offset:1024 lds
  v_mfma_f32_16x16x32_bf16 a[232:235], v[208:211], v[40:43], a[232:235]
  v_mfma_f32_16x16x32_bf16 a[232:235], v[212:215], v[44:47], a[232:235]
  v_mfma_f32_16x16x32_bf16 a[236:239], v[216:219], v[40:43], a[236:239]
  v_mfma_f32_16x16x32_bf16 a[236:239], v[220:223], v[44:47], a[236:239]
  buffer_load_dwordx4 v21, s[8:11], s50 offen offset:2048 lds
  v_mfma_f32_16x16x32_bf16 a[240:243], v[224:227], v[40:43], a[240:243]
  s_waitcnt lgkmcnt(2)
  s_nop 0
  v_mfma_f32_16x16x32_bf16 a[240:243], v[228:231], v[44:47], a[240:243]
  v_mfma_f32_16x16x32_bf16 a[244:247], v[232:235], v[40:43], a[244:247]
  buffer_store_dwordx4 v[48:51], v57, s[20:23], s6 offen sc1
  v_mfma_f32_16x16x32_bf16 a[244:247], v[236:239], v[44:47], a[244:247]
  buffer_load_dwordx4 v22, s[8:11], s50 offen offset:3072 lds
  v_mfma_f32_16x16x32_bf16 a[248:251], v[240:243], v[40:43], a[248:251]
  buffer_store_dwordx4 v[52:55], v57, s[20:23], s37 offen sc1
  v_mfma_f32_16x16x32_bf16 a[248:251], v[244:247], v[44:47], a[248:251]
  v_mfma_f32_16x16x32_bf16 a[252:255], v[248:251], v[40:43], a[252:255]
  s_add_u32 m0, s52, 36864
  v_mfma_f32_16x16x32_bf16 a[252:255], v[252:255], v[44:47], a[252:255]
  s_waitcnt lgkmcnt(0)
L_k1_loop0:
  s_nop 0
  v_mfma_f32_16x16x32_bf16 a[0:3], v[128:131], v[32:35], a[0:3]
  ds_read_b128 v[40:43], v9 offset:2048
  v_mfma_f32_16x16x32_bf16 a[0:3], v[132:135], v[36:39], a[0:3]
  ds_read_b128 v[44:47], v10 offset:2048
  buffer_load_dwordx4 v23, s[8:11], s50 offen offset:0 lds
  v_mfma_f32_16x16x32_bf16 a[4:7], v[136:139], v[32:35], a[4:7]
  ds_read_b64_tr_b16 v[192:193], v1 offset:32768
  v_mfma_f32_16x16x32_bf16 a[4:7], v[140:143], v[36:39], a[4:7]
  v_mfma_f32_16x16x32_bf16 a[8:11], v[144:147], v[32:35], a[8:11]
  ds_read_b64_tr_b16 v[194:195], v1 offset:34816
  v_mfma_f32_16x16x32_bf16 a[8:11], v[148:151], v[36:39], a[8:11]
  v_mfma_f32_16x16x32_bf16 a[12:15], v[152:155], v[32:35], a[12:15]
  buffer_load_dwordx4 v24, s[8:11], s50 offen offset:1024 lds
  v_mfma_f32_16x16x32_bf16 a[12:15], v[156:159], v[36:39], a[12:15]
  ds_read_b64_tr_b16 v[196:197], v1 offset:49152
  v_mfma_f32_16x16x32_bf16 a[16:19], v[160:163], v[32:35], a[16:19]
  v_mfma_f32_16x16x32_bf16 a[16:19], v[164:167], v[36:39], a[16:19]
  ds_read_b64_tr_b16 v[198:199], v1 offset:51200
  v_mfma_f32_16x16x32_bf16 a[20:23], v[168:171], v[32:35], a[20:23]
  v_mfma_f32_16x16x32_bf16 a[20:23], v[172:175], v[36:39], a[20:23]
  buffer_load_dwordx4 v25, s[8:11], s50 offen offset:2048 lds
  v_mfma_f32_16x16x32_bf16 a[24:27], v[176:179], v[32:35], a[24:27]
  ds_read_b64_tr_b16 v[200:201], v2 offset:32768
  v_mfma_f32_16x16x32_bf16 a[24:27], v[180:183], v[36:39], a[24:27]
  v_mfma_f32_16x16x32_bf16 a[28:31], v[184:187], v[32:35], a[28:31]
  ds_read_b64_tr_b16 v[202:203], v2 offset:34816
  v_mfma_f32_16x16x32_bf16 a[28:31], v[188:191], v[36:39], a[28:31]
  s_waitcnt lgkmcnt(6)
  s_nop 0
  v_mfma_f32_16x16x32_bf16 a[32:35], v[128:131], v[40:43], a[32:35]
  ds_read_b128 v[32:35], v9 offset:4096
  buffer_load_dwordx4 v26, s[8:11], s50 offen offset:3072 lds
  v_mfma_f32_16x16x32_bf16 a[32:35], v[132:135], v[44:47], a[32:35]
  ds_read_b128 v[36:39], v10 offset:4096
  ds_read_b64_tr_b16 v[204:205], v2 offset:49152
  v_mfma_f32_16x16x32_bf16 a[36:39], v[136:139], v[40:43], a[36:39]
  v_mfma_f32_16x16x32_bf16 a[36:39], v[140:143], v[44:47], a[36:39]
  ds_read_b64_tr_b16 v[206:207], v2 offset:51200
  v_mfma_f32_16x16x32_bf16 a[40:43], v[144:147], v[40:43], a[40:43]
  s_add_u32 s50, s50, 128
  s_add_u32 m0, s52, 65536
  v_mfma_f32_16x16x32_bf16 a[40:43], v[148:151], v[44:47], a[40:43]
  buffer_load_dwordx4 v11, s[12:15], s51 offen offset:0  lds
  v_mfma_f32_16x16x32_bf16 a[44:47], v[152:155], v[40:43], a[44:47]
  ds_read_b64_tr_b16 v[208:209], v3 offset:32768
  v_mfma_f32_16x16x32_bf16 a[44:47], v[156:159], v[44:47], a[44:47]
  v_mfma_f32_16x16x32_bf16 a[48:51], v[160:163], v[40:43], a[48:51]
  ds_read_b64_tr_b16 v[210:211], v3 offset:34816
  v_mfma_f32_16x16x32_bf16 a[48:51], v[164:167], v[44:47], a[48:51]
  v_mfma_f32_16x16x32_bf16 a[52:55], v[168:171], v[40:43], a[52:55]
  buffer_load_dwordx4 v12, s[12:15], s51 offen offset:1024  lds
  v_mfma_f32_16x16x32_bf16 a[52:55], v[172:175], v[44:47], a[52:55]
  ds_read_b64_tr_b16 v[212:213], v3 offset:49152
  v_mfma_f32_16x16x32_bf16 a[56:59], v[176:179], v[40:43], a[56:59]
  v_mfma_f32_16x16x32_bf16 a[56:59], v[180:183], v[44:47], a[56:59]
  ds_read_b64_tr_b16 v[214:215], v3 offset:51200
  v_mfma_f32_16x16x32_bf16 a[60:63], v[184:187], v[40:43], a[60:63]
  v_mfma_f32_16x16x32_bf16 a[60:63], v[188:191], v[44:47], a[60:63]
  s_waitcnt lgkmcnt(6)
  buffer_load_dwordx4 v13, s[12:15], s51 offen offset:2048  lds
  v_mfma_f32_16x16x32_bf16 a[64:67], v[128:131], v[32:35], a[64:67]
  ds_read_b128 v[40:43], v9 offset:6144
  ds_read_b64_tr_b16 v[216:217], v4 offset:32768
  v_mfma_f32_16x16x32_bf16 a[64:67], v[132:135], v[36:39], a[64:67]
  s_nop 0
  ds_read_b128 v[44:47], v10 offset:6144
  v_mfma_f32_16x16x32_bf16 a[68:71], v[136:139], v[32:35], a[68:71]
  ds_read_b64_tr_b16 v[218:219], v4 offset:34816
  v_mfma_f32_16x16x32_bf16 a[68:71], v[140:143], v[36:39], a[68:71]
  v_mfma_f32_16x16x32_bf16 a[72:75], v[144:147], v[32:35], a[72:75]
  buffer_load_dwordx4 v14, s[12:15], s51 offen offset:3072  lds
  v_mfma_f32_16x16x32_bf16 a[72:75], v[148:151], v[36:39], a[72:75]
  ds_read_b64_tr_b16 v[220:221], v4 offset:49152
  v_mfma_f32_16x16x32_bf16 a[76:79], v[152:155], v[32:35], a[76:79]
  v_mfma_f32_16x16x32_bf16 a[76:79], v[156:159], v[36:39], a[76:79]
  ds_read_b64_tr_b16 v[222:223], v4 offset:51200
  v_mfma_f32_16x16x32_bf16 a[80:83], v[160:163], v[32:35], a[80:83]
  s_add_u32 m0, s52, 69632
  v_mfma_f32_16x16x32_bf16 a[80:83], v[164:167], v[36:39], a[80:83]
  buffer_load_dwordx4 v15, s[12:15], s51 offen offset:0  lds
  v_mfma_f32_16x16x32_bf16 a[84:87], v[168:171], v[32:35], a[84:87]
  ds_read_b64_tr_b16 v[224:225], v5 offset:32768
  v_mfma_f32_16x16x32_bf16 a[84:87], v[172:175], v[36:39], a[84:87]
  v_mfma_f32_16x16x32_bf16 a[88:91], v[176:179], v[32:35], a[88:91]
  ds_read_b64_tr_b16 v[226:227], v5 offset:34816
  v_mfma_f32_16x16x32_bf16 a[88:91], v[180:183], v[36:39], a[88:91]
  v_mfma_f32_16x16x32_bf16 a[92:95], v[184:187], v[32:35], a[92:95]
  buffer_load_dwordx4 v16, s[12:15], s51 offen offset:1024  lds
  v_mfma_f32_16x16x32_bf16 a[92:95], v[188:191], v[36:39], a[92:95]
  s_waitcnt lgkmcnt(5)
  ds_read_b64_tr_b16 v[228:229], v5 offset:49152
  v_mfma_f32_16x16x32_bf16 a[96:99], v[128:131], v[40:43], a[96:99]
  s_nop 0
  ds_read_b128 v[32:35], v9 offset:8192
  v_mfma_f32_16x16x32_bf16 a[96:99], v[132:135], v[44:47], a[96:99]
  ds_read_b128 v[36:39], v10 offset:8192
  ds_read_b64_tr_b16 v[230:231], v5 offset:51200
  v_mfma_f32_16x16x32_bf16 a[100:103], v[136:139], v[40:43], a[100:103]
  v_mfma_f32_16x16x32_bf16 a[100:103], v[140:143], v[44:47], a[100:103]
  buffer_load_dwordx4 v17, s[12:15], s51 offen offset:2048  lds
  v_mfma_f32_16x16x32_bf16 a[104:107], v[144:147], v[40:43], a[104:107]
  ds_read_b64_tr_b16 v[232:233], v6 offset:32768
  v_mfma_f32_16x16x32_bf16 a[104:107], v[148:151], v[44:47], a[104:107]
  v_mfma_f32_16x16x32_bf16 a[108:111], v[152:155], v[40:43], a[108:111]
  ds_read_b64_tr_b16 v[234:235], v6 offset:34816
  v_mfma_f32_16x16x32_bf16 a[108:111], v[156:159], v[44:47], a[108:111]
  v_mfma_f32_16x16x32_bf16 a[112:115], v[160:163], v[40:43], a[112:115]
  buffer_load_dwordx4 v18, s[12:15], s51 offen offset:3072  lds
  v_mfma_f32_16x16x32_bf16 a[112:115], v[164:167], v[44:47], a[112:115]
  ds_read_b64_tr_b16 v[236:237], v6 offset:49152
  v_mfma_f32_16x16x32_bf16 a[116:119], v[168:171], v[40:43], a[116:119]
  v_mfma_f32_16x16x32_bf16 a[116:119], v[172:175], v[44:47], a[116:119]
  ds_read_b64_tr_b16 v[238:239], v6 offset:51200
  v_mfma_f32_16x16x32_bf16 a[120:123], v[176:179], v[40:43], a[120:123]
  s_add_u32 s51, s51, 524288
  v_mfma_f32_16x16x32_bf16 a[120:123], v[180:183], v[44:47], a[120:123]
  buffer_load_dword v29, v27, s[8:11], s50 offen offset:128
  v_mfma_f32_16x16x32_bf16 a[124:127], v[184:187], v[40:43], a[124:127]
  ds_read_b64_tr_b16 v[240:241], v7 offset:32768
  v_mfma_f32_16x16x32_bf16 a[124:127], v[188:191], v[44:47], a[124:127]
  s_waitcnt lgkmcnt(6)
  s_nop 0
  v_mfma_f32_16x16x32_bf16 a[128:131], v[128:131], v[32:35], a[128:131]
  ds_read_b128 v[40:43], v9 offset:10240
  buffer_load_dword v29, v28, s[12:15], s51 offen
  v_mfma_f32_16x16x32_bf16 a[128:131], v[132:135], v[36:39], a[128:131]
  ds_read_b128 v[44:47], v10 offset:10240
  ds_read_b64_tr_b16 v[242:243], v7 offset:34816
  v_mfma_f32_16x16x32_bf16 a[132:135], v[136:139], v[32:35], a[132:135]
  v_mfma_f32_16x16x32_bf16 a[132:135], v[140:143], v[36:39], a[132:135]
  buffer_load_dword v29, v62, s[28:31], s36 offen
  ds_read_b64_tr_b16 v[244:245], v7 offset:49152
  v_mfma_f32_16x16x32_bf16 a[136:139], v[144:147], v[32:35], a[136:139]
  v_mfma_f32_16x16x32_bf16 a[136:139], v[148:151], v[36:39], a[136:139]
  s_add_u32 s36, s36, 622592
  ds_read_b64_tr_b16 v[246:247], v7 offset:51200
  v_mfma_f32_16x16x32_bf16 a[140:143], v[152:155], v[32:35], a[140:143]
  v_mfma_f32_16x16x32_bf16 a[140:143], v[156:159], v[36:39], a[140:143]
  v_mfma_f32_16x16x32_bf16 a[144:147], v[160:163], v[32:35], a[144:147]
  ds_read_b64_tr_b16 v[248:249], v8 offset:32768
  v_mfma_f32_16x16x32_bf16 a[144:147], v[164:167], v[36:39], a[144:147]
  v_mfma_f32_16x16x32_bf16 a[148:151], v[168:171], v[32:35], a[148:151]
  ds_read_b64_tr_b16 v[250:251], v8 offset:34816
  v_mfma_f32_16x16x32_bf16 a[148:151], v[172:175], v[36:39], a[148:151]
  v_mfma_f32_16x16x32_bf16 a[152:155], v[176:179], v[32:35], a[152:155]
  v_mfma_f32_16x16x32_bf16 a[152:155], v[180:183], v[36:39], a[152:155]
  ds_read_b64_tr_b16 v[252:253], v8 offset:49152
  v_mfma_f32_16x16x32_bf16 a[156:159], v[184:187], v[32:35], a[156:159]
  v_mfma_f32_16x16x32_bf16 a[156:159], v[188:191], v[36:39], a[156:159]
  s_waitcnt lgkmcnt(6)
  s_nop 0
  v_mfma_f32_16x16x32_bf16 a[160:163], v[128:131], v[40:43], a[160:163]
  ds_read_b128 v[32:35], v9 offset:12288
  ds_read_b64_tr_b16 v[254:255], v8 offset:51200
  v_mfma_f32_16x16x32_bf16 a[160:163], v[132:135], v[44:47], a[160:163]
  ds_read_b128 v[36:39], v10 offset:12288
  v_mfma_f32_16x16x32_bf16 a[164:167], v[136:139], v[40:43], a[164:167]
  v_mfma_f32_16x16x32_bf16 a[164:167], v[140:143], v[44:47], a[164:167]
  v_mfma_f32_16x16x32_bf16 a[168:171], v[144:147], v[40:43], a[168:171]
  v_mfma_f32_16x16x32_bf16 a[168:171], v[148:151], v[44:47], a[168:171]
  v_mfma_f32_16x16x32_bf16 a[172:175], v[152:155], v[40:43], a[172:175]
  v_mfma_f32_16x16x32_bf16 a[172:175], v[156:159], v[44:47], a[172:175]
  v_mfma_f32_16x16x32_bf16 a[176:179], v[160:163], v[40:43], a[176:179]
  v_mfma_f32_16x16x32_bf16 a[176:179], v[164:167], v[44:47], a[176:179]
  v_mfma_f32_16x16x32_bf16 a[180:183], v[168:171], v[40:43], a[180:183]
  v_mfma_f32_16x16x32_bf16 a[180:183], v[172:175], v[44:47], a[180:183]
  v_mfma_f32_16x16x32_bf16 a[184:187], v[176:179], v[40:43], a[184:187]
  v_mfma_f32_16x16x32_bf16 a[184:187], v[180:183], v[44:47], a[184:187]
  v_mfma_f32_16x16x32_bf16 a[188:191], v[184:187], v[40:43], a[188:191]
  v_mfma_f32_16x16x32_bf16 a[188:191], v[188:191], v[44:47], a[188:191]
  s_waitcnt lgkmcnt(0)
  s_nop 0
  v_mfma_f32_16x16x32_bf16 a[192:195], v[128:131], v[32:35], a[192:195]
  ds_read_b128 v[40:43], v9 offset:14336
  v_mfma_f32_16x16x32_bf16 a[192:195], v[132:135], v[36:39], a[192:195]
  ds_read_b128 v[44:47], v10 offset:14336
  v_mfma_f32_16x16x32_bf16 a[196:199], v[136:139], v[32:35], a[196:199]
  v_mfma_f32_16x16x32_bf16 a[196:199], v[140:143], v[36:39], a[196:199]
  v_mfma_f32_16x16x32_bf16 a[200:203], v[144:147], v[32:35], a[200:203]
  v_mfma_f32_16x16x32_bf16 a[200:203], v[148:151], v[36:39], a[200:203]
  v_mfma_f32_16x16x32_bf16 a[204:207], v[152:155], v[32:35], a[204:207]
  v_mfma_f32_16x16x32_bf16 a[204:207], v[156:159], v[36:39], a[204:207]
  v_mfma_f32_16x16x32_bf16 a[208:211], v[160:163], v[32:35], a[208:211]
  v_mfma_f32_16x16x32_bf16 a[208:211], v[164:167], v[36:39], a[208:211]
  v_mfma_f32_16x16x32_bf16 a[212:215], v[168:171], v[32:35], a[212:215]
  v_mfma_f32_16x16x32_bf16 a[212:215], v[172:175], v[36:39], a[212:215]
  v_mfma_f32_16x16x32_bf16 a[216:219], v[176:179], v[32:35], a[216:219]
  v_mfma_f32_16x16x32_bf16 a[216:219], v[180:183], v[36:39], a[216:219]
  s_waitcnt vmcnt(3) lgkmcnt(0)
  s_barrier
  v_mfma_f32_16x16x32_bf16 a[220:223], v[184:187], v[32:35], a[220:223]
  s_add_u32 m0, s52, 0
  s_nop 0
  v_mfma_f32_16x16x32_bf16 a[220:223], v[188:191], v[36:39], a[220:223]
  buffer_load_dwordx4 v19, s[8:11], s50 offen offset:0 lds
  v_mfma_f32_16x16x32_bf16 a[224:227], v[128:131], v[40:43], a[224:227]
  ds_read_b128 v[32:35], v9 offset:32768
  v_mfma_f32_16x16x32_bf16 a[224:227], v[132:135], v[44:47], a[224:227]
  ds_read_b128 v[36:39], v10 offset:32768
  s_bitcmp1_b32 s61, s54
  v_mfma_f32_16x16x32_bf16 a[228:231], v[136:139], v[40:43], a[228:231]
  s_cbranch_scc1 L_k1_evt0
L_k1_evtret0:
  v_mfma_f32_16x16x32_bf16 a[228:231], v[140:143], v[44:47], a[228:231]
  buffer_load_dwordx4 v20, s[8:11], s50 offen offset:1024 lds
  v_mfma_f32_16x16x32_bf16 a[232:235], v[144:147], v[40:43], a[232:235]
  v_mfma_f32_16x16x32_bf16 a[232:235], v[148:151], v[44:47], a[232:235]
  v_mfma_f32_16x16x32_bf16 a[236:239], v[152:155], v[40:43], a[236:239]
  v_mfma_f32_16x16x32_bf16 a[236:239], v[156:159], v[44:47], a[236:239]
  buffer_load_dwordx4 v21, s[8:11], s50 offen offset:2048 lds
  v_mfma_f32_16x16x32_bf16 a[240:243], v[160:163], v[40:43], a[240:243]
  v_mfma_f32_16x16x32_bf16 a[240:243], v[164:167], v[44:47], a[240:243]
  v_mfma_f32_16x16x32_bf16 a[244:247], v[168:171], v[40:43], a[244:247]
  v_mfma_f32_16x16x32_bf16 a[244:247], v[172:175], v[44:47], a[244:247]
  buffer_load_dwordx4 v22, s[8:11], s50 offen offset:3072 lds
  v_mfma_f32_16x16x32_bf16 a[248:251], v[176:179], v[40:43], a[248:251]
  v_mfma_f32_16x16x32_bf16 a[248:251], v[180:183], v[44:47], a[248:251]
  v_mfma_f32_16x16x32_bf16 a[252:255], v[184:187], v[40:43], a[252:255]
  s_add_u32 m0, s52, 4096
  v_mfma_f32_16x16x32_bf16 a[252:255], v[188:191], v[44:47], a[252:255]
  s_waitcnt lgkmcnt(0)
  s_nop 0
  v_mfma_f32_16x16x32_bf16 a[0:3], v[192:195], v[32:35], a[0:3]
  ds_read_b128 v[40:43], v9 offset:34816
  v_mfma_f32_16x16x32_bf16 a[0:3], v[196:199], v[36:39], a[0:3]
  ds_read_b128 v[44:47], v10 offset:34816
  buffer_load_dwordx4 v23, s[8:11], s50 offen offset:0 lds
  v_mfma_f32_16x16x32_bf16 a[4:7], v[200:203], v[32:35], a[4:7]
  ds_read_b64_tr_b16 v[128:129], v1 offset:0
  v_mfma_f32_16x16x32_bf16 a[4:7], v[204:207], v[36:39], a[4:7]
  v_mfma_f32_16x16x32_bf16 a[8:11], v[208:211], v[32:35], a[8:11]
  ds_read_b64_tr_b16 v[130:131], v1 offset:2048
  v_mfma_f32_16x16x32_bf16 a[8:11], v[212:215], v[36:39], a[8:11]
  v_mfma_f32_16x16x32_bf16 a[12:15], v[216:219], v[32:35], a[12:15]
  buffer_load_dwordx4 v24, s[8:11], s50 offen offset:1024 lds
  v_mfma_f32_16x16x32_bf16 a[12:15], v[220:223], v[36:39], a[12:15]
  ds_read_b64_tr_b16 v[132:133], v1 offset:16384
  v_mfma_f32_16x16x32_bf16 a[16:19], v[224:227], v[32:35], a[16:19]
  v_mfma_f32_16x16x32_bf16 a[16:19], v[228:231], v[36:39], a[16:19]
  ds_read_b64_tr_b16 v[134:135], v1 offset:18432
  v_mfma_f32_16x16x32_bf16 a[20:23], v[232:235], v[32:35], a[20:23]
  v_mfma_f32_16x16x32_bf16 a[20:23], v[236:239], v[36:39], a[20:23]
  buffer_load_dwordx4 v25, s[8:11], s50 offen offset:2048 lds
  v_mfma_f32_16x16x32_bf16 a[24:27], v[240:243], v[32:35], a[24:27]
  ds_read_b64_tr_b16 v[136:137], v2 offset:0
  v_mfma_f32_16x16x32_bf16 a[24:27], v[244:247], v[36:39], a[24:27]
  v_mfma_f32_16x16x32_bf16 a[28:31], v[248:251], v[32:35], a[28:31]
  ds_read_b64_tr_b16 v[138:139], v2 offset:2048
  v_mfma_f32_16x16x32_bf16 a[28:31], v[252:255], v[36:39], a[28:31]
  s_waitcnt lgkmcnt(6)
  s_nop 0
  v_mfma_f32_16x16x32_bf16 a[32:35], v[192:195], v[40:43], a[32:35]
  ds_read_b128 v[32:35], v9 offset:36864
  buffer_load_dwordx4 v26, s[8:11], s50 offen offset:3072 lds
  v_mfma_f32_16x16x32_bf16 a[32:35], v[196:199], v[44:47], a[32:35]
  ds_read_b128 v[36:39], v10 offset:36864
  ds_read_b64_tr_b16 v[140:141], v2 offset:16384
  v_mfma_f32_16x16x32_bf16 a[36:39], v[200:203], v[40:43], a[36:39]
  v_mfma_f32_16x16x32_bf16 a[36:39], v[204:207], v[44:47], a[36:39]
  ds_read_b64_tr_b16 v[142:143], v2 offset:18432
  v_mfma_f32_16x16x32_bf16 a[40:43], v[208:211], v[40:43], a[40:43]
  s_add_u32 s50, s50, 128
  s_add_u32 m0, s52, 98304
  v_mfma_f32_16x16x32_bf16 a[40:43], v[212:215], v[44:47], a[40:43]
  buffer_load_dwordx4 v11, s[12:15], s51 offen offset:0  lds
  v_mfma_f32_16x16x32_bf16 a[44:47], v[216:219], v[40:43], a[44:47]
  ds_read_b64_tr_b16 v[144:145], v3 offset:0
  v_mfma_f32_16x16x32_bf16 a[44:47], v[220:223], v[44:47], a[44:47]
  v_mfma_f32_16x16x32_bf16 a[48:51], v[224:227], v[40:43], a[48:51]
  ds_read_b64_tr_b16 v[146:147], v3 offset:2048
  v_mfma_f32_16x16x32_bf16 a[48:51], v[228:231], v[44:47], a[48:51]
  v_mfma_f32_16x16x32_bf16 a[52:55], v[232:235], v[40:43], a[52:55]
  buffer_load_dwordx4 v12, s[12:15], s51 offen offset:1024  lds
  v_mfma_f32_16x16x32_bf16 a[52:55], v[236:239], v[44:47], a[52:55]
  ds_read_b64_tr_b16 v[148:149], v3 offset:16384
  v_mfma_f32_16x16x32_bf16 a[56:59], v[240:243], v[40:43], a[56:59]
  v_mfma_f32_16x16x32_bf16 a[56:59], v[244:247], v[44:47], a[56:59]
  ds_read_b64_tr_b16 v[150:151], v3 offset:18432
  v_mfma_f32_16x16x32_bf16 a[60:63], v[248:251], v[40:43], a[60:63]
  v_mfma_f32_16x16x32_bf16 a[60:63], v[252:255], v[44:47], a[60:63]
  s_waitcnt lgkmcnt(6)
  buffer_load_dwordx4 v13, s[12:15], s51 offen offset:2048  lds
  v_mfma_f32_16x16x32_bf16 a[64:67], v[192:195], v[32:35], a[64:67]
  ds_read_b128 v[40:43], v9 offset:38912
  ds_read_b64_tr_b16 v[152:153], v4 offset:0
  v_mfma_f32_16x16x32_bf16 a[64:67], v[196:199], v[36:39], a[64:67]
  s_nop 0
  ds_read_b128 v[44:47], v10 offset:38912
  v_mfma_f32_16x16x32_bf16 a[68:71], v[200:203], v[32:35], a[68:71]
  ds_read_b64_tr_b16 v[154:155], v4 offset:2048
  v_mfma_f32_16x16x32_bf16 a[68:71], v[204:207], v[36:39], a[68:71]
  v_mfma_f32_16x16x32_bf16 a[72:75], v[208:211], v[32:35], a[72:75]
  buffer_load_dwordx4 v14, s[12:15], s51 offen offset:3072  lds
  v_mfma_f32_16x16x32_bf16 a[72:75], v[212:215], v[36:39], a[72:75]
  ds_read_b64_tr_b16 v[156:157], v4 offset:16384
  v_mfma_f32_16x16x32_bf16 a[76:79], v[216:219], v[32:35], a[76:79]
  v_mfma_f32_16x16x32_bf16 a[76:79], v[220:223], v[36:39], a[76:79]
  ds_read_b64_tr_b16 v[158:159], v4 offset:18432
  v_mfma_f32_16x16x32_bf16 a[80:83], v[224:227], v[32:35], a[80:83]
  s_add_u32 m0, s52, 102400
  v_mfma_f32_16x16x32_bf16 a[80:83], v[228:231], v[36:39], a[80:83]
  buffer_load_dwordx4 v15, s[12:15], s51 offen offset:0  lds
  v_mfma_f32_16x16x32_bf16 a[84:87], v[232:235], v[32:35], a[84:87]
  ds_read_b64_tr_b16 v[160:161], v5 offset:0
  v_mfma_f32_16x16x32_bf16 a[84:87], v[236:239], v[36:39], a[84:87]
  v_mfma_f32_16x16x32_bf16 a[88:91], v[240:243], v[32:35], a[88:91]
  ds_read_b64_tr_b16 v[162:163], v5 offset:2048
  v_mfma_f32_16x16x32_bf16 a[88:91], v[244:247], v[36:39], a[88:91]
  v_mfma_f32_16x16x32_bf16 a[92:95], v[248:251], v[32:35], a[92:95]
  buffer_load_dwordx4 v16, s[12:15], s51 offen offset:1024  lds
  v_mfma_f32_16x16x32_bf16 a[92:95], v[252:255], v[36:39], a[92:95]
  s_waitcnt lgkmcnt(5)
  ds_read_b64_tr_b16 v[164:165], v5 offset:16384
  v_mfma_f32_16x16x32_bf16 a[96:99], v[192:195], v[40:43], a[96:99]
  s_nop 0
  ds_read_b128 v[32:35], v9 offset:40960
  v_mfma_f32_16x16x32_bf16 a[96:99], v[196:199], v[44:47], a[96:99]
  ds_read_b128 v[36:39], v10 offset:40960
  ds_read_b64_tr_b16 v[166:167], v5 offset:18432
  v_mfma_f32_16x16x32_bf16 a[100:103], v[200:203], v[40:43], a[100:103]
  v_mfma_f32_16x16x32_bf16 a[100:103], v[204:207], v[44:47], a[100:103]
  buffer_load_dwordx4 v17, s[12:15], s51 offen offset:2048  lds
  v_mfma_f32_16x16x32_bf16 a[104:107], v[208:211], v[40:43], a[104:107]
  ds_read_b64_tr_b16 v[168:169], v6 offset:0
  v_mfma_f32_16x16x32_bf16 a[104:107], v[212:215], v[44:47], a[104:107]
  v_mfma_f32_16x16x32_bf16 a[108:111], v[216:219], v[40:43], a[108:111]
  ds_read_b64_tr_b16 v[170:171], v6 offset:2048
  v_mfma_f32_16x16x32_bf16 a[108:111], v[220:223], v[44:47], a[108:111]
  v_mfma_f32_16x16x32_bf16 a[112:115], v[224:227], v[40:43], a[112:115]
  buffer_load_dwordx4 v18, s[12:15], s51 offen offset:3072  lds
  v_mfma_f32_16x16x32_bf16 a[112:115], v[228:231], v[44:47], a[112:115]
  ds_read_b64_tr_b16 v[172:173], v6 offset:16384
  v_mfma_f32_16x16x32_bf16 a[116:119], v[232:235], v[40:43], a[116:119]
  v_mfma_f32_16x16x32_bf16 a[116:119], v[236:239], v[44:47], a[116:119]
  ds_read_b64_tr_b16 v[174:175], v6 offset:18432
  v_mfma_f32_16x16x32_bf16 a[120:123], v[240:243], v[40:43], a[120:123]
  s_add_u32 s51, s51, 524288
  v_mfma_f32_16x16x32_bf16 a[120:123], v[244:247], v[44:47], a[120:123]
  buffer_load_dword v29, v27, s[8:11], s50 offen offset:128
  v_mfma_f32_16x16x32_bf16 a[124:127], v[248:251], v[40:43], a[124:127]
  ds_read_b64_tr_b16 v[176:177], v7 offset:0
  v_mfma_f32_16x16x32_bf16 a[124:127], v[252:255], v[44:47], a[124:127]
  s_waitcnt lgkmcnt(6)
  s_nop 0
  v_mfma_f32_16x16x32_bf16 a[128:131], v[192:195], v[32:35], a[128:131]
  ds_read_b128 v[40:43], v9 offset:43008
  buffer_load_dword v29, v28, s[12:15], s51 offen
  v_mfma_f32_16x16x32_bf16 a[128:131], v[196:199], v[36:39], a[128:131]
  ds_read_b128 v[44:47], v10 offset:43008
  ds_read_b64_tr_b16 v[178:179], v7 offset:2048
  v_mfma_f32_16x16x32_bf16 a[132:135], v[200:203], v[32:35], a[132:135]
  v_mfma_f32_16x16x32_bf16 a[132:135], v[204:207], v[36:39], a[132:135]
  buffer_load_dword v29, v62, s[28:31], s36 offen
  ds_read_b64_tr_b16 v[180:181], v7 offset:16384
  v_mfma_f32_16x16x32_bf16 a[136:139], v[208:211], v[32:35], a[136:139]
  v_mfma_f32_16x16x32_bf16 a[136:139], v[212:215], v[36:39], a[136:139]
  s_add_u32 s36, s36, 622592
  ds_read_b64_tr_b16 v[182:183], v7 offset:18432
  v_mfma_f32_16x16x32_bf16 a[140:143], v[216:219], v[32:35], a[140:143]
  v_mfma_f32_16x16x32_bf16 a[140:143], v[220:223], v[36:39], a[140:143]
  v_mfma_f32_16x16x32_bf16 a[144:147], v[224:227], v[32:35], a[144:147]
  ds_read_b64_tr_b16 v[184:185], v8 offset:0
  v_mfma_f32_16x16x32_bf16 a[144:147], v[228:231], v[36:39], a[144:147]
  v_mfma_f32_16x16x32_bf16 a[148:151], v[232:235], v[32:35], a[148:151]
  ds_read_b64_tr_b16 v[186:187], v8 offset:2048
  v_mfma_f32_16x16x32_bf16 a[148:151], v[236:239], v[36:39], a[148:151]
  v_mfma_f32_16x16x32_bf16 a[152:155], v[240:243], v[32:35], a[152:155]
  v_mfma_f32_16x16x32_bf16 a[152:155], v[244:247], v[36:39], a[152:155]
  ds_read_b64_tr_b16 v[188:189], v8 offset:16384
  v_mfma_f32_16x16x32_bf16 a[156:159], v[248:251], v[32:35], a[156:159]
  v_mfma_f32_16x16x32_bf16 a[156:159], v[252:255], v[36:39], a[156:159]
  s_waitcnt lgkmcnt(6)
  s_nop 0
  v_mfma_f32_16x16x32_bf16 a[160:163], v[192:195], v[40:43], a[160:163]
  ds_read_b128 v[32:35], v9 offset:45056
  ds_read_b64_tr_b16 v[190:191], v8 offset:18432
  v_mfma_f32_16x16x32_bf16 a[160:163], v[196:199], v[44:47], a[160:163]
  ds_read_b128 v[36:39], v10 offset:45056
  v_mfma_f32_16x16x32_bf16 a[164:167], v[200:203], v[40:43], a[164:167]
  v_mfma_f32_16x16x32_bf16 a[164:167], v[204:207], v[44:47], a[164:167]
  v_mfma_f32_16x16x32_bf16 a[168:171], v[208:211], v[40:43], a[168:171]
  v_mfma_f32_16x16x32_bf16 a[168:171], v[212:215], v[44:47], a[168:171]
  v_mfma_f32_16x16x32_bf16 a[172:175], v[216:219], v[40:43], a[172:175]
  v_mfma_f32_16x16x32_bf16 a[172:175], v[220:223], v[44:47], a[172:175]
  v_mfma_f32_16x16x32_bf16 a[176:179], v[224:227], v[40:43], a[176:179]
  v_mfma_f32_16x16x32_bf16 a[176:179], v[228:231], v[44:47], a[176:179]
  v_mfma_f32_16x16x32_bf16 a[180:183], v[232:235], v[40:43], a[180:183]
  v_mfma_f32_16x16x32_bf16 a[180:183], v[236:239], v[44:47], a[180:183]
  v_mfma_f32_16x16x32_bf16 a[184:187], v[240:243], v[40:43], a[184:187]
  v_mfma_f32_16x16x32_bf16 a[184:187], v[244:247], v[44:47], a[184:187]
  v_mfma_f32_16x16x32_bf16 a[188:191], v[248:251], v[40:43], a[188:191]
  v_mfma_f32_16x16x32_bf16 a[188:191], v[252:255], v[44:47], a[188:191]
  s_waitcnt lgkmcnt(0)
  s_nop 0
  v_mfma_f32_16x16x32_bf16 a[192:195], v[192:195], v[32:35], a[192:195]
  ds_read_b128 v[40:43], v9 offset:47104
  v_mfma_f32_16x16x32_bf16 a[192:195], v[196:199], v[36:39], a[192:195]
  ds_read_b128 v[44:47], v10 offset:47104
  v_mfma_f32_16x16x32_bf16 a[196:199], v[200:203], v[32:35], a[196:199]
  v_mfma_f32_16x16x32_bf16 a[196:199], v[204:207], v[36:39], a[196:199]
  v_mfma_f32_16x16x32_bf16 a[200:203], v[208:211], v[32:35], a[200:203]
  v_mfma_f32_16x16x32_bf16 a[200:203], v[212:215], v[36:39], a[200:203]
  v_mfma_f32_16x16x32_bf16 a[204:207], v[216:219], v[32:35], a[204:207]
  v_mfma_f32_16x16x32_bf16 a[204:207], v[220:223], v[36:39], a[204:207]
  v_mfma_f32_16x16x32_bf16 a[208:211], v[224:227], v[32:35], a[208:211]
  v_mfma_f32_16x16x32_bf16 a[208:211], v[228:231], v[36:39], a[208:211]
  v_mfma_f32_16x16x32_bf16 a[212:215], v[232:235], v[32:35], a[212:215]
  v_mfma_f32_16x16x32_bf16 a[212:215], v[236:239], v[36:39], a[212:215]
  v_mfma_f32_16x16x32_bf16 a[216:219], v[240:243], v[32:35], a[216:219]
  v_mfma_f32_16x16x32_bf16 a[216:219], v[244:247], v[36:39], a[216:219]
  s_waitcnt vmcnt(3) lgkmcnt(0)
  s_barrier
  v_mfma_f32_16x16x32_bf16 a[220:223], v[248:251], v[32:35], a[220:223]
  s_add_u32 m0, s52, 32768
  v_mfma_f32_16x16x32_bf16 a[220:223], v[252:255], v[36:39], a[220:223]
  buffer_load_dwordx4 v19, s[8:11], s50 offen offset:0 lds
  v_mfma_f32_16x16x32_bf16 a[224:227], v[192:195], v[40:43], a[224:227]
  ds_read_b128 v[32:35], v9 offset:0
  v_mfma_f32_16x16x32_bf16 a[224:227], v[196:199], v[44:47], a[224:227]
  ds_read_b128 v[36:39], v10 offset:0
  v_mfma_f32_16x16x32_bf16 a[228:231], v[200:203], v[40:43], a[228:231]
  v_mfma_f32_16x16x32_bf16 a[228:231], v[204:207], v[44:47], a[228:231]
  buffer_load_dwordx4 v20, s[8:11], s50 offen offset:1024 lds
  v_mfma_f32_16x16x32_bf16 a[232:235], v[208:211], v[40:43], a[232:235]
  v_mfma_f32_16x16x32_bf16 a[232:235], v[212:215], v[44:47], a[232:235]
  v_mfma_f32_16x16x32_bf16 a[236:239], v[216:219], v[40:43], a[236:239]
  v_mfma_f32_16x16x32_bf16 a[236:239], v[220:223], v[44:47], a[236:239]
  buffer_load_dwordx4 v21, s[8:11], s50 offen offset:2048 lds
  v_mfma_f32_16x16x32_bf16 a[240:243], v[224:227], v[40:43], a[240:243]
  v_mfma_f32_16x16x32_bf16 a[240:243], v[228:231], v[44:47], a[240:243]
  v_mfma_f32_16x16x32_bf16 a[244:247], v[232:235], v[40:43], a[244:247]
  v_mfma_f32_16x16x32_bf16 a[244:247], v[236:239], v[44:47], a[244:247]
  buffer_load_dwordx4 v22, s[8:11], s50 offen offset:3072 lds
  v_mfma_f32_16x16x32_bf16 a[248:251], v[240:243], v[40:43], a[248:251]
  s_add_u32 s54, s54, 1
  s_nop 0
  v_mfma_f32_16x16x32_bf16 a[248:251], v[244:247], v[44:47], a[248:251]
  v_mfma_f32_16x16x32_bf16 a[252:255], v[248:251], v[40:43], a[252:255]
  s_add_u32 m0, s52, 36864
  s_cmp_lt_u32 s54, 6
  v_mfma_f32_16x16x32_bf16 a[252:255], v[252:255], v[44:47], a[252:255]
  s_waitcnt lgkmcnt(0)
  s_cbranch_scc1 L_k1_loop0
L_k1_s14:
  v_mfma_f32_16x16x32_bf16 a[0:3], v[128:131], v[32:35], a[0:3]
  s_nop 0
  ds_read_b128 v[40:43], v9 offset:2048
  v_mfma_f32_16x16x32_bf16 a[0:3], v[132:135], v[36:39], a[0:3]
  ds_read_b128 v[44:47], v10 offset:2048
  global_load_dword v30, v31, s[40:41] sc1
  v_mfma_f32_16x16x32_bf16 a[4:7], v[136:139], v[32:35], a[4:7]
  ds_read_b64_tr_b16 v[192:193], v1 offset:32768
  v_mfma_f32_16x16x32_bf16 a[4:7], v[140:143], v[36:39], a[4:7]
  v_mfma_f32_16x16x32_bf16 a[8:11], v[144:147], v[32:35], a[8:11]
  ds_read_b64_tr_b16 v[194:195], v1 offset:34816
  v_mfma_f32_16x16x32_bf16 a[8:11], v[148:151], v[36:39], a[8:11]
  buffer_load_dwordx4 v23, s[8:11], s50 offen offset:0 lds
  v_mfma_f32_16x16x32_bf16 a[12:15], v[152:155], v[32:35], a[12:15]
  v_mfma_f32_16x16x32_bf16 a[12:15], v[156:159], v[36:39], a[12:15]
  ds_read_b64_tr_b16 v[196:197], v1 offset:49152
  v_mfma_f32_16x16x32_bf16 a[16:19], v[160:163], v[32:35], a[16:19]
  v_mfma_f32_16x16x32_bf16 a[16:19], v[164:167], v[36:39], a[16:19]
  buffer_load_dwordx4 v24, s[8:11], s50 offen offset:1024 lds
  ds_read_b64_tr_b16 v[198:199], v1 offset:51200
  v_mfma_f32_16x16x32_bf16 a[20:23], v[168:171], v[32:35], a[20:23]
  v_mfma_f32_16x16x32_bf16 a[20:23], v[172:175], v[36:39], a[20:23]
  v_mfma_f32_16x16x32_bf16 a[24:27], v[176:179], v[32:35], a[24:27]
  ds_read_b64_tr_b16 v[200:201], v2 offset:32768
  v_mfma_f32_16x16x32_bf16 a[24:27], v[180:183], v[36:39], a[24:27]
  buffer_load_dwordx4 v25, s[8:11], s50 offen offset:2048 lds
  v_mfma_f32_16x16x32_bf16 a[28:31], v[184:187], v[32:35], a[28:31]
  ds_read_b64_tr_b16 v[202:203], v2 offset:34816
  v_mfma_f32_16x16x32_bf16 a[28:31], v[188:191], v[36:39], a[28:31]
  s_waitcnt lgkmcnt(6)
  s_nop 0
  v_mfma_f32_16x16x32_bf16 a[32:35], v[128:131], v[40:43], a[32:35]
  ds_read_b128 v[32:35], v9 offset:4096
  v_mfma_f32_16x16x32_bf16 a[32:35], v[132:135], v[44:47], a[32:35]
  ds_read_b128 v[36:39], v10 offset:4096
  buffer_load_dwordx4 v26, s[8:11], s50 offen offset:3072 lds
  v_mfma_f32_16x16x32_bf16 a[36:39], v[136:139], v[40:43], a[36:39]
  ds_read_b64_tr_b16 v[204:205], v2 offset:49152
  v_mfma_f32_16x16x32_bf16 a[36:39], v[140:143], v[44:47], a[36:39]
  ds_read_b64_tr_b16 v[206:207], v2 offset:51200
  v_mfma_f32_16x16x32_bf16 a[40:43], v[144:147], v[40:43], a[40:43]
  s_add_u32 s50, s50, 128
  s_add_u32 m0, s52, 65536
  v_mfma_f32_16x16x32_bf16 a[40:43], v[148:151], v[44:47], a[40:43]
  buffer_load_dwordx4 v11, s[12:15], s51 offen offset:0  lds
  v_mfma_f32_16x16x32_bf16 a[44:47], v[152:155], v[40:43], a[44:47]
  ds_read_b64_tr_b16 v[208:209], v3 offset:32768
  v_mfma_f32_16x16x32_bf16 a[44:47], v[156:159], v[44:47], a[44:47]
  v_mfma_f32_16x16x32_bf16 a[48:51], v[160:163], v[40:43], a[48:51]
  ds_read_b64_tr_b16 v[210:211], v3 offset:34816
  v_mfma_f32_16x16x32_bf16 a[48:51], v[164:167], v[44:47], a[48:51]
  buffer_load_dwordx4 v12, s[12:15], s51 offen offset:1024  lds
  v_mfma_f32_16x16x32_bf16 a[52:55], v[168:171], v[40:43], a[52:55]
  v_mfma_f32_16x16x32_bf16 a[52:55], v[172:175], v[44:47], a[52:55]
  ds_read_b64_tr_b16 v[212:213], v3 offset:49152
  v_mfma_f32_16x16x32_bf16 a[56:59], v[176:179], v[40:43], a[56:59]
  v_mfma_f32_16x16x32_bf16 a[56:59], v[180:183], v[44:47], a[56:59]
  buffer_load_dwordx4 v13, s[12:15], s51 offen offset:2048  lds
  ds_read_b64_tr_b16 v[214:215], v3 offset:51200
  v_mfma_f32_16x16x32_bf16 a[60:63], v[184:187], v[40:43], a[60:63]
  v_mfma_f32_16x16x32_bf16 a[60:63], v[188:191], v[44:47], a[60:63]
  s_waitcnt lgkmcnt(6)
  s_nop 0
  v_mfma_f32_16x16x32_bf16 a[64:67], v[128:131], v[32:35], a[64:67]
  ds_read_b128 v[40:43], v9 offset:6144
  ds_read_b64_tr_b16 v[216:217], v4 offset:32768
  v_mfma_f32_16x16x32_bf16 a[64:67], v[132:135], v[36:39], a[64:67]
  ds_read_b128 v[44:47], v10 offset:6144
  buffer_load_dwordx4 v14, s[12:15], s51 offen offset:3072  lds
  v_mfma_f32_16x16x32_bf16 a[68:71], v[136:139], v[32:35], a[68:71]
  ds_read_b64_tr_b16 v[218:219], v4 offset:34816
  v_mfma_f32_16x16x32_bf16 a[68:71], v[140:143], v[36:39], a[68:71]
  v_mfma_f32_16x16x32_bf16 a[72:75], v[144:147], v[32:35], a[72:75]
  s_add_u32 m0, s52, 69632
  v_mfma_f32_16x16x32_bf16 a[72:75], v[148:151], v[36:39], a[72:75]
  buffer_load_dwordx4 v15, s[12:15], s51 offen offset:0  lds
  ds_read_b64_tr_b16 v[220:221], v4 offset:49152
  v_mfma_f32_16x16x32_bf16 a[76:79], v[152:155], v[32:35], a[76:79]
  v_mfma_f32_16x16x32_bf16 a[76:79], v[156:159], v[36:39], a[76:79]
  ds_read_b64_tr_b16 v[222:223], v4 offset:51200
  v_mfma_f32_16x16x32_bf16 a[80:83], v[160:163], v[32:35], a[80:83]
  v_mfma_f32_16x16x32_bf16 a[80:83], v[164:167], v[36:39], a[80:83]
  buffer_load_dwordx4 v16, s[12:15], s51 offen offset:1024  lds
  v_mfma_f32_16x16x32_bf16 a[84:87], v[168:171], v[32:35], a[84:87]
  ds_read_b64_tr_b16 v[224:225], v5 offset:32768
  v_mfma_f32_16x16x32_bf16 a[84:87], v[172:175], v[36:39], a[84:87]
  v_mfma_f32_16x16x32_bf16 a[88:91], v[176:179], v[32:35], a[88:91]
  ds_read_b64_tr_b16 v[226:227], v5 offset:34816
  v_mfma_f32_16x16x32_bf16 a[88:91], v[180:183], v[36:39], a[88:91]
  buffer_load_dwordx4 v17, s[12:15], s51 offen offset:2048  lds
  v_mfma_f32_16x16x32_bf16 a[92:95], v[184:187], v[32:35], a[92:95]
  v_mfma_f32_16x16x32_bf16 a[92:95], v[188:191], v[36:39], a[92:95]
  s_waitcnt lgkmcnt(5)
  ds_read_b64_tr_b16 v[228:229], v5 offset:49152
  v_mfma_f32_16x16x32_bf16 a[96:99], v[128:131], v[40:43], a[96:99]
  s_nop 0
  ds_read_b128 v[32:35], v9 offset:8192
  v_mfma_f32_16x16x32_bf16 a[96:99], v[132:135], v[44:47], a[96:99]
  ds_read_b128 v[36:39], v10 offset:8192
  buffer_load_dwordx4 v18, s[12:15], s51 offen offset:3072  lds
  v_mfma_f32_16x16x32_bf16 a[100:103], v[136:139], v[40:43], a[100:103]
  ds_read_b64_tr_b16 v[230:231], v5 offset:51200
  v_mfma_f32_16x16x32_bf16 a[100:103], v[140:143], v[44:47], a[100:103]
  v_mfma_f32_16x16x32_bf16 a[104:107], v[144:147], v[40:43], a[104:107]
  s_add_u32 s51, s51, 524288
  ds_read_b64_tr_b16 v[232:233], v6 offset:32768
  v_mfma_f32_16x16x32_bf16 a[104:107], v[148:151], v[44:47], a[104:107]
  buffer_load_dword v29, v27, s[8:11], s50 offen offset:128
  v_mfma_f32_16x16x32_bf16 a[108:111], v[152:155], v[40:43], a[108:111]
  ds_read_b64_tr_b16 v[234:235], v6 offset:34816
  v_mfma_f32_16x16x32_bf16 a[108:111], v[156:159], v[44:47], a[108:111]
  v_mfma_f32_16x16x32_bf16 a[112:115], v[160:163], v[40:43], a[112:115]
  buffer_load_dword v29, v28, s[12:15], s51 offen
  v_mfma_f32_16x16x32_bf16 a[112:115], v[164:167], v[44:47], a[112:115]
  ds_read_b64_tr_b16 v[236:237], v6 offset:49152
  v_mfma_f32_16x16x32_bf16 a[116:119], v[168:171], v[40:43], a[116:119]
  v_mfma_f32_16x16x32_bf16 a[116:119], v[172:175], v[44:47], a[116:119]
  buffer_load_dword v29, v62, s[28:31], s36 offen
  ds_read_b64_tr_b16 v[238:239], v6 offset:51200
  v_mfma_f32_16x16x32_bf16 a[120:123], v[176:179], v[40:43], a[120:123]
  v_mfma_f32_16x16x32_bf16 a[120:123], v[180:183], v[44:47], a[120:123]
  s_add_u32 s36, s36, 622592
  v_mfma_f32_16x16x32_bf16 a[124:127], v[184:187], v[40:43], a[124:127]
  s_lshl_b32 s60, s45, 9
  s_add_u32 s33, s60, 1048576
  v_mfma_f32_16x16x32_bf16 a[124:127], v[188:191], v[44:47], a[124:127]
  s_waitcnt lgkmcnt(5)
  s_add_u32 m0, s52, 131072
  v_mfma_f32_16x16x32_bf16 a[128:131], v[128:131], v[32:35], a[128:131]
  ds_read_b128 v[40:43], v9 offset:10240
  buffer_load_dwordx4 v11, s[16:19], s33 offen offset:0  lds
  v_mfma_f32_16x16x32_bf16 a[128:131], v[132:135], v[36:39], a[128:131]
  ds_read_b128 v[44:47], v10 offset:10240
  ds_read_b64_tr_b16 v[240:241], v7 offset:32768
  v_mfma_f32_16x16x32_bf16 a[132:135], v[136:139], v[32:35], a[132:135]
  ds_read_b64_tr_b16 v[242:243], v7 offset:34816
  v_mfma_f32_16x16x32_bf16 a[132:135], v[140:143], v[36:39], a[132:135]
  ds_read_b64_tr_b16 v[244:245], v7 offset:49152
  v_mfma_f32_16x16x32_bf16 a[136:139], v[144:147], v[32:35], a[136:139]
  buffer_load_dwordx4 v12, s[16:19], s33 offen offset:1024  lds
  v_mfma_f32_16x16x32_bf16 a[136:139], v[148:151], v[36:39], a[136:139]
  ds_read_b64_tr_b16 v[246:247], v7 offset:51200
  v_mfma_f32_16x16x32_bf16 a[140:143], v[152:155], v[32:35], a[140:143]
  v_mfma_f32_16x16x32_bf16 a[140:143], v[156:159], v[36:39], a[140:143]
  v_mfma_f32_16x16x32_bf16 a[144:147], v[160:163], v[32:35], a[144:147]
  buffer_load_dwordx4 v13, s[16:19], s33 offen offset:2048  lds
  ds_read_b64_tr_b16 v[248:249], v8 offset:32768
  v_mfma_f32_16x16x32_bf16 a[144:147], v[164:167], v[36:39], a[144:147]
  v_mfma_f32_16x16x32_bf16 a[148:151], v[168:171], v[32:35], a[148:151]
  ds_read_b64_tr_b16 v[250:251], v8 offset:34816
  v_mfma_f32_16x16x32_bf16 a[148:151], v[172:175], v[36:39], a[148:151]
  v_mfma_f32_16x16x32_bf16 a[152:155], v[176:179], v[32:35], a[152:155]
  buffer_load_dwordx4 v14, s[16:19], s33 offen offset:3072  lds
  v_mfma_f32_16x16x32_bf16 a[152:155], v[180:183], v[36:39], a[152:155]
  ds_read_b64_tr_b16 v[252:253], v8 offset:49152
  v_mfma_f32_16x16x32_bf16 a[156:159], v[184:187], v[32:35], a[156:159]
  v_mfma_f32_16x16x32_bf16 a[156:159], v[188:191], v[36:39], a[156:159]
  s_waitcnt lgkmcnt(7)
  s_add_u32 m0, s52, 135168
  v_mfma_f32_16x16x32_bf16 a[160:163], v[128:131], v[40:43], a[160:163]
  ds_read_b128 v[32:35], v9 offset:12288
  buffer_load_dwordx4 v15, s[16:19], s33 offen offset:0  lds
  v_mfma_f32_16x16x32_bf16 a[160:163], v[132:135], v[44:47], a[160:163]
  ds_read_b128 v[36:39], v10 offset:12288
  ds_read_b64_tr_b16 v[254:255], v8 offset:51200
  v_mfma_f32_16x16x32_bf16 a[164:167], v[136:139], v[40:43], a[164:167]
  s_nop 0
  v_mfma_f32_16x16x32_bf16 a[164:167], v[140:143], v[44:47], a[164:167]
  v_mfma_f32_16x16x32_bf16 a[168:171], v[144:147], v[40:43], a[168:171]
  buffer_load_dwordx4 v16, s[16:19], s33 offen offset:1024  lds
  v_mfma_f32_16x16x32_bf16 a[168:171], v[148:151], v[44:47], a[168:171]
  v_mfma_f32_16x16x32_bf16 a[172:175], v[152:155], v[40:43], a[172:175]
  v_mfma_f32_16x16x32_bf16 a[172:175], v[156:159], v[44:47], a[172:175]
  v_mfma_f32_16x16x32_bf16 a[176:179], v[160:163], v[40:43], a[176:179]
  buffer_load_dwordx4 v17, s[16:19], s33 offen offset:2048  lds
  v_mfma_f32_16x16x32_bf16 a[176:179], v[164:167], v[44:47], a[176:179]
  v_mfma_f32_16x16x32_bf16 a[180:183], v[168:171], v[40:43], a[180:183]
  v_mfma_f32_16x16x32_bf16 a[180:183], v[172:175], v[44:47], a[180:183]
  v_mfma_f32_16x16x32_bf16 a[184:187], v[176:179], v[40:43], a[184:187]
  buffer_load_dwordx4 v18, s[16:19], s33 offen offset:3072  lds
  v_mfma_f32_16x16x32_bf16 a[184:187], v[180:183], v[44:47], a[184:187]
  v_mfma_f32_16x16x32_bf16 a[188:191], v[184:187], v[40:43], a[188:191]
  v_mfma_f32_16x16x32_bf16 a[188:191], v[188:191], v[44:47], a[188:191]
  s_waitcnt lgkmcnt(1)
  s_nop 0
  v_mfma_f32_16x16x32_bf16 a[192:195], v[128:131], v[32:35], a[192:195]
  ds_read_b128 v[40:43], v9 offset:14336
  v_mfma_f32_16x16x32_bf16 a[192:195], v[132:135], v[36:39], a[192:195]
  ds_read_b128 v[44:47], v10 offset:14336
  v_mfma_f32_16x16x32_bf16 a[196:199], v[136:139], v[32:35], a[196:199]
  v_mfma_f32_16x16x32_bf16 a[196:199], v[140:143], v[36:39], a[196:199]
  v_mfma_f32_16x16x32_bf16 a[200:203], v[144:147], v[32:35], a[200:203]
  v_mfma_f32_16x16x32_bf16 a[200:203], v[148:151], v[36:39], a[200:203]
  v_mfma_f32_16x16x32_bf16 a[204:207], v[152:155], v[32:35], a[204:207]
  v_mfma_f32_16x16x32_bf16 a[204:207], v[156:159], v[36:39], a[204:207]
  v_mfma_f32_16x16x32_bf16 a[208:211], v[160:163], v[32:35], a[208:211]
  v_mfma_f32_16x16x32_bf16 a[208:211], v[164:167], v[36:39], a[208:211]
  v_mfma_f32_16x16x32_bf16 a[212:215], v[168:171], v[32:35], a[212:215]
  v_mfma_f32_16x16x32_bf16 a[212:215], v[172:175], v[36:39], a[212:215]
  v_mfma_f32_16x16x32_bf16 a[216:219], v[176:179], v[32:35], a[216:219]
  v_mfma_f32_16x16x32_bf16 a[216:219], v[180:183], v[36:39], a[216:219]
  s_waitcnt vmcnt(11) lgkmcnt(0)
  s_barrier
  v_mfma_f32_16x16x32_bf16 a[220:223], v[184:187], v[32:35], a[220:223]
  s_add_u32 m0, s52, 0
  s_nop 0
  v_mfma_f32_16x16x32_bf16 a[220:223], v[188:191], v[36:39], a[220:223]
  buffer_load_dwordx4 v19, s[8:11], s50 offen offset:0 lds
  v_mfma_f32_16x16x32_bf16 a[224:227], v[128:131], v[40:43], a[224:227]
  ds_read_b128 v[32:35], v9 offset:32768
  v_mfma_f32_16x16x32_bf16 a[224:227], v[132:135], v[44:47], a[224:227]
  ds_read_b128 v[36:39], v10 offset:32768
  v_cmp_gt_u32 vcc, 16, v30
  v_mfma_f32_16x16x32_bf16 a[228:231], v[136:139], v[40:43], a[228:231]
  s_nop 0
  v_mfma_f32_16x16x32_bf16 a[228:231], v[140:143], v[44:47], a[228:231]
  buffer_load_dwordx4 v20, s[8:11], s50 offen offset:1024 lds
  v_mfma_f32_16x16x32_bf16 a[232:235], v[144:147], v[40:43], a[232:235]
  v_mfma_f32_16x16x32_bf16 a[232:235], v[148:151], v[44:47], a[232:235]
  s_cbranch_vccnz L_k1_spin0
L_k1_spinret0:
  s_nop 0
  v_mfma_f32_16x16x32_bf16 a[236:239], v[152:155], v[40:43], a[236:239]
  v_mfma_f32_16x16x32_bf16 a[236:239], v[156:159], v[44:47], a[236:239]
  buffer_load_dwordx4 v21, s[8:11], s50 offen offset:2048 lds
  v_mfma_f32_16x16x32_bf16 a[240:243], v[160:163], v[40:43], a[240:243]
  v_mfma_f32_16x16x32_bf16 a[240:243], v[164:167], v[44:47], a[240:243]
  v_mfma_f32_16x16x32_bf16 a[244:247], v[168:171], v[40:43], a[244:247]
  v_mfma_f32_16x16x32_bf16 a[244:247], v[172:175], v[44:47], a[244:247]
  buffer_load_dwordx4 v22, s[8:11], s50 offen offset:3072 lds
  v_mfma_f32_16x16x32_bf16 a[248:251], v[176:179], v[40:43], a[248:251]
  v_mfma_f32_16x16x32_bf16 a[248:251], v[180:183], v[44:47], a[248:251]
  v_mfma_f32_16x16x32_bf16 a[252:255], v[184:187], v[40:43], a[252:255]
  s_add_u32 m0, s52, 4096
  v_mfma_f32_16x16x32_bf16 a[252:255], v[188:191], v[44:47], a[252:255]
  s_waitcnt lgkmcnt(0)
  s_nop 0
  v_mfma_f32_16x16x32_bf16 a[0:3], v[192:195], v[32:35], a[0:3]
  ds_read_b128 v[40:43], v9 offset:34816
  v_mfma_f32_16x16x32_bf16 a[0:3], v[196:199], v[36:39], a[0:3]
  ds_read_b128 v[44:47], v10 offset:34816
  buffer_load_dwordx4 v23, s[8:11], s50 offen offset:0 lds
  v_mfma_f32_16x16x32_bf16 a[4:7], v[200:203], v[32:35], a[4:7]
  ds_read_b64_tr_b16 v[128:129], v1 offset:0
  v_mfma_f32_16x16x32_bf16 a[4:7], v[204:207], v[36:39], a[4:7]
  v_mfma_f32_16x16x32_bf16 a[8:11], v[208:211], v[32:35], a[8:11]
  ds_read_b64_tr_b16 v[130:131], v1 offset:2048
  v_mfma_f32_16x16x32_bf16 a[8:11], v[212:215], v[36:39], a[8:11]
  buffer_load_dwordx4 v24, s[8:11], s50 offen offset:1024 lds
  v_mfma_f32_16x16x32_bf16 a[12:15], v[216:219], v[32:35], a[12:15]
  v_mfma_f32_16x16x32_bf16 a[12:15], v[220:223], v[36:39], a[12:15]
  ds_read_b64_tr_b16 v[132:133], v1 offset:16384
  v_mfma_f32_16x16x32_bf16 a[16:19], v[224:227], v[32:35], a[16:19]
  v_mfma_f32_16x16x32_bf16 a[16:19], v[228:231], v[36:39], a[16:19]
  buffer_load_dwordx4 v25, s[8:11], s50 offen offset:2048 lds
  ds_read_b64_tr_b16 v[134:135], v1 offset:18432
  v_mfma_f32_16x16x32_bf16 a[20:23], v[232:235], v[32:35], a[20:23]
  v_mfma_f32_16x16x32_bf16 a[20:23], v[236:239], v[36:39], a[20:23]
  v_mfma_f32_16x16x32_bf16 a[24:27], v[240:243], v[32:35], a[24:27]
  ds_read_b64_tr_b16 v[136:137], v2 offset:0
  v_mfma_f32_16x16x32_bf16 a[24:27], v[244:247], v[36:39], a[24:27]
  buffer_load_dwordx4 v26, s[8:11], s50 offen offset:3072 lds
  v_mfma_f32_16x16x32_bf16 a[28:31], v[248:251], v[32:35], a[28:31]
  ds_read_b64_tr_b16 v[138:139], v2 offset:2048
  v_mfma_f32_16x16x32_bf16 a[28:31], v[252:255], v[36:39], a[28:31]
  s_waitcnt lgkmcnt(6)
  s_nop 0
  v_mfma_f32_16x16x32_bf16 a[32:35], v[192:195], v[40:43], a[32:35]
  ds_read_b128 v[32:35], v9 offset:36864
  s_add_u32 s50, s50, 128
  v_mfma_f32_16x16x32_bf16 a[32:35], v[196:199], v[44:47], a[32:35]
  ds_read_b128 v[36:39], v10 offset:36864
  s_add_u32 m0, s52, 98304
  v_mfma_f32_16x16x32_bf16 a[36:39], v[200:203], v[40:43], a[36:39]
  buffer_load_dwordx4 v11, s[12:15], s51 offen offset:0  lds
  ds_read_b64_tr_b16 v[140:141], v2 offset:16384
  v_mfma_f32_16x16x32_bf16 a[36:39], v[204:207], v[44:47], a[36:39]
  ds_read_b64_tr_b16 v[142:143], v2 offset:18432
  v_mfma_f32_16x16x32_bf16 a[40:43], v[208:211], v[40:43], a[40:43]
  v_mfma_f32_16x16x32_bf16 a[40:43], v[212:215], v[44:47], a[40:43]
  v_mfma_f32_16x16x32_bf16 a[44:47], v[216:219], v[40:43], a[44:47]
  buffer_load_dwordx4 v12, s[12:15], s51 offen offset:1024  lds
  ds_read_b64_tr_b16 v[144:145], v3 offset:0
  v_mfma_f32_16x16x32_bf16 a[44:47], v[220:223], v[44:47], a[44:47]
  v_mfma_f32_16x16x32_bf16 a[48:51], v[224:227], v[40:43], a[48:51]
  ds_read_b64_tr_b16 v[146:147], v3 offset:2048
  v_mfma_f32_16x16x32_bf16 a[48:51], v[228:231], v[44:47], a[48:51]
  v_mfma_f32_16x16x32_bf16 a[52:55], v[232:235], v[40:43], a[52:55]
  buffer_load_dwordx4 v13, s[12:15], s51 offen offset:2048  lds
  v_mfma_f32_16x16x32_bf16 a[52:55], v[236:239], v[44:47], a[52:55]
  ds_read_b64_tr_b16 v[148:149], v3 offset:16384
  v_mfma_f32_16x16x32_bf16 a[56:59], v[240:243], v[40:43], a[56:59]
  v_mfma_f32_16x16x32_bf16 a[56:59], v[244:247], v[44:47], a[56:59]
  ds_read_b64_tr_b16 v[150:151], v3 offset:18432
  v_mfma_f32_16x16x32_bf16 a[60:63], v[248:251], v[40:43], a[60:63]
  buffer_load_dwordx4 v14, s[12:15], s51 offen offset:3072  lds
  v_mfma_f32_16x16x32_bf16 a[60:63], v[252:255], v[44:47], a[60:63]
  s_waitcnt lgkmcnt(6)
  s_nop 0
  v_mfma_f32_16x16x32_bf16 a[64:67], v[192:195], v[32:35], a[64:67]
  ds_read_b128 v[40:43], v9 offset:38912
  ds_read_b64_tr_b16 v[152:153], v4 offset:0
  v_mfma_f32_16x16x32_bf16 a[64:67], v[196:199], v[36:39], a[64:67]
  ds_read_b128 v[44:47], v10 offset:38912
  s_add_u32 m0, s52, 102400
  v_mfma_f32_16x16x32_bf16 a[68:71], v[200:203], v[32:35], a[68:71]
  buffer_load_dwordx4 v15, s[12:15], s51 offen offset:0  lds
  ds_read_b64_tr_b16 v[154:155], v4 offset:2048
  v_mfma_f32_16x16x32_bf16 a[68:71], v[204:207], v[36:39], a[68:71]
  v_mfma_f32_16x16x32_bf16 a[72:75], v[208:211], v[32:35], a[72:75]
  v_mfma_f32_16x16x32_bf16 a[72:75], v[212:215], v[36:39], a[72:75]
  ds_read_b64_tr_b16 v[156:157], v4 offset:16384
  v_mfma_f32_16x16x32_bf16 a[76:79], v[216:219], v[32:35], a[76:79]
  buffer_load_dwordx4 v16, s[12:15], s51 offen offset:1024  lds
  v_mfma_f32_16x16x32_bf16 a[76:79], v[220:223], v[36:39], a[76:79]
  ds_read_b64_tr_b16 v[158:159], v4 offset:18432
  v_mfma_f32_16x16x32_bf16 a[80:83], v[224:227], v[32:35], a[80:83]
  v_mfma_f32_16x16x32_bf16 a[80:83], v[228:231], v[36:39], a[80:83]
  v_mfma_f32_16x16x32_bf16 a[84:87], v[232:235], v[32:35], a[84:87]
  buffer_load_dwordx4 v17, s[12:15], s51 offen offset:2048  lds
  ds_read_b64_tr_b16 v[160:161], v5 offset:0
  v_mfma_f32_16x16x32_bf16 a[84:87], v[236:239], v[36:39], a[84:87]
  v_mfma_f32_16x16x32_bf16 a[88:91], v[240:243], v[32:35], a[88:91]
  ds_read_b64_tr_b16 v[162:163], v5 offset:2048
  v_mfma_f32_16x16x32_bf16 a[88:91], v[244:247], v[36:39], a[88:91]
  v_mfma_f32_16x16x32_bf16 a[92:95], v[248:251], v[32:35], a[92:95]
  buffer_load_dwordx4 v18, s[12:15], s51 offen offset:3072  lds
  v_mfma_f32_16x16x32_bf16 a[92:95], v[252:255], v[36:39], a[92:95]
  s_waitcnt lgkmcnt(5)
  ds_read_b64_tr_b16 v[164:165], v5 offset:16384
  v_mfma_f32_16x16x32_bf16 a[96:99], v[192:195], v[40:43], a[96:99]
  s_nop 0
  ds_read_b128 v[32:35], v9 offset:40960
  v_mfma_f32_16x16x32_bf16 a[96:99], v[196:199], v[44:47], a[96:99]
  ds_read_b128 v[36:39], v10 offset:40960
  s_add_u32 s51, s51, 524288
  v_mfma_f32_16x16x32_bf16 a[100:103], v[200:203], v[40:43], a[100:103]
  buffer_load_dword v29, v27, s[8:11], s50 offen offset:128
  ds_read_b64_tr_b16 v[166:167], v5 offset:18432
  v_mfma_f32_16x16x32_bf16 a[100:103], v[204:207], v[44:47], a[100:103]
  v_mfma_f32_16x16x32_bf16 a[104:107], v[208:211], v[40:43], a[104:107]
  ds_read_b64_tr_b16 v[168:169], v6 offset:0
  v_mfma_f32_16x16x32_bf16 a[104:107], v[212:215], v[44:47], a[104:107]
  buffer_load_dword v29, v62, s[28:31], s36 offen
  v_mfma_f32_16x16x32_bf16 a[108:111], v[216:219], v[40:43], a[108:111]
  ds_read_b64_tr_b16 v[170:171], v6 offset:2048
  v_mfma_f32_16x16x32_bf16 a[108:111], v[220:223], v[44:47], a[108:111]
  s_add_u32 s36, s36, 622592
  v_mfma_f32_16x16x32_bf16 a[112:115], v[224:227], v[40:43], a[112:115]
  buffer_load_dwordx4 v[48:51], v0, s[20:23], s34 offen offset:0 sc1
  v_mfma_f32_16x16x32_bf16 a[112:115], v[228:231], v[44:47], a[112:115]
  ds_read_b64_tr_b16 v[172:173], v6 offset:16384
  v_mfma_f32_16x16x32_bf16 a[116:119], v[232:235], v[40:43], a[116:119]
  v_mfma_f32_16x16x32_bf16 a[116:119], v[236:239], v[44:47], a[116:119]
  ds_read_b64_tr_b16 v[174:175], v6 offset:18432
  v_mfma_f32_16x16x32_bf16 a[120:123], v[240:243], v[40:43], a[120:123]
  buffer_load_dwordx4 v[52:55], v0, s[20:23], s34 offen offset:1024 sc1
  v_mfma_f32_16x16x32_bf16 a[120:123], v[244:247], v[44:47], a[120:123]
  v_mfma_f32_16x16x32_bf16 a[124:127], v[248:251], v[40:43], a[124:127]
  ds_read_b64_tr_b16 v[176:177], v7 offset:0
  v_mfma_f32_16x16x32_bf16 a[124:127], v[252:255], v[44:47], a[124:127]
  s_waitcnt lgkmcnt(6)
  s_nop 0
  v_mfma_f32_16x16x32_bf16 a[128:131], v[192:195], v[32:35], a[128:131]
  ds_read_b128 v[40:43], v9 offset:43008
  buffer_load_dwordx4 v[56:59], v0, s[20:23], s35 offen offset:0 sc1
  v_mfma_f32_16x16x32_bf16 a[128:131], v[196:199], v[36:39], a[128:131]
  ds_read_b128 v[44:47], v10 offset:43008
  ds_read_b64_tr_b16 v[178:179], v7 offset:2048
  v_mfma_f32_16x16x32_bf16 a[132:135], v[200:203], v[32:35], a[132:135]
  v_mfma_f32_16x16x32_bf16 a[132:135], v[204:207], v[36:39], a[132:135]
  ds_read_b64_tr_b16 v[180:181], v7 offset:16384
  v_mfma_f32_16x16x32_bf16 a[136:139], v[208:211], v[32:35], a[136:139]
  buffer_load_dwordx4 v[60:63], v0, s[20:23], s35 offen offset:1024 sc1
  v_mfma_f32_16x16x32_bf16 a[136:139], v[212:215], v[36:39], a[136:139]
  ds_read_b64_tr_b16 v[182:183], v7 offset:18432
  v_mfma_f32_16x16x32_bf16 a[140:143], v[216:219], v[32:35], a[140:143]
  v_mfma_f32_16x16x32_bf16 a[140:143], v[220:223], v[36:39], a[140:143]
  v_mfma_f32_16x16x32_bf16 a[144:147], v[224:227], v[32:35], a[144:147]
  buffer_load_dwordx4 v[64:67], v0, s[20:23], s34 offen offset:2048 sc1
  ds_read_b64_tr_b16 v[184:185], v8 offset:0
  v_mfma_f32_16x16x32_bf16 a[144:147], v[228:231], v[36:39], a[144:147]
  v_mfma_f32_16x16x32_bf16 a[148:151], v[232:235], v[32:35], a[148:151]
  ds_read_b64_tr_b16 v[186:187], v8 offset:2048
  v_mfma_f32_16x16x32_bf16 a[148:151], v[236:239], v[36:39], a[148:151]
  v_mfma_f32_16x16x32_bf16 a[152:155], v[240:243], v[32:35], a[152:155]
  buffer_load_dwordx4 v[68:71], v0, s[20:23], s34 offen offset:3072 sc1
  v_mfma_f32_16x16x32_bf16 a[152:155], v[244:247], v[36:39], a[152:155]
  ds_read_b64_tr_b16 v[188:189], v8 offset:16384
  v_mfma_f32_16x16x32_bf16 a[156:159], v[248:251], v[32:35], a[156:159]
  v_mfma_f32_16x16x32_bf16 a[156:159], v[252:255], v[36:39], a[156:159]
  s_waitcnt lgkmcnt(6)
  s_nop 0
  v_mfma_f32_16x16x32_bf16 a[160:163], v[192:195], v[40:43], a[160:163]
  ds_read_b128 v[32:35], v9 offset:45056
  buffer_load_dwordx4 v[72:75], v0, s[20:23], s35 offen offset:2048 sc1
  v_mfma_f32_16x16x32_bf16 a[160:163], v[196:199], v[44:47], a[160:163]
  ds_read_b128 v[36:39], v10 offset:45056
  ds_read_b64_tr_b16 v[190:191], v8 offset:18432
  v_mfma_f32_16x16x32_bf16 a[164:167], v[200:203], v[40:43], a[164:167]
  v_mfma_f32_16x16x32_bf16 a[164:167], v[204:207], v[44:47], a[164:167]
  v_mfma_f32_16x16x32_bf16 a[168:171], v[208:211], v[40:43], a[168:171]
  buffer_load_dwordx4 v[76:79], v0, s[20:23], s35 offen offset:3072 sc1
  v_mfma_f32_16x16x32_bf16 a[168:171], v[212:215], v[44:47], a[168:171]
  v_mfma_f32_16x16x32_bf16 a[172:175], v[216:219], v[40:43], a[172:175]
  v_mfma_f32_16x16x32_bf16 a[172:175], v[220:223], v[44:47], a[172:175]
  s_add_u32 s34, s34, 4096
  s_add_u32 s35, s35, 4096
  v_mfma_f32_16x16x32_bf16 a[176:179], v[224:227], v[40:43], a[176:179]
  buffer_load_dwordx4 v[80:83], v0, s[20:23], s34 offen offset:0 sc1
  v_mfma_f32_16x16x32_bf16 a[176:179], v[228:231], v[44:47], a[176:179]
  v_mfma_f32_16x16x32_bf16 a[180:183], v[232:235], v[40:43], a[180:183]
  v_mfma_f32_16x16x32_bf16 a[180:183], v[236:239], v[44:47], a[180:183]
  v_mfma_f32_16x16x32_bf16 a[184:187], v[240:243], v[40:43], a[184:187]
  buffer_load_dwordx4 v[84:87], v0, s[20:23], s34 offen offset:1024 sc1
  v_mfma_f32_16x16x32_bf16 a[184:187], v[244:247], v[44:47], a[184:187]
  v_mfma_f32_16x16x32_bf16 a[188:191], v[248:251], v[40:43], a[188:191]
  v_mfma_f32_16x16x32_bf16 a[188:191], v[252:255], v[44:47], a[188:191]
  s_waitcnt lgkmcnt(1)
  s_nop 0
  v_mfma_f32_16x16x32_bf16 a[192:195], v[192:195], v[32:35], a[192:195]
  ds_read_b128 v[40:43], v9 offset:47104
  buffer_load_dwordx4 v[88:91], v0, s[20:23], s35 offen offset:0 sc1
  v_mfma_f32_16x16x32_bf16 a[192:195], v[196:199], v[36:39], a[192:195]
  ds_read_b128 v[44:47], v10 offset:47104
  v_mfma_f32_16x16x32_bf16 a[196:199], v[200:203], v[32:35], a[196:199]
  v_mfma_f32_16x16x32_bf16 a[196:199], v[204:207], v[36:39], a[196:199]
  v_mfma_f32_16x16x32_bf16 a[200:203], v[208:211], v[32:35], a[200:203]
  buffer_load_dwordx4 v[92:95], v0, s[20:23], s35 offen offset:1024 sc1
  v_mfma_f32_16x16x32_bf16 a[200:203], v[212:215], v[36:39], a[200:203]
  v_mfma_f32_16x16x32_bf16 a[204:207], v[216:219], v[32:35], a[204:207]
  v_mfma_f32_16x16x32_bf16 a[204:207], v[220:223], v[36:39], a[204:207]
  v_mfma_f32_16x16x32_bf16 a[208:211], v[224:227], v[32:35], a[208:211]
  v_mfma_f32_16x16x32_bf16 a[208:211], v[228:231], v[36:39], a[208:211]
  v_mfma_f32_16x16x32_bf16 a[212:215], v[232:235], v[32:35], a[212:215]
  v_mfma_f32_16x16x32_bf16 a[212:215], v[236:239], v[36:39], a[212:215]
  v_mfma_f32_16x16x32_bf16 a[216:219], v[240:243], v[32:35], a[216:219]
  v_mfma_f32_16x16x32_bf16 a[216:219], v[244:247], v[36:39], a[216:219]
  s_waitcnt vmcnt(14) lgkmcnt(0)
  s_barrier
  v_mfma_f32_16x16x32_bf16 a[220:223], v[248:251], v[32:35], a[220:223]
  s_add_u32 m0, s52, 32768
  v_mfma_f32_16x16x32_bf16 a[220:223], v[252:255], v[36:39], a[220:223]
  buffer_load_dwordx4 v19, s[8:11], s50 offen offset:0 lds
  v_mfma_f32_16x16x32_bf16 a[224:227], v[192:195], v[40:43], a[224:227]
  ds_read_b128 v[32:35], v9 offset:0
  v_mfma_f32_16x16x32_bf16 a[224:227], v[196:199], v[44:47], a[224:227]
  ds_read_b128 v[36:39], v10 offset:0
  v_mfma_f32_16x16x32_bf16 a[228:231], v[200:203], v[40:43], a[228:231]
  v_mfma_f32_16x16x32_bf16 a[228:231], v[204:207], v[44:47], a[228:231]
  buffer_load_dwordx4 v20, s[8:11], s50 offen offset:1024 lds
  v_mfma_f32_16x16x32_bf16 a[232:235], v[208:211], v[40:43], a[232:235]
  v_mfma_f32_16x16x32_bf16 a[232:235], v[212:215], v[44:47], a[232:235]
  v_mfma_f32_16x16x32_bf16 a[236:239], v[216:219], v[40:43], a[236:239]
  v_mfma_f32_16x16x32_bf16 a[236:239], v[220:223], v[44:47], a[236:239]
  buffer_load_dwordx4 v21, s[8:11], s50 offen offset:2048 lds
  v_mfma_f32_16x16x32_bf16 a[240:243], v[224:227], v[40:43], a[240:243]
  v_mfma_f32_16x16x32_bf16 a[240:243], v[228:231], v[44:47], a[240:243]
  v_mfma_f32_16x16x32_bf16 a[244:247], v[232:235], v[40:43], a[244:247]
  v_mfma_f32_16x16x32_bf16 a[244:247], v[236:239], v[44:47], a[244:247]
  buffer_load_dwordx4 v22, s[8:11], s50 offen offset:3072 lds
  v_mfma_f32_16x16x32_bf16 a[248:251], v[240:243], v[40:43], a[248:251]
  v_mfma_f32_16x16x32_bf16 a[248:251], v[244:247], v[44:47], a[248:251]
  v_mfma_f32_16x16x32_bf16 a[252:255], v[248:251], v[40:43], a[252:255]
  s_add_u32 m0, s52, 36864
  v_mfma_f32_16x16x32_bf16 a[252:255], v[252:255], v[44:47], a[252:255]
  s_waitcnt lgkmcnt(0)
  s_nop 0
  v_mfma_f32_16x16x32_bf16 a[0:3], v[128:131], v[32:35], a[0:3]
  ds_read_b128 v[40:43], v9 offset:2048
  v_mfma_f32_16x16x32_bf16 a[0:3], v[132:135], v[36:39], a[0:3]
  ds_read_b128 v[44:47], v10 offset:2048
  ds_read_b64_tr_b16 v[192:193], v1 offset:32768
  v_mfma_f32_16x16x32_bf16 a[4:7], v[136:139], v[32:35], a[4:7]
  ds_read_b64_tr_b16 v[194:195], v1 offset:34816
  buffer_load_dwordx4 v23, s[8:11], s50 offen offset:0 lds
  v_mfma_f32_16x16x32_bf16 a[4:7], v[140:143], v[36:39], a[4:7]
  ds_read_b64_tr_b16 v[196:197], v1 offset:49152
  v_mfma_f32_16x16x32_bf16 a[8:11], v[144:147], v[32:35], a[8:11]
  ds_read_b64_tr_b16 v[198:199], v1 offset:51200
  v_mfma_f32_16x16x32_bf16 a[8:11], v[148:151], v[36:39], a[8:11]
  ds_read_b64_tr_b16 v[200:201], v2 offset:32768
  v_mfma_f32_16x16x32_bf16 a[12:15], v[152:155], v[32:35], a[12:15]
  ds_read_b64_tr_b16 v[202:203], v2 offset:34816
  buffer_load_dwordx4 v24, s[8:11], s50 offen offset:1024 lds
  v_mfma_f32_16x16x32_bf16 a[12:15], v[156:159], v[36:39], a[12:15]
  ds_read_b64_tr_b16 v[204:205], v2 offset:49152
  v_mfma_f32_16x16x32_bf16 a[16:19], v[160:163], v[32:35], a[16:19]
  ds_read_b64_tr_b16 v[206:207], v2 offset:51200
  v_mfma_f32_16x16x32_bf16 a[16:19], v[164:167], v[36:39], a[16:19]
  ds_read_b64_tr_b16 v[208:209], v3 offset:32768
  v_mfma_f32_16x16x32_bf16 a[20:23], v[168:171], v[32:35], a[20:23]
  ds_read_b64_tr_b16 v[210:211], v3 offset:34816
  buffer_load_dwordx4 v25, s[8:11], s50 offen offset:2048 lds
  v_mfma_f32_16x16x32_bf16 a[20:23], v[172:175], v[36:39], a[20:23]
  ds_read_b64_tr_b16 v[212:213], v3 offset:49152
  v_mfma_f32_16x16x32_bf16 a[24:27], v[176:179], v[32:35], a[24:27]
  ds_read_b64_tr_b16 v[214:215], v3 offset:51200
  v_mfma_f32_16x16x32_bf16 a[24:27], v[180:183], v[36:39], a[24:27]
  ds_read_b64_tr_b16 v[216:217], v4 offset:32768
  v_mfma_f32_16x16x32_bf16 a[28:31], v[184:187], v[32:35], a[28:31]
  ds_read_b64_tr_b16 v[218:219], v4 offset:34816
  buffer_load_dwordx4 v26, s[8:11], s50 offen offset:3072 lds
  v_mfma_f32_16x16x32_bf16 a[28:31], v[188:191], v[36:39], a[28:31]
  s_waitcnt lgkmcnt(14)
  ds_read_b64_tr_b16 v[220:221], v4 offset:49152
  v_mfma_f32_16x16x32_bf16 a[32:35], v[128:131], v[40:43], a[32:35]
  s_nop 0
  ds_read_b64_tr_b16 v[222:223], v4 offset:51200
  v_mfma_f32_16x16x32_bf16 a[32:35], v[132:135], v[44:47], a[32:35]
  s_add_u32 s50, s50, 128
  s_add_u32 s33, s60, 0
  v_mfma_f32_16x16x32_bf16 a[36:39], v[136:139], v[40:43], a[36:39]
  ds_read_b64_tr_b16 v[224:225], v5 offset:32768
  s_add_u32 m0, s52, 65536
  v_mfma_f32_16x16x32_bf16 a[36:39], v[140:143], v[44:47], a[36:39]
  s_waitcnt vmcnt(4)
  s_barrier
  v_mfma_f32_16x16x32_bf16 a[40:43], v[144:147], v[40:43], a[40:43]
  ds_read_b128 v[32:35], v9 offset:32768
  ds_read_b64_tr_b16 v[226:227], v5 offset:34816
  v_mfma_f32_16x16x32_bf16 a[40:43], v[148:151], v[44:47], a[40:43]
  ds_read_b128 v[36:39], v10 offset:32768
  ds_read_b64_tr_b16 v[228:229], v5 offset:49152
  v_mfma_f32_16x16x32_bf16 a[44:47], v[152:155], v[40:43], a[44:47]
  ds_read_b64_tr_b16 v[230:231], v5 offset:51200
  ds_read_b64_tr_b16 v[232:233], v6 offset:32768
  v_mfma_f32_16x16x32_bf16 a[44:47], v[156:159], v[44:47], a[44:47]
  ds_read_b64_tr_b16 v[234:235], v6 offset:34816
  buffer_load_dwordx4 v11, s[16:19], s33 offen offset:0  lds
  v_mfma_f32_16x16x32_bf16 a[48:51], v[160:163], v[40:43], a[48:51]
  s_nop 0
  ds_read_b64_tr_b16 v[236:237], v6 offset:49152
  v_mfma_f32_16x16x32_bf16 a[48:51], v[164:167], v[44:47], a[48:51]
  ds_read_b64_tr_b16 v[238:239], v6 offset:51200
  v_mfma_f32_16x16x32_bf16 a[52:55], v[168:171], v[40:43], a[52:55]
  ds_read_b64_tr_b16 v[240:241], v7 offset:32768
  v_mfma_f32_16x16x32_bf16 a[52:55], v[172:175], v[44:47], a[52:55]
  ds_read_b64_tr_b16 v[242:243], v7 offset:34816
  buffer_load_dwordx4 v12, s[16:19], s33 offen offset:1024  lds
  v_mfma_f32_16x16x32_bf16 a[56:59], v[176:179], v[40:43], a[56:59]
  ds_read_b64_tr_b16 v[244:245], v7 offset:49152
  v_mfma_f32_16x16x32_bf16 a[56:59], v[180:183], v[44:47], a[56:59]
  ds_read_b64_tr_b16 v[246:247], v7 offset:51200
  v_mfma_f32_16x16x32_bf16 a[60:63], v[184:187], v[40:43], a[60:63]
  ds_read_b64_tr_b16 v[248:249], v8 offset:32768
  v_mfma_f32_16x16x32_bf16 a[60:63], v[188:191], v[44:47], a[60:63]
  s_waitcnt lgkmcnt(11)
  ds_read_b64_tr_b16 v[250:251], v8 offset:34816
  v_mfma_f32_16x16x32_bf16 a[0:3], v[192:195], v[32:35], a[0:3]
  ds_read_b128 v[40:43], v9 offset:34816
  ds_read_b64_tr_b16 v[252:253], v8 offset:49152
  v_mfma_f32_16x16x32_bf16 a[0:3], v[196:199], v[36:39], a[0:3]
  ds_read_b128 v[44:47], v10 offset:34816
  buffer_load_dwordx4 v13, s[16:19], s33 offen offset:2048  lds
  v_mfma_f32_16x16x32_bf16 a[4:7], v[200:203], v[32:35], a[4:7]
  s_nop 0
  ds_read_b64_tr_b16 v[254:255], v8 offset:51200
  v_mfma_f32_16x16x32_bf16 a[4:7], v[204:207], v[36:39], a[4:7]
  s_waitcnt lgkmcnt(15)
  s_nop 0
  v_mfma_f32_16x16x32_bf16 a[8:11], v[208:211], v[32:35], a[8:11]
  v_mfma_f32_16x16x32_bf16 a[8:11], v[212:215], v[36:39], a[8:11]
  buffer_load_dwordx4 v14, s[16:19], s33 offen offset:3072  lds
  v_mfma_f32_16x16x32_bf16 a[12:15], v[216:219], v[32:35], a[12:15]
  v_mfma_f32_16x16x32_bf16 a[12:15], v[220:223], v[36:39], a[12:15]
  s_waitcnt lgkmcnt(10)
  s_nop 0
  v_mfma_f32_16x16x32_bf16 a[16:19], v[224:227], v[32:35], a[16:19]
  s_add_u32 m0, s52, 69632
  v_mfma_f32_16x16x32_bf16 a[16:19], v[228:231], v[36:39], a[16:19]
  buffer_load_dwordx4 v15, s[16:19], s33 offen offset:0  lds
  v_mfma_f32_16x16x32_bf16 a[20:23], v[232:235], v[32:35], a[20:23]
  v_mfma_f32_16x16x32_bf16 a[20:23], v[236:239], v[36:39], a[20:23]
  s_waitcnt lgkmcnt(0)
  s_nop 0
  v_mfma_f32_16x16x32_bf16 a[24:27], v[240:243], v[32:35], a[24:27]
  v_mfma_f32_16x16x32_bf16 a[24:27], v[244:247], v[36:39], a[24:27]
  buffer_load_dwordx4 v16, s[16:19], s33 offen offset:1024  lds
  v_mfma_f32_16x16x32_bf16 a[28:31], v[248:251], v[32:35], a[28:31]
  v_mfma_f32_16x16x32_bf16 a[28:31], v[252:255], v[36:39], a[28:31]
  s_barrier
  s_waitcnt lgkmcnt(15)
  v_mfma_f32_16x16x32_bf16 a[32:35], v[192:195], v[40:43], a[32:35]
  ds_read_b128 v[32:35], v9 offset:4096
  v_subrev_u32_e64 v1, s7, v1
  v_mfma_f32_16x16x32_bf16 a[32:35], v[196:199], v[44:47], a[32:35]
  ds_read_b128 v[36:39], v10 offset:4096
  buffer_load_dwordx4 v17, s[16:19], s33 offen offset:2048  lds
  v_mfma_f32_16x16x32_bf16 a[36:39], v[200:203], v[40:43], a[36:39]
  v_subrev_u32_e64 v2, s7, v2
  v_mfma_f32_16x16x32_bf16 a[36:39], v[204:207], v[44:47], a[36:39]
  v_mfma_f32_16x16x32_bf16 a[40:43], v[208:211], v[40:43], a[40:43]
  v_subrev_u32_e64 v3, s7, v3
  v_mfma_f32_16x16x32_bf16 a[40:43], v[212:215], v[44:47], a[40:43]
  buffer_load_dwordx4 v18, s[16:19], s33 offen offset:3072  lds
  v_mfma_f32_16x16x32_bf16 a[44:47], v[216:219], v[40:43], a[44:47]
  v_subrev_u32_e64 v4, s7, v4
  v_mfma_f32_16x16x32_bf16 a[44:47], v[220:223], v[44:47], a[44:47]
  v_mfma_f32_16x16x32_bf16 a[48:51], v[224:227], v[40:43], a[48:51]
  v_subrev_u32_e64 v5, s7, v5
  v_mfma_f32_16x16x32_bf16 a[48:51], v[228:231], v[44:47], a[48:51]
  s_add_u32 s33, s60, 524288
  s_add_u32 m0, s52, 98304
  v_mfma_f32_16x16x32_bf16 a[52:55], v[232:235], v[40:43], a[52:55]
  buffer_load_dwordx4 v11, s[16:19], s33 offen offset:0  lds
  v_subrev_u32_e64 v6, s7, v6
  v_mfma_f32_16x16x32_bf16 a[52:55], v[236:239], v[44:47], a[52:55]
  v_mfma_f32_16x16x32_bf16 a[56:59], v[240:243], v[40:43], a[56:59]
  v_subrev_u32_e64 v7, s7, v7
  v_mfma_f32_16x16x32_bf16 a[56:59], v[244:247], v[44:47], a[56:59]
  v_mfma_f32_16x16x32_bf16 a[60:63], v[248:251], v[40:43], a[60:63]
  v_subrev_u32_e64 v8, s7, v8
  v_mfma_f32_16x16x32_bf16 a[60:63], v[252:255], v[44:47], a[60:63]
  s_waitcnt lgkmcnt(0)
  buffer_load_dwordx4 v12, s[16:19], s33 offen offset:1024  lds
  v_mfma_f32_16x16x32_bf16 a[64:67], v[128:131], v[32:35], a[64:67]
  s_nop 0
  ds_read_b128 v[40:43], v9 offset:6144
  v_mfma_f32_16x16x32_bf16 a[64:67], v[132:135], v[36:39], a[64:67]
  ds_read_b128 v[44:47], v10 offset:6144
  v_mfma_f32_16x16x32_bf16 a[68:71], v[136:139], v[32:35], a[68:71]
  v_mfma_f32_16x16x32_bf16 a[68:71], v[140:143], v[36:39], a[68:71]
  v_mfma_f32_16x16x32_bf16 a[72:75], v[144:147], v[32:35], a[72:75]
  buffer_load_dwordx4 v13, s[16:19], s33 offen offset:2048  lds
  v_mfma_f32_16x16x32_bf16 a[72:75], v[148:151], v[36:39], a[72:75]
  v_accvgpr_read_b32 v96, a0
  v_accvgpr_read_b32 v97, a1
  v_mfma_f32_16x16x32_bf16 a[76:79], v[152:155], v[32:35], a[76:79]
  v_accvgpr_read_b32 v98, a2
  v_accvgpr_read_b32 v99, a3
  v_mfma_f32_16x16x32_bf16 a[76:79], v[156:159], v[36:39], a[76:79]
  v_accvgpr_read_b32 v100, a4
  v_accvgpr_read_b32 v101, a5
  v_mfma_f32_16x16x32_bf16 a[80:83], v[160:163], v[32:35], a[80:83]
  v_accvgpr_read_b32 v102, a6
  v_accvgpr_read_b32 v103, a7
  v_mfma_f32_16x16x32_bf16 a[80:83], v[164:167], v[36:39], a[80:83]
  buffer_load_dwordx4 v14, s[16:19], s33 offen offset:3072  lds
  v_cvt_pk_bf16_f32 v96, v96, v97
  v_mfma_f32_16x16x32_bf16 a[84:87], v[168:171], v[32:35], a[84:87]
  v_cvt_pk_bf16_f32 v97, v98, v99
  v_cvt_pk_bf16_f32 v98, v100, v101
  v_mfma_f32_16x16x32_bf16 a[84:87], v[172:175], v[36:39], a[84:87]
  v_cvt_pk_bf16_f32 v99, v102, v103
  buffer_store_dwordx4 v[96:99], v0, s[20:23], s55 offen offset:0 sc1
  v_mfma_f32_16x16x32_bf16 a[88:91], v[176:179], v[32:35], a[88:91]
  v_mfma_f32_16x16x32_bf16 a[88:91], v[180:183], v[36:39], a[88:91]
  s_add_u32 m0, s52, 102400
  v_mfma_f32_16x16x32_bf16 a[92:95], v[184:187], v[32:35], a[92:95]
  buffer_load_dwordx4 v15, s[16:19], s33 offen offset:0  lds
  v_mfma_f32_16x16x32_bf16 a[92:95], v[188:191], v[36:39], a[92:95]
  s_waitcnt lgkmcnt(0)
  s_nop 0
  v_mfma_f32_16x16x32_bf16 a[96:99], v[128:131], v[40:43], a[96:99]
  ds_read_b128 v[32:35], v9 offset:8192
  v_mfma_f32_16x16x32_bf16 a[96:99], v[132:135], v[44:47], a[96:99]
  ds_read_b128 v[36:39], v10 offset:8192
  v_mfma_f32_16x16x32_bf16 a[100:103], v[136:139], v[40:43], a[100:103]
  v_mfma_f32_16x16x32_bf16 a[100:103], v[140:143], v[44:47], a[100:103]
  buffer_load_dwordx4 v16, s[16:19], s33 offen offset:1024  lds
  v_mfma_f32_16x16x32_bf16 a[104:107], v[144:147], v[40:43], a[104:107]
  v_accvgpr_read_b32 v104, a8
  v_accvgpr_read_b32 v105, a9
  v_mfma_f32_16x16x32_bf16 a[104:107], v[148:151], v[44:47], a[104:107]
  v_accvgpr_read_b32 v106, a10
  v_accvgpr_read_b32 v107, a11
  v_mfma_f32_16x16x32_bf16 a[108:111], v[152:155], v[40:43], a[108:111]
  v_accvgpr_read_b32 v108, a12
  v_accvgpr_read_b32 v109, a13
  v_mfma_f32_16x16x32_bf16 a[108:111], v[156:159], v[44:47], a[108:111]
  v_accvgpr_read_b32 v110, a14
  v_accvgpr_read_b32 v111, a15
  v_mfma_f32_16x16x32_bf16 a[112:115], v[160:163], v[40:43], a[112:115]
  buffer_load_dwordx4 v17, s[16:19], s33 offen offset:2048  lds
  v_cvt_pk_bf16_f32 v104, v104, v105
  v_mfma_f32_16x16x32_bf16 a[112:115], v[164:167], v[44:47], a[112:115]
  v_cvt_pk_bf16_f32 v105, v106, v107
  v_cvt_pk_bf16_f32 v106, v108, v109
  v_mfma_f32_16x16x32_bf16 a[116:119], v[168:171], v[40:43], a[116:119]
  v_cvt_pk_bf16_f32 v107, v110, v111
  buffer_store_dwordx4 v[104:107], v0, s[20:23], s55 offen offset:1024 sc1
  v_mfma_f32_16x16x32_bf16 a[116:119], v[172:175], v[44:47], a[116:119]
  v_mfma_f32_16x16x32_bf16 a[120:123], v[176:179], v[40:43], a[120:123]
  v_mfma_f32_16x16x32_bf16 a[120:123], v[180:183], v[44:47], a[120:123]
  buffer_load_dwordx4 v18, s[16:19], s33 offen offset:3072  lds
  v_mfma_f32_16x16x32_bf16 a[124:127], v[184:187], v[40:43], a[124:127]
  v_mfma_f32_16x16x32_bf16 a[124:127], v[188:191], v[44:47], a[124:127]
  s_waitcnt lgkmcnt(0)
  s_nop 0
  v_mfma_f32_16x16x32_bf16 a[128:131], v[128:131], v[32:35], a[128:131]
  ds_read_b128 v[40:43], v9 offset:10240
  v_mfma_f32_16x16x32_bf16 a[128:131], v[132:135], v[36:39], a[128:131]
  ds_read_b128 v[44:47], v10 offset:10240
  v_mfma_f32_16x16x32_bf16 a[132:135], v[136:139], v[32:35], a[132:135]
  v_mfma_f32_16x16x32_bf16 a[132:135], v[140:143], v[36:39], a[132:135]
  v_mfma_f32_16x16x32_bf16 a[136:139], v[144:147], v[32:35], a[136:139]
  v_accvgpr_read_b32 v96, a16
  v_accvgpr_read_b32 v97, a17
  v_mfma_f32_16x16x32_bf16 a[136:139], v[148:151], v[36:39], a[136:139]
  v_accvgpr_read_b32 v98, a18
  v_accvgpr_read_b32 v99, a19
  v_mfma_f32_16x16x32_bf16 a[140:143], v[152:155], v[32:35], a[140:143]
  v_accvgpr_read_b32 v100, a20
  v_accvgpr_read_b32 v101, a21
  v_mfma_f32_16x16x32_bf16 a[140:143], v[156:159], v[36:39], a[140:143]
  v_accvgpr_read_b32 v102, a22
  v_accvgpr_read_b32 v103, a23
  v_mfma_f32_16x16x32_bf16 a[144:147], v[160:163], v[32:35], a[144:147]
  v_cvt_pk_bf16_f32 v96, v96, v97
  v_cvt_pk_bf16_f32 v97, v98, v99
  v_mfma_f32_16x16x32_bf16 a[144:147], v[164:167], v[36:39], a[144:147]
  v_cvt_pk_bf16_f32 v98, v100, v101
  v_cvt_pk_bf16_f32 v99, v102, v103
  v_mfma_f32_16x16x32_bf16 a[148:151], v[168:171], v[32:35], a[148:151]
  buffer_store_dwordx4 v[96:99], v0, s[20:23], s55 offen offset:2048 sc1
  v_mfma_f32_16x16x32_bf16 a[148:151], v[172:175], v[36:39], a[148:151]
  v_mfma_f32_16x16x32_bf16 a[152:155], v[176:179], v[32:35], a[152:155]
  v_mfma_f32_16x16x32_bf16 a[152:155], v[180:183], v[36:39], a[152:155]
  v_mfma_f32_16x16x32_bf16 a[156:159], v[184:187], v[32:35], a[156:159]
  v_mfma_f32_16x16x32_bf16 a[156:159], v[188:191], v[36:39], a[156:159]
  s_waitcnt lgkmcnt(0)
  s_nop 0
  v_mfma_f32_16x16x32_bf16 a[160:163], v[128:131], v[40:43], a[160:163]
  ds_read_b128 v[32:35], v9 offset:12288
  v_mfma_f32_16x16x32_bf16 a[160:163], v[132:135], v[44:47], a[160:163]
  ds_read_b128 v[36:39], v10 offset:12288
  v_mfma_f32_16x16x32_bf16 a[164:167], v[136:139], v[40:43], a[164:167]
  v_mfma_f32_16x16x32_bf16 a[164:167], v[140:143], v[44:47], a[164:167]
  v_accvgpr_read_b32 v104, a24
  v_accvgpr_read_b32 v105, a25
  v_mfma_f32_16x16x32_bf16 a[168:171], v[144:147], v[40:43], a[168:171]
  v_accvgpr_read_b32 v106, a26
  v_accvgpr_read_b32 v107, a27
  v_mfma_f32_16x16x32_bf16 a[168:171], v[148:151], v[44:47], a[168:171]
  v_accvgpr_read_b32 v108, a28
  v_accvgpr_read_b32 v109, a29
  v_mfma_f32_16x16x32_bf16 a[172:175], v[152:155], v[40:43], a[172:175]
  v_accvgpr_read_b32 v110, a30
  v_accvgpr_read_b32 v111, a31
  v_mfma_f32_16x16x32_bf16 a[172:175], v[156:159], v[44:47], a[172:175]
  v_cvt_pk_bf16_f32 v104, v104, v105
  v_cvt_pk_bf16_f32 v105, v106, v107
  v_mfma_f32_16x16x32_bf16 a[176:179], v[160:163], v[40:43], a[176:179]
  v_cvt_pk_bf16_f32 v106, v108, v109
  v_cvt_pk_bf16_f32 v107, v110, v111
  v_mfma_f32_16x16x32_bf16 a[176:179], v[164:167], v[44:47], a[176:179]
  buffer_store_dwordx4 v[104:107], v0, s[20:23], s55 offen offset:3072 sc1
  s_add_u32 s55, s55, s56
  v_mfma_f32_16x16x32_bf16 a[180:183], v[168:171], v[40:43], a[180:183]
  s_nop 0
  v_mfma_f32_16x16x32_bf16 a[180:183], v[172:175], v[44:47], a[180:183]
  v_mfma_f32_16x16x32_bf16 a[184:187], v[176:179], v[40:43], a[184:187]
  v_mfma_f32_16x16x32_bf16 a[184:187], v[180:183], v[44:47], a[184:187]
  v_mfma_f32_16x16x32_bf16 a[188:191], v[184:187], v[40:43], a[188:191]
  v_mfma_f32_16x16x32_bf16 a[188:191], v[188:191], v[44:47], a[188:191]
  s_waitcnt lgkmcnt(0)
  s_nop 0
  v_mfma_f32_16x16x32_bf16 a[192:195], v[128:131], v[32:35], a[192:195]
  ds_read_b128 v[40:43], v9 offset:14336
  v_mfma_f32_16x16x32_bf16 a[192:195], v[132:135], v[36:39], a[192:195]
  ds_read_b128 v[44:47], v10 offset:14336
  v_mfma_f32_16x16x32_bf16 a[196:199], v[136:139], v[32:35], a[196:199]
  v_mfma_f32_16x16x32_bf16 a[196:199], v[140:143], v[36:39], a[196:199]
  v_accvgpr_read_b32 v96, a32
  v_accvgpr_read_b32 v97, a33
  v_mfma_f32_16x16x32_bf16 a[200:203], v[144:147], v[32:35], a[200:203]
  v_accvgpr_read_b32 v98, a34
  v_accvgpr_read_b32 v99, a35
  v_mfma_f32_16x16x32_bf16 a[200:203], v[148:151], v[36:39], a[200:203]
  v_accvgpr_read_b32 v100, a36
  v_accvgpr_read_b32 v101, a37
  v_mfma_f32_16x16x32_bf16 a[204:207], v[152:155], v[32:35], a[204:207]
  v_accvgpr_read_b32 v102, a38
  v_accvgpr_read_b32 v103, a39
  v_mfma_f32_16x16x32_bf16 a[204:207], v[156:159], v[36:39], a[204:207]
  v_cvt_pk_bf16_f32 v96, v96, v97
  v_cvt_pk_bf16_f32 v97, v98, v99
  v_mfma_f32_16x16x32_bf16 a[208:211], v[160:163], v[32:35], a[208:211]
  v_cvt_pk_bf16_f32 v98, v100, v101
  v_cvt_pk_bf16_f32 v99, v102, v103
  v_mfma_f32_16x16x32_bf16 a[208:211], v[164:167], v[36:39], a[208:211]
  buffer_store_dwordx4 v[96:99], v0, s[20:23], s55 offen offset:0 sc1
  v_mfma_f32_16x16x32_bf16 a[212:215], v[168:171], v[32:35], a[212:215]
  v_mfma_f32_16x16x32_bf16 a[212:215], v[172:175], v[36:39], a[212:215]
  v_mfma_f32_16x16x32_bf16 a[216:219], v[176:179], v[32:35], a[216:219]
  s_waitcnt vmcnt(13)
  s_nop 0
  v_mfma_f32_16x16x32_bf16 a[216:219], v[180:183], v[36:39], a[216:219]
  s_waitcnt vmcnt(63) lgkmcnt(0)
  s_barrier
  v_mfma_f32_16x16x32_bf16 a[220:223], v[184:187], v[32:35], a[220:223]
  s_add_u32 s33, s60, 1572864
  s_add_u32 m0, s52, 0
  v_mfma_f32_16x16x32_bf16 a[220:223], v[188:191], v[36:39], a[220:223]
  s_waitcnt lgkmcnt(15)
  buffer_load_dwordx4 v11, s[16:19], s33 offen offset:0  lds
  v_mfma_f32_16x16x32_bf16 a[224:227], v[128:131], v[40:43], a[224:227]
  ds_read_b128 v[32:35], v9 offset:36864
  v_mfma_f32_16x16x32_bf16 a[224:227], v[132:135], v[44:47], a[224:227]
  ds_read_b128 v[36:39], v10 offset:36864
  v_mfma_f32_16x16x32_bf16 a[228:231], v[136:139], v[40:43], a[228:231]
  v_accvgpr_read_b32 v104, a40
  v_accvgpr_read_b32 v105, a41
  v_mfma_f32_16x16x32_bf16 a[228:231], v[140:143], v[44:47], a[228:231]
  v_accvgpr_read_b32 v106, a42
  v_accvgpr_read_b32 v107, a43
  v_mfma_f32_16x16x32_bf16 a[232:235], v[144:147], v[40:43], a[232:235]
  buffer_load_dwordx4 v12, s[16:19], s33 offen offset:1024  lds
  v_accvgpr_read_b32 v108, a44
  v_mfma_f32_16x16x32_bf16 a[232:235], v[148:151], v[44:47], a[232:235]
  v_accvgpr_read_b32 v109, a45
  v_accvgpr_read_b32 v110, a46
  v_mfma_f32_16x16x32_bf16 a[236:239], v[152:155], v[40:43], a[236:239]
  s_lshl_b32 s53, s45, 11
  v_accvgpr_read_b32 v111, a47
  v_mfma_f32_16x16x32_bf16 a[236:239], v[156:159], v[44:47], a[236:239]
  s_add_u32 s53, s53, 8290304
  v_cvt_pk_bf16_f32 v104, v104, v105
  v_mfma_f32_16x16x32_bf16 a[240:243], v[160:163], v[40:43], a[240:243]
  s_bfe_u32 s3, s2, 0x40003
  v_cvt_pk_bf16_f32 v105, v106, v107
  v_mfma_f32_16x16x32_bf16 a[240:243], v[164:167], v[44:47], a[240:243]
  buffer_load_dwordx4 v13, s[16:19], s33 offen offset:2048  lds
  s_lshl_b32 s3, s3, 7
  v_mfma_f32_16x16x32_bf16 a[244:247], v[168:171], v[40:43], a[244:247]
  s_add_u32 s48, s53, s3
  v_cvt_pk_bf16_f32 v106, v108, v109
  v_mfma_f32_16x16x32_bf16 a[244:247], v[172:175], v[44:47], a[244:247]
  v_add_u32 v19, s52, v0
  v_cvt_pk_bf16_f32 v107, v110, v111
  v_mfma_f32_16x16x32_bf16 a[248:251], v[176:179], v[40:43], a[248:251]
  v_add_u32 v20, 4096, v19
  buffer_store_dwordx4 v[104:107], v0, s[20:23], s55 offen offset:1024 sc1
  v_mfma_f32_16x16x32_bf16 a[248:251], v[180:183], v[44:47], a[248:251]
  v_min_u32 v21, 1, v19
  s_nop 0
  v_mfma_f32_16x16x32_bf16 a[252:255], v[184:187], v[40:43], a[252:255]
  buffer_load_dwordx4 v14, s[16:19], s33 offen offset:3072  lds
  v_lshlrev_b32_e64 v21, 30, v21
  v_mfma_f32_16x16x32_bf16 a[252:255], v[188:191], v[44:47], a[252:255]
  s_waitcnt lgkmcnt(0)
  v_mov_b32 v22, 1
  v_mfma_f32_16x16x32_bf16 a[64:67], v[192:195], v[32:35], a[64:67]
  ds_read_b128 v[40:43], v9 offset:38912
  v_lshlrev_b32_e64 v23, 3, v31
  v_mfma_f32_16x16x32_bf16 a[64:67], v[196:199], v[36:39], a[64:67]
  ds_read_b128 v[44:47], v10 offset:38912
  s_bfe_u32 s3, s2, 0x10006
  v_mfma_f32_16x16x32_bf16 a[68:71], v[200:203], v[32:35], a[68:71]
  s_add_u32 m0, s52, 4096
  s_mul_i32 s3, s3, 491520
  v_mfma_f32_16x16x32_bf16 a[68:71], v[204:207], v[36:39], a[68:71]
  buffer_load_dwordx4 v15, s[16:19], s33 offen offset:0  lds
  s_lshl_b32 s50, s45, 20
  v_mfma_f32_16x16x32_bf16 a[72:75], v[208:211], v[32:35], a[72:75]
  s_add_u32 s50, s50, s3
  v_accvgpr_read_b32 v96, a48
  v_mfma_f32_16x16x32_bf16 a[72:75], v[212:215], v[36:39], a[72:75]
  s_add_u32 s50, s50, 20971520
  v_accvgpr_read_b32 v97, a49
  v_mfma_f32_16x16x32_bf16 a[76:79], v[216:219], v[32:35], a[76:79]
  v_accvgpr_read_b32 v98, a50
  v_accvgpr_read_b32 v99, a51
  v_mfma_f32_16x16x32_bf16 a[76:79], v[220:223], v[36:39], a[76:79]
  v_accvgpr_read_b32 v100, a52
  v_accvgpr_read_b32 v101, a53
  v_mfma_f32_16x16x32_bf16 a[80:83], v[224:227], v[32:35], a[80:83]
  buffer_load_dwordx4 v16, s[16:19], s33 offen offset:1024  lds
  v_accvgpr_read_b32 v102, a54
  v_mfma_f32_16x16x32_bf16 a[80:83], v[228:231], v[36:39], a[80:83]
  v_accvgpr_read_b32 v103, a55
  v_cvt_pk_bf16_f32 v96, v96, v97
  v_mfma_f32_16x16x32_bf16 a[84:87], v[232:235], v[32:35], a[84:87]
  v_cvt_pk_bf16_f32 v97, v98, v99
  v_cvt_pk_bf16_f32 v98, v100, v101
  v_mfma_f32_16x16x32_bf16 a[84:87], v[236:239], v[36:39], a[84:87]
  v_cvt_pk_bf16_f32 v99, v102, v103
  buffer_store_dwordx4 v[96:99], v0, s[20:23], s55 offen offset:2048 sc1
  v_mfma_f32_16x16x32_bf16 a[88:91], v[240:243], v[32:35], a[88:91]
  v_mfma_f32_16x16x32_bf16 a[88:91], v[244:247], v[36:39], a[88:91]
  buffer_load_dwordx4 v17, s[16:19], s33 offen offset:2048  lds
  v_mfma_f32_16x16x32_bf16 a[92:95], v[248:251], v[32:35], a[92:95]
  v_mfma_f32_16x16x32_bf16 a[92:95], v[252:255], v[36:39], a[92:95]
  s_waitcnt lgkmcnt(0)
  s_nop 0
  v_mfma_f32_16x16x32_bf16 a[96:99], v[192:195], v[40:43], a[96:99]
  ds_read_b128 v[32:35], v9 offset:40960
  v_mfma_f32_16x16x32_bf16 a[96:99], v[196:199], v[44:47], a[96:99]
  ds_read_b128 v[36:39], v10 offset:40960
  v_accvgpr_read_b32 v136, a56
  v_mfma_f32_16x16x32_bf16 a[100:103], v[200:203], v[40:43], a[100:103]
  buffer_load_dwordx4 v18, s[16:19], s33 offen offset:3072  lds
  v_accvgpr_read_b32 v137, a57
  v_mfma_f32_16x16x32_bf16 a[100:103], v[204:207], v[44:47], a[100:103]
  v_accvgpr_read_b32 v138, a58
  v_accvgpr_read_b32 v139, a59
  v_mfma_f32_16x16x32_bf16 a[104:107], v[208:211], v[40:43], a[104:107]
  v_accvgpr_read_b32 v140, a60
  v_accvgpr_read_b32 v141, a61
  v_mfma_f32_16x16x32_bf16 a[104:107], v[212:215], v[44:47], a[104:107]
  v_accvgpr_read_b32 v142, a62
  v_accvgpr_read_b32 v143, a63
  v_mfma_f32_16x16x32_bf16 a[108:111], v[216:219], v[40:43], a[108:111]
  v_cvt_pk_bf16_f32 v136, v136, v137
  v_cvt_pk_bf16_f32 v137, v138, v139
  v_mfma_f32_16x16x32_bf16 a[108:111], v[220:223], v[44:47], a[108:111]
  v_cvt_pk_bf16_f32 v138, v140, v141
  v_cvt_pk_bf16_f32 v139, v142, v143
  v_mfma_f32_16x16x32_bf16 a[112:115], v[224:227], v[40:43], a[112:115]
  buffer_store_dwordx4 v[136:139], v0, s[20:23], s55 offen offset:3072 sc1
  s_add_u32 s55, s55, s57
  v_mfma_f32_16x16x32_bf16 a[112:115], v[228:231], v[44:47], a[112:115]
  s_nop 0
  v_mfma_f32_16x16x32_bf16 a[116:119], v[232:235], v[40:43], a[116:119]
  v_mfma_f32_16x16x32_bf16 a[116:119], v[236:239], v[44:47], a[116:119]
  v_mfma_f32_16x16x32_bf16 a[120:123], v[240:243], v[40:43], a[120:123]
  v_mfma_f32_16x16x32_bf16 a[120:123], v[244:247], v[44:47], a[120:123]
  v_mfma_f32_16x16x32_bf16 a[124:127], v[248:251], v[40:43], a[124:127]
  v_mfma_f32_16x16x32_bf16 a[124:127], v[252:255], v[44:47], a[124:127]
  s_waitcnt lgkmcnt(0)
  s_nop 0
  v_mfma_f32_16x16x32_bf16 a[128:131], v[192:195], v[32:35], a[128:131]
  ds_read_b128 v[40:43], v9 offset:43008
  v_mfma_f32_16x16x32_bf16 a[128:131], v[196:199], v[36:39], a[128:131]
  ds_read_b128 v[44:47], v10 offset:43008
  v_mfma_f32_16x16x32_bf16 a[132:135], v[200:203], v[32:35], a[132:135]
  v_mfma_f32_16x16x32_bf16 a[132:135], v[204:207], v[36:39], a[132:135]
  v_mfma_f32_16x16x32_bf16 a[136:139], v[208:211], v[32:35], a[136:139]
  v_mfma_f32_16x16x32_bf16 a[136:139], v[212:215], v[36:39], a[136:139]
  v_accvgpr_read_b32 v128, a64
  v_accvgpr_read_b32 v129, a65
  v_mfma_f32_16x16x32_bf16 a[140:143], v[216:219], v[32:35], a[140:143]
  v_accvgpr_read_b32 v130, a66
  v_accvgpr_read_b32 v131, a67
  v_mfma_f32_16x16x32_bf16 a[140:143], v[220:223], v[36:39], a[140:143]
  v_accvgpr_read_b32 v132, a68
  v_accvgpr_read_b32 v133, a69
  v_mfma_f32_16x16x32_bf16 a[144:147], v[224:227], v[32:35], a[144:147]
  v_accvgpr_read_b32 v134, a70
  v_accvgpr_read_b32 v135, a71
  v_mfma_f32_16x16x32_bf16 a[144:147], v[228:231], v[36:39], a[144:147]
  v_cvt_pk_bf16_f32 v128, v128, v129
  v_cvt_pk_bf16_f32 v129, v130, v131
  v_mfma_f32_16x16x32_bf16 a[148:151], v[232:235], v[32:35], a[148:151]
  v_cvt_pk_bf16_f32 v130, v132, v133
  v_cvt_pk_bf16_f32 v131, v134, v135
  v_mfma_f32_16x16x32_bf16 a[148:151], v[236:239], v[36:39], a[148:151]
  buffer_store_dwordx4 v[128:131], v0, s[20:23], s55 offen offset:0 sc1
  v_mfma_f32_16x16x32_bf16 a[152:155], v[240:243], v[32:35], a[152:155]
  v_mfma_f32_16x16x32_bf16 a[152:155], v[244:247], v[36:39], a[152:155]
  v_mfma_f32_16x16x32_bf16 a[156:159], v[248:251], v[32:35], a[156:159]
  v_mfma_f32_16x16x32_bf16 a[156:159], v[252:255], v[36:39], a[156:159]
  s_waitcnt lgkmcnt(0)
  s_nop 0
  v_mfma_f32_16x16x32_bf16 a[160:163], v[192:195], v[40:43], a[160:163]
  ds_read_b128 v[32:35], v9 offset:45056
  v_accvgpr_read_b32 v136, a72
  v_mfma_f32_16x16x32_bf16 a[160:163], v[196:199], v[44:47], a[160:163]
  ds_read_b128 v[36:39], v10 offset:45056
  v_accvgpr_read_b32 v137, a73
  v_mfma_f32_16x16x32_bf16 a[164:167], v[200:203], v[40:43], a[164:167]
  v_accvgpr_read_b32 v138, a74
  v_accvgpr_read_b32 v139, a75
  v_mfma_f32_16x16x32_bf16 a[164:167], v[204:207], v[44:47], a[164:167]
  v_accvgpr_read_b32 v140, a76
  v_accvgpr_read_b32 v141, a77
  v_mfma_f32_16x16x32_bf16 a[168:171], v[208:211], v[40:43], a[168:171]
  v_accvgpr_read_b32 v142, a78
  v_accvgpr_read_b32 v143, a79
  v_mfma_f32_16x16x32_bf16 a[168:171], v[212:215], v[44:47], a[168:171]
  v_cvt_pk_bf16_f32 v136, v136, v137
  v_cvt_pk_bf16_f32 v137, v138, v139
  v_mfma_f32_16x16x32_bf16 a[172:175], v[216:219], v[40:43], a[172:175]
  v_cvt_pk_bf16_f32 v138, v140, v141
  v_cvt_pk_bf16_f32 v139, v142, v143
  v_mfma_f32_16x16x32_bf16 a[172:175], v[220:223], v[44:47], a[172:175]
  buffer_store_dwordx4 v[136:139], v0, s[20:23], s55 offen offset:1024 sc1
  v_mfma_f32_16x16x32_bf16 a[176:179], v[224:227], v[40:43], a[176:179]
  v_mfma_f32_16x16x32_bf16 a[176:179], v[228:231], v[44:47], a[176:179]
  v_mfma_f32_16x16x32_bf16 a[180:183], v[232:235], v[40:43], a[180:183]
  v_mfma_f32_16x16x32_bf16 a[180:183], v[236:239], v[44:47], a[180:183]
  v_mfma_f32_16x16x32_bf16 a[184:187], v[240:243], v[40:43], a[184:187]
  v_mfma_f32_16x16x32_bf16 a[184:187], v[244:247], v[44:47], a[184:187]
  v_mfma_f32_16x16x32_bf16 a[188:191], v[248:251], v[40:43], a[188:191]
  v_mfma_f32_16x16x32_bf16 a[188:191], v[252:255], v[44:47], a[188:191]
  s_waitcnt lgkmcnt(0)
  s_nop 0
  v_mfma_f32_16x16x32_bf16 a[192:195], v[192:195], v[32:35], a[192:195]
  ds_read_b128 v[40:43], v9 offset:47104
  v_accvgpr_read_b32 v128, a80
  v_mfma_f32_16x16x32_bf16 a[192:195], v[196:199], v[36:39], a[192:195]
  ds_read_b128 v[44:47], v10 offset:47104
  v_accvgpr_read_b32 v129, a81
  v_mfma_f32_16x16x32_bf16 a[196:199], v[200:203], v[32:35], a[196:199]
  v_accvgpr_read_b32 v130, a82
  v_accvgpr_read_b32 v131, a83
  v_mfma_f32_16x16x32_bf16 a[196:199], v[204:207], v[36:39], a[196:199]
  v_accvgpr_read_b32 v132, a84
  v_accvgpr_read_b32 v133, a85
  v_mfma_f32_16x16x32_bf16 a[200:203], v[208:211], v[32:35], a[200:203]
  ds_read_b64_tr_b16 v[96:97], v1 offset:0
  v_accvgpr_read_b32 v134, a86
  v_mfma_f32_16x16x32_bf16 a[200:203], v[212:215], v[36:39], a[200:203]
  v_accvgpr_read_b32 v135, a87
  v_cvt_pk_bf16_f32 v128, v128, v129
  v_mfma_f32_16x16x32_bf16 a[204:207], v[216:219], v[32:35], a[204:207]
  ds_read_b64_tr_b16 v[98:99], v1 offset:2048
  v_cvt_pk_bf16_f32 v129, v130, v131
  v_mfma_f32_16x16x32_bf16 a[204:207], v[220:223], v[36:39], a[204:207]
  v_cvt_pk_bf16_f32 v130, v132, v133
  v_cvt_pk_bf16_f32 v131, v134, v135
  v_mfma_f32_16x16x32_bf16 a[208:211], v[224:227], v[32:35], a[208:211]
  ds_read_b64_tr_b16 v[100:101], v1 offset:16384
  buffer_store_dwordx4 v[128:131], v0, s[20:23], s55 offen offset:2048 sc1
  v_mfma_f32_16x16x32_bf16 a[208:211], v[228:231], v[36:39], a[208:211]
  v_mfma_f32_16x16x32_bf16 a[212:215], v[232:235], v[32:35], a[212:215]
  ds_read_b64_tr_b16 v[102:103], v1 offset:18432
  v_mfma_f32_16x16x32_bf16 a[212:215], v[236:239], v[36:39], a[212:215]
  v_mfma_f32_16x16x32_bf16 a[216:219], v[240:243], v[32:35], a[216:219]
  ds_read_b64_tr_b16 v[104:105], v2 offset:0
  v_mfma_f32_16x16x32_bf16 a[216:219], v[244:247], v[36:39], a[216:219]
  s_waitcnt lgkmcnt(5)
  s_barrier
  v_mfma_f32_16x16x32_bf16 a[220:223], v[248:251], v[32:35], a[220:223]
  ds_read_b64_tr_b16 v[106:107], v2 offset:2048
  s_add_u32 s33, s60, 2097152
  v_mfma_f32_16x16x32_bf16 a[220:223], v[252:255], v[36:39], a[220:223]
  s_add_u32 m0, s52, 32768
  v_accvgpr_read_b32 v136, a88
  v_mfma_f32_16x16x32_bf16 a[224:227], v[192:195], v[40:43], a[224:227]
  ds_read_b64_tr_b16 v[108:109], v2 offset:16384
  buffer_load_dwordx4 v11, s[16:19], s33 offen offset:0  lds
  v_mfma_f32_16x16x32_bf16 a[224:227], v[196:199], v[44:47], a[224:227]
  v_accvgpr_read_b32 v137, a89
  v_accvgpr_read_b32 v138, a90
  v_mfma_f32_16x16x32_bf16 a[228:231], v[200:203], v[40:43], a[228:231]
  ds_read_b64_tr_b16 v[110:111], v2 offset:18432
  v_accvgpr_read_b32 v139, a91
  v_mfma_f32_16x16x32_bf16 a[228:231], v[204:207], v[44:47], a[228:231]
  v_accvgpr_read_b32 v140, a92
  v_accvgpr_read_b32 v141, a93
  v_mfma_f32_16x16x32_bf16 a[232:235], v[208:211], v[40:43], a[232:235]
  ds_read_b64_tr_b16 v[112:113], v3 offset:0
  buffer_load_dwordx4 v12, s[16:19], s33 offen offset:1024  lds
  v_mfma_f32_16x16x32_bf16 a[232:235], v[212:215], v[44:47], a[232:235]
  v_accvgpr_read_b32 v142, a94
  v_accvgpr_read_b32 v143, a95
  v_mfma_f32_16x16x32_bf16 a[236:239], v[216:219], v[40:43], a[236:239]
  ds_read_b64_tr_b16 v[114:115], v3 offset:2048
  v_cvt_pk_bf16_f32 v136, v136, v137
  v_mfma_f32_16x16x32_bf16 a[236:239], v[220:223], v[44:47], a[236:239]
  v_cvt_pk_bf16_f32 v137, v138, v139
  v_cvt_pk_bf16_f32 v138, v140, v141
  v_mfma_f32_16x16x32_bf16 a[240:243], v[224:227], v[40:43], a[240:243]
  ds_read_b64_tr_b16 v[116:117], v3 offset:16384
  buffer_load_dwordx4 v13, s[16:19], s33 offen offset:2048  lds
  v_mfma_f32_16x16x32_bf16 a[240:243], v[228:231], v[44:47], a[240:243]
  v_cvt_pk_bf16_f32 v139, v142, v143
  buffer_store_dwordx4 v[136:139], v0, s[20:23], s55 offen offset:3072 sc1
  v_mfma_f32_16x16x32_bf16 a[244:247], v[232:235], v[40:43], a[244:247]
  ds_read_b64_tr_b16 v[118:119], v3 offset:18432
  s_add_u32 s55, s55, s56
  v_mfma_f32_16x16x32_bf16 a[244:247], v[236:239], v[44:47], a[244:247]
  s_nop 0
  v_mfma_f32_16x16x32_bf16 a[248:251], v[240:243], v[40:43], a[248:251]
  buffer_load_dwordx4 v14, s[16:19], s33 offen offset:3072  lds
  v_mfma_f32_16x16x32_bf16 a[248:251], v[244:247], v[44:47], a[248:251]
  v_mfma_f32_16x16x32_bf16 a[252:255], v[248:251], v[40:43], a[252:255]
  v_mfma_f32_16x16x32_bf16 a[252:255], v[252:255], v[44:47], a[252:255]
  s_waitcnt lgkmcnt(8)
  s_add_u32 m0, s52, 36864
  s_branch L_k1_Q
L_k1_exit:
  s_endpgm
L_k1_kvspin:
  s_mov_b32 s61, 0
L_k1_kvl:
  buffer_load_dword v24, v23, s[20:23], s53 offen sc0 sc1
  s_add_u32 s61, s61, 1
  s_cmp_ge_u32 s61, 0x40000
  s_waitcnt vmcnt(0)
  s_cbranch_scc1 L_k1_kvret
  v_cmp_ne_u32 vcc, 1, v24
  s_nop 0
  s_cbranch_vccnz L_k1_kvl
  s_branch L_k1_kvret
L_k1_evt0:
  s_cmp_lt_u32 s54, 5
  s_cbranch_scc1 L_k1_pub0
  s_getpc_b64 s[4:5]
L_cp_a0:
  s_add_u32 s4, s4, L_k1_s14-L_cp_a0
  s_addc_u32 s5, s5, (L_k1_s14-L_cp_a0)>>32
  s_lshr_b32 s3, s2, 3
  s_lshl_b32 s3, s3, 2
  s_add_u32 s3, s3, s44
  s_mul_i32 s3, s3, 512
  v_lshlrev_b32 v50, 3, v0
  v_min_u32 v50, 384, v50
  v_add_u32_e64 v50, s3, v50
  v_min_u32 v50, L_k2_last1-L_k1_s14-4, v50
  global_load_dword v52, v50, s[4:5]
  s_branch L_k1_evtret0
L_k1_pub0:
  s_cmp_lg_u32 s44, 0
  s_cbranch_scc1 L_k1_evtret0
  s_and_b32 s3, s2, 0xf0
  v_mov_b32 v48, s3
  v_mov_b32 v49, 1
  s_mov_b64 exec, 1
  global_atomic_add v48, v49, s[40:41] sc1
  s_mov_b64 exec, -1
  s_branch L_k1_evtret0
L_k1_spin0:
  s_mov_b32 s61, 0
L_k1_spinl0:
  s_sleep 8
  global_load_dword v49, v31, s[40:41] sc1
  s_add_u32 s61, s61, 1
  s_cmp_ge_u32 s61, 0x40000
  s_cbranch_scc1 L_k1_spinx0
  s_waitcnt vmcnt(0)
  v_cmp_gt_u32 vcc, 16, v49
  s_cbranch_vccnz L_k1_spinl0
L_k1_spinx0:
  s_waitcnt vmcnt(0)
  s_branch L_k1_spinret0
L_k1_evt1:
  s_cmp_lt_u32 s54, 5
  s_cbranch_scc1 L_k1_pub1
  s_getpc_b64 s[4:5]
L_cp_a1:
  s_add_u32 s4, s4, L_k1_s14-L_cp_a1
  s_addc_u32 s5, s5, (L_k1_s14-L_cp_a1)>>32
  s_lshr_b32 s3, s2, 3
  s_lshl_b32 s3, s3, 2
  s_add_u32 s3, s3, s44
  s_mul_i32 s3, s3, 512
  v_lshlrev_b32 v50, 3, v0
  v_min_u32 v50, 384, v50
  v_add_u32_e64 v50, s3, v50
  v_min_u32 v50, L_k2_last1-L_k1_s14-4, v50
  global_load_dword v52, v50, s[4:5]
  s_branch L_k1_evtret1
L_k1_pub1:
  s_cmp_lg_u32 s44, 0
  s_cbranch_scc1 L_k1_evtret1
  s_and_b32 s3, s2, 0xf0
  v_mov_b32 v48, s3
  v_mov_b32 v49, 1
  s_mov_b64 exec, 1
  global_atomic_add v48, v49, s[40:41] sc1
  s_mov_b64 exec, -1
  s_branch L_k1_evtret1
L_k1_spin1:
  s_mov_b32 s61, 0
L_k1_spinl1:
  s_sleep 8
  global_load_dword v49, v31, s[40:41] sc1
  s_add_u32 s61, s61, 1
  s_cmp_ge_u32 s61, 0x40000
  s_cbranch_scc1 L_k1_spinx1
  s_waitcnt vmcnt(0)
  v_cmp_gt_u32 vcc, 16, v49
  s_cbranch_vccnz L_k1_spinl1
L_k1_spinx1:
  s_waitcnt vmcnt(0)
  s_branch L_k1_spinret1
L_k1_V:
  s_waitcnt lgkmcnt(8)
  v_mfma_f32_16x16x32_bf16 a[0:3], v[32:35], v[128:131], 0
  ds_read_b64_tr_b16 v[152:153], v4 offset:0
  ds_read_b64_tr_b16 v[154:155], v4 offset:2048
  v_mfma_f32_16x16x32_bf16 a[0:3], v[36:39], v[132:135], a[0:3]
  ds_read_b64_tr_b16 v[156:157], v4 offset:16384
  ds_read_b64_tr_b16 v[158:159], v4 offset:18432
  s_waitcnt lgkmcnt(8)
  v_mfma_f32_16x16x32_bf16 a[8:11], v[32:35], v[136:139], 0
  ds_read_b64_tr_b16 v[160:161], v5 offset:0
  ds_read_b64_tr_b16 v[162:163], v5 offset:2048
  v_mfma_f32_16x16x32_bf16 a[8:11], v[36:39], v[140:143], a[8:11]
  ds_read_b64_tr_b16 v[164:165], v5 offset:16384
  ds_read_b64_tr_b16 v[166:167], v5 offset:18432
  s_waitcnt lgkmcnt(8)
  v_mfma_f32_16x16x32_bf16 a[16:19], v[32:35], v[144:147], 0
  ds_read_b128 v[40:43], v9 offset:2048
  ds_read_b128 v[44:47], v10 offset:2048
  v_mfma_f32_16x16x32_bf16 a[16:19], v[36:39], v[148:151], a[16:19]
  ds_read_b64_tr_b16 v[168:169], v6 offset:0
  ds_read_b64_tr_b16 v[170:171], v6 offset:2048
  s_waitcnt lgkmcnt(8)
  v_mfma_f32_16x16x32_bf16 a[24:27], v[32:35], v[152:155], 0
  ds_read_b64_tr_b16 v[172:173], v6 offset:16384
  ds_read_b64_tr_b16 v[174:175], v6 offset:18432
  v_mfma_f32_16x16x32_bf16 a[24:27], v[36:39], v[156:159], a[24:27]
  ds_read_b64_tr_b16 v[176:177], v7 offset:0
  ds_read_b64_tr_b16 v[178:179], v7 offset:2048
  s_waitcnt lgkmcnt(8)
  v_mfma_f32_16x16x32_bf16 a[32:35], v[32:35], v[160:163], 0
  ds_read_b64_tr_b16 v[180:181], v7 offset:16384
  ds_read_b64_tr_b16 v[182:183], v7 offset:18432
  v_mfma_f32_16x16x32_bf16 a[32:35], v[36:39], v[164:167], a[32:35]
  ds_read_b64_tr_b16 v[184:185], v8 offset:0
  ds_read_b64_tr_b16 v[186:187], v8 offset:2048
  s_waitcnt lgkmcnt(6)
  v_mfma_f32_16x16x32_bf16 a[40:43], v[32:35], v[168:171], 0
  ds_read_b64_tr_b16 v[188:189], v8 offset:16384
  ds_read_b64_tr_b16 v[190:191], v8 offset:18432
  v_mfma_f32_16x16x32_bf16 a[40:43], v[36:39], v[172:175], a[40:43]
  s_waitcnt lgkmcnt(4)
  s_add_u32 m0, s52, 32768
  v_mfma_f32_16x16x32_bf16 a[48:51], v[32:35], v[176:179], 0
  buffer_load_dwordx4 v19, s[8:11], s50 offen offset:0 lds
  v_mfma_f32_16x16x32_bf16 a[48:51], v[36:39], v[180:183], a[48:51]
  s_waitcnt lgkmcnt(0)
  s_nop 0
  v_mfma_f32_16x16x32_bf16 a[56:59], v[32:35], v[184:187], 0
  v_mfma_f32_16x16x32_bf16 a[56:59], v[36:39], v[188:191], a[56:59]
  v_mfma_f32_16x16x32_bf16 a[4:7], v[40:43], v[128:131], 0
  ds_read_b128 v[32:35], v9 offset:4096
  buffer_load_dwordx4 v20, s[8:11], s50 offen offset:1024 lds
  v_mfma_f32_16x16x32_bf16 a[4:7], v[44:47], v[132:135], a[4:7]
  ds_read_b128 v[36:39], v10 offset:4096
  v_mfma_f32_16x16x32_bf16 a[12:15], v[40:43], v[136:139], 0
  v_mfma_f32_16x16x32_bf16 a[12:15], v[44:47], v[140:143], a[12:15]
  v_mfma_f32_16x16x32_bf16 a[20:23], v[40:43], v[144:147], 0
  s_waitcnt vmcnt(4)
  s_barrier
  v_mfma_f32_16x16x32_bf16 a[20:23], v[44:47], v[148:151], a[20:23]
  buffer_load_dwordx4 v21, s[8:11], s50 offen offset:2048 lds
  ds_read_b64_tr_b16 v[192:193], v1 offset:32768
  v_mfma_f32_16x16x32_bf16 a[28:31], v[40:43], v[152:155], 0
  v_mfma_f32_16x16x32_bf16 a[28:31], v[44:47], v[156:159], a[28:31]
  ds_read_b64_tr_b16 v[194:195], v1 offset:34816
  v_mfma_f32_16x16x32_bf16 a[36:39], v[40:43], v[160:163], 0
  v_mfma_f32_16x16x32_bf16 a[36:39], v[44:47], v[164:167], a[36:39]
  buffer_load_dwordx4 v22, s[8:11], s50 offen offset:3072 lds
  v_mfma_f32_16x16x32_bf16 a[44:47], v[40:43], v[168:171], 0
  ds_read_b64_tr_b16 v[196:197], v1 offset:49152
  v_mfma_f32_16x16x32_bf16 a[44:47], v[44:47], v[172:175], a[44:47]
  v_mfma_f32_16x16x32_bf16 a[52:55], v[40:43], v[176:179], 0
  s_add_u32 m0, s52, 36864
  ds_read_b64_tr_b16 v[198:199], v1 offset:51200
  v_mfma_f32_16x16x32_bf16 a[52:55], v[44:47], v[180:183], a[52:55]
  buffer_load_dwordx4 v23, s[8:11], s50 offen offset:0 lds
  v_mfma_f32_16x16x32_bf16 a[60:63], v[40:43], v[184:187], 0
  v_mfma_f32_16x16x32_bf16 a[60:63], v[44:47], v[188:191], a[60:63]
  s_waitcnt lgkmcnt(4)
  ds_read_b64_tr_b16 v[200:201], v2 offset:32768
  v_mfma_f32_16x16x32_bf16 a[64:67], v[32:35], v[128:131], 0
  s_nop 0
  ds_read_b128 v[40:43], v9 offset:6144
  v_mfma_f32_16x16x32_bf16 a[64:67], v[36:39], v[132:135], a[64:67]
  ds_read_b128 v[44:47], v10 offset:6144
  buffer_load_dwordx4 v24, s[8:11], s50 offen offset:1024 lds
  v_mfma_f32_16x16x32_bf16 a[72:75], v[32:35], v[136:139], 0
  ds_read_b64_tr_b16 v[202:203], v2 offset:34816
  v_mfma_f32_16x16x32_bf16 a[72:75], v[36:39], v[140:143], a[72:75]
  v_mfma_f32_16x16x32_bf16 a[80:83], v[32:35], v[144:147], 0
  ds_read_b64_tr_b16 v[204:205], v2 offset:49152
  v_mfma_f32_16x16x32_bf16 a[80:83], v[36:39], v[148:151], a[80:83]
  buffer_load_dwordx4 v25, s[8:11], s50 offen offset:2048 lds
  v_mfma_f32_16x16x32_bf16 a[88:91], v[32:35], v[152:155], 0
  ds_read_b64_tr_b16 v[206:207], v2 offset:51200
  v_mfma_f32_16x16x32_bf16 a[88:91], v[36:39], v[156:159], a[88:91]
  v_mfma_f32_16x16x32_bf16 a[96:99], v[32:35], v[160:163], 0
  v_mfma_f32_16x16x32_bf16 a[96:99], v[36:39], v[164:167], a[96:99]
  buffer_load_dwordx4 v26, s[8:11], s50 offen offset:3072 lds
  ds_read_b64_tr_b16 v[208:209], v3 offset:32768
  v_mfma_f32_16x16x32_bf16 a[104:107], v[32:35], v[168:171], 0
  v_mfma_f32_16x16x32_bf16 a[104:107], v[36:39], v[172:175], a[104:107]
  ds_read_b64_tr_b16 v[210:211], v3 offset:34816
  v_mfma_f32_16x16x32_bf16 a[112:115], v[32:35], v[176:179], 0
  s_add_u32 s50, s50, 128
  v_mfma_f32_16x16x32_bf16 a[112:115], v[36:39], v[180:183], a[112:115]
  s_add_u32 m0, s52, 65536
  v_mfma_f32_16x16x32_bf16 a[120:123], v[32:35], v[184:187], 0
  buffer_load_dwordx4 v11, s[12:15], s51 offen offset:0  lds
  ds_read_b64_tr_b16 v[212:213], v3 offset:49152
  v_mfma_f32_16x16x32_bf16 a[120:123], v[36:39], v[188:191], a[120:123]
  s_waitcnt lgkmcnt(6)
  s_nop 0
  v_mfma_f32_16x16x32_bf16 a[68:71], v[40:43], v[128:131], 0
  ds_read_b128 v[32:35], v9 offset:8192
  v_mfma_f32_16x16x32_bf16 a[68:71], v[44:47], v[132:135], a[68:71]
  ds_read_b128 v[36:39], v10 offset:8192
  ds_read_b64_tr_b16 v[214:215], v3 offset:51200
  v_mfma_f32_16x16x32_bf16 a[76:79], v[40:43], v[136:139], 0
  buffer_load_dwordx4 v12, s[12:15], s51 offen offset:1024  lds
  v_mfma_f32_16x16x32_bf16 a[76:79], v[44:47], v[140:143], a[76:79]
  ds_read_b64_tr_b16 v[216:217], v4 offset:32768
  v_mfma_f32_16x16x32_bf16 a[84:87], v[40:43], v[144:147], 0
  v_mfma_f32_16x16x32_bf16 a[84:87], v[44:47], v[148:151], a[84:87]
  v_mfma_f32_16x16x32_bf16 a[92:95], v[40:43], v[152:155], 0
  buffer_load_dwordx4 v13, s[12:15], s51 offen offset:2048  lds
  ds_read_b64_tr_b16 v[218:219], v4 offset:34816
  v_mfma_f32_16x16x32_bf16 a[92:95], v[44:47], v[156:159], a[92:95]
  v_mfma_f32_16x16x32_bf16 a[100:103], v[40:43], v[160:163], 0
  ds_read_b64_tr_b16 v[220:221], v4 offset:49152
  s_waitcnt vmcnt(11)
  v_mfma_f32_16x16x32_bf16 a[100:103], v[44:47], v[164:167], a[100:103]
  v_lshlrev_b32 v72, 16, v48
  v_mfma_f32_16x16x32_bf16 a[108:111], v[40:43], v[168:171], 0
  buffer_load_dwordx4 v14, s[12:15], s51 offen offset:3072  lds
  v_and_b32 v73, 0xffff0000, v48
  v_mfma_f32_16x16x32_bf16 a[108:111], v[44:47], v[172:175], a[108:111]
  ds_read_b64_tr_b16 v[222:223], v4 offset:51200
  v_lshlrev_b32_e64 v74, 16, v49
  v_mfma_f32_16x16x32_bf16 a[116:119], v[40:43], v[176:179], 0
  v_and_b32 v75, 0xffff0000, v49
  v_mfma_f32_16x16x32_bf16 a[116:119], v[44:47], v[180:183], a[116:119]
  s_add_u32 m0, s52, 69632
  ds_read_b64_tr_b16 v[224:225], v5 offset:32768
  v_mfma_f32_16x16x32_bf16 a[124:127], v[40:43], v[184:187], 0
  buffer_load_dwordx4 v15, s[12:15], s51 offen offset:0  lds
  v_lshlrev_b32_e64 v76, 16, v50
  v_mfma_f32_16x16x32_bf16 a[124:127], v[44:47], v[188:191], a[124:127]
  s_waitcnt lgkmcnt(6)
  v_and_b32 v77, 0xffff0000, v50
  v_mfma_f32_16x16x32_bf16 a[128:131], v[32:35], v[128:131], 0
  ds_read_b128 v[40:43], v9 offset:10240
  ds_read_b64_tr_b16 v[226:227], v5 offset:34816
  v_mfma_f32_16x16x32_bf16 a[128:131], v[36:39], v[132:135], a[128:131]
  ds_read_b128 v[44:47], v10 offset:10240
  v_lshlrev_b32 v78, 16, v51
  v_mfma_f32_16x16x32_bf16 a[136:139], v[32:35], v[136:139], 0
  buffer_load_dwordx4 v16, s[12:15], s51 offen offset:1024  lds
  ds_read_b64_tr_b16 v[228:229], v5 offset:49152
  v_mfma_f32_16x16x32_bf16 a[136:139], v[36:39], v[140:143], a[136:139]
  v_and_b32 v79, 0xffff0000, v51
  v_lshlrev_b32_e64 v80, 16, v52
  v_mfma_f32_16x16x32_bf16 a[144:147], v[32:35], v[144:147], 0
  v_and_b32 v81, 0xffff0000, v52
  v_lshlrev_b32_e64 v82, 16, v53
  v_mfma_f32_16x16x32_bf16 a[144:147], v[36:39], v[148:151], a[144:147]
  ds_read_b64_tr_b16 v[230:231], v5 offset:51200
  v_and_b32 v83, 0xffff0000, v53
  v_mfma_f32_16x16x32_bf16 a[152:155], v[32:35], v[152:155], 0
  buffer_load_dwordx4 v17, s[12:15], s51 offen offset:2048  lds
  v_lshlrev_b32_e64 v84, 16, v54
  v_mfma_f32_16x16x32_bf16 a[152:155], v[36:39], v[156:159], a[152:155]
  ds_read_b64_tr_b16 v[232:233], v6 offset:32768
  v_and_b32 v85, 0xffff0000, v54
  v_mfma_f32_16x16x32_bf16 a[160:163], v[32:35], v[160:163], 0
  v_lshlrev_b32_e64 v86, 16, v55
  v_and_b32 v87, 0xffff0000, v55
  v_mfma_f32_16x16x32_bf16 a[160:163], v[36:39], v[164:167], a[160:163]
  v_add_f32_e64 v88, v72, v73
  v_mfma_f32_16x16x32_bf16 a[168:171], v[32:35], v[168:171], 0
  buffer_load_dwordx4 v18, s[12:15], s51 offen offset:3072  lds
  ds_read_b64_tr_b16 v[234:235], v6 offset:34816
  v_mfma_f32_16x16x32_bf16 a[168:171], v[36:39], v[172:175], a[168:171]
  v_mul_f32 v90, v72, v72
  v_add_f32 v89, v80, v81
  v_mfma_f32_16x16x32_bf16 a[176:179], v[32:35], v[176:179], 0
  v_mul_f32_e64 v91, v80, v80
  v_mfma_f32_16x16x32_bf16 a[176:179], v[36:39], v[180:183], a[176:179]
  s_add_u32 s51, s51, 524288
  ds_read_b64_tr_b16 v[236:237], v6 offset:49152
  v_mfma_f32_16x16x32_bf16 a[184:187], v[32:35], v[184:187], 0
  buffer_load_dword v29, v27, s[8:11], s50 offen offset:0
  v_fmac_f32_e64 v90, v73, v73
  v_mfma_f32_16x16x32_bf16 a[184:187], v[36:39], v[188:191], a[184:187]
  s_waitcnt lgkmcnt(5)
  ds_read_b64_tr_b16 v[238:239], v6 offset:51200
  v_mfma_f32_16x16x32_bf16 a[132:135], v[40:43], v[128:131], 0
  ds_read_b128 v[32:35], v9 offset:12288
  v_fmac_f32 v91, v81, v81
  v_mfma_f32_16x16x32_bf16 a[132:135], v[44:47], v[132:135], a[132:135]
  ds_read_b128 v[36:39], v10 offset:12288
  buffer_load_dword v29, v28, s[12:15], s51 offen
  v_mfma_f32_16x16x32_bf16 a[140:143], v[40:43], v[136:139], 0
  ds_read_b64_tr_b16 v[240:241], v7 offset:32768
  v_add_f32_e64 v88, v88, v74
  v_mfma_f32_16x16x32_bf16 a[140:143], v[44:47], v[140:143], a[140:143]
  v_fmac_f32 v90, v74, v74
  v_add_f32 v89, v89, v82
  v_mfma_f32_16x16x32_bf16 a[148:151], v[40:43], v[144:147], 0
  ds_read_b64_tr_b16 v[242:243], v7 offset:34816
  v_fmac_f32_e64 v91, v82, v82
  v_mfma_f32_16x16x32_bf16 a[148:151], v[44:47], v[148:151], a[148:151]
  v_add_f32 v88, v88, v75
  v_fmac_f32 v90, v75, v75
  v_mfma_f32_16x16x32_bf16 a[156:159], v[40:43], v[152:155], 0
  v_add_f32 v89, v89, v83
  v_fmac_f32 v91, v83, v83
  v_mfma_f32_16x16x32_bf16 a[156:159], v[44:47], v[156:159], a[156:159]
  ds_read_b64_tr_b16 v[244:245], v7 offset:49152
  v_add_f32_e64 v88, v88, v76
  v_mfma_f32_16x16x32_bf16 a[164:167], v[40:43], v[160:163], 0
  v_fmac_f32_e64 v90, v76, v76
  v_mfma_f32_16x16x32_bf16 a[164:167], v[44:47], v[164:167], a[164:167]
  ds_read_b64_tr_b16 v[246:247], v7 offset:51200
  v_add_f32_e64 v89, v89, v84
  v_mfma_f32_16x16x32_bf16 a[172:175], v[40:43], v[168:171], 0
  v_fmac_f32_e64 v91, v84, v84
  v_mfma_f32_16x16x32_bf16 a[172:175], v[44:47], v[172:175], a[172:175]
  v_add_f32_e64 v88, v88, v77
  v_mfma_f32_16x16x32_bf16 a[180:183], v[40:43], v[176:179], 0
  ds_read_b64_tr_b16 v[248:249], v8 offset:32768
  v_fmac_f32_e64 v90, v77, v77
  v_mfma_f32_16x16x32_bf16 a[180:183], v[44:47], v[180:183], a[180:183]
  v_add_f32_e64 v89, v89, v85
  v_mfma_f32_16x16x32_bf16 a[188:191], v[40:43], v[184:187], 0
  ds_read_b64_tr_b16 v[250:251], v8 offset:34816
  v_fmac_f32_e64 v91, v85, v85
  v_mfma_f32_16x16x32_bf16 a[188:191], v[44:47], v[188:191], a[188:191]
  s_waitcnt lgkmcnt(6)
  v_add_f32 v88, v88, v78
  v_mfma_f32_16x16x32_bf16 a[192:195], v[32:35], v[128:131], 0
  ds_read_b128 v[40:43], v9 offset:14336
  v_fmac_f32_e64 v90, v78, v78
  v_mfma_f32_16x16x32_bf16 a[192:195], v[36:39], v[132:135], a[192:195]
  ds_read_b128 v[44:47], v10 offset:14336
  ds_read_b64_tr_b16 v[252:253], v8 offset:49152
  v_mfma_f32_16x16x32_bf16 a[200:203], v[32:35], v[136:139], 0
  v_add_f32 v89, v89, v86
  v_fmac_f32 v91, v86, v86
  v_mfma_f32_16x16x32_bf16 a[200:203], v[36:39], v[140:143], a[200:203]
  v_add_f32_e64 v88, v88, v79
  v_mfma_f32_16x16x32_bf16 a[208:211], v[32:35], v[144:147], 0
  ds_read_b64_tr_b16 v[254:255], v8 offset:51200
  v_fmac_f32_e64 v90, v79, v79
  v_mfma_f32_16x16x32_bf16 a[208:211], v[36:39], v[148:151], a[208:211]
  v_add_f32_e64 v89, v89, v87
  v_mfma_f32_16x16x32_bf16 a[216:219], v[32:35], v[152:155], 0
  v_fmac_f32_e64 v91, v87, v87
  v_mfma_f32_16x16x32_bf16 a[216:219], v[36:39], v[156:159], a[216:219]
  s_nop 1
  v_mfma_f32_16x16x32_bf16 a[224:227], v[32:35], v[160:163], 0
  s_nop 0
  v_add_f32_dpp v88, v88, v88 row_shr:1 row_mask:0xf bank_mask:0xf bound_ctrl:1
  v_mfma_f32_16x16x32_bf16 a[224:227], v[36:39], v[164:167], a[224:227]
  v_add_f32_dpp v89, v89, v89 row_shr:1 row_mask:0xf bank_mask:0xf bound_ctrl:1
  v_mfma_f32_16x16x32_bf16 a[232:235], v[32:35], v[168:171], 0
  v_add_f32_dpp v90, v90, v90 row_shr:1 row_mask:0xf bank_mask:0xf bound_ctrl:1
  v_mfma_f32_16x16x32_bf16 a[232:235], v[36:39], v[172:175], a[232:235]
  v_add_f32_dpp v91, v91, v91 row_shr:1 row_mask:0xf bank_mask:0xf bound_ctrl:1
  v_mfma_f32_16x16x32_bf16 a[240:243], v[32:35], v[176:179], 0
  v_add_f32_dpp v88, v88, v88 row_shr:2 row_mask:0xf bank_mask:0xf bound_ctrl:1
  v_mfma_f32_16x16x32_bf16 a[240:243], v[36:39], v[180:183], a[240:243]
  s_waitcnt vmcnt(10) lgkmcnt(0)
  s_barrier
  v_mfma_f32_16x16x32_bf16 a[248:251], v[32:35], v[184:187], 0
  s_add_u32 m0, s52, 0
  v_add_f32_dpp v89, v89, v89 row_shr:2 row_mask:0xf bank_mask:0xf bound_ctrl:1
  v_mfma_f32_16x16x32_bf16 a[248:251], v[36:39], v[188:191], a[248:251]
  buffer_load_dwordx4 v19, s[8:11], s50 offen offset:0 lds
  v_add_f32_dpp v90, v90, v90 row_shr:2 row_mask:0xf bank_mask:0xf bound_ctrl:1
  v_mfma_f32_16x16x32_bf16 a[196:199], v[40:43], v[128:131], 0
  ds_read_b128 v[32:35], v9 offset:32768
  v_add_f32_dpp v91, v91, v91 row_shr:2 row_mask:0xf bank_mask:0xf bound_ctrl:1
  v_mfma_f32_16x16x32_bf16 a[196:199], v[44:47], v[132:135], a[196:199]
  ds_read_b128 v[36:39], v10 offset:32768
  v_add_f32_dpp v88, v88, v88 row_shr:4 row_mask:0xf bank_mask:0xf bound_ctrl:1
  v_mfma_f32_16x16x32_bf16 a[204:207], v[40:43], v[136:139], 0
  v_add_f32_dpp v89, v89, v89 row_shr:4 row_mask:0xf bank_mask:0xf bound_ctrl:1
  v_add_f32_dpp v90, v90, v90 row_shr:4 row_mask:0xf bank_mask:0xf bound_ctrl:1
  v_mfma_f32_16x16x32_bf16 a[204:207], v[44:47], v[140:143], a[204:207]
  buffer_load_dwordx4 v20, s[8:11], s50 offen offset:1024 lds
  v_add_f32_dpp v91, v91, v91 row_shr:4 row_mask:0xf bank_mask:0xf bound_ctrl:1
  v_mfma_f32_16x16x32_bf16 a[212:215], v[40:43], v[144:147], 0
  s_nop 0
  v_add_f32_dpp v88, v88, v88 row_shr:8 row_mask:0xf bank_mask:0xf bound_ctrl:1
  v_mfma_f32_16x16x32_bf16 a[212:215], v[44:47], v[148:151], a[212:215]
  v_mfma_f32_16x16x32_bf16 a[220:223], v[40:43], v[152:155], 0
  v_mfma_f32_16x16x32_bf16 a[220:223], v[44:47], v[156:159], a[220:223]
  buffer_load_dwordx4 v21, s[8:11], s50 offen offset:2048 lds
  v_mfma_f32_16x16x32_bf16 a[228:231], v[40:43], v[160:163], 0
  v_mfma_f32_16x16x32_bf16 a[228:231], v[44:47], v[164:167], a[228:231]
  v_mfma_f32_16x16x32_bf16 a[236:239], v[40:43], v[168:171], 0
  v_mfma_f32_16x16x32_bf16 a[236:239], v[44:47], v[172:175], a[236:239]
  buffer_load_dwordx4 v22, s[8:11], s50 offen offset:3072 lds
  v_mfma_f32_16x16x32_bf16 a[244:247], v[40:43], v[176:179], 0
  v_mfma_f32_16x16x32_bf16 a[244:247], v[44:47], v[180:183], a[244:247]
  v_mfma_f32_16x16x32_bf16 a[252:255], v[40:43], v[184:187], 0
  s_add_u32 m0, s52, 4096
  v_mfma_f32_16x16x32_bf16 a[252:255], v[44:47], v[188:191], a[252:255]
  s_waitcnt lgkmcnt(0)
  s_nop 0
  v_mfma_f32_16x16x32_bf16 a[0:3], v[32:35], v[192:195], a[0:3]
  ds_read_b128 v[40:43], v9 offset:34816
  v_add_f32_dpp v89, v89, v89 row_shr:8 row_mask:0xf bank_mask:0xf bound_ctrl:1
  v_mfma_f32_16x16x32_bf16 a[0:3], v[36:39], v[196:199], a[0:3]
  ds_read_b128 v[44:47], v10 offset:34816
  buffer_load_dwordx4 v23, s[8:11], s50 offen offset:0 lds
  v_mfma_f32_16x16x32_bf16 a[8:11], v[32:35], v[200:203], a[8:11]
  v_add_f32_dpp v90, v90, v90 row_shr:8 row_mask:0xf bank_mask:0xf bound_ctrl:1
  v_add_f32_dpp v91, v91, v91 row_shr:8 row_mask:0xf bank_mask:0xf bound_ctrl:1
  v_mfma_f32_16x16x32_bf16 a[8:11], v[36:39], v[204:207], a[8:11]
  v_add_f32_dpp v88, v88, v88 row_bcast:15 row_mask:0xa bank_mask:0xf
  v_mfma_f32_16x16x32_bf16 a[16:19], v[32:35], v[208:211], a[16:19]
  v_add_f32_dpp v89, v89, v89 row_bcast:15 row_mask:0xa bank_mask:0xf
  v_mfma_f32_16x16x32_bf16 a[16:19], v[36:39], v[212:215], a[16:19]
  v_add_f32_dpp v90, v90, v90 row_bcast:15 row_mask:0xa bank_mask:0xf
  v_mfma_f32_16x16x32_bf16 a[24:27], v[32:35], v[216:219], a[24:27]
  buffer_load_dwordx4 v24, s[8:11], s50 offen offset:1024 lds
  v_add_f32_dpp v91, v91, v91 row_bcast:15 row_mask:0xa bank_mask:0xf
  v_mfma_f32_16x16x32_bf16 a[24:27], v[36:39], v[220:223], a[24:27]
  v_add_f32_dpp v88, v88, v88 row_bcast:31 row_mask:0xc bank_mask:0xf
  v_mfma_f32_16x16x32_bf16 a[32:35], v[32:35], v[224:227], a[32:35]
  v_add_f32_dpp v89, v89, v89 row_bcast:31 row_mask:0xc bank_mask:0xf
  v_mfma_f32_16x16x32_bf16 a[32:35], v[36:39], v[228:231], a[32:35]
  v_add_f32_dpp v90, v90, v90 row_bcast:31 row_mask:0xc bank_mask:0xf
  v_mfma_f32_16x16x32_bf16 a[40:43], v[32:35], v[232:235], a[40:43]
  v_add_f32_dpp v91, v91, v91 row_bcast:31 row_mask:0xc bank_mask:0xf
  v_mfma_f32_16x16x32_bf16 a[40:43], v[36:39], v[236:239], a[40:43]
  buffer_load_dwordx4 v25, s[8:11], s50 offen offset:2048 lds
  v_mul_f32 v88, 0x3b124925, v88
  v_mfma_f32_16x16x32_bf16 a[48:51], v[32:35], v[240:243], a[48:51]
  v_mul_f32 v89, 0x3b124925, v89
  v_mfma_f32_16x16x32_bf16 a[48:51], v[36:39], v[244:247], a[48:51]
  v_mul_f32 v90, 0x3b124925, v90
  v_mfma_f32_16x16x32_bf16 a[56:59], v[32:35], v[248:251], a[56:59]
  v_mul_f32 v91, 0x3b124925, v91
  v_mfma_f32_16x16x32_bf16 a[56:59], v[36:39], v[252:255], a[56:59]
  s_waitcnt lgkmcnt(0)
  v_fma_f32 v90, -v88, v88, v90
  v_mfma_f32_16x16x32_bf16 a[4:7], v[40:43], v[192:195], a[4:7]
  ds_read_b128 v[32:35], v9 offset:36864
  s_waitcnt vmcnt(9)
  s_barrier
  v_mfma_f32_16x16x32_bf16 a[4:7], v[44:47], v[196:199], a[4:7]
  ds_read_b128 v[36:39], v10 offset:36864
  buffer_load_dwordx4 v26, s[8:11], s50 offen offset:3072 lds
  v_mfma_f32_16x16x32_bf16 a[12:15], v[40:43], v[200:203], a[12:15]
  ds_read_b64_tr_b16 v[128:129], v1 offset:0
  v_fma_f32 v91, -v89, v89, v91
  v_mfma_f32_16x16x32_bf16 a[12:15], v[44:47], v[204:207], a[12:15]
  ds_read_b64_tr_b16 v[130:131], v1 offset:2048
  v_max_f32 v90, 0, v90
  v_mfma_f32_16x16x32_bf16 a[20:23], v[40:43], v[208:211], a[20:23]
  v_max_f32_e64 v91, 0, v91
  v_add_f32 v90, 0x3727c5ac, v90
  v_mfma_f32_16x16x32_bf16 a[20:23], v[44:47], v[212:215], a[20:23]
  s_add_u32 s50, s50, 128
  s_add_u32 m0, s52, 98304
  v_mfma_f32_16x16x32_bf16 a[28:31], v[40:43], v[216:219], a[28:31]
  buffer_load_dwordx4 v11, s[12:15], s51 offen offset:0  lds
  ds_read_b64_tr_b16 v[132:133], v1 offset:16384
  v_mfma_f32_16x16x32_bf16 a[28:31], v[44:47], v[220:223], a[28:31]
  v_add_f32 v91, 0x3727c5ac, v91
  v_mfma_f32_16x16x32_bf16 a[36:39], v[40:43], v[224:227], a[36:39]
  v_rsq_f32 v90, v90
  v_mfma_f32_16x16x32_bf16 a[36:39], v[44:47], v[228:231], a[36:39]
  s_nop 0
  ds_read_b64_tr_b16 v[134:135], v1 offset:18432
  v_mfma_f32_16x16x32_bf16 a[44:47], v[40:43], v[232:235], a[44:47]
  v_rsq_f32 v91, v91
  v_mfma_f32_16x16x32_bf16 a[44:47], v[44:47], v[236:239], a[44:47]
  buffer_load_dwordx4 v12, s[12:15], s51 offen offset:1024  lds
  ds_read_b64_tr_b16 v[136:137], v2 offset:0
  v_mfma_f32_16x16x32_bf16 a[52:55], v[40:43], v[240:243], a[52:55]
  s_nop 0
  v_mul_f32 v90, 0x3db8aa3b, v90
  v_mfma_f32_16x16x32_bf16 a[52:55], v[44:47], v[244:247], a[52:55]
  v_mul_f32 v91, 0x3db8aa3b, v91
  v_mul_f32_e64 v88, v88, v90
  v_mfma_f32_16x16x32_bf16 a[60:63], v[40:43], v[248:251], a[60:63]
  ds_read_b64_tr_b16 v[138:139], v2 offset:2048
  v_mul_f32_e64 v89, v89, v91
  v_mfma_f32_16x16x32_bf16 a[60:63], v[44:47], v[252:255], a[60:63]
  s_waitcnt lgkmcnt(6)
  s_nop 0
  v_mfma_f32_16x16x32_bf16 a[64:67], v[32:35], v[192:195], a[64:67]
  ds_read_b128 v[40:43], v9 offset:38912
  buffer_load_dwordx4 v13, s[12:15], s51 offen offset:2048  lds
  v_mfma_f32_16x16x32_bf16 a[64:67], v[36:39], v[196:199], a[64:67]
  ds_read_b128 v[44:47], v10 offset:38912
  ds_read_b64_tr_b16 v[140:141], v2 offset:16384
  v_mfma_f32_16x16x32_bf16 a[72:75], v[32:35], v[200:203], a[72:75]
  v_readlane_b32 s62, v88, 63
  v_readlane_b32 s63, v89, 63
  v_mfma_f32_16x16x32_bf16 a[72:75], v[36:39], v[204:207], a[72:75]
  ds_read_b64_tr_b16 v[142:143], v2 offset:18432
  v_readlane_b32 s64, v90, 63
  v_mfma_f32_16x16x32_bf16 a[80:83], v[32:35], v[208:211], a[80:83]
  v_readlane_b32 s65, v91, 63
  v_mfma_f32_16x16x32_bf16 a[80:83], v[36:39], v[212:215], a[80:83]
  buffer_load_dwordx4 v14, s[12:15], s51 offen offset:3072  lds
  v_mfma_f32_16x16x32_bf16 a[88:91], v[32:35], v[216:219], a[88:91]
  ds_read_b64_tr_b16 v[144:145], v3 offset:0
  v_mfma_f32_16x16x32_bf16 a[88:91], v[36:39], v[220:223], a[88:91]
  s_nop 1
  v_mfma_f32_16x16x32_bf16 a[96:99], v[32:35], v[224:227], a[96:99]
  v_mov_b32 v88, s62
  v_mov_b32_e64 v89, s63
  v_mfma_f32_16x16x32_bf16 a[96:99], v[36:39], v[228:231], a[96:99]
  s_add_u32 m0, s52, 102400
  ds_read_b64_tr_b16 v[146:147], v3 offset:2048
  v_mfma_f32_16x16x32_bf16 a[104:107], v[32:35], v[232:235], a[104:107]
  buffer_load_dwordx4 v15, s[12:15], s51 offen offset:0  lds
  v_fma_f32 v72, v72, s64, -v88
  v_mfma_f32_16x16x32_bf16 a[104:107], v[36:39], v[236:239], a[104:107]
  ds_read_b64_tr_b16 v[148:149], v3 offset:16384
  v_fma_f32 v80, v80, s65, -v89
  v_mfma_f32_16x16x32_bf16 a[112:115], v[32:35], v[240:243], a[112:115]
  v_fma_f32 v73, v73, s64, -v88
  v_fma_f32 v81, v81, s65, -v89
  v_mfma_f32_16x16x32_bf16 a[112:115], v[36:39], v[244:247], a[112:115]
  v_fma_f32 v74, v74, s64, -v88
  v_fma_f32 v82, v82, s65, -v89
  v_mfma_f32_16x16x32_bf16 a[120:123], v[32:35], v[248:251], a[120:123]
  ds_read_b64_tr_b16 v[150:151], v3 offset:18432
  v_fma_f32 v75, v75, s64, -v88
  v_mfma_f32_16x16x32_bf16 a[120:123], v[36:39], v[252:255], a[120:123]
  s_waitcnt lgkmcnt(6)
  buffer_load_dwordx4 v16, s[12:15], s51 offen offset:1024  lds
  v_mfma_f32_16x16x32_bf16 a[68:71], v[40:43], v[192:195], a[68:71]
  ds_read_b128 v[32:35], v9 offset:40960
  v_fma_f32 v83, v83, s65, -v89
  v_mfma_f32_16x16x32_bf16 a[68:71], v[44:47], v[196:199], a[68:71]
  ds_read_b128 v[36:39], v10 offset:40960
  ds_read_b64_tr_b16 v[152:153], v4 offset:0
  v_mfma_f32_16x16x32_bf16 a[76:79], v[40:43], v[200:203], a[76:79]
  v_fma_f32 v76, v76, s64, -v88
  v_fma_f32 v84, v84, s65, -v89
  v_mfma_f32_16x16x32_bf16 a[76:79], v[44:47], v[204:207], a[76:79]
  ds_read_b64_tr_b16 v[154:155], v4 offset:2048
  v_fma_f32 v77, v77, s64, -v88
  v_mfma_f32_16x16x32_bf16 a[84:87], v[40:43], v[208:211], a[84:87]
  buffer_load_dwordx4 v17, s[12:15], s51 offen offset:2048  lds
  v_fma_f32 v85, v85, s65, -v89
  v_mfma_f32_16x16x32_bf16 a[84:87], v[44:47], v[212:215], a[84:87]
  v_fma_f32 v78, v78, s64, -v88
  v_fma_f32 v86, v86, s65, -v89
  v_mfma_f32_16x16x32_bf16 a[92:95], v[40:43], v[216:219], a[92:95]
  ds_read_b64_tr_b16 v[156:157], v4 offset:16384
  v_fma_f32 v79, v79, s64, -v88
  v_mfma_f32_16x16x32_bf16 a[92:95], v[44:47], v[220:223], a[92:95]
  v_fma_f32 v87, v87, s65, -v89
  v_cvt_pk_bf16_f32 v48, v72, v73
  v_mfma_f32_16x16x32_bf16 a[100:103], v[40:43], v[224:227], a[100:103]
  v_cvt_pk_bf16_f32 v52, v80, v81
  v_cvt_pk_bf16_f32 v49, v74, v75
  v_mfma_f32_16x16x32_bf16 a[100:103], v[44:47], v[228:231], a[100:103]
  buffer_load_dwordx4 v18, s[12:15], s51 offen offset:3072  lds
  ds_read_b64_tr_b16 v[158:159], v4 offset:18432
  v_mfma_f32_16x16x32_bf16 a[108:111], v[40:43], v[232:235], a[108:111]
  v_cvt_pk_bf16_f32 v53, v82, v83
  v_cvt_pk_bf16_f32 v50, v76, v77
  v_mfma_f32_16x16x32_bf16 a[108:111], v[44:47], v[236:239], a[108:111]
  ds_read_b64_tr_b16 v[160:161], v5 offset:0
  v_cvt_pk_bf16_f32 v54, v84, v85
  v_mfma_f32_16x16x32_bf16 a[116:119], v[40:43], v[240:243], a[116:119]
  v_cvt_pk_bf16_f32 v51, v78, v79
  v_cvt_pk_bf16_f32 v55, v86, v87
  v_mfma_f32_16x16x32_bf16 a[116:119], v[44:47], v[244:247], a[116:119]
  s_add_u32 s51, s51, 524288
  ds_write_b128 v59, v[48:51]
  v_mfma_f32_16x16x32_bf16 a[124:127], v[40:43], v[248:251], a[124:127]
  buffer_load_dword v29, v27, s[8:11], s50 offen offset:0
  ds_read_b64_tr_b16 v[162:163], v5 offset:2048
  v_mfma_f32_16x16x32_bf16 a[124:127], v[44:47], v[252:255], a[124:127]
  s_waitcnt lgkmcnt(7)
  ds_write_b128 v59, v[52:55] offset:16
  v_mfma_f32_16x16x32_bf16 a[128:131], v[32:35], v[192:195], a[128:131]
  ds_read_b128 v[40:43], v9 offset:43008
  v_mfma_f32_16x16x32_bf16 a[128:131], v[36:39], v[196:199], a[128:131]
  ds_read_b128 v[44:47], v10 offset:43008
  buffer_load_dword v29, v28, s[12:15], s51 offen
  v_mfma_f32_16x16x32_bf16 a[136:139], v[32:35], v[200:203], a[136:139]
  ds_read_b64_tr_b16 v[164:165], v5 offset:16384
  v_mfma_f32_16x16x32_bf16 a[136:139], v[36:39], v[204:207], a[136:139]
  ds_read_b64_tr_b16 v[166:167], v5 offset:18432
  v_mfma_f32_16x16x32_bf16 a[144:147], v[32:35], v[208:211], a[144:147]
  buffer_load_dword v29, v27, s[8:11], s50 offen offset:128
  v_mfma_f32_16x16x32_bf16 a[144:147], v[36:39], v[212:215], a[144:147]
  v_mfma_f32_16x16x32_bf16 a[152:155], v[32:35], v[216:219], a[152:155]
  ds_read_b64_tr_b16 v[168:169], v6 offset:0
  v_mfma_f32_16x16x32_bf16 a[152:155], v[36:39], v[220:223], a[152:155]
  buffer_store_dwordx4 v[68:71], v0, s[20:23], s48 offen sc1
  v_mfma_f32_16x16x32_bf16 a[160:163], v[32:35], v[224:227], a[160:163]
  v_mfma_f32_16x16x32_bf16 a[160:163], v[36:39], v[228:231], a[160:163]
  ds_read_b64_tr_b16 v[170:171], v6 offset:2048
  v_mfma_f32_16x16x32_bf16 a[168:171], v[32:35], v[232:235], a[168:171]
  buffer_store_dwordx4 v[68:71], v0, s[20:23], s53 offen sc1
  v_mfma_f32_16x16x32_bf16 a[168:171], v[36:39], v[236:239], a[168:171]
  ds_read_b64_tr_b16 v[172:173], v6 offset:16384
  v_mfma_f32_16x16x32_bf16 a[176:179], v[32:35], v[240:243], a[176:179]
  v_mfma_f32_16x16x32_bf16 a[176:179], v[36:39], v[244:247], a[176:179]
  v_mfma_f32_16x16x32_bf16 a[184:187], v[32:35], v[248:251], a[184:187]
  ds_read_b64_tr_b16 v[174:175], v6 offset:18432
  v_mfma_f32_16x16x32_bf16 a[184:187], v[36:39], v[252:255], a[184:187]
  s_waitcnt lgkmcnt(6)
  s_nop 0
  v_mfma_f32_16x16x32_bf16 a[132:135], v[40:43], v[192:195], a[132:135]
  ds_read_b128 v[32:35], v9 offset:45056
  v_mfma_f32_16x16x32_bf16 a[132:135], v[44:47], v[196:199], a[132:135]
  ds_read_b128 v[36:39], v10 offset:45056
  ds_read_b64_tr_b16 v[176:177], v7 offset:0
  v_mfma_f32_16x16x32_bf16 a[140:143], v[40:43], v[200:203], a[140:143]
  v_mfma_f32_16x16x32_bf16 a[140:143], v[44:47], v[204:207], a[140:143]
  ds_read_b64_tr_b16 v[178:179], v7 offset:2048
  v_mfma_f32_16x16x32_bf16 a[148:151], v[40:43], v[208:211], a[148:151]
  v_mfma_f32_16x16x32_bf16 a[148:151], v[44:47], v[212:215], a[148:151]
  v_mfma_f32_16x16x32_bf16 a[156:159], v[40:43], v[216:219], a[156:159]
  ds_read_b64_tr_b16 v[180:181], v7 offset:16384
  v_mfma_f32_16x16x32_bf16 a[156:159], v[44:47], v[220:223], a[156:159]
  v_mfma_f32_16x16x32_bf16 a[164:167], v[40:43], v[224:227], a[164:167]
  v_mfma_f32_16x16x32_bf16 a[164:167], v[44:47], v[228:231], a[164:167]
  ds_read_b64_tr_b16 v[182:183], v7 offset:18432
  v_mfma_f32_16x16x32_bf16 a[172:175], v[40:43], v[232:235], a[172:175]
  v_mfma_f32_16x16x32_bf16 a[172:175], v[44:47], v[236:239], a[172:175]
  ds_read_b64_tr_b16 v[184:185], v8 offset:0
  v_mfma_f32_16x16x32_bf16 a[180:183], v[40:43], v[240:243], a[180:183]
  v_mfma_f32_16x16x32_bf16 a[180:183], v[44:47], v[244:247], a[180:183]
  v_mfma_f32_16x16x32_bf16 a[188:191], v[40:43], v[248:251], a[188:191]
  ds_read_b64_tr_b16 v[186:187], v8 offset:2048
  v_mfma_f32_16x16x32_bf16 a[188:191], v[44:47], v[252:255], a[188:191]
  s_waitcnt lgkmcnt(6)
  s_nop 0
  v_mfma_f32_16x16x32_bf16 a[192:195], v[32:35], v[192:195], a[192:195]
  ds_read_b128 v[40:43], v9 offset:47104
  v_mfma_f32_16x16x32_bf16 a[192:195], v[36:39], v[196:199], a[192:195]
  ds_read_b128 v[44:47], v10 offset:47104
  ds_read_b64_tr_b16 v[188:189], v8 offset:16384
  v_mfma_f32_16x16x32_bf16 a[200:203], v[32:35], v[200:203], a[200:203]
  v_mfma_f32_16x16x32_bf16 a[200:203], v[36:39], v[204:207], a[200:203]
  v_mfma_f32_16x16x32_bf16 a[208:211], v[32:35], v[208:211], a[208:211]
  ds_read_b64_tr_b16 v[190:191], v8 offset:18432
  v_mfma_f32_16x16x32_bf16 a[208:211], v[36:39], v[212:215], a[208:211]
  v_mfma_f32_16x16x32_bf16 a[216:219], v[32:35], v[216:219], a[216:219]
  v_mfma_f32_16x16x32_bf16 a[216:219], v[36:39], v[220:223], a[216:219]
  v_mfma_f32_16x16x32_bf16 a[224:227], v[32:35], v[224:227], a[224:227]
  v_mfma_f32_16x16x32_bf16 a[224:227], v[36:39], v[228:231], a[224:227]
  v_mfma_f32_16x16x32_bf16 a[232:235], v[32:35], v[232:235], a[232:235]
  v_mfma_f32_16x16x32_bf16 a[232:235], v[36:39], v[236:239], a[232:235]
  v_mfma_f32_16x16x32_bf16 a[240:243], v[32:35], v[240:243], a[240:243]
  v_mfma_f32_16x16x32_bf16 a[240:243], v[36:39], v[244:247], a[240:243]
  s_waitcnt vmcnt(5) lgkmcnt(0)
  s_barrier
  v_mfma_f32_16x16x32_bf16 a[248:251], v[32:35], v[248:251], a[248:251]
  ds_read_b128 v[48:51], v56
  s_add_u32 m0, s52, 32768
  v_mfma_f32_16x16x32_bf16 a[248:251], v[36:39], v[252:255], a[248:251]
  ds_read_b128 v[52:55], v56 offset:4608
  buffer_load_dwordx4 v19, s[8:11], s50 offen offset:0 lds
  v_mfma_f32_16x16x32_bf16 a[196:199], v[40:43], v[192:195], a[196:199]
  ds_read_b128 v[32:35], v9 offset:0
  v_mfma_f32_16x16x32_bf16 a[196:199], v[44:47], v[196:199], a[196:199]
  ds_read_b128 v[36:39], v10 offset:0
  v_mfma_f32_16x16x32_bf16 a[204:207], v[40:43], v[200:203], a[204:207]
  v_mfma_f32_16x16x32_bf16 a[204:207], v[44:47], v[204:207], a[204:207]
  buffer_load_dwordx4 v20, s[8:11], s50 offen offset:1024 lds
  v_mfma_f32_16x16x32_bf16 a[212:215], v[40:43], v[208:211], a[212:215]
  v_mfma_f32_16x16x32_bf16 a[212:215], v[44:47], v[212:215], a[212:215]
  v_mfma_f32_16x16x32_bf16 a[220:223], v[40:43], v[216:219], a[220:223]
  v_mfma_f32_16x16x32_bf16 a[220:223], v[44:47], v[220:223], a[220:223]
  buffer_load_dwordx4 v21, s[8:11], s50 offen offset:2048 lds
  v_mfma_f32_16x16x32_bf16 a[228:231], v[40:43], v[224:227], a[228:231]
  s_waitcnt lgkmcnt(2)
  s_nop 0
  v_mfma_f32_16x16x32_bf16 a[228:231], v[44:47], v[228:231], a[228:231]
  v_mfma_f32_16x16x32_bf16 a[236:239], v[40:43], v[232:235], a[236:239]
  buffer_store_dwordx4 v[48:51], v57, s[20:23], s6 offen sc1
  v_mfma_f32_16x16x32_bf16 a[236:239], v[44:47], v[236:239], a[236:239]
  buffer_load_dwordx4 v22, s[8:11], s50 offen offset:3072 lds
  v_mfma_f32_16x16x32_bf16 a[244:247], v[40:43], v[240:243], a[244:247]
  buffer_store_dwordx4 v[52:55], v57, s[20:23], s37 offen sc1
  v_mfma_f32_16x16x32_bf16 a[244:247], v[44:47], v[244:247], a[244:247]
  v_mfma_f32_16x16x32_bf16 a[252:255], v[40:43], v[248:251], a[252:255]
  s_add_u32 m0, s52, 36864
  v_mfma_f32_16x16x32_bf16 a[252:255], v[44:47], v[252:255], a[252:255]
  s_waitcnt lgkmcnt(0)
L_k1_loop1:
  s_nop 0
  v_mfma_f32_16x16x32_bf16 a[0:3], v[32:35], v[128:131], a[0:3]
  ds_read_b128 v[40:43], v9 offset:2048
  v_mfma_f32_16x16x32_bf16 a[0:3], v[36:39], v[132:135], a[0:3]
  ds_read_b128 v[44:47], v10 offset:2048
  buffer_load_dwordx4 v23, s[8:11], s50 offen offset:0 lds
  v_mfma_f32_16x16x32_bf16 a[8:11], v[32:35], v[136:139], a[8:11]
  ds_read_b64_tr_b16 v[192:193], v1 offset:32768
  v_mfma_f32_16x16x32_bf16 a[8:11], v[36:39], v[140:143], a[8:11]
  v_mfma_f32_16x16x32_bf16 a[16:19], v[32:35], v[144:147], a[16:19]
  ds_read_b64_tr_b16 v[194:195], v1 offset:34816
  v_mfma_f32_16x16x32_bf16 a[16:19], v[36:39], v[148:151], a[16:19]
  v_mfma_f32_16x16x32_bf16 a[24:27], v[32:35], v[152:155], a[24:27]
  buffer_load_dwordx4 v24, s[8:11], s50 offen offset:1024 lds
  v_mfma_f32_16x16x32_bf16 a[24:27], v[36:39], v[156:159], a[24:27]
  ds_read_b64_tr_b16 v[196:197], v1 offset:49152
  v_mfma_f32_16x16x32_bf16 a[32:35], v[32:35], v[160:163], a[32:35]
  v_mfma_f32_16x16x32_bf16 a[32:35], v[36:39], v[164:167], a[32:35]
  ds_read_b64_tr_b16 v[198:199], v1 offset:51200
  v_mfma_f32_16x16x32_bf16 a[40:43], v[32:35], v[168:171], a[40:43]
  v_mfma_f32_16x16x32_bf16 a[40:43], v[36:39], v[172:175], a[40:43]
  buffer_load_dwordx4 v25, s[8:11], s50 offen offset:2048 lds
  v_mfma_f32_16x16x32_bf16 a[48:51], v[32:35], v[176:179], a[48:51]
  ds_read_b64_tr_b16 v[200:201], v2 offset:32768
  v_mfma_f32_16x16x32_bf16 a[48:51], v[36:39], v[180:183], a[48:51]
  v_mfma_f32_16x16x32_bf16 a[56:59], v[32:35], v[184:187], a[56:59]
  ds_read_b64_tr_b16 v[202:203], v2 offset:34816
  v_mfma_f32_16x16x32_bf16 a[56:59], v[36:39], v[188:191], a[56:59]
  s_waitcnt lgkmcnt(6)
  s_nop 0
  v_mfma_f32_16x16x32_bf16 a[4:7], v[40:43], v[128:131], a[4:7]
  ds_read_b128 v[32:35], v9 offset:4096
  buffer_load_dwordx4 v26, s[8:11], s50 offen offset:3072 lds
  v_mfma_f32_16x16x32_bf16 a[4:7], v[44:47], v[132:135], a[4:7]
  ds_read_b128 v[36:39], v10 offset:4096
  ds_read_b64_tr_b16 v[204:205], v2 offset:49152
  v_mfma_f32_16x16x32_bf16 a[12:15], v[40:43], v[136:139], a[12:15]
  v_mfma_f32_16x16x32_bf16 a[12:15], v[44:47], v[140:143], a[12:15]
  ds_read_b64_tr_b16 v[206:207], v2 offset:51200
  v_mfma_f32_16x16x32_bf16 a[20:23], v[40:43], v[144:147], a[20:23]
  s_add_u32 s50, s50, 128
  s_add_u32 m0, s52, 65536
  v_mfma_f32_16x16x32_bf16 a[20:23], v[44:47], v[148:151], a[20:23]
  buffer_load_dwordx4 v11, s[12:15], s51 offen offset:0  lds
  v_mfma_f32_16x16x32_bf16 a[28:31], v[40:43], v[152:155], a[28:31]
  ds_read_b64_tr_b16 v[208:209], v3 offset:32768
  v_mfma_f32_16x16x32_bf16 a[28:31], v[44:47], v[156:159], a[28:31]
  v_mfma_f32_16x16x32_bf16 a[36:39], v[40:43], v[160:163], a[36:39]
  ds_read_b64_tr_b16 v[210:211], v3 offset:34816
  v_mfma_f32_16x16x32_bf16 a[36:39], v[44:47], v[164:167], a[36:39]
  v_mfma_f32_16x16x32_bf16 a[44:47], v[40:43], v[168:171], a[44:47]
  buffer_load_dwordx4 v12, s[12:15], s51 offen offset:1024  lds
  v_mfma_f32_16x16x32_bf16 a[44:47], v[44:47], v[172:175], a[44:47]
  ds_read_b64_tr_b16 v[212:213], v3 offset:49152
  v_mfma_f32_16x16x32_bf16 a[52:55], v[40:43], v[176:179], a[52:55]
  v_mfma_f32_16x16x32_bf16 a[52:55], v[44:47], v[180:183], a[52:55]
  ds_read_b64_tr_b16 v[214:215], v3 offset:51200
  v_mfma_f32_16x16x32_bf16 a[60:63], v[40:43], v[184:187], a[60:63]
  v_mfma_f32_16x16x32_bf16 a[60:63], v[44:47], v[188:191], a[60:63]
  s_waitcnt lgkmcnt(6)
  buffer_load_dwordx4 v13, s[12:15], s51 offen offset:2048  lds
  v_mfma_f32_16x16x32_bf16 a[64:67], v[32:35], v[128:131], a[64:67]
  ds_read_b128 v[40:43], v9 offset:6144
  ds_read_b64_tr_b16 v[216:217], v4 offset:32768
  v_mfma_f32_16x16x32_bf16 a[64:67], v[36:39], v[132:135], a[64:67]
  s_nop 0
  ds_read_b128 v[44:47], v10 offset:6144
  v_mfma_f32_16x16x32_bf16 a[72:75], v[32:35], v[136:139], a[72:75]
  ds_read_b64_tr_b16 v[218:219], v4 offset:34816
  v_mfma_f32_16x16x32_bf16 a[72:75], v[36:39], v[140:143], a[72:75]
  v_mfma_f32_16x16x32_bf16 a[80:83], v[32:35], v[144:147], a[80:83]
  buffer_load_dwordx4 v14, s[12:15], s51 offen offset:3072  lds
  v_mfma_f32_16x16x32_bf16 a[80:83], v[36:39], v[148:151], a[80:83]
  ds_read_b64_tr_b16 v[220:221], v4 offset:49152
  v_mfma_f32_16x16x32_bf16 a[88:91], v[32:35], v[152:155], a[88:91]
  v_mfma_f32_16x16x32_bf16 a[88:91], v[36:39], v[156:159], a[88:91]
  ds_read_b64_tr_b16 v[222:223], v4 offset:51200
  v_mfma_f32_16x16x32_bf16 a[96:99], v[32:35], v[160:163], a[96:99]
  s_add_u32 m0, s52, 69632
  v_mfma_f32_16x16x32_bf16 a[96:99], v[36:39], v[164:167], a[96:99]
  buffer_load_dwordx4 v15, s[12:15], s51 offen offset:0  lds
  v_mfma_f32_16x16x32_bf16 a[104:107], v[32:35], v[168:171], a[104:107]
  ds_read_b64_tr_b16 v[224:225], v5 offset:32768
  v_mfma_f32_16x16x32_bf16 a[104:107], v[36:39], v[172:175], a[104:107]
  v_mfma_f32_16x16x32_bf16 a[112:115], v[32:35], v[176:179], a[112:115]
  ds_read_b64_tr_b16 v[226:227], v5 offset:34816
  v_mfma_f32_16x16x32_bf16 a[112:115], v[36:39], v[180:183], a[112:115]
  v_mfma_f32_16x16x32_bf16 a[120:123], v[32:35], v[184:187], a[120:123]
  buffer_load_dwordx4 v16, s[12:15], s51 offen offset:1024  lds
  v_mfma_f32_16x16x32_bf16 a[120:123], v[36:39], v[188:191], a[120:123]
  s_waitcnt lgkmcnt(5)
  ds_read_b64_tr_b16 v[228:229], v5 offset:49152
  v_mfma_f32_16x16x32_bf16 a[68:71], v[40:43], v[128:131], a[68:71]
  s_nop 0
  ds_read_b128 v[32:35], v9 offset:8192
  v_mfma_f32_16x16x32_bf16 a[68:71], v[44:47], v[132:135], a[68:71]
  ds_read_b128 v[36:39], v10 offset:8192
  ds_read_b64_tr_b16 v[230:231], v5 offset:51200
  v_mfma_f32_16x16x32_bf16 a[76:79], v[40:43], v[136:139], a[76:79]
  v_mfma_f32_16x16x32_bf16 a[76:79], v[44:47], v[140:143], a[76:79]
  buffer_load_dwordx4 v17, s[12:15], s51 offen offset:2048  lds
  v_mfma_f32_16x16x32_bf16 a[84:87], v[40:43], v[144:147], a[84:87]
  ds_read_b64_tr_b16 v[232:233], v6 offset:32768
  v_mfma_f32_16x16x32_bf16 a[84:87], v[44:47], v[148:151], a[84:87]
  v_mfma_f32_16x16x32_bf16 a[92:95], v[40:43], v[152:155], a[92:95]
  ds_read_b64_tr_b16 v[234:235], v6 offset:34816
  v_mfma_f32_16x16x32_bf16 a[92:95], v[44:47], v[156:159], a[92:95]
  v_mfma_f32_16x16x32_bf16 a[100:103], v[40:43], v[160:163], a[100:103]
  buffer_load_dwordx4 v18, s[12:15], s51 offen offset:3072  lds
  v_mfma_f32_16x16x32_bf16 a[100:103], v[44:47], v[164:167], a[100:103]
  ds_read_b64_tr_b16 v[236:237], v6 offset:49152
  v_mfma_f32_16x16x32_bf16 a[108:111], v[40:43], v[168:171], a[108:111]
  v_mfma_f32_16x16x32_bf16 a[108:111], v[44:47], v[172:175], a[108:111]
  ds_read_b64_tr_b16 v[238:239], v6 offset:51200
  v_mfma_f32_16x16x32_bf16 a[116:119], v[40:43], v[176:179], a[116:119]
  s_add_u32 s51, s51, 524288
  v_mfma_f32_16x16x32_bf16 a[116:119], v[44:47], v[180:183], a[116:119]
  buffer_load_dword v29, v27, s[8:11], s50 offen offset:128
  v_mfma_f32_16x16x32_bf16 a[124:127], v[40:43], v[184:187], a[124:127]
  ds_read_b64_tr_b16 v[240:241], v7 offset:32768
  v_mfma_f32_16x16x32_bf16 a[124:127], v[44:47], v[188:191], a[124:127]
  s_waitcnt lgkmcnt(6)
  s_nop 0
  v_mfma_f32_16x16x32_bf16 a[128:131], v[32:35], v[128:131], a[128:131]
  ds_read_b128 v[40:43], v9 offset:10240
  buffer_load_dword v29, v28, s[12:15], s51 offen
  v_mfma_f32_16x16x32_bf16 a[128:131], v[36:39], v[132:135], a[128:131]
  ds_read_b128 v[44:47], v10 offset:10240
  ds_read_b64_tr_b16 v[242:243], v7 offset:34816
  v_mfma_f32_16x16x32_bf16 a[136:139], v[32:35], v[136:139], a[136:139]
  v_mfma_f32_16x16x32_bf16 a[136:139], v[36:39], v[140:143], a[136:139]
  buffer_load_dword v29, v62, s[28:31], s36 offen
  ds_read_b64_tr_b16 v[244:245], v7 offset:49152
  v_mfma_f32_16x16x32_bf16 a[144:147], v[32:35], v[144:147], a[144:147]
  v_mfma_f32_16x16x32_bf16 a[144:147], v[36:39], v[148:151], a[144:147]
  s_add_u32 s36, s36, 622592
  ds_read_b64_tr_b16 v[246:247], v7 offset:51200
  v_mfma_f32_16x16x32_bf16 a[152:155], v[32:35], v[152:155], a[152:155]
  v_mfma_f32_16x16x32_bf16 a[152:155], v[36:39], v[156:159], a[152:155]
  v_mfma_f32_16x16x32_bf16 a[160:163], v[32:35], v[160:163], a[160:163]
  ds_read_b64_tr_b16 v[248:249], v8 offset:32768
  v_mfma_f32_16x16x32_bf16 a[160:163], v[36:39], v[164:167], a[160:163]
  v_mfma_f32_16x16x32_bf16 a[168:171], v[32:35], v[168:171], a[168:171]
  ds_read_b64_tr_b16 v[250:251], v8 offset:34816
  v_mfma_f32_16x16x32_bf16 a[168:171], v[36:39], v[172:175], a[168:171]
  v_mfma_f32_16x16x32_bf16 a[176:179], v[32:35], v[176:179], a[176:179]
  v_mfma_f32_16x16x32_bf16 a[176:179], v[36:39], v[180:183], a[176:179]
  ds_read_b64_tr_b16 v[252:253], v8 offset:49152
  v_mfma_f32_16x16x32_bf16 a[184:187], v[32:35], v[184:187], a[184:187]
  v_mfma_f32_16x16x32_bf16 a[184:187], v[36:39], v[188:191], a[184:187]
  s_waitcnt lgkmcnt(6)
  s_nop 0
  v_mfma_f32_16x16x32_bf16 a[132:135], v[40:43], v[128:131], a[132:135]
  ds_read_b128 v[32:35], v9 offset:12288
  ds_read_b64_tr_b16 v[254:255], v8 offset:51200
  v_mfma_f32_16x16x32_bf16 a[132:135], v[44:47], v[132:135], a[132:135]
  ds_read_b128 v[36:39], v10 offset:12288
  v_mfma_f32_16x16x32_bf16 a[140:143], v[40:43], v[136:139], a[140:143]
  v_mfma_f32_16x16x32_bf16 a[140:143], v[44:47], v[140:143], a[140:143]
  v_mfma_f32_16x16x32_bf16 a[148:151], v[40:43], v[144:147], a[148:151]
  v_mfma_f32_16x16x32_bf16 a[148:151], v[44:47], v[148:151], a[148:151]
  v_mfma_f32_16x16x32_bf16 a[156:159], v[40:43], v[152:155], a[156:159]
  v_mfma_f32_16x16x32_bf16 a[156:159], v[44:47], v[156:159], a[156:159]
  v_mfma_f32_16x16x32_bf16 a[164:167], v[40:43], v[160:163], a[164:167]
  v_mfma_f32_16x16x32_bf16 a[164:167], v[44:47], v[164:167], a[164:167]
  v_mfma_f32_16x16x32_bf16 a[172:175], v[40:43], v[168:171], a[172:175]
  v_mfma_f32_16x16x32_bf16 a[172:175], v[44:47], v[172:175], a[172:175]
  v_mfma_f32_16x16x32_bf16 a[180:183], v[40:43], v[176:179], a[180:183]
  v_mfma_f32_16x16x32_bf16 a[180:183], v[44:47], v[180:183], a[180:183]
  v_mfma_f32_16x16x32_bf16 a[188:191], v[40:43], v[184:187], a[188:191]
  v_mfma_f32_16x16x32_bf16 a[188:191], v[44:47], v[188:191], a[188:191]
  s_waitcnt lgkmcnt(0)
  s_nop 0
  v_mfma_f32_16x16x32_bf16 a[192:195], v[32:35], v[128:131], a[192:195]
  ds_read_b128 v[40:43], v9 offset:14336
  v_mfma_f32_16x16x32_bf16 a[192:195], v[36:39], v[132:135], a[192:195]
  ds_read_b128 v[44:47], v10 offset:14336
  v_mfma_f32_16x16x32_bf16 a[200:203], v[32:35], v[136:139], a[200:203]
  v_mfma_f32_16x16x32_bf16 a[200:203], v[36:39], v[140:143], a[200:203]
  v_mfma_f32_16x16x32_bf16 a[208:211], v[32:35], v[144:147], a[208:211]
  v_mfma_f32_16x16x32_bf16 a[208:211], v[36:39], v[148:151], a[208:211]
  v_mfma_f32_16x16x32_bf16 a[216:219], v[32:35], v[152:155], a[216:219]
  v_mfma_f32_16x16x32_bf16 a[216:219], v[36:39], v[156:159], a[216:219]
  v_mfma_f32_16x16x32_bf16 a[224:227], v[32:35], v[160:163], a[224:227]
  v_mfma_f32_16x16x32_bf16 a[224:227], v[36:39], v[164:167], a[224:227]
  v_mfma_f32_16x16x32_bf16 a[232:235], v[32:35], v[168:171], a[232:235]
  v_mfma_f32_16x16x32_bf16 a[232:235], v[36:39], v[172:175], a[232:235]
  v_mfma_f32_16x16x32_bf16 a[240:243], v[32:35], v[176:179], a[240:243]
  v_mfma_f32_16x16x32_bf16 a[240:243], v[36:39], v[180:183], a[240:243]
  s_waitcnt vmcnt(3) lgkmcnt(0)
  s_barrier
  v_mfma_f32_16x16x32_bf16 a[248:251], v[32:35], v[184:187], a[248:251]
  s_add_u32 m0, s52, 0
  s_nop 0
  v_mfma_f32_16x16x32_bf16 a[248:251], v[36:39], v[188:191], a[248:251]
  buffer_load_dwordx4 v19, s[8:11], s50 offen offset:0 lds
  v_mfma_f32_16x16x32_bf16 a[196:199], v[40:43], v[128:131], a[196:199]
  ds_read_b128 v[32:35], v9 offset:32768
  v_mfma_f32_16x16x32_bf16 a[196:199], v[44:47], v[132:135], a[196:199]
  ds_read_b128 v[36:39], v10 offset:32768
  s_bitcmp1_b32 s61, s54
  v_mfma_f32_16x16x32_bf16 a[204:207], v[40:43], v[136:139], a[204:207]
  s_cbranch_scc1 L_k1_evt1
L_k1_evtret1:
  v_mfma_f32_16x16x32_bf16 a[204:207], v[44:47], v[140:143], a[204:207]
  buffer_load_dwordx4 v20, s[8:11], s50 offen offset:1024 lds
  v_mfma_f32_16x16x32_bf16 a[212:215], v[40:43], v[144:147], a[212:215]
  v_mfma_f32_16x16x32_bf16 a[212:215], v[44:47], v[148:151], a[212:215]
  v_mfma_f32_16x16x32_bf16 a[220:223], v[40:43], v[152:155], a[220:223]
  v_mfma_f32_16x16x32_bf16 a[220:223], v[44:47], v[156:159], a[220:223]
  buffer_load_dwordx4 v21, s[8:11], s50 offen offset:2048 lds
  v_mfma_f32_16x16x32_bf16 a[228:231], v[40:43], v[160:163], a[228:231]
  v_mfma_f32_16x16x32_bf16 a[228:231], v[44:47], v[164:167], a[228:231]
  v_mfma_f32_16x16x32_bf16 a[236:239], v[40:43], v[168:171], a[236:239]
  v_mfma_f32_16x16x32_bf16 a[236:239], v[44:47], v[172:175], a[236:239]
  buffer_load_dwordx4 v22, s[8:11], s50 offen offset:3072 lds
  v_mfma_f32_16x16x32_bf16 a[244:247], v[40:43], v[176:179], a[244:247]
  v_mfma_f32_16x16x32_bf16 a[244:247], v[44:47], v[180:183], a[244:247]
  v_mfma_f32_16x16x32_bf16 a[252:255], v[40:43], v[184:187], a[252:255]
  s_add_u32 m0, s52, 4096
  v_mfma_f32_16x16x32_bf16 a[252:255], v[44:47], v[188:191], a[252:255]
  s_waitcnt lgkmcnt(0)
  s_nop 0
  v_mfma_f32_16x16x32_bf16 a[0:3], v[32:35], v[192:195], a[0:3]
  ds_read_b128 v[40:43], v9 offset:34816
  v_mfma_f32_16x16x32_bf16 a[0:3], v[36:39], v[196:199], a[0:3]
  ds_read_b128 v[44:47], v10 offset:34816
  buffer_load_dwordx4 v23, s[8:11], s50 offen offset:0 lds
  v_mfma_f32_16x16x32_bf16 a[8:11], v[32:35], v[200:203], a[8:11]
  ds_read_b64_tr_b16 v[128:129], v1 offset:0
  v_mfma_f32_16x16x32_bf16 a[8:11], v[36:39], v[204:207], a[8:11]
  v_mfma_f32_16x16x32_bf16 a[16:19], v[32:35], v[208:211], a[16:19]
  ds_read_b64_tr_b16 v[130:131], v1 offset:2048
  v_mfma_f32_16x16x32_bf16 a[16:19], v[36:39], v[212:215], a[16:19]
  v_mfma_f32_16x16x32_bf16 a[24:27], v[32:35], v[216:219], a[24:27]
  buffer_load_dwordx4 v24, s[8:11], s50 offen offset:1024 lds
  v_mfma_f32_16x16x32_bf16 a[24:27], v[36:39], v[220:223], a[24:27]
  ds_read_b64_tr_b16 v[132:133], v1 offset:16384
  v_mfma_f32_16x16x32_bf16 a[32:35], v[32:35], v[224:227], a[32:35]
  v_mfma_f32_16x16x32_bf16 a[32:35], v[36:39], v[228:231], a[32:35]
  ds_read_b64_tr_b16 v[134:135], v1 offset:18432
  v_mfma_f32_16x16x32_bf16 a[40:43], v[32:35], v[232:235], a[40:43]
  v_mfma_f32_16x16x32_bf16 a[40:43], v[36:39], v[236:239], a[40:43]
  buffer_load_dwordx4 v25, s[8:11], s50 offen offset:2048 lds
  v_mfma_f32_16x16x32_bf16 a[48:51], v[32:35], v[240:243], a[48:51]
  ds_read_b64_tr_b16 v[136:137], v2 offset:0
  v_mfma_f32_16x16x32_bf16 a[48:51], v[36:39], v[244:247], a[48:51]
  v_mfma_f32_16x16x32_bf16 a[56:59], v[32:35], v[248:251], a[56:59]
  ds_read_b64_tr_b16 v[138:139], v2 offset:2048
  v_mfma_f32_16x16x32_bf16 a[56:59], v[36:39], v[252:255], a[56:59]
  s_waitcnt lgkmcnt(6)
  s_nop 0
  v_mfma_f32_16x16x32_bf16 a[4:7], v[40:43], v[192:195], a[4:7]
  ds_read_b128 v[32:35], v9 offset:36864
  buffer_load_dwordx4 v26, s[8:11], s50 offen offset:3072 lds
  v_mfma_f32_16x16x32_bf16 a[4:7], v[44:47], v[196:199], a[4:7]
  ds_read_b128 v[36:39], v10 offset:36864
  ds_read_b64_tr_b16 v[140:141], v2 offset:16384
  v_mfma_f32_16x16x32_bf16 a[12:15], v[40:43], v[200:203], a[12:15]
  v_mfma_f32_16x16x32_bf16 a[12:15], v[44:47], v[204:207], a[12:15]
  ds_read_b64_tr_b16 v[142:143], v2 offset:18432
  v_mfma_f32_16x16x32_bf16 a[20:23], v[40:43], v[208:211], a[20:23]
  s_add_u32 s50, s50, 128
  s_add_u32 m0, s52, 98304
  v_mfma_f32_16x16x32_bf16 a[20:23], v[44:47], v[212:215], a[20:23]
  buffer_load_dwordx4 v11, s[12:15], s51 offen offset:0  lds
  v_mfma_f32_16x16x32_bf16 a[28:31], v[40:43], v[216:219], a[28:31]
  ds_read_b64_tr_b16 v[144:145], v3 offset:0
  v_mfma_f32_16x16x32_bf16 a[28:31], v[44:47], v[220:223], a[28:31]
  v_mfma_f32_16x16x32_bf16 a[36:39], v[40:43], v[224:227], a[36:39]
  ds_read_b64_tr_b16 v[146:147], v3 offset:2048
  v_mfma_f32_16x16x32_bf16 a[36:39], v[44:47], v[228:231], a[36:39]
  v_mfma_f32_16x16x32_bf16 a[44:47], v[40:43], v[232:235], a[44:47]
  buffer_load_dwordx4 v12, s[12:15], s51 offen offset:1024  lds
  v_mfma_f32_16x16x32_bf16 a[44:47], v[44:47], v[236:239], a[44:47]
  ds_read_b64_tr_b16 v[148:149], v3 offset:16384
  v_mfma_f32_16x16x32_bf16 a[52:55], v[40:43], v[240:243], a[52:55]
  v_mfma_f32_16x16x32_bf16 a[52:55], v[44:47], v[244:247], a[52:55]
  ds_read_b64_tr_b16 v[150:151], v3 offset:18432
  v_mfma_f32_16x16x32_bf16 a[60:63], v[40:43], v[248:251], a[60:63]
  v_mfma_f32_16x16x32_bf16 a[60:63], v[44:47], v[252:255], a[60:63]
  s_waitcnt lgkmcnt(6)
  buffer_load_dwordx4 v13, s[12:15], s51 offen offset:2048  lds
  v_mfma_f32_16x16x32_bf16 a[64:67], v[32:35], v[192:195], a[64:67]
  ds_read_b128 v[40:43], v9 offset:38912
  ds_read_b64_tr_b16 v[152:153], v4 offset:0
  v_mfma_f32_16x16x32_bf16 a[64:67], v[36:39], v[196:199], a[64:67]
  s_nop 0
  ds_read_b128 v[44:47], v10 offset:38912
  v_mfma_f32_16x16x32_bf16 a[72:75], v[32:35], v[200:203], a[72:75]
  ds_read_b64_tr_b16 v[154:155], v4 offset:2048
  v_mfma_f32_16x16x32_bf16 a[72:75], v[36:39], v[204:207], a[72:75]
  v_mfma_f32_16x16x32_bf16 a[80:83], v[32:35], v[208:211], a[80:83]
  buffer_load_dwordx4 v14, s[12:15], s51 offen offset:3072  lds
  v_mfma_f32_16x16x32_bf16 a[80:83], v[36:39], v[212:215], a[80:83]
  ds_read_b64_tr_b16 v[156:157], v4 offset:16384
  v_mfma_f32_16x16x32_bf16 a[88:91], v[32:35], v[216:219], a[88:91]
  v_mfma_f32_16x16x32_bf16 a[88:91], v[36:39], v[220:223], a[88:91]
  ds_read_b64_tr_b16 v[158:159], v4 offset:18432
  v_mfma_f32_16x16x32_bf16 a[96:99], v[32:35], v[224:227], a[96:99]
  s_add_u32 m0, s52, 102400
  v_mfma_f32_16x16x32_bf16 a[96:99], v[36:39], v[228:231], a[96:99]
  buffer_load_dwordx4 v15, s[12:15], s51 offen offset:0  lds
  v_mfma_f32_16x16x32_bf16 a[104:107], v[32:35], v[232:235], a[104:107]
  ds_read_b64_tr_b16 v[160:161], v5 offset:0
  v_mfma_f32_16x16x32_bf16 a[104:107], v[36:39], v[236:239], a[104:107]
  v_mfma_f32_16x16x32_bf16 a[112:115], v[32:35], v[240:243], a[112:115]
  ds_read_b64_tr_b16 v[162:163], v5 offset:2048
  v_mfma_f32_16x16x32_bf16 a[112:115], v[36:39], v[244:247], a[112:115]
  v_mfma_f32_16x16x32_bf16 a[120:123], v[32:35], v[248:251], a[120:123]
  buffer_load_dwordx4 v16, s[12:15], s51 offen offset:1024  lds
  v_mfma_f32_16x16x32_bf16 a[120:123], v[36:39], v[252:255], a[120:123]
  s_waitcnt lgkmcnt(5)
  ds_read_b64_tr_b16 v[164:165], v5 offset:16384
  v_mfma_f32_16x16x32_bf16 a[68:71], v[40:43], v[192:195], a[68:71]
  s_nop 0
  ds_read_b128 v[32:35], v9 offset:40960
  v_mfma_f32_16x16x32_bf16 a[68:71], v[44:47], v[196:199], a[68:71]
  ds_read_b128 v[36:39], v10 offset:40960
  ds_read_b64_tr_b16 v[166:167], v5 offset:18432
  v_mfma_f32_16x16x32_bf16 a[76:79], v[40:43], v[200:203], a[76:79]
  v_mfma_f32_16x16x32_bf16 a[76:79], v[44:47], v[204:207], a[76:79]
  buffer_load_dwordx4 v17, s[12:15], s51 offen offset:2048  lds
  v_mfma_f32_16x16x32_bf16 a[84:87], v[40:43], v[208:211], a[84:87]
  ds_read_b64_tr_b16 v[168:169], v6 offset:0
  v_mfma_f32_16x16x32_bf16 a[84:87], v[44:47], v[212:215], a[84:87]
  v_mfma_f32_16x16x32_bf16 a[92:95], v[40:43], v[216:219], a[92:95]
  ds_read_b64_tr_b16 v[170:171], v6 offset:2048
  v_mfma_f32_16x16x32_bf16 a[92:95], v[44:47], v[220:223], a[92:95]
  v_mfma_f32_16x16x32_bf16 a[100:103], v[40:43], v[224:227], a[100:103]
  buffer_load_dwordx4 v18, s[12:15], s51 offen offset:3072  lds
  v_mfma_f32_16x16x32_bf16 a[100:103], v[44:47], v[228:231], a[100:103]
  ds_read_b64_tr_b16 v[172:173], v6 offset:16384
  v_mfma_f32_16x16x32_bf16 a[108:111], v[40:43], v[232:235], a[108:111]
  v_mfma_f32_16x16x32_bf16 a[108:111], v[44:47], v[236:239], a[108:111]
  ds_read_b64_tr_b16 v[174:175], v6 offset:18432
  v_mfma_f32_16x16x32_bf16 a[116:119], v[40:43], v[240:243], a[116:119]
  s_add_u32 s51, s51, 524288
  v_mfma_f32_16x16x32_bf16 a[116:119], v[44:47], v[244:247], a[116:119]
  buffer_load_dword v29, v27, s[8:11], s50 offen offset:128
  v_mfma_f32_16x16x32_bf16 a[124:127], v[40:43], v[248:251], a[124:127]
  ds_read_b64_tr_b16 v[176:177], v7 offset:0
  v_mfma_f32_16x16x32_bf16 a[124:127], v[44:47], v[252:255], a[124:127]
  s_waitcnt lgkmcnt(6)
  s_nop 0
  v_mfma_f32_16x16x32_bf16 a[128:131], v[32:35], v[192:195], a[128:131]
  ds_read_b128 v[40:43], v9 offset:43008
  buffer_load_dword v29, v28, s[12:15], s51 offen
  v_mfma_f32_16x16x32_bf16 a[128:131], v[36:39], v[196:199], a[128:131]
  ds_read_b128 v[44:47], v10 offset:43008
  ds_read_b64_tr_b16 v[178:179], v7 offset:2048
  v_mfma_f32_16x16x32_bf16 a[136:139], v[32:35], v[200:203], a[136:139]
  v_mfma_f32_16x16x32_bf16 a[136:139], v[36:39], v[204:207], a[136:139]
  buffer_load_dword v29, v62, s[28:31], s36 offen
  ds_read_b64_tr_b16 v[180:181], v7 offset:16384
  v_mfma_f32_16x16x32_bf16 a[144:147], v[32:35], v[208:211], a[144:147]
  v_mfma_f32_16x16x32_bf16 a[144:147], v[36:39], v[212:215], a[144:147]
  s_add_u32 s36, s36, 622592
  ds_read_b64_tr_b16 v[182:183], v7 offset:18432
  v_mfma_f32_16x16x32_bf16 a[152:155], v[32:35], v[216:219], a[152:155]
  v_mfma_f32_16x16x32_bf16 a[152:155], v[36:39], v[220:223], a[152:155]
  v_mfma_f32_16x16x32_bf16 a[160:163], v[32:35], v[224:227], a[160:163]
  ds_read_b64_tr_b16 v[184:185], v8 offset:0
  v_mfma_f32_16x16x32_bf16 a[160:163], v[36:39], v[228:231], a[160:163]
  v_mfma_f32_16x16x32_bf16 a[168:171], v[32:35], v[232:235], a[168:171]
  ds_read_b64_tr_b16 v[186:187], v8 offset:2048
  v_mfma_f32_16x16x32_bf16 a[168:171], v[36:39], v[236:239], a[168:171]
  v_mfma_f32_16x16x32_bf16 a[176:179], v[32:35], v[240:243], a[176:179]
  v_mfma_f32_16x16x32_bf16 a[176:179], v[36:39], v[244:247], a[176:179]
  ds_read_b64_tr_b16 v[188:189], v8 offset:16384
  v_mfma_f32_16x16x32_bf16 a[184:187], v[32:35], v[248:251], a[184:187]
  v_mfma_f32_16x16x32_bf16 a[184:187], v[36:39], v[252:255], a[184:187]
  s_waitcnt lgkmcnt(6)
  s_nop 0
  v_mfma_f32_16x16x32_bf16 a[132:135], v[40:43], v[192:195], a[132:135]
  ds_read_b128 v[32:35], v9 offset:45056
  ds_read_b64_tr_b16 v[190:191], v8 offset:18432
  v_mfma_f32_16x16x32_bf16 a[132:135], v[44:47], v[196:199], a[132:135]
  ds_read_b128 v[36:39], v10 offset:45056
  v_mfma_f32_16x16x32_bf16 a[140:143], v[40:43], v[200:203], a[140:143]
  v_mfma_f32_16x16x32_bf16 a[140:143], v[44:47], v[204:207], a[140:143]
  v_mfma_f32_16x16x32_bf16 a[148:151], v[40:43], v[208:211], a[148:151]
  v_mfma_f32_16x16x32_bf16 a[148:151], v[44:47], v[212:215], a[148:151]
  v_mfma_f32_16x16x32_bf16 a[156:159], v[40:43], v[216:219], a[156:159]
  v_mfma_f32_16x16x32_bf16 a[156:159], v[44:47], v[220:223], a[156:159]
  v_mfma_f32_16x16x32_bf16 a[164:167], v[40:43], v[224:227], a[164:167]
  v_mfma_f32_16x16x32_bf16 a[164:167], v[44:47], v[228:231], a[164:167]
  v_mfma_f32_16x16x32_bf16 a[172:175], v[40:43], v[232:235], a[172:175]
  v_mfma_f32_16x16x32_bf16 a[172:175], v[44:47], v[236:239], a[172:175]
  v_mfma_f32_16x16x32_bf16 a[180:183], v[40:43], v[240:243], a[180:183]
  v_mfma_f32_16x16x32_bf16 a[180:183], v[44:47], v[244:247], a[180:183]
  v_mfma_f32_16x16x32_bf16 a[188:191], v[40:43], v[248:251], a[188:191]
  v_mfma_f32_16x16x32_bf16 a[188:191], v[44:47], v[252:255], a[188:191]
  s_waitcnt lgkmcnt(0)
  s_nop 0
  v_mfma_f32_16x16x32_bf16 a[192:195], v[32:35], v[192:195], a[192:195]
  ds_read_b128 v[40:43], v9 offset:47104
  v_mfma_f32_16x16x32_bf16 a[192:195], v[36:39], v[196:199], a[192:195]
  ds_read_b128 v[44:47], v10 offset:47104
  v_mfma_f32_16x16x32_bf16 a[200:203], v[32:35], v[200:203], a[200:203]
  v_mfma_f32_16x16x32_bf16 a[200:203], v[36:39], v[204:207], a[200:203]
  v_mfma_f32_16x16x32_bf16 a[208:211], v[32:35], v[208:211], a[208:211]
  v_mfma_f32_16x16x32_bf16 a[208:211], v[36:39], v[212:215], a[208:211]
  v_mfma_f32_16x16x32_bf16 a[216:219], v[32:35], v[216:219], a[216:219]
  v_mfma_f32_16x16x32_bf16 a[216:219], v[36:39], v[220:223], a[216:219]
  v_mfma_f32_16x16x32_bf16 a[224:227], v[32:35], v[224:227], a[224:227]
  v_mfma_f32_16x16x32_bf16 a[224:227], v[36:39], v[228:231], a[224:227]
  v_mfma_f32_16x16x32_bf16 a[232:235], v[32:35], v[232:235], a[232:235]
  v_mfma_f32_16x16x32_bf16 a[232:235], v[36:39], v[236:239], a[232:235]
  v_mfma_f32_16x16x32_bf16 a[240:243], v[32:35], v[240:243], a[240:243]
  v_mfma_f32_16x16x32_bf16 a[240:243], v[36:39], v[244:247], a[240:243]
  s_waitcnt vmcnt(3) lgkmcnt(0)
  s_barrier
  v_mfma_f32_16x16x32_bf16 a[248:251], v[32:35], v[248:251], a[248:251]
  s_add_u32 m0, s52, 32768
  v_mfma_f32_16x16x32_bf16 a[248:251], v[36:39], v[252:255], a[248:251]
  buffer_load_dwordx4 v19, s[8:11], s50 offen offset:0 lds
  v_mfma_f32_16x16x32_bf16 a[196:199], v[40:43], v[192:195], a[196:199]
  ds_read_b128 v[32:35], v9 offset:0
  v_mfma_f32_16x16x32_bf16 a[196:199], v[44:47], v[196:199], a[196:199]
  ds_read_b128 v[36:39], v10 offset:0
  v_mfma_f32_16x16x32_bf16 a[204:207], v[40:43], v[200:203], a[204:207]
  v_mfma_f32_16x16x32_bf16 a[204:207], v[44:47], v[204:207], a[204:207]
  buffer_load_dwordx4 v20, s[8:11], s50 offen offset:1024 lds
  v_mfma_f32_16x16x32_bf16 a[212:215], v[40:43], v[208:211], a[212:215]
  v_mfma_f32_16x16x32_bf16 a[212:215], v[44:47], v[212:215], a[212:215]
  v_mfma_f32_16x16x32_bf16 a[220:223], v[40:43], v[216:219], a[220:223]
  v_mfma_f32_16x16x32_bf16 a[220:223], v[44:47], v[220:223], a[220:223]
  buffer_load_dwordx4 v21, s[8:11], s50 offen offset:2048 lds
  v_mfma_f32_16x16x32_bf16 a[228:231], v[40:43], v[224:227], a[228:231]
  v_mfma_f32_16x16x32_bf16 a[228:231], v[44:47], v[228:231], a[228:231]
  v_mfma_f32_16x16x32_bf16 a[236:239], v[40:43], v[232:235], a[236:239]
  v_mfma_f32_16x16x32_bf16 a[236:239], v[44:47], v[236:239], a[236:239]
  buffer_load_dwordx4 v22, s[8:11], s50 offen offset:3072 lds
  v_mfma_f32_16x16x32_bf16 a[244:247], v[40:43], v[240:243], a[244:247]
  s_add_u32 s54, s54, 1
  s_nop 0
  v_mfma_f32_16x16x32_bf16 a[244:247], v[44:47], v[244:247], a[244:247]
  v_mfma_f32_16x16x32_bf16 a[252:255], v[40:43], v[248:251], a[252:255]
  s_add_u32 m0, s52, 36864
  s_cmp_lt_u32 s54, 6
  v_mfma_f32_16x16x32_bf16 a[252:255], v[44:47], v[252:255], a[252:255]
  s_waitcnt lgkmcnt(0)
  s_cbranch_scc1 L_k1_loop1
  v_mfma_f32_16x16x32_bf16 a[0:3], v[32:35], v[128:131], a[0:3]
  s_nop 0
  ds_read_b128 v[40:43], v9 offset:2048
  v_mfma_f32_16x16x32_bf16 a[0:3], v[36:39], v[132:135], a[0:3]
  ds_read_b128 v[44:47], v10 offset:2048
  global_load_dword v30, v31, s[40:41] sc1
  v_mfma_f32_16x16x32_bf16 a[8:11], v[32:35], v[136:139], a[8:11]
  ds_read_b64_tr_b16 v[192:193], v1 offset:32768
  v_mfma_f32_16x16x32_bf16 a[8:11], v[36:39], v[140:143], a[8:11]
  v_mfma_f32_16x16x32_bf16 a[16:19], v[32:35], v[144:147], a[16:19]
  ds_read_b64_tr_b16 v[194:195], v1 offset:34816
  v_mfma_f32_16x16x32_bf16 a[16:19], v[36:39], v[148:151], a[16:19]
  buffer_load_dwordx4 v23, s[8:11], s50 offen offset:0 lds
  v_mfma_f32_16x16x32_bf16 a[24:27], v[32:35], v[152:155], a[24:27]
  v_mfma_f32_16x16x32_bf16 a[24:27], v[36:39], v[156:159], a[24:27]
  ds_read_b64_tr_b16 v[196:197], v1 offset:49152
  v_mfma_f32_16x16x32_bf16 a[32:35], v[32:35], v[160:163], a[32:35]
  v_mfma_f32_16x16x32_bf16 a[32:35], v[36:39], v[164:167], a[32:35]
  buffer_load_dwordx4 v24, s[8:11], s50 offen offset:1024 lds
  ds_read_b64_tr_b16 v[198:199], v1 offset:51200
  v_mfma_f32_16x16x32_bf16 a[40:43], v[32:35], v[168:171], a[40:43]
  v_mfma_f32_16x16x32_bf16 a[40:43], v[36:39], v[172:175], a[40:43]
  v_mfma_f32_16x16x32_bf16 a[48:51], v[32:35], v[176:179], a[48:51]
  ds_read_b64_tr_b16 v[200:201], v2 offset:32768
  v_mfma_f32_16x16x32_bf16 a[48:51], v[36:39], v[180:183], a[48:51]
  buffer_load_dwordx4 v25, s[8:11], s50 offen offset:2048 lds
  v_mfma_f32_16x16x32_bf16 a[56:59], v[32:35], v[184:187], a[56:59]
  ds_read_b64_tr_b16 v[202:203], v2 offset:34816
  v_mfma_f32_16x16x32_bf16 a[56:59], v[36:39], v[188:191], a[56:59]
  s_waitcnt lgkmcnt(6)
  s_nop 0
  v_mfma_f32_16x16x32_bf16 a[4:7], v[40:43], v[128:131], a[4:7]
  ds_read_b128 v[32:35], v9 offset:4096
  v_mfma_f32_16x16x32_bf16 a[4:7], v[44:47], v[132:135], a[4:7]
  ds_read_b128 v[36:39], v10 offset:4096
  buffer_load_dwordx4 v26, s[8:11], s50 offen offset:3072 lds
  v_mfma_f32_16x16x32_bf16 a[12:15], v[40:43], v[136:139], a[12:15]
  ds_read_b64_tr_b16 v[204:205], v2 offset:49152
  v_mfma_f32_16x16x32_bf16 a[12:15], v[44:47], v[140:143], a[12:15]
  ds_read_b64_tr_b16 v[206:207], v2 offset:51200
  v_mfma_f32_16x16x32_bf16 a[20:23], v[40:43], v[144:147], a[20:23]
  s_add_u32 s50, s50, 128
  s_add_u32 m0, s52, 65536
  v_mfma_f32_16x16x32_bf16 a[20:23], v[44:47], v[148:151], a[20:23]
  buffer_load_dwordx4 v11, s[12:15], s51 offen offset:0  lds
  v_mfma_f32_16x16x32_bf16 a[28:31], v[40:43], v[152:155], a[28:31]
  ds_read_b64_tr_b16 v[208:209], v3 offset:32768
  v_mfma_f32_16x16x32_bf16 a[28:31], v[44:47], v[156:159], a[28:31]
  v_mfma_f32_16x16x32_bf16 a[36:39], v[40:43], v[160:163], a[36:39]
  ds_read_b64_tr_b16 v[210:211], v3 offset:34816
  v_mfma_f32_16x16x32_bf16 a[36:39], v[44:47], v[164:167], a[36:39]
  buffer_load_dwordx4 v12, s[12:15], s51 offen offset:1024  lds
  v_mfma_f32_16x16x32_bf16 a[44:47], v[40:43], v[168:171], a[44:47]
  v_mfma_f32_16x16x32_bf16 a[44:47], v[44:47], v[172:175], a[44:47]
  ds_read_b64_tr_b16 v[212:213], v3 offset:49152
  v_mfma_f32_16x16x32_bf16 a[52:55], v[40:43], v[176:179], a[52:55]
  v_mfma_f32_16x16x32_bf16 a[52:55], v[44:47], v[180:183], a[52:55]
  buffer_load_dwordx4 v13, s[12:15], s51 offen offset:2048  lds
  ds_read_b64_tr_b16 v[214:215], v3 offset:51200
  v_mfma_f32_16x16x32_bf16 a[60:63], v[40:43], v[184:187], a[60:63]
  v_mfma_f32_16x16x32_bf16 a[60:63], v[44:47], v[188:191], a[60:63]
  s_waitcnt lgkmcnt(6)
  s_nop 0
  v_mfma_f32_16x16x32_bf16 a[64:67], v[32:35], v[128:131], a[64:67]
  ds_read_b128 v[40:43], v9 offset:6144
  ds_read_b64_tr_b16 v[216:217], v4 offset:32768
  v_mfma_f32_16x16x32_bf16 a[64:67], v[36:39], v[132:135], a[64:67]
  ds_read_b128 v[44:47], v10 offset:6144
  buffer_load_dwordx4 v14, s[12:15], s51 offen offset:3072  lds
  v_mfma_f32_16x16x32_bf16 a[72:75], v[32:35], v[136:139], a[72:75]
  ds_read_b64_tr_b16 v[218:219], v4 offset:34816
  v_mfma_f32_16x16x32_bf16 a[72:75], v[36:39], v[140:143], a[72:75]
  v_mfma_f32_16x16x32_bf16 a[80:83], v[32:35], v[144:147], a[80:83]
  s_add_u32 m0, s52, 69632
  v_mfma_f32_16x16x32_bf16 a[80:83], v[36:39], v[148:151], a[80:83]
  buffer_load_dwordx4 v15, s[12:15], s51 offen offset:0  lds
  ds_read_b64_tr_b16 v[220:221], v4 offset:49152
  v_mfma_f32_16x16x32_bf16 a[88:91], v[32:35], v[152:155], a[88:91]
  v_mfma_f32_16x16x32_bf16 a[88:91], v[36:39], v[156:159], a[88:91]
  ds_read_b64_tr_b16 v[222:223], v4 offset:51200
  v_mfma_f32_16x16x32_bf16 a[96:99], v[32:35], v[160:163], a[96:99]
  v_mfma_f32_16x16x32_bf16 a[96:99], v[36:39], v[164:167], a[96:99]
  buffer_load_dwordx4 v16, s[12:15], s51 offen offset:1024  lds
  v_mfma_f32_16x16x32_bf16 a[104:107], v[32:35], v[168:171], a[104:107]
  ds_read_b64_tr_b16 v[224:225], v5 offset:32768
  v_mfma_f32_16x16x32_bf16 a[104:107], v[36:39], v[172:175], a[104:107]
  v_mfma_f32_16x16x32_bf16 a[112:115], v[32:35], v[176:179], a[112:115]
  ds_read_b64_tr_b16 v[226:227], v5 offset:34816
  v_mfma_f32_16x16x32_bf16 a[112:115], v[36:39], v[180:183], a[112:115]
  buffer_load_dwordx4 v17, s[12:15], s51 offen offset:2048  lds
  v_mfma_f32_16x16x32_bf16 a[120:123], v[32:35], v[184:187], a[120:123]
  v_mfma_f32_16x16x32_bf16 a[120:123], v[36:39], v[188:191], a[120:123]
  s_waitcnt lgkmcnt(5)
  ds_read_b64_tr_b16 v[228:229], v5 offset:49152
  v_mfma_f32_16x16x32_bf16 a[68:71], v[40:43], v[128:131], a[68:71]
  s_nop 0
  ds_read_b128 v[32:35], v9 offset:8192
  v_mfma_f32_16x16x32_bf16 a[68:71], v[44:47], v[132:135], a[68:71]
  ds_read_b128 v[36:39], v10 offset:8192
  buffer_load_dwordx4 v18, s[12:15], s51 offen offset:3072  lds
  v_mfma_f32_16x16x32_bf16 a[76:79], v[40:43], v[136:139], a[76:79]
  ds_read_b64_tr_b16 v[230:231], v5 offset:51200
  v_mfma_f32_16x16x32_bf16 a[76:79], v[44:47], v[140:143], a[76:79]
  v_mfma_f32_16x16x32_bf16 a[84:87], v[40:43], v[144:147], a[84:87]
  s_add_u32 s51, s51, 524288
  ds_read_b64_tr_b16 v[232:233], v6 offset:32768
  v_mfma_f32_16x16x32_bf16 a[84:87], v[44:47], v[148:151], a[84:87]
  buffer_load_dword v29, v27, s[8:11], s50 offen offset:128
  v_mfma_f32_16x16x32_bf16 a[92:95], v[40:43], v[152:155], a[92:95]
  ds_read_b64_tr_b16 v[234:235], v6 offset:34816
  v_mfma_f32_16x16x32_bf16 a[92:95], v[44:47], v[156:159], a[92:95]
  v_mfma_f32_16x16x32_bf16 a[100:103], v[40:43], v[160:163], a[100:103]
  buffer_load_dword v29, v28, s[12:15], s51 offen
  v_mfma_f32_16x16x32_bf16 a[100:103], v[44:47], v[164:167], a[100:103]
  ds_read_b64_tr_b16 v[236:237], v6 offset:49152
  v_mfma_f32_16x16x32_bf16 a[108:111], v[40:43], v[168:171], a[108:111]
  v_mfma_f32_16x16x32_bf16 a[108:111], v[44:47], v[172:175], a[108:111]
  buffer_load_dword v29, v62, s[28:31], s36 offen
  ds_read_b64_tr_b16 v[238:239], v6 offset:51200
  v_mfma_f32_16x16x32_bf16 a[116:119], v[40:43], v[176:179], a[116:119]
  v_mfma_f32_16x16x32_bf16 a[116:119], v[44:47], v[180:183], a[116:119]
  s_add_u32 s36, s36, 622592
  v_mfma_f32_16x16x32_bf16 a[124:127], v[40:43], v[184:187], a[124:127]
  s_lshl_b32 s60, s45, 9
  s_add_u32 s33, s60, 1048576
  v_mfma_f32_16x16x32_bf16 a[124:127], v[44:47], v[188:191], a[124:127]
  s_waitcnt lgkmcnt(5)
  s_add_u32 m0, s52, 131072
  v_mfma_f32_16x16x32_bf16 a[128:131], v[32:35], v[128:131], a[128:131]
  ds_read_b128 v[40:43], v9 offset:10240
  buffer_load_dwordx4 v11, s[16:19], s33 offen offset:0  lds
  v_mfma_f32_16x16x32_bf16 a[128:131], v[36:39], v[132:135], a[128:131]
  ds_read_b128 v[44:47], v10 offset:10240
  ds_read_b64_tr_b16 v[240:241], v7 offset:32768
  v_mfma_f32_16x16x32_bf16 a[136:139], v[32:35], v[136:139], a[136:139]
  ds_read_b64_tr_b16 v[242:243], v7 offset:34816
  v_mfma_f32_16x16x32_bf16 a[136:139], v[36:39], v[140:143], a[136:139]
  ds_read_b64_tr_b16 v[244:245], v7 offset:49152
  v_mfma_f32_16x16x32_bf16 a[144:147], v[32:35], v[144:147], a[144:147]
  buffer_load_dwordx4 v12, s[16:19], s33 offen offset:1024  lds
  v_mfma_f32_16x16x32_bf16 a[144:147], v[36:39], v[148:151], a[144:147]
  ds_read_b64_tr_b16 v[246:247], v7 offset:51200
  v_mfma_f32_16x16x32_bf16 a[152:155], v[32:35], v[152:155], a[152:155]
  v_mfma_f32_16x16x32_bf16 a[152:155], v[36:39], v[156:159], a[152:155]
  v_mfma_f32_16x16x32_bf16 a[160:163], v[32:35], v[160:163], a[160:163]
  buffer_load_dwordx4 v13, s[16:19], s33 offen offset:2048  lds
  ds_read_b64_tr_b16 v[248:249], v8 offset:32768
  v_mfma_f32_16x16x32_bf16 a[160:163], v[36:39], v[164:167], a[160:163]
  v_mfma_f32_16x16x32_bf16 a[168:171], v[32:35], v[168:171], a[168:171]
  ds_read_b64_tr_b16 v[250:251], v8 offset:34816
  v_mfma_f32_16x16x32_bf16 a[168:171], v[36:39], v[172:175], a[168:171]
  v_mfma_f32_16x16x32_bf16 a[176:179], v[32:35], v[176:179], a[176:179]
  buffer_load_dwordx4 v14, s[16:19], s33 offen offset:3072  lds
  v_mfma_f32_16x16x32_bf16 a[176:179], v[36:39], v[180:183], a[176:179]
  ds_read_b64_tr_b16 v[252:253], v8 offset:49152
  v_mfma_f32_16x16x32_bf16 a[184:187], v[32:35], v[184:187], a[184:187]
  v_mfma_f32_16x16x32_bf16 a[184:187], v[36:39], v[188:191], a[184:187]
  s_waitcnt lgkmcnt(7)
  s_add_u32 m0, s52, 135168
  v_mfma_f32_16x16x32_bf16 a[132:135], v[40:43], v[128:131], a[132:135]
  ds_read_b128 v[32:35], v9 offset:12288
  buffer_load_dwordx4 v15, s[16:19], s33 offen offset:0  lds
  v_mfma_f32_16x16x32_bf16 a[132:135], v[44:47], v[132:135], a[132:135]
  ds_read_b128 v[36:39], v10 offset:12288
  ds_read_b64_tr_b16 v[254:255], v8 offset:51200
  v_mfma_f32_16x16x32_bf16 a[140:143], v[40:43], v[136:139], a[140:143]
  s_nop 0
  v_mfma_f32_16x16x32_bf16 a[140:143], v[44:47], v[140:143], a[140:143]
  v_mfma_f32_16x16x32_bf16 a[148:151], v[40:43], v[144:147], a[148:151]
  buffer_load_dwordx4 v16, s[16:19], s33 offen offset:1024  lds
  v_mfma_f32_16x16x32_bf16 a[148:151], v[44:47], v[148:151], a[148:151]
  v_mfma_f32_16x16x32_bf16 a[156:159], v[40:43], v[152:155], a[156:159]
  v_mfma_f32_16x16x32_bf16 a[156:159], v[44:47], v[156:159], a[156:159]
  v_mfma_f32_16x16x32_bf16 a[164:167], v[40:43], v[160:163], a[164:167]
  buffer_load_dwordx4 v17, s[16:19], s33 offen offset:2048  lds
  v_mfma_f32_16x16x32_bf16 a[164:167], v[44:47], v[164:167], a[164:167]
  v_mfma_f32_16x16x32_bf16 a[172:175], v[40:43], v[168:171], a[172:175]
  v_mfma_f32_16x16x32_bf16 a[172:175], v[44:47], v[172:175], a[172:175]
  v_mfma_f32_16x16x32_bf16 a[180:183], v[40:43], v[176:179], a[180:183]
  buffer_load_dwordx4 v18, s[16:19], s33 offen offset:3072  lds
  v_mfma_f32_16x16x32_bf16 a[180:183], v[44:47], v[180:183], a[180:183]
  v_mfma_f32_16x16x32_bf16 a[188:191], v[40:43], v[184:187], a[188:191]
  v_mfma_f32_16x16x32_bf16 a[188:191], v[44:47], v[188:191], a[188:191]
  s_waitcnt lgkmcnt(1)
  s_nop 0
  v_mfma_f32_16x16x32_bf16 a[192:195], v[32:35], v[128:131], a[192:195]
  ds_read_b128 v[40:43], v9 offset:14336
  v_mfma_f32_16x16x32_bf16 a[192:195], v[36:39], v[132:135], a[192:195]
  ds_read_b128 v[44:47], v10 offset:14336
  v_mfma_f32_16x16x32_bf16 a[200:203], v[32:35], v[136:139], a[200:203]
  v_mfma_f32_16x16x32_bf16 a[200:203], v[36:39], v[140:143], a[200:203]
  v_mfma_f32_16x16x32_bf16 a[208:211], v[32:35], v[144:147], a[208:211]
  v_mfma_f32_16x16x32_bf16 a[208:211], v[36:39], v[148:151], a[208:211]
  v_mfma_f32_16x16x32_bf16 a[216:219], v[32:35], v[152:155], a[216:219]
  v_mfma_f32_16x16x32_bf16 a[216:219], v[36:39], v[156:159], a[216:219]
  v_mfma_f32_16x16x32_bf16 a[224:227], v[32:35], v[160:163], a[224:227]
  v_mfma_f32_16x16x32_bf16 a[224:227], v[36:39], v[164:167], a[224:227]
  v_mfma_f32_16x16x32_bf16 a[232:235], v[32:35], v[168:171], a[232:235]
  v_mfma_f32_16x16x32_bf16 a[232:235], v[36:39], v[172:175], a[232:235]
  v_mfma_f32_16x16x32_bf16 a[240:243], v[32:35], v[176:179], a[240:243]
  v_mfma_f32_16x16x32_bf16 a[240:243], v[36:39], v[180:183], a[240:243]
  s_waitcnt vmcnt(11) lgkmcnt(0)
  s_barrier
  v_mfma_f32_16x16x32_bf16 a[248:251], v[32:35], v[184:187], a[248:251]
  s_add_u32 m0, s52, 0
  s_nop 0
  v_mfma_f32_16x16x32_bf16 a[248:251], v[36:39], v[188:191], a[248:251]
  buffer_load_dwordx4 v19, s[8:11], s50 offen offset:0 lds
  v_mfma_f32_16x16x32_bf16 a[196:199], v[40:43], v[128:131], a[196:199]
  ds_read_b128 v[32:35], v9 offset:32768
  v_mfma_f32_16x16x32_bf16 a[196:199], v[44:47], v[132:135], a[196:199]
  ds_read_b128 v[36:39], v10 offset:32768
  v_cmp_gt_u32 vcc, 16, v30
  v_mfma_f32_16x16x32_bf16 a[204:207], v[40:43], v[136:139], a[204:207]
  s_nop 0
  v_mfma_f32_16x16x32_bf16 a[204:207], v[44:47], v[140:143], a[204:207]
  buffer_load_dwordx4 v20, s[8:11], s50 offen offset:1024 lds
  v_mfma_f32_16x16x32_bf16 a[212:215], v[40:43], v[144:147], a[212:215]
  v_mfma_f32_16x16x32_bf16 a[212:215], v[44:47], v[148:151], a[212:215]
  s_cbranch_vccnz L_k1_spin1
L_k1_spinret1:
  s_nop 0
  v_mfma_f32_16x16x32_bf16 a[220:223], v[40:43], v[152:155], a[220:223]
  v_mfma_f32_16x16x32_bf16 a[220:223], v[44:47], v[156:159], a[220:223]
  buffer_load_dwordx4 v21, s[8:11], s50 offen offset:2048 lds
  v_mfma_f32_16x16x32_bf16 a[228:231], v[40:43], v[160:163], a[228:231]
  v_mfma_f32_16x16x32_bf16 a[228:231], v[44:47], v[164:167], a[228:231]
  v_mfma_f32_16x16x32_bf16 a[236:239], v[40:43], v[168:171], a[236:239]
  v_mfma_f32_16x16x32_bf16 a[236:239], v[44:47], v[172:175], a[236:239]
  buffer_load_dwordx4 v22, s[8:11], s50 offen offset:3072 lds
  v_mfma_f32_16x16x32_bf16 a[244:247], v[40:43], v[176:179], a[244:247]
  v_mfma_f32_16x16x32_bf16 a[244:247], v[44:47], v[180:183], a[244:247]
  v_mfma_f32_16x16x32_bf16 a[252:255], v[40:43], v[184:187], a[252:255]
  s_add_u32 m0, s52, 4096
  v_mfma_f32_16x16x32_bf16 a[252:255], v[44:47], v[188:191], a[252:255]
  s_waitcnt lgkmcnt(0)
  s_nop 0
  v_mfma_f32_16x16x32_bf16 a[0:3], v[32:35], v[192:195], a[0:3]
  ds_read_b128 v[40:43], v9 offset:34816
  v_mfma_f32_16x16x32_bf16 a[0:3], v[36:39], v[196:199], a[0:3]
  ds_read_b128 v[44:47], v10 offset:34816
  buffer_load_dwordx4 v23, s[8:11], s50 offen offset:0 lds
  v_mfma_f32_16x16x32_bf16 a[8:11], v[32:35], v[200:203], a[8:11]
  ds_read_b64_tr_b16 v[128:129], v1 offset:0
  v_mfma_f32_16x16x32_bf16 a[8:11], v[36:39], v[204:207], a[8:11]
  v_mfma_f32_16x16x32_bf16 a[16:19], v[32:35], v[208:211], a[16:19]
  ds_read_b64_tr_b16 v[130:131], v1 offset:2048
  v_mfma_f32_16x16x32_bf16 a[16:19], v[36:39], v[212:215], a[16:19]
  buffer_load_dwordx4 v24, s[8:11], s50 offen offset:1024 lds
  v_mfma_f32_16x16x32_bf16 a[24:27], v[32:35], v[216:219], a[24:27]
  v_mfma_f32_16x16x32_bf16 a[24:27], v[36:39], v[220:223], a[24:27]
  ds_read_b64_tr_b16 v[132:133], v1 offset:16384
  v_mfma_f32_16x16x32_bf16 a[32:35], v[32:35], v[224:227], a[32:35]
  v_mfma_f32_16x16x32_bf16 a[32:35], v[36:39], v[228:231], a[32:35]
  buffer_load_dwordx4 v25, s[8:11], s50 offen offset:2048 lds
  ds_read_b64_tr_b16 v[134:135], v1 offset:18432
  v_mfma_f32_16x16x32_bf16 a[40:43], v[32:35], v[232:235], a[40:43]
  v_mfma_f32_16x16x32_bf16 a[40:43], v[36:39], v[236:239], a[40:43]
  v_mfma_f32_16x16x32_bf16 a[48:51], v[32:35], v[240:243], a[48:51]
  ds_read_b64_tr_b16 v[136:137], v2 offset:0
  v_mfma_f32_16x16x32_bf16 a[48:51], v[36:39], v[244:247], a[48:51]
  buffer_load_dwordx4 v26, s[8:11], s50 offen offset:3072 lds
  v_mfma_f32_16x16x32_bf16 a[56:59], v[32:35], v[248:251], a[56:59]
  ds_read_b64_tr_b16 v[138:139], v2 offset:2048
  v_mfma_f32_16x16x32_bf16 a[56:59], v[36:39], v[252:255], a[56:59]
  s_waitcnt lgkmcnt(6)
  s_nop 0
  v_mfma_f32_16x16x32_bf16 a[4:7], v[40:43], v[192:195], a[4:7]
  ds_read_b128 v[32:35], v9 offset:36864
  s_add_u32 s50, s50, 128
  v_mfma_f32_16x16x32_bf16 a[4:7], v[44:47], v[196:199], a[4:7]
  ds_read_b128 v[36:39], v10 offset:36864
  s_add_u32 m0, s52, 98304
  v_mfma_f32_16x16x32_bf16 a[12:15], v[40:43], v[200:203], a[12:15]
  buffer_load_dwordx4 v11, s[12:15], s51 offen offset:0  lds
  ds_read_b64_tr_b16 v[140:141], v2 offset:16384
  v_mfma_f32_16x16x32_bf16 a[12:15], v[44:47], v[204:207], a[12:15]
  ds_read_b64_tr_b16 v[142:143], v2 offset:18432
  v_mfma_f32_16x16x32_bf16 a[20:23], v[40:43], v[208:211], a[20:23]
  v_mfma_f32_16x16x32_bf16 a[20:23], v[44:47], v[212:215], a[20:23]
  v_mfma_f32_16x16x32_bf16 a[28:31], v[40:43], v[216:219], a[28:31]
  buffer_load_dwordx4 v12, s[12:15], s51 offen offset:1024  lds
  ds_read_b64_tr_b16 v[144:145], v3 offset:0
  v_mfma_f32_16x16x32_bf16 a[28:31], v[44:47], v[220:223], a[28:31]
  v_mfma_f32_16x16x32_bf16 a[36:39], v[40:43], v[224:227], a[36:39]
  ds_read_b64_tr_b16 v[146:147], v3 offset:2048
  v_mfma_f32_16x16x32_bf16 a[36:39], v[44:47], v[228:231], a[36:39]
  v_mfma_f32_16x16x32_bf16 a[44:47], v[40:43], v[232:235], a[44:47]
  buffer_load_dwordx4 v13, s[12:15], s51 offen offset:2048  lds
  v_mfma_f32_16x16x32_bf16 a[44:47], v[44:47], v[236:239], a[44:47]
  ds_read_b64_tr_b16 v[148:149], v3 offset:16384
  v_mfma_f32_16x16x32_bf16 a[52:55], v[40:43], v[240:243], a[52:55]
  v_mfma_f32_16x16x32_bf16 a[52:55], v[44:47], v[244:247], a[52:55]
  ds_read_b64_tr_b16 v[150:151], v3 offset:18432
  v_mfma_f32_16x16x32_bf16 a[60:63], v[40:43], v[248:251], a[60:63]
  buffer_load_dwordx4 v14, s[12:15], s51 offen offset:3072  lds
  v_mfma_f32_16x16x32_bf16 a[60:63], v[44:47], v[252:255], a[60:63]
  s_waitcnt lgkmcnt(6)
  s_nop 0
  v_mfma_f32_16x16x32_bf16 a[64:67], v[32:35], v[192:195], a[64:67]
  ds_read_b128 v[40:43], v9 offset:38912
  ds_read_b64_tr_b16 v[152:153], v4 offset:0
  v_mfma_f32_16x16x32_bf16 a[64:67], v[36:39], v[196:199], a[64:67]
  ds_read_b128 v[44:47], v10 offset:38912
  s_add_u32 m0, s52, 102400
  v_mfma_f32_16x16x32_bf16 a[72:75], v[32:35], v[200:203], a[72:75]
  buffer_load_dwordx4 v15, s[12:15], s51 offen offset:0  lds
  ds_read_b64_tr_b16 v[154:155], v4 offset:2048
  v_mfma_f32_16x16x32_bf16 a[72:75], v[36:39], v[204:207], a[72:75]
  v_mfma_f32_16x16x32_bf16 a[80:83], v[32:35], v[208:211], a[80:83]
  v_mfma_f32_16x16x32_bf16 a[80:83], v[36:39], v[212:215], a[80:83]
  ds_read_b64_tr_b16 v[156:157], v4 offset:16384
  v_mfma_f32_16x16x32_bf16 a[88:91], v[32:35], v[216:219], a[88:91]
  buffer_load_dwordx4 v16, s[12:15], s51 offen offset:1024  lds
  v_mfma_f32_16x16x32_bf16 a[88:91], v[36:39], v[220:223], a[88:91]
  ds_read_b64_tr_b16 v[158:159], v4 offset:18432
  v_mfma_f32_16x16x32_bf16 a[96:99], v[32:35], v[224:227], a[96:99]
  v_mfma_f32_16x16x32_bf16 a[96:99], v[36:39], v[228:231], a[96:99]
  v_mfma_f32_16x16x32_bf16 a[104:107], v[32:35], v[232:235], a[104:107]
  buffer_load_dwordx4 v17, s[12:15], s51 offen offset:2048  lds
  ds_read_b64_tr_b16 v[160:161], v5 offset:0
  v_mfma_f32_16x16x32_bf16 a[104:107], v[36:39], v[236:239], a[104:107]
  v_mfma_f32_16x16x32_bf16 a[112:115], v[32:35], v[240:243], a[112:115]
  ds_read_b64_tr_b16 v[162:163], v5 offset:2048
  v_mfma_f32_16x16x32_bf16 a[112:115], v[36:39], v[244:247], a[112:115]
  v_mfma_f32_16x16x32_bf16 a[120:123], v[32:35], v[248:251], a[120:123]
  buffer_load_dwordx4 v18, s[12:15], s51 offen offset:3072  lds
  v_mfma_f32_16x16x32_bf16 a[120:123], v[36:39], v[252:255], a[120:123]
  s_waitcnt lgkmcnt(5)
  ds_read_b64_tr_b16 v[164:165], v5 offset:16384
  v_mfma_f32_16x16x32_bf16 a[68:71], v[40:43], v[192:195], a[68:71]
  s_nop 0
  ds_read_b128 v[32:35], v9 offset:40960
  v_mfma_f32_16x16x32_bf16 a[68:71], v[44:47], v[196:199], a[68:71]
  ds_read_b128 v[36:39], v10 offset:40960
  s_add_u32 s51, s51, 524288
  v_mfma_f32_16x16x32_bf16 a[76:79], v[40:43], v[200:203], a[76:79]
  buffer_load_dword v29, v27, s[8:11], s50 offen offset:128
  ds_read_b64_tr_b16 v[166:167], v5 offset:18432
  v_mfma_f32_16x16x32_bf16 a[76:79], v[44:47], v[204:207], a[76:79]
  v_mfma_f32_16x16x32_bf16 a[84:87], v[40:43], v[208:211], a[84:87]
  ds_read_b64_tr_b16 v[168:169], v6 offset:0
  v_mfma_f32_16x16x32_bf16 a[84:87], v[44:47], v[212:215], a[84:87]
  buffer_load_dword v29, v62, s[28:31], s36 offen
  v_mfma_f32_16x16x32_bf16 a[92:95], v[40:43], v[216:219], a[92:95]
  ds_read_b64_tr_b16 v[170:171], v6 offset:2048
  v_mfma_f32_16x16x32_bf16 a[92:95], v[44:47], v[220:223], a[92:95]
  s_add_u32 s36, s36, 622592
  v_mfma_f32_16x16x32_bf16 a[100:103], v[40:43], v[224:227], a[100:103]
  buffer_load_dwordx4 v[48:51], v0, s[20:23], s34 offen offset:0 sc1
  v_mfma_f32_16x16x32_bf16 a[100:103], v[44:47], v[228:231], a[100:103]
  ds_read_b64_tr_b16 v[172:173], v6 offset:16384
  v_mfma_f32_16x16x32_bf16 a[108:111], v[40:43], v[232:235], a[108:111]
  v_mfma_f32_16x16x32_bf16 a[108:111], v[44:47], v[236:239], a[108:111]
  ds_read_b64_tr_b16 v[174:175], v6 offset:18432
  v_mfma_f32_16x16x32_bf16 a[116:119], v[40:43], v[240:243], a[116:119]
  buffer_load_dwordx4 v[52:55], v0, s[20:23], s34 offen offset:1024 sc1
  v_mfma_f32_16x16x32_bf16 a[116:119], v[44:47], v[244:247], a[116:119]
  v_mfma_f32_16x16x32_bf16 a[124:127], v[40:43], v[248:251], a[124:127]
  ds_read_b64_tr_b16 v[176:177], v7 offset:0
  v_mfma_f32_16x16x32_bf16 a[124:127], v[44:47], v[252:255], a[124:127]
  s_waitcnt lgkmcnt(6)
  s_nop 0
  v_mfma_f32_16x16x32_bf16 a[128:131], v[32:35], v[192:195], a[128:131]
  ds_read_b128 v[40:43], v9 offset:43008
  buffer_load_dwordx4 v[56:59], v0, s[20:23], s35 offen offset:0 sc1
  v_mfma_f32_16x16x32_bf16 a[128:131], v[36:39], v[196:199], a[128:131]
  ds_read_b128 v[44:47], v10 offset:43008
  ds_read_b64_tr_b16 v[178:179], v7 offset:2048
  v_mfma_f32_16x16x32_bf16 a[136:139], v[32:35], v[200:203], a[136:139]
  v_mfma_f32_16x16x32_bf16 a[136:139], v[36:39], v[204:207], a[136:139]
  ds_read_b64_tr_b16 v[180:181], v7 offset:16384
  v_mfma_f32_16x16x32_bf16 a[144:147], v[32:35], v[208:211], a[144:147]
  buffer_load_dwordx4 v[60:63], v0, s[20:23], s35 offen offset:1024 sc1
  v_mfma_f32_16x16x32_bf16 a[144:147], v[36:39], v[212:215], a[144:147]
  ds_read_b64_tr_b16 v[182:183], v7 offset:18432
  v_mfma_f32_16x16x32_bf16 a[152:155], v[32:35], v[216:219], a[152:155]
  v_mfma_f32_16x16x32_bf16 a[152:155], v[36:39], v[220:223], a[152:155]
  v_mfma_f32_16x16x32_bf16 a[160:163], v[32:35], v[224:227], a[160:163]
  buffer_load_dwordx4 v[64:67], v0, s[20:23], s34 offen offset:2048 sc1
  ds_read_b64_tr_b16 v[184:185], v8 offset:0
  v_mfma_f32_16x16x32_bf16 a[160:163], v[36:39], v[228:231], a[160:163]
  v_mfma_f32_16x16x32_bf16 a[168:171], v[32:35], v[232:235], a[168:171]
  ds_read_b64_tr_b16 v[186:187], v8 offset:2048
  v_mfma_f32_16x16x32_bf16 a[168:171], v[36:39], v[236:239], a[168:171]
  v_mfma_f32_16x16x32_bf16 a[176:179], v[32:35], v[240:243], a[176:179]
  buffer_load_dwordx4 v[68:71], v0, s[20:23], s34 offen offset:3072 sc1
  v_mfma_f32_16x16x32_bf16 a[176:179], v[36:39], v[244:247], a[176:179]
  ds_read_b64_tr_b16 v[188:189], v8 offset:16384
  v_mfma_f32_16x16x32_bf16 a[184:187], v[32:35], v[248:251], a[184:187]
  v_mfma_f32_16x16x32_bf16 a[184:187], v[36:39], v[252:255], a[184:187]
  s_waitcnt lgkmcnt(6)
  s_nop 0
  v_mfma_f32_16x16x32_bf16 a[132:135], v[40:43], v[192:195], a[132:135]
  ds_read_b128 v[32:35], v9 offset:45056
  buffer_load_dwordx4 v[72:75], v0, s[20:23], s35 offen offset:2048 sc1
  v_mfma_f32_16x16x32_bf16 a[132:135], v[44:47], v[196:199], a[132:135]
  ds_read_b128 v[36:39], v10 offset:45056
  ds_read_b64_tr_b16 v[190:191], v8 offset:18432
  v_mfma_f32_16x16x32_bf16 a[140:143], v[40:43], v[200:203], a[140:143]
  v_mfma_f32_16x16x32_bf16 a[140:143], v[44:47], v[204:207], a[140:143]
  v_mfma_f32_16x16x32_bf16 a[148:151], v[40:43], v[208:211], a[148:151]
  buffer_load_dwordx4 v[76:79], v0, s[20:23], s35 offen offset:3072 sc1
  v_mfma_f32_16x16x32_bf16 a[148:151], v[44:47], v[212:215], a[148:151]
  v_mfma_f32_16x16x32_bf16 a[156:159], v[40:43], v[216:219], a[156:159]
  v_mfma_f32_16x16x32_bf16 a[156:159], v[44:47], v[220:223], a[156:159]
  s_add_u32 s34, s34, 4096
  s_add_u32 s35, s35, 4096
  v_mfma_f32_16x16x32_bf16 a[164:167], v[40:43], v[224:227], a[164:167]
  buffer_load_dwordx4 v[80:83], v0, s[20:23], s34 offen offset:0 sc1
  v_mfma_f32_16x16x32_bf16 a[164:167], v[44:47], v[228:231], a[164:167]
  v_mfma_f32_16x16x32_bf16 a[172:175], v[40:43], v[232:235], a[172:175]
  v_mfma_f32_16x16x32_bf16 a[172:175], v[44:47], v[236:239], a[172:175]
  v_mfma_f32_16x16x32_bf16 a[180:183], v[40:43], v[240:243], a[180:183]
  buffer_load_dwordx4 v[84:87], v0, s[20:23], s34 offen offset:1024 sc1
  v_mfma_f32_16x16x32_bf16 a[180:183], v[44:47], v[244:247], a[180:183]
  v_mfma_f32_16x16x32_bf16 a[188:191], v[40:43], v[248:251], a[188:191]
  v_mfma_f32_16x16x32_bf16 a[188:191], v[44:47], v[252:255], a[188:191]
  s_waitcnt lgkmcnt(1)
  s_nop 0
  v_mfma_f32_16x16x32_bf16 a[192:195], v[32:35], v[192:195], a[192:195]
  ds_read_b128 v[40:43], v9 offset:47104
  buffer_load_dwordx4 v[88:91], v0, s[20:23], s35 offen offset:0 sc1
  v_mfma_f32_16x16x32_bf16 a[192:195], v[36:39], v[196:199], a[192:195]
  ds_read_b128 v[44:47], v10 offset:47104
  v_mfma_f32_16x16x32_bf16 a[200:203], v[32:35], v[200:203], a[200:203]
  v_mfma_f32_16x16x32_bf16 a[200:203], v[36:39], v[204:207], a[200:203]
  v_mfma_f32_16x16x32_bf16 a[208:211], v[32:35], v[208:211], a[208:211]
  buffer_load_dwordx4 v[92:95], v0, s[20:23], s35 offen offset:1024 sc1
  v_mfma_f32_16x16x32_bf16 a[208:211], v[36:39], v[212:215], a[208:211]
  v_mfma_f32_16x16x32_bf16 a[216:219], v[32:35], v[216:219], a[216:219]
  v_mfma_f32_16x16x32_bf16 a[216:219], v[36:39], v[220:223], a[216:219]
  v_mfma_f32_16x16x32_bf16 a[224:227], v[32:35], v[224:227], a[224:227]
  v_mfma_f32_16x16x32_bf16 a[224:227], v[36:39], v[228:231], a[224:227]
  v_mfma_f32_16x16x32_bf16 a[232:235], v[32:35], v[232:235], a[232:235]
  v_mfma_f32_16x16x32_bf16 a[232:235], v[36:39], v[236:239], a[232:235]
  v_mfma_f32_16x16x32_bf16 a[240:243], v[32:35], v[240:243], a[240:243]
  v_mfma_f32_16x16x32_bf16 a[240:243], v[36:39], v[244:247], a[240:243]
  s_waitcnt vmcnt(14) lgkmcnt(0)
  s_barrier
  v_mfma_f32_16x16x32_bf16 a[248:251], v[32:35], v[248:251], a[248:251]
  s_add_u32 m0, s52, 32768
  v_mfma_f32_16x16x32_bf16 a[248:251], v[36:39], v[252:255], a[248:251]
  buffer_load_dwordx4 v19, s[8:11], s50 offen offset:0 lds
  v_mfma_f32_16x16x32_bf16 a[196:199], v[40:43], v[192:195], a[196:199]
  ds_read_b128 v[32:35], v9 offset:0
  v_mfma_f32_16x16x32_bf16 a[196:199], v[44:47], v[196:199], a[196:199]
  ds_read_b128 v[36:39], v10 offset:0
  v_mfma_f32_16x16x32_bf16 a[204:207], v[40:43], v[200:203], a[204:207]
  v_mfma_f32_16x16x32_bf16 a[204:207], v[44:47], v[204:207], a[204:207]
  buffer_load_dwordx4 v20, s[8:11], s50 offen offset:1024 lds
  v_mfma_f32_16x16x32_bf16 a[212:215], v[40:43], v[208:211], a[212:215]
  v_mfma_f32_16x16x32_bf16 a[212:215], v[44:47], v[212:215], a[212:215]
  v_mfma_f32_16x16x32_bf16 a[220:223], v[40:43], v[216:219], a[220:223]
  v_mfma_f32_16x16x32_bf16 a[220:223], v[44:47], v[220:223], a[220:223]
  buffer_load_dwordx4 v21, s[8:11], s50 offen offset:2048 lds
  v_mfma_f32_16x16x32_bf16 a[228:231], v[40:43], v[224:227], a[228:231]
  v_mfma_f32_16x16x32_bf16 a[228:231], v[44:47], v[228:231], a[228:231]
  v_mfma_f32_16x16x32_bf16 a[236:239], v[40:43], v[232:235], a[236:239]
  v_mfma_f32_16x16x32_bf16 a[236:239], v[44:47], v[236:239], a[236:239]
  buffer_load_dwordx4 v22, s[8:11], s50 offen offset:3072 lds
  v_mfma_f32_16x16x32_bf16 a[244:247], v[40:43], v[240:243], a[244:247]
  v_mfma_f32_16x16x32_bf16 a[244:247], v[44:47], v[244:247], a[244:247]
  v_mfma_f32_16x16x32_bf16 a[252:255], v[40:43], v[248:251], a[252:255]
  s_add_u32 m0, s52, 36864
  v_mfma_f32_16x16x32_bf16 a[252:255], v[44:47], v[252:255], a[252:255]
  s_waitcnt lgkmcnt(0)
  s_nop 0
  v_mfma_f32_16x16x32_bf16 a[0:3], v[32:35], v[128:131], a[0:3]
  ds_read_b128 v[40:43], v9 offset:2048
  v_mfma_f32_16x16x32_bf16 a[0:3], v[36:39], v[132:135], a[0:3]
  ds_read_b128 v[44:47], v10 offset:2048
  ds_read_b64_tr_b16 v[192:193], v1 offset:32768
  v_mfma_f32_16x16x32_bf16 a[8:11], v[32:35], v[136:139], a[8:11]
  ds_read_b64_tr_b16 v[194:195], v1 offset:34816
  buffer_load_dwordx4 v23, s[8:11], s50 offen offset:0 lds
  v_mfma_f32_16x16x32_bf16 a[8:11], v[36:39], v[140:143], a[8:11]
  ds_read_b64_tr_b16 v[196:197], v1 offset:49152
  v_mfma_f32_16x16x32_bf16 a[16:19], v[32:35], v[144:147], a[16:19]
  ds_read_b64_tr_b16 v[198:199], v1 offset:51200
  v_mfma_f32_16x16x32_bf16 a[16:19], v[36:39], v[148:151], a[16:19]
  ds_read_b64_tr_b16 v[200:201], v2 offset:32768
  v_mfma_f32_16x16x32_bf16 a[24:27], v[32:35], v[152:155], a[24:27]
  ds_read_b64_tr_b16 v[202:203], v2 offset:34816
  buffer_load_dwordx4 v24, s[8:11], s50 offen offset:1024 lds
  v_mfma_f32_16x16x32_bf16 a[24:27], v[36:39], v[156:159], a[24:27]
  ds_read_b64_tr_b16 v[204:205], v2 offset:49152
  v_mfma_f32_16x16x32_bf16 a[32:35], v[32:35], v[160:163], a[32:35]
  ds_read_b64_tr_b16 v[206:207], v2 offset:51200
  v_mfma_f32_16x16x32_bf16 a[32:35], v[36:39], v[164:167], a[32:35]
  ds_read_b64_tr_b16 v[208:209], v3 offset:32768
  v_mfma_f32_16x16x32_bf16 a[40:43], v[32:35], v[168:171], a[40:43]
  ds_read_b64_tr_b16 v[210:211], v3 offset:34816
  buffer_load_dwordx4 v25, s[8:11], s50 offen offset:2048 lds
  v_mfma_f32_16x16x32_bf16 a[40:43], v[36:39], v[172:175], a[40:43]
  ds_read_b64_tr_b16 v[212:213], v3 offset:49152
  v_mfma_f32_16x16x32_bf16 a[48:51], v[32:35], v[176:179], a[48:51]
  ds_read_b64_tr_b16 v[214:215], v3 offset:51200
  v_mfma_f32_16x16x32_bf16 a[48:51], v[36:39], v[180:183], a[48:51]
  ds_read_b64_tr_b16 v[216:217], v4 offset:32768
  v_mfma_f32_16x16x32_bf16 a[56:59], v[32:35], v[184:187], a[56:59]
  ds_read_b64_tr_b16 v[218:219], v4 offset:34816
  buffer_load_dwordx4 v26, s[8:11], s50 offen offset:3072 lds
  v_mfma_f32_16x16x32_bf16 a[56:59], v[36:39], v[188:191], a[56:59]
  s_waitcnt lgkmcnt(14)
  ds_read_b64_tr_b16 v[220:221], v4 offset:49152
  v_mfma_f32_16x16x32_bf16 a[4:7], v[40:43], v[128:131], a[4:7]
  s_nop 0
  ds_read_b64_tr_b16 v[222:223], v4 offset:51200
  v_mfma_f32_16x16x32_bf16 a[4:7], v[44:47], v[132:135], a[4:7]
  s_add_u32 s50, s50, 128
  s_add_u32 s33, s60, 0
  v_mfma_f32_16x16x32_bf16 a[12:15], v[40:43], v[136:139], a[12:15]
  ds_read_b64_tr_b16 v[224:225], v5 offset:32768
  s_add_u32 m0, s52, 65536
  v_mfma_f32_16x16x32_bf16 a[12:15], v[44:47], v[140:143], a[12:15]
  s_waitcnt vmcnt(4)
  s_barrier
  v_mfma_f32_16x16x32_bf16 a[20:23], v[40:43], v[144:147], a[20:23]
  ds_read_b128 v[32:35], v9 offset:32768
  ds_read_b64_tr_b16 v[226:227], v5 offset:34816
  v_mfma_f32_16x16x32_bf16 a[20:23], v[44:47], v[148:151], a[20:23]
  ds_read_b128 v[36:39], v10 offset:32768
  ds_read_b64_tr_b16 v[228:229], v5 offset:49152
  v_mfma_f32_16x16x32_bf16 a[28:31], v[40:43], v[152:155], a[28:31]
  ds_read_b64_tr_b16 v[230:231], v5 offset:51200
  ds_read_b64_tr_b16 v[232:233], v6 offset:32768
  v_mfma_f32_16x16x32_bf16 a[28:31], v[44:47], v[156:159], a[28:31]
  ds_read_b64_tr_b16 v[234:235], v6 offset:34816
  buffer_load_dwordx4 v11, s[16:19], s33 offen offset:0  lds
  v_mfma_f32_16x16x32_bf16 a[36:39], v[40:43], v[160:163], a[36:39]
  s_nop 0
  ds_read_b64_tr_b16 v[236:237], v6 offset:49152
  v_mfma_f32_16x16x32_bf16 a[36:39], v[44:47], v[164:167], a[36:39]
  ds_read_b64_tr_b16 v[238:239], v6 offset:51200
  v_mfma_f32_16x16x32_bf16 a[44:47], v[40:43], v[168:171], a[44:47]
  ds_read_b64_tr_b16 v[240:241], v7 offset:32768
  v_mfma_f32_16x16x32_bf16 a[44:47], v[44:47], v[172:175], a[44:47]
  ds_read_b64_tr_b16 v[242:243], v7 offset:34816
  buffer_load_dwordx4 v12, s[16:19], s33 offen offset:1024  lds
  v_mfma_f32_16x16x32_bf16 a[52:55], v[40:43], v[176:179], a[52:55]
  ds_read_b64_tr_b16 v[244:245], v7 offset:49152
  v_mfma_f32_16x16x32_bf16 a[52:55], v[44:47], v[180:183], a[52:55]
  ds_read_b64_tr_b16 v[246:247], v7 offset:51200
  v_mfma_f32_16x16x32_bf16 a[60:63], v[40:43], v[184:187], a[60:63]
  ds_read_b64_tr_b16 v[248:249], v8 offset:32768
  v_mfma_f32_16x16x32_bf16 a[60:63], v[44:47], v[188:191], a[60:63]
  s_waitcnt lgkmcnt(11)
  ds_read_b64_tr_b16 v[250:251], v8 offset:34816
  v_mfma_f32_16x16x32_bf16 a[0:3], v[32:35], v[192:195], a[0:3]
  ds_read_b128 v[40:43], v9 offset:34816
  ds_read_b64_tr_b16 v[252:253], v8 offset:49152
  v_mfma_f32_16x16x32_bf16 a[0:3], v[36:39], v[196:199], a[0:3]
  ds_read_b128 v[44:47], v10 offset:34816
  buffer_load_dwordx4 v13, s[16:19], s33 offen offset:2048  lds
  v_mfma_f32_16x16x32_bf16 a[8:11], v[32:35], v[200:203], a[8:11]
  s_nop 0
  ds_read_b64_tr_b16 v[254:255], v8 offset:51200
  v_mfma_f32_16x16x32_bf16 a[8:11], v[36:39], v[204:207], a[8:11]
  s_waitcnt lgkmcnt(15)
  s_nop 0
  v_mfma_f32_16x16x32_bf16 a[16:19], v[32:35], v[208:211], a[16:19]
  v_mfma_f32_16x16x32_bf16 a[16:19], v[36:39], v[212:215], a[16:19]
  buffer_load_dwordx4 v14, s[16:19], s33 offen offset:3072  lds
  v_mfma_f32_16x16x32_bf16 a[24:27], v[32:35], v[216:219], a[24:27]
  v_mfma_f32_16x16x32_bf16 a[24:27], v[36:39], v[220:223], a[24:27]
  s_waitcnt lgkmcnt(10)
  s_nop 0
  v_mfma_f32_16x16x32_bf16 a[32:35], v[32:35], v[224:227], a[32:35]
  s_add_u32 m0, s52, 69632
  v_mfma_f32_16x16x32_bf16 a[32:35], v[36:39], v[228:231], a[32:35]
  buffer_load_dwordx4 v15, s[16:19], s33 offen offset:0  lds
  v_mfma_f32_16x16x32_bf16 a[40:43], v[32:35], v[232:235], a[40:43]
  v_mfma_f32_16x16x32_bf16 a[40:43], v[36:39], v[236:239], a[40:43]
  s_waitcnt lgkmcnt(0)
  s_nop 0
  v_mfma_f32_16x16x32_bf16 a[48:51], v[32:35], v[240:243], a[48:51]
  v_mfma_f32_16x16x32_bf16 a[48:51], v[36:39], v[244:247], a[48:51]
  buffer_load_dwordx4 v16, s[16:19], s33 offen offset:1024  lds
  v_mfma_f32_16x16x32_bf16 a[56:59], v[32:35], v[248:251], a[56:59]
  v_mfma_f32_16x16x32_bf16 a[56:59], v[36:39], v[252:255], a[56:59]
  s_barrier
  s_waitcnt lgkmcnt(15)
  v_mfma_f32_16x16x32_bf16 a[4:7], v[40:43], v[192:195], a[4:7]
  ds_read_b128 v[32:35], v9 offset:4096
  v_subrev_u32_e64 v1, s7, v1
  v_mfma_f32_16x16x32_bf16 a[4:7], v[44:47], v[196:199], a[4:7]
  ds_read_b128 v[36:39], v10 offset:4096
  buffer_load_dwordx4 v17, s[16:19], s33 offen offset:2048  lds
  v_mfma_f32_16x16x32_bf16 a[12:15], v[40:43], v[200:203], a[12:15]
  v_subrev_u32_e64 v2, s7, v2
  v_mfma_f32_16x16x32_bf16 a[12:15], v[44:47], v[204:207], a[12:15]
  v_mfma_f32_16x16x32_bf16 a[20:23], v[40:43], v[208:211], a[20:23]
  v_subrev_u32_e64 v3, s7, v3
  v_mfma_f32_16x16x32_bf16 a[20:23], v[44:47], v[212:215], a[20:23]
  buffer_load_dwordx4 v18, s[16:19], s33 offen offset:3072  lds
  v_mfma_f32_16x16x32_bf16 a[28:31], v[40:43], v[216:219], a[28:31]
  v_subrev_u32_e64 v4, s7, v4
  v_mfma_f32_16x16x32_bf16 a[28:31], v[44:47], v[220:223], a[28:31]
  v_mfma_f32_16x16x32_bf16 a[36:39], v[40:43], v[224:227], a[36:39]
  v_subrev_u32_e64 v5, s7, v5
  v_mfma_f32_16x16x32_bf16 a[36:39], v[44:47], v[228:231], a[36:39]
  s_add_u32 s33, s60, 524288
  s_add_u32 m0, s52, 98304
  v_mfma_f32_16x16x32_bf16 a[44:47], v[40:43], v[232:235], a[44:47]
  buffer_load_dwordx4 v11, s[16:19], s33 offen offset:0  lds
  v_subrev_u32_e64 v6, s7, v6
  v_mfma_f32_16x16x32_bf16 a[44:47], v[44:47], v[236:239], a[44:47]
  v_mfma_f32_16x16x32_bf16 a[52:55], v[40:43], v[240:243], a[52:55]
  v_subrev_u32_e64 v7, s7, v7
  v_mfma_f32_16x16x32_bf16 a[52:55], v[44:47], v[244:247], a[52:55]
  v_mfma_f32_16x16x32_bf16 a[60:63], v[40:43], v[248:251], a[60:63]
  v_subrev_u32_e64 v8, s7, v8
  v_mfma_f32_16x16x32_bf16 a[60:63], v[44:47], v[252:255], a[60:63]
  s_waitcnt lgkmcnt(0)
  buffer_load_dwordx4 v12, s[16:19], s33 offen offset:1024  lds
  v_mfma_f32_16x16x32_bf16 a[64:67], v[32:35], v[128:131], a[64:67]
  s_nop 0
  ds_read_b128 v[40:43], v9 offset:6144
  v_mfma_f32_16x16x32_bf16 a[64:67], v[36:39], v[132:135], a[64:67]
  ds_read_b128 v[44:47], v10 offset:6144
  v_mfma_f32_16x16x32_bf16 a[72:75], v[32:35], v[136:139], a[72:75]
  v_mfma_f32_16x16x32_bf16 a[72:75], v[36:39], v[140:143], a[72:75]
  v_mfma_f32_16x16x32_bf16 a[80:83], v[32:35], v[144:147], a[80:83]
  buffer_load_dwordx4 v13, s[16:19], s33 offen offset:2048  lds
  v_mfma_f32_16x16x32_bf16 a[80:83], v[36:39], v[148:151], a[80:83]
  v_accvgpr_read_b32 v96, a0
  v_accvgpr_read_b32 v97, a1
  v_mfma_f32_16x16x32_bf16 a[88:91], v[32:35], v[152:155], a[88:91]
  v_accvgpr_read_b32 v98, a2
  v_accvgpr_read_b32 v99, a3
  v_mfma_f32_16x16x32_bf16 a[88:91], v[36:39], v[156:159], a[88:91]
  v_accvgpr_read_b32 v100, a4
  v_accvgpr_read_b32 v101, a5
  v_mfma_f32_16x16x32_bf16 a[96:99], v[32:35], v[160:163], a[96:99]
  v_accvgpr_read_b32 v102, a6
  v_accvgpr_read_b32 v103, a7
  v_mfma_f32_16x16x32_bf16 a[96:99], v[36:39], v[164:167], a[96:99]
  buffer_load_dwordx4 v14, s[16:19], s33 offen offset:3072  lds
  v_cvt_pk_bf16_f32 v96, v96, v97
  v_mfma_f32_16x16x32_bf16 a[104:107], v[32:35], v[168:171], a[104:107]
  v_cvt_pk_bf16_f32 v97, v98, v99
  v_cvt_pk_bf16_f32 v98, v100, v101
  v_mfma_f32_16x16x32_bf16 a[104:107], v[36:39], v[172:175], a[104:107]
  v_cvt_pk_bf16_f32 v99, v102, v103
  buffer_store_dwordx4 v[96:99], v0, s[20:23], s55 offen offset:0 sc1
  v_mfma_f32_16x16x32_bf16 a[112:115], v[32:35], v[176:179], a[112:115]
  v_mfma_f32_16x16x32_bf16 a[112:115], v[36:39], v[180:183], a[112:115]
  s_add_u32 m0, s52, 102400
  v_mfma_f32_16x16x32_bf16 a[120:123], v[32:35], v[184:187], a[120:123]
  buffer_load_dwordx4 v15, s[16:19], s33 offen offset:0  lds
  v_mfma_f32_16x16x32_bf16 a[120:123], v[36:39], v[188:191], a[120:123]
  s_waitcnt lgkmcnt(0)
  s_nop 0
  v_mfma_f32_16x16x32_bf16 a[68:71], v[40:43], v[128:131], a[68:71]
  ds_read_b128 v[32:35], v9 offset:8192
  v_mfma_f32_16x16x32_bf16 a[68:71], v[44:47], v[132:135], a[68:71]
  ds_read_b128 v[36:39], v10 offset:8192
  v_mfma_f32_16x16x32_bf16 a[76:79], v[40:43], v[136:139], a[76:79]
  v_mfma_f32_16x16x32_bf16 a[76:79], v[44:47], v[140:143], a[76:79]
  buffer_load_dwordx4 v16, s[16:19], s33 offen offset:1024  lds
  v_mfma_f32_16x16x32_bf16 a[84:87], v[40:43], v[144:147], a[84:87]
  v_accvgpr_read_b32 v104, a8
  v_accvgpr_read_b32 v105, a9
  v_mfma_f32_16x16x32_bf16 a[84:87], v[44:47], v[148:151], a[84:87]
  v_accvgpr_read_b32 v106, a10
  v_accvgpr_read_b32 v107, a11
  v_mfma_f32_16x16x32_bf16 a[92:95], v[40:43], v[152:155], a[92:95]
  v_accvgpr_read_b32 v108, a12
  v_accvgpr_read_b32 v109, a13
  v_mfma_f32_16x16x32_bf16 a[92:95], v[44:47], v[156:159], a[92:95]
  v_accvgpr_read_b32 v110, a14
  v_accvgpr_read_b32 v111, a15
  v_mfma_f32_16x16x32_bf16 a[100:103], v[40:43], v[160:163], a[100:103]
  buffer_load_dwordx4 v17, s[16:19], s33 offen offset:2048  lds
  v_cvt_pk_bf16_f32 v104, v104, v105
  v_mfma_f32_16x16x32_bf16 a[100:103], v[44:47], v[164:167], a[100:103]
  v_cvt_pk_bf16_f32 v105, v106, v107
  v_cvt_pk_bf16_f32 v106, v108, v109
  v_mfma_f32_16x16x32_bf16 a[108:111], v[40:43], v[168:171], a[108:111]
  v_cvt_pk_bf16_f32 v107, v110, v111
  buffer_store_dwordx4 v[104:107], v0, s[20:23], s55 offen offset:1024 sc1
  v_mfma_f32_16x16x32_bf16 a[108:111], v[44:47], v[172:175], a[108:111]
  v_mfma_f32_16x16x32_bf16 a[116:119], v[40:43], v[176:179], a[116:119]
  v_mfma_f32_16x16x32_bf16 a[116:119], v[44:47], v[180:183], a[116:119]
  buffer_load_dwordx4 v18, s[16:19], s33 offen offset:3072  lds
  v_mfma_f32_16x16x32_bf16 a[124:127], v[40:43], v[184:187], a[124:127]
  v_mfma_f32_16x16x32_bf16 a[124:127], v[44:47], v[188:191], a[124:127]
  s_waitcnt lgkmcnt(0)
  s_nop 0
  v_mfma_f32_16x16x32_bf16 a[128:131], v[32:35], v[128:131], a[128:131]
  ds_read_b128 v[40:43], v9 offset:10240
  v_mfma_f32_16x16x32_bf16 a[128:131], v[36:39], v[132:135], a[128:131]
  ds_read_b128 v[44:47], v10 offset:10240
  v_mfma_f32_16x16x32_bf16 a[136:139], v[32:35], v[136:139], a[136:139]
  v_mfma_f32_16x16x32_bf16 a[136:139], v[36:39], v[140:143], a[136:139]
  v_mfma_f32_16x16x32_bf16 a[144:147], v[32:35], v[144:147], a[144:147]
  v_accvgpr_read_b32 v96, a16
  v_accvgpr_read_b32 v97, a17
  v_mfma_f32_16x16x32_bf16 a[144:147], v[36:39], v[148:151], a[144:147]
  v_accvgpr_read_b32 v98, a18
  v_accvgpr_read_b32 v99, a19
  v_mfma_f32_16x16x32_bf16 a[152:155], v[32:35], v[152:155], a[152:155]
  v_accvgpr_read_b32 v100, a20
  v_accvgpr_read_b32 v101, a21
  v_mfma_f32_16x16x32_bf16 a[152:155], v[36:39], v[156:159], a[152:155]
  v_accvgpr_read_b32 v102, a22
  v_accvgpr_read_b32 v103, a23
  v_mfma_f32_16x16x32_bf16 a[160:163], v[32:35], v[160:163], a[160:163]
  v_cvt_pk_bf16_f32 v96, v96, v97
  v_cvt_pk_bf16_f32 v97, v98, v99
  v_mfma_f32_16x16x32_bf16 a[160:163], v[36:39], v[164:167], a[160:163]
  v_cvt_pk_bf16_f32 v98, v100, v101
  v_cvt_pk_bf16_f32 v99, v102, v103
  v_mfma_f32_16x16x32_bf16 a[168:171], v[32:35], v[168:171], a[168:171]
  buffer_store_dwordx4 v[96:99], v0, s[20:23], s55 offen offset:2048 sc1
  v_mfma_f32_16x16x32_bf16 a[168:171], v[36:39], v[172:175], a[168:171]
  v_mfma_f32_16x16x32_bf16 a[176:179], v[32:35], v[176:179], a[176:179]
  v_mfma_f32_16x16x32_bf16 a[176:179], v[36:39], v[180:183], a[176:179]
  v_mfma_f32_16x16x32_bf16 a[184:187], v[32:35], v[184:187], a[184:187]
  v_mfma_f32_16x16x32_bf16 a[184:187], v[36:39], v[188:191], a[184:187]
  s_waitcnt lgkmcnt(0)
  s_nop 0
  v_mfma_f32_16x16x32_bf16 a[132:135], v[40:43], v[128:131], a[132:135]
  ds_read_b128 v[32:35], v9 offset:12288
  v_mfma_f32_16x16x32_bf16 a[132:135], v[44:47], v[132:135], a[132:135]
  ds_read_b128 v[36:39], v10 offset:12288
  v_mfma_f32_16x16x32_bf16 a[140:143], v[40:43], v[136:139], a[140:143]
  v_mfma_f32_16x16x32_bf16 a[140:143], v[44:47], v[140:143], a[140:143]
  v_accvgpr_read_b32 v104, a24
  v_accvgpr_read_b32 v105, a25
  v_mfma_f32_16x16x32_bf16 a[148:151], v[40:43], v[144:147], a[148:151]
  v_accvgpr_read_b32 v106, a26
  v_accvgpr_read_b32 v107, a27
  v_mfma_f32_16x16x32_bf16 a[148:151], v[44:47], v[148:151], a[148:151]
  v_accvgpr_read_b32 v108, a28
  v_accvgpr_read_b32 v109, a29
  v_mfma_f32_16x16x32_bf16 a[156:159], v[40:43], v[152:155], a[156:159]
  v_accvgpr_read_b32 v110, a30
  v_accvgpr_read_b32 v111, a31
  v_mfma_f32_16x16x32_bf16 a[156:159], v[44:47], v[156:159], a[156:159]
  v_cvt_pk_bf16_f32 v104, v104, v105
  v_cvt_pk_bf16_f32 v105, v106, v107
  v_mfma_f32_16x16x32_bf16 a[164:167], v[40:43], v[160:163], a[164:167]
  v_cvt_pk_bf16_f32 v106, v108, v109
  v_cvt_pk_bf16_f32 v107, v110, v111
  v_mfma_f32_16x16x32_bf16 a[164:167], v[44:47], v[164:167], a[164:167]
  buffer_store_dwordx4 v[104:107], v0, s[20:23], s55 offen offset:3072 sc1
  s_add_u32 s55, s55, s56
  v_mfma_f32_16x16x32_bf16 a[172:175], v[40:43], v[168:171], a[172:175]
  s_nop 0
  v_mfma_f32_16x16x32_bf16 a[172:175], v[44:47], v[172:175], a[172:175]
  v_mfma_f32_16x16x32_bf16 a[180:183], v[40:43], v[176:179], a[180:183]
  v_mfma_f32_16x16x32_bf16 a[180:183], v[44:47], v[180:183], a[180:183]
  v_mfma_f32_16x16x32_bf16 a[188:191], v[40:43], v[184:187], a[188:191]
  v_mfma_f32_16x16x32_bf16 a[188:191], v[44:47], v[188:191], a[188:191]
  s_waitcnt lgkmcnt(0)
  s_nop 0
  v_mfma_f32_16x16x32_bf16 a[192:195], v[32:35], v[128:131], a[192:195]
  ds_read_b128 v[40:43], v9 offset:14336
  v_mfma_f32_16x16x32_bf16 a[192:195], v[36:39], v[132:135], a[192:195]
  ds_read_b128 v[44:47], v10 offset:14336
  v_mfma_f32_16x16x32_bf16 a[200:203], v[32:35], v[136:139], a[200:203]
  v_mfma_f32_16x16x32_bf16 a[200:203], v[36:39], v[140:143], a[200:203]
  v_accvgpr_read_b32 v96, a32
  v_accvgpr_read_b32 v97, a33
  v_mfma_f32_16x16x32_bf16 a[208:211], v[32:35], v[144:147], a[208:211]
  v_accvgpr_read_b32 v98, a34
  v_accvgpr_read_b32 v99, a35
  v_mfma_f32_16x16x32_bf16 a[208:211], v[36:39], v[148:151], a[208:211]
  v_accvgpr_read_b32 v100, a36
  v_accvgpr_read_b32 v101, a37
  v_mfma_f32_16x16x32_bf16 a[216:219], v[32:35], v[152:155], a[216:219]
  v_accvgpr_read_b32 v102, a38
  v_accvgpr_read_b32 v103, a39
  v_mfma_f32_16x16x32_bf16 a[216:219], v[36:39], v[156:159], a[216:219]
  v_cvt_pk_bf16_f32 v96, v96, v97
  v_cvt_pk_bf16_f32 v97, v98, v99
  v_mfma_f32_16x16x32_bf16 a[224:227], v[32:35], v[160:163], a[224:227]
  v_cvt_pk_bf16_f32 v98, v100, v101
  v_cvt_pk_bf16_f32 v99, v102, v103
  v_mfma_f32_16x16x32_bf16 a[224:227], v[36:39], v[164:167], a[224:227]
  buffer_store_dwordx4 v[96:99], v0, s[20:23], s55 offen offset:0 sc1
  v_mfma_f32_16x16x32_bf16 a[232:235], v[32:35], v[168:171], a[232:235]
  v_mfma_f32_16x16x32_bf16 a[232:235], v[36:39], v[172:175], a[232:235]
  v_mfma_f32_16x16x32_bf16 a[240:243], v[32:35], v[176:179], a[240:243]
  s_waitcnt vmcnt(13)
  s_nop 0
  v_mfma_f32_16x16x32_bf16 a[240:243], v[36:39], v[180:183], a[240:243]
  s_waitcnt vmcnt(63) lgkmcnt(0)
  s_barrier
  v_mfma_f32_16x16x32_bf16 a[248:251], v[32:35], v[184:187], a[248:251]
  s_add_u32 s33, s60, 1572864
  s_add_u32 m0, s52, 0
  v_mfma_f32_16x16x32_bf16 a[248:251], v[36:39], v[188:191], a[248:251]
  s_waitcnt lgkmcnt(15)
  buffer_load_dwordx4 v11, s[16:19], s33 offen offset:0  lds
  v_mfma_f32_16x16x32_bf16 a[196:199], v[40:43], v[128:131], a[196:199]
  ds_read_b128 v[32:35], v9 offset:36864
  v_mfma_f32_16x16x32_bf16 a[196:199], v[44:47], v[132:135], a[196:199]
  ds_read_b128 v[36:39], v10 offset:36864
  v_mfma_f32_16x16x32_bf16 a[204:207], v[40:43], v[136:139], a[204:207]
  v_accvgpr_read_b32 v104, a40
  v_accvgpr_read_b32 v105, a41
  v_mfma_f32_16x16x32_bf16 a[204:207], v[44:47], v[140:143], a[204:207]
  v_accvgpr_read_b32 v106, a42
  v_accvgpr_read_b32 v107, a43
  v_mfma_f32_16x16x32_bf16 a[212:215], v[40:43], v[144:147], a[212:215]
  buffer_load_dwordx4 v12, s[16:19], s33 offen offset:1024  lds
  v_accvgpr_read_b32 v108, a44
  v_mfma_f32_16x16x32_bf16 a[212:215], v[44:47], v[148:151], a[212:215]
  v_accvgpr_read_b32 v109, a45
  v_accvgpr_read_b32 v110, a46
  v_mfma_f32_16x16x32_bf16 a[220:223], v[40:43], v[152:155], a[220:223]
  s_lshl_b32 s53, s45, 11
  v_accvgpr_read_b32 v111, a47
  v_mfma_f32_16x16x32_bf16 a[220:223], v[44:47], v[156:159], a[220:223]
  s_add_u32 s53, s53, 8290304
  v_cvt_pk_bf16_f32 v104, v104, v105
  v_mfma_f32_16x16x32_bf16 a[228:231], v[40:43], v[160:163], a[228:231]
  s_bfe_u32 s3, s2, 0x40003
  v_cvt_pk_bf16_f32 v105, v106, v107
  v_mfma_f32_16x16x32_bf16 a[228:231], v[44:47], v[164:167], a[228:231]
  buffer_load_dwordx4 v13, s[16:19], s33 offen offset:2048  lds
  s_lshl_b32 s3, s3, 7
  v_mfma_f32_16x16x32_bf16 a[236:239], v[40:43], v[168:171], a[236:239]
  s_add_u32 s48, s53, s3
  v_cvt_pk_bf16_f32 v106, v108, v109
  v_mfma_f32_16x16x32_bf16 a[236:239], v[44:47], v[172:175], a[236:239]
  v_add_u32 v19, s52, v0
  v_cvt_pk_bf16_f32 v107, v110, v111
  v_mfma_f32_16x16x32_bf16 a[244:247], v[40:43], v[176:179], a[244:247]
  v_add_u32 v20, 4096, v19
  buffer_store_dwordx4 v[104:107], v0, s[20:23], s55 offen offset:1024 sc1
  v_mfma_f32_16x16x32_bf16 a[244:247], v[44:47], v[180:183], a[244:247]
  v_min_u32 v21, 1, v19
  s_nop 0
  v_mfma_f32_16x16x32_bf16 a[252:255], v[40:43], v[184:187], a[252:255]
  buffer_load_dwordx4 v14, s[16:19], s33 offen offset:3072  lds
  v_lshlrev_b32_e64 v21, 30, v21
  v_mfma_f32_16x16x32_bf16 a[252:255], v[44:47], v[188:191], a[252:255]
  s_waitcnt lgkmcnt(0)
  v_mov_b32 v22, 1
  v_mfma_f32_16x16x32_bf16 a[64:67], v[32:35], v[192:195], a[64:67]
  ds_read_b128 v[40:43], v9 offset:38912
  v_lshlrev_b32_e64 v23, 3, v31
  v_mfma_f32_16x16x32_bf16 a[64:67], v[36:39], v[196:199], a[64:67]
  ds_read_b128 v[44:47], v10 offset:38912
  s_bfe_u32 s3, s2, 0x10006
  v_mfma_f32_16x16x32_bf16 a[72:75], v[32:35], v[200:203], a[72:75]
  s_add_u32 m0, s52, 4096
  s_mul_i32 s3, s3, 491520
  v_mfma_f32_16x16x32_bf16 a[72:75], v[36:39], v[204:207], a[72:75]
  buffer_load_dwordx4 v15, s[16:19], s33 offen offset:0  lds
  s_lshl_b32 s50, s45, 20
  v_mfma_f32_16x16x32_bf16 a[80:83], v[32:35], v[208:211], a[80:83]
  s_add_u32 s50, s50, s3
  v_accvgpr_read_b32 v96, a48
  v_mfma_f32_16x16x32_bf16 a[80:83], v[36:39], v[212:215], a[80:83]
  s_add_u32 s50, s50, 20971520
  v_accvgpr_read_b32 v97, a49
  v_mfma_f32_16x16x32_bf16 a[88:91], v[32:35], v[216:219], a[88:91]
  v_accvgpr_read_b32 v98, a50
  v_accvgpr_read_b32 v99, a51
  v_mfma_f32_16x16x32_bf16 a[88:91], v[36:39], v[220:223], a[88:91]
  v_accvgpr_read_b32 v100, a52
  v_accvgpr_read_b32 v101, a53
  v_mfma_f32_16x16x32_bf16 a[96:99], v[32:35], v[224:227], a[96:99]
  buffer_load_dwordx4 v16, s[16:19], s33 offen offset:1024  lds
  v_accvgpr_read_b32 v102, a54
  v_mfma_f32_16x16x32_bf16 a[96:99], v[36:39], v[228:231], a[96:99]
  v_accvgpr_read_b32 v103, a55
  v_cvt_pk_bf16_f32 v96, v96, v97
  v_mfma_f32_16x16x32_bf16 a[104:107], v[32:35], v[232:235], a[104:107]
  v_cvt_pk_bf16_f32 v97, v98, v99
  v_cvt_pk_bf16_f32 v98, v100, v101
  v_mfma_f32_16x16x32_bf16 a[104:107], v[36:39], v[236:239], a[104:107]
  v_cvt_pk_bf16_f32 v99, v102, v103
  buffer_store_dwordx4 v[96:99], v0, s[20:23], s55 offen offset:2048 sc1
  v_mfma_f32_16x16x32_bf16 a[112:115], v[32:35], v[240:243], a[112:115]
  v_mfma_f32_16x16x32_bf16 a[112:115], v[36:39], v[244:247], a[112:115]
  buffer_load_dwordx4 v17, s[16:19], s33 offen offset:2048  lds
  v_mfma_f32_16x16x32_bf16 a[120:123], v[32:35], v[248:251], a[120:123]
  v_mfma_f32_16x16x32_bf16 a[120:123], v[36:39], v[252:255], a[120:123]
  s_waitcnt lgkmcnt(0)
  s_nop 0
  v_mfma_f32_16x16x32_bf16 a[68:71], v[40:43], v[192:195], a[68:71]
  ds_read_b128 v[32:35], v9 offset:40960
  v_mfma_f32_16x16x32_bf16 a[68:71], v[44:47], v[196:199], a[68:71]
  ds_read_b128 v[36:39], v10 offset:40960
  v_accvgpr_read_b32 v136, a56
  v_mfma_f32_16x16x32_bf16 a[76:79], v[40:43], v[200:203], a[76:79]
  buffer_load_dwordx4 v18, s[16:19], s33 offen offset:3072  lds
  v_accvgpr_read_b32 v137, a57
  v_mfma_f32_16x16x32_bf16 a[76:79], v[44:47], v[204:207], a[76:79]
  v_accvgpr_read_b32 v138, a58
  v_accvgpr_read_b32 v139, a59
  v_mfma_f32_16x16x32_bf16 a[84:87], v[40:43], v[208:211], a[84:87]
  v_accvgpr_read_b32 v140, a60
  v_accvgpr_read_b32 v141, a61
  v_mfma_f32_16x16x32_bf16 a[84:87], v[44:47], v[212:215], a[84:87]
  v_accvgpr_read_b32 v142, a62
  v_accvgpr_read_b32 v143, a63
  v_mfma_f32_16x16x32_bf16 a[92:95], v[40:43], v[216:219], a[92:95]
  v_cvt_pk_bf16_f32 v136, v136, v137
  v_cvt_pk_bf16_f32 v137, v138, v139
  v_mfma_f32_16x16x32_bf16 a[92:95], v[44:47], v[220:223], a[92:95]
  v_cvt_pk_bf16_f32 v138, v140, v141
  v_cvt_pk_bf16_f32 v139, v142, v143
  v_mfma_f32_16x16x32_bf16 a[100:103], v[40:43], v[224:227], a[100:103]
  buffer_store_dwordx4 v[136:139], v0, s[20:23], s55 offen offset:3072 sc1
  s_add_u32 s55, s55, s57
  v_mfma_f32_16x16x32_bf16 a[100:103], v[44:47], v[228:231], a[100:103]
  s_nop 0
  v_mfma_f32_16x16x32_bf16 a[108:111], v[40:43], v[232:235], a[108:111]
  v_mfma_f32_16x16x32_bf16 a[108:111], v[44:47], v[236:239], a[108:111]
  v_mfma_f32_16x16x32_bf16 a[116:119], v[40:43], v[240:243], a[116:119]
  v_mfma_f32_16x16x32_bf16 a[116:119], v[44:47], v[244:247], a[116:119]
  v_mfma_f32_16x16x32_bf16 a[124:127], v[40:43], v[248:251], a[124:127]
  v_mfma_f32_16x16x32_bf16 a[124:127], v[44:47], v[252:255], a[124:127]
  s_waitcnt lgkmcnt(0)
  s_nop 0
  v_mfma_f32_16x16x32_bf16 a[128:131], v[32:35], v[192:195], a[128:131]
  ds_read_b128 v[40:43], v9 offset:43008
  v_mfma_f32_16x16x32_bf16 a[128:131], v[36:39], v[196:199], a[128:131]
  ds_read_b128 v[44:47], v10 offset:43008
  v_mfma_f32_16x16x32_bf16 a[136:139], v[32:35], v[200:203], a[136:139]
  v_mfma_f32_16x16x32_bf16 a[136:139], v[36:39], v[204:207], a[136:139]
  v_mfma_f32_16x16x32_bf16 a[144:147], v[32:35], v[208:211], a[144:147]
  v_mfma_f32_16x16x32_bf16 a[144:147], v[36:39], v[212:215], a[144:147]
  v_accvgpr_read_b32 v128, a64
  v_accvgpr_read_b32 v129, a65
  v_mfma_f32_16x16x32_bf16 a[152:155], v[32:35], v[216:219], a[152:155]
  v_accvgpr_read_b32 v130, a66
  v_accvgpr_read_b32 v131, a67
  v_mfma_f32_16x16x32_bf16 a[152:155], v[36:39], v[220:223], a[152:155]
  v_accvgpr_read_b32 v132, a68
  v_accvgpr_read_b32 v133, a69
  v_mfma_f32_16x16x32_bf16 a[160:163], v[32:35], v[224:227], a[160:163]
  v_accvgpr_read_b32 v134, a70
  v_accvgpr_read_b32 v135, a71
  v_mfma_f32_16x16x32_bf16 a[160:163], v[36:39], v[228:231], a[160:163]
  v_cvt_pk_bf16_f32 v128, v128, v129
  v_cvt_pk_bf16_f32 v129, v130, v131
  v_mfma_f32_16x16x32_bf16 a[168:171], v[32:35], v[232:235], a[168:171]
  v_cvt_pk_bf16_f32 v130, v132, v133
  v_cvt_pk_bf16_f32 v131, v134, v135
  v_mfma_f32_16x16x32_bf16 a[168:171], v[36:39], v[236:239], a[168:171]
  buffer_store_dwordx4 v[128:131], v0, s[20:23], s55 offen offset:0 sc1
  v_mfma_f32_16x16x32_bf16 a[176:179], v[32:35], v[240:243], a[176:179]
  v_mfma_f32_16x16x32_bf16 a[176:179], v[36:39], v[244:247], a[176:179]
  v_mfma_f32_16x16x32_bf16 a[184:187], v[32:35], v[248:251], a[184:187]
  v_mfma_f32_16x16x32_bf16 a[184:187], v[36:39], v[252:255], a[184:187]
  s_waitcnt lgkmcnt(0)
  s_nop 0
  v_mfma_f32_16x16x32_bf16 a[132:135], v[40:43], v[192:195], a[132:135]
  ds_read_b128 v[32:35], v9 offset:45056
  v_accvgpr_read_b32 v136, a72
  v_mfma_f32_16x16x32_bf16 a[132:135], v[44:47], v[196:199], a[132:135]
  ds_read_b128 v[36:39], v10 offset:45056
  v_accvgpr_read_b32 v137, a73
  v_mfma_f32_16x16x32_bf16 a[140:143], v[40:43], v[200:203], a[140:143]
  v_accvgpr_read_b32 v138, a74
  v_accvgpr_read_b32 v139, a75
  v_mfma_f32_16x16x32_bf16 a[140:143], v[44:47], v[204:207], a[140:143]
  v_accvgpr_read_b32 v140, a76
  v_accvgpr_read_b32 v141, a77
  v_mfma_f32_16x16x32_bf16 a[148:151], v[40:43], v[208:211], a[148:151]
  v_accvgpr_read_b32 v142, a78
  v_accvgpr_read_b32 v143, a79
  v_mfma_f32_16x16x32_bf16 a[148:151], v[44:47], v[212:215], a[148:151]
  v_cvt_pk_bf16_f32 v136, v136, v137
  v_cvt_pk_bf16_f32 v137, v138, v139
  v_mfma_f32_16x16x32_bf16 a[156:159], v[40:43], v[216:219], a[156:159]
  v_cvt_pk_bf16_f32 v138, v140, v141
  v_cvt_pk_bf16_f32 v139, v142, v143
  v_mfma_f32_16x16x32_bf16 a[156:159], v[44:47], v[220:223], a[156:159]
  buffer_store_dwordx4 v[136:139], v0, s[20:23], s55 offen offset:1024 sc1
  v_mfma_f32_16x16x32_bf16 a[164:167], v[40:43], v[224:227], a[164:167]
  v_mfma_f32_16x16x32_bf16 a[164:167], v[44:47], v[228:231], a[164:167]
  v_mfma_f32_16x16x32_bf16 a[172:175], v[40:43], v[232:235], a[172:175]
  v_mfma_f32_16x16x32_bf16 a[172:175], v[44:47], v[236:239], a[172:175]
  v_mfma_f32_16x16x32_bf16 a[180:183], v[40:43], v[240:243], a[180:183]
  v_mfma_f32_16x16x32_bf16 a[180:183], v[44:47], v[244:247], a[180:183]
  v_mfma_f32_16x16x32_bf16 a[188:191], v[40:43], v[248:251], a[188:191]
  v_mfma_f32_16x16x32_bf16 a[188:191], v[44:47], v[252:255], a[188:191]
  s_waitcnt lgkmcnt(0)
  s_nop 0
  v_mfma_f32_16x16x32_bf16 a[192:195], v[32:35], v[192:195], a[192:195]
  ds_read_b128 v[40:43], v9 offset:47104
  v_accvgpr_read_b32 v128, a80
  v_mfma_f32_16x16x32_bf16 a[192:195], v[36:39], v[196:199], a[192:195]
  ds_read_b128 v[44:47], v10 offset:47104
  v_accvgpr_read_b32 v129, a81
  v_mfma_f32_16x16x32_bf16 a[200:203], v[32:35], v[200:203], a[200:203]
  v_accvgpr_read_b32 v130, a82
  v_accvgpr_read_b32 v131, a83
  v_mfma_f32_16x16x32_bf16 a[200:203], v[36:39], v[204:207], a[200:203]
  v_accvgpr_read_b32 v132, a84
  v_accvgpr_read_b32 v133, a85
  v_mfma_f32_16x16x32_bf16 a[208:211], v[32:35], v[208:211], a[208:211]
  ds_read_b64_tr_b16 v[96:97], v1 offset:0
  v_accvgpr_read_b32 v134, a86
  v_mfma_f32_16x16x32_bf16 a[208:211], v[36:39], v[212:215], a[208:211]
  v_accvgpr_read_b32 v135, a87
  v_cvt_pk_bf16_f32 v128, v128, v129
  v_mfma_f32_16x16x32_bf16 a[216:219], v[32:35], v[216:219], a[216:219]
  ds_read_b64_tr_b16 v[98:99], v1 offset:2048
  v_cvt_pk_bf16_f32 v129, v130, v131
  v_mfma_f32_16x16x32_bf16 a[216:219], v[36:39], v[220:223], a[216:219]
  v_cvt_pk_bf16_f32 v130, v132, v133
  v_cvt_pk_bf16_f32 v131, v134, v135
  v_mfma_f32_16x16x32_bf16 a[224:227], v[32:35], v[224:227], a[224:227]
  ds_read_b64_tr_b16 v[100:101], v1 offset:16384
  buffer_store_dwordx4 v[128:131], v0, s[20:23], s55 offen offset:2048 sc1
  v_mfma_f32_16x16x32_bf16 a[224:227], v[36:39], v[228:231], a[224:227]
  v_mfma_f32_16x16x32_bf16 a[232:235], v[32:35], v[232:235], a[232:235]
  ds_read_b64_tr_b16 v[102:103], v1 offset:18432
  v_mfma_f32_16x16x32_bf16 a[232:235], v[36:39], v[236:239], a[232:235]
  v_mfma_f32_16x16x32_bf16 a[240:243], v[32:35], v[240:243], a[240:243]
  ds_read_b64_tr_b16 v[104:105], v2 offset:0
  v_mfma_f32_16x16x32_bf16 a[240:243], v[36:39], v[244:247], a[240:243]
  s_waitcnt lgkmcnt(5)
  s_barrier
  v_mfma_f32_16x16x32_bf16 a[248:251], v[32:35], v[248:251], a[248:251]
  ds_read_b64_tr_b16 v[106:107], v2 offset:2048
  s_add_u32 s33, s60, 2097152
  v_mfma_f32_16x16x32_bf16 a[248:251], v[36:39], v[252:255], a[248:251]
  s_add_u32 m0, s52, 32768
  v_accvgpr_read_b32 v136, a88
  v_mfma_f32_16x16x32_bf16 a[196:199], v[40:43], v[192:195], a[196:199]
  ds_read_b64_tr_b16 v[108:109], v2 offset:16384
  buffer_load_dwordx4 v11, s[16:19], s33 offen offset:0  lds
  v_mfma_f32_16x16x32_bf16 a[196:199], v[44:47], v[196:199], a[196:199]
  v_accvgpr_read_b32 v137, a89
  v_accvgpr_read_b32 v138, a90
  v_mfma_f32_16x16x32_bf16 a[204:207], v[40:43], v[200:203], a[204:207]
  ds_read_b64_tr_b16 v[110:111], v2 offset:18432
  v_accvgpr_read_b32 v139, a91
  v_mfma_f32_16x16x32_bf16 a[204:207], v[44:47], v[204:207], a[204:207]
  v_accvgpr_read_b32 v140, a92
  v_accvgpr_read_b32 v141, a93
  v_mfma_f32_16x16x32_bf16 a[212:215], v[40:43], v[208:211], a[212:215]
  ds_read_b64_tr_b16 v[112:113], v3 offset:0
  buffer_load_dwordx4 v12, s[16:19], s33 offen offset:1024  lds
  v_mfma_f32_16x16x32_bf16 a[212:215], v[44:47], v[212:215], a[212:215]
  v_accvgpr_read_b32 v142, a94
  v_accvgpr_read_b32 v143, a95
  v_mfma_f32_16x16x32_bf16 a[220:223], v[40:43], v[216:219], a[220:223]
  ds_read_b64_tr_b16 v[114:115], v3 offset:2048
  v_cvt_pk_bf16_f32 v136, v136, v137
  v_mfma_f32_16x16x32_bf16 a[220:223], v[44:47], v[220:223], a[220:223]
  v_cvt_pk_bf16_f32 v137, v138, v139
  v_cvt_pk_bf16_f32 v138, v140, v141
  v_mfma_f32_16x16x32_bf16 a[228:231], v[40:43], v[224:227], a[228:231]
  ds_read_b64_tr_b16 v[116:117], v3 offset:16384
  buffer_load_dwordx4 v13, s[16:19], s33 offen offset:2048  lds
  v_mfma_f32_16x16x32_bf16 a[228:231], v[44:47], v[228:231], a[228:231]
  v_cvt_pk_bf16_f32 v139, v142, v143
  buffer_store_dwordx4 v[136:139], v0, s[20:23], s55 offen offset:3072 sc1
  v_mfma_f32_16x16x32_bf16 a[236:239], v[40:43], v[232:235], a[236:239]
  ds_read_b64_tr_b16 v[118:119], v3 offset:18432
  s_add_u32 s55, s55, s56
  v_mfma_f32_16x16x32_bf16 a[236:239], v[44:47], v[236:239], a[236:239]
  s_nop 0
  v_mfma_f32_16x16x32_bf16 a[244:247], v[40:43], v[240:243], a[244:247]
  buffer_load_dwordx4 v14, s[16:19], s33 offen offset:3072  lds
  v_mfma_f32_16x16x32_bf16 a[244:247], v[44:47], v[244:247], a[244:247]
  v_mfma_f32_16x16x32_bf16 a[252:255], v[40:43], v[248:251], a[252:255]
  v_mfma_f32_16x16x32_bf16 a[252:255], v[44:47], v[252:255], a[252:255]
  s_waitcnt lgkmcnt(8)
  s_add_u32 m0, s52, 36864
L_k1_Q:
  v_mfma_f32_16x16x32_bf16 v[128:131], v[96:99], v[48:51], 0
  ds_read_b64_tr_b16 v[120:121], v4 offset:0
  buffer_load_dwordx4 v15, s[16:19], s33 offen offset:0  lds
  v_mfma_f32_16x16x32_bf16 v[128:131], v[100:103], v[52:55], v[128:131]
  s_nop 0
  ds_read_b64_tr_b16 v[122:123], v4 offset:2048
  v_mfma_f32_16x16x32_bf16 v[192:195], v[96:99], v[56:59], 0
  ds_read_b64_tr_b16 v[124:125], v4 offset:16384
  v_mfma_f32_16x16x32_bf16 v[192:195], v[100:103], v[60:63], v[192:195]
  ds_read_b64_tr_b16 v[126:127], v4 offset:18432
  s_waitcnt lgkmcnt(8)
  v_mfma_f32_16x16x32_bf16 v[132:135], v[104:107], v[48:51], 0
  ds_read_b64_tr_b16 v[96:97], v5 offset:0
  buffer_load_dwordx4 v16, s[16:19], s33 offen offset:1024  lds
  v_mfma_f32_16x16x32_bf16 v[132:135], v[108:111], v[52:55], v[132:135]
  s_nop 0
  ds_read_b64_tr_b16 v[98:99], v5 offset:2048
  v_mfma_f32_16x16x32_bf16 v[196:199], v[104:107], v[56:59], 0
  ds_read_b64_tr_b16 v[100:101], v5 offset:16384
  v_accvgpr_read_b32 v32, a96
  v_mfma_f32_16x16x32_bf16 v[196:199], v[108:111], v[60:63], v[196:199]
  ds_read_b64_tr_b16 v[102:103], v5 offset:18432
  s_waitcnt lgkmcnt(8)
  v_mfma_f32_16x16x32_bf16 v[136:139], v[112:115], v[48:51], 0
  ds_read_b64_tr_b16 v[104:105], v6 offset:0
  buffer_load_dwordx4 v17, s[16:19], s33 offen offset:2048  lds
  v_mfma_f32_16x16x32_bf16 v[136:139], v[116:119], v[52:55], v[136:139]
  ds_read_b64_tr_b16 v[106:107], v6 offset:2048
  v_accvgpr_read_b32 v33, a97
  v_accvgpr_read_b32 v34, a98
  v_mfma_f32_16x16x32_bf16 v[200:203], v[112:115], v[56:59], 0
  ds_read_b64_tr_b16 v[108:109], v6 offset:16384
  v_accvgpr_read_b32 v35, a99
  v_mfma_f32_16x16x32_bf16 v[200:203], v[116:119], v[60:63], v[200:203]
  ds_read_b64_tr_b16 v[110:111], v6 offset:18432
  s_waitcnt lgkmcnt(8)
  v_mfma_f32_16x16x32_bf16 v[140:143], v[120:123], v[48:51], 0
  ds_read_b64_tr_b16 v[112:113], v7 offset:0
  buffer_load_dwordx4 v18, s[16:19], s33 offen offset:3072  lds
  v_mfma_f32_16x16x32_bf16 v[140:143], v[124:127], v[52:55], v[140:143]
  ds_read_b64_tr_b16 v[114:115], v7 offset:2048
  v_accvgpr_read_b32 v36, a100
  v_accvgpr_read_b32 v37, a101
  v_mfma_f32_16x16x32_bf16 v[204:207], v[120:123], v[56:59], 0
  ds_read_b64_tr_b16 v[116:117], v7 offset:16384
  v_accvgpr_read_b32 v38, a102
  v_mfma_f32_16x16x32_bf16 v[204:207], v[124:127], v[60:63], v[204:207]
  ds_read_b64_tr_b16 v[118:119], v7 offset:18432
  s_waitcnt lgkmcnt(8)
  v_mfma_f32_16x16x32_bf16 v[144:147], v[96:99], v[48:51], 0
  ds_read_b64_tr_b16 v[120:121], v8 offset:0
  v_accvgpr_read_b32 v39, a103
  v_mfma_f32_16x16x32_bf16 v[144:147], v[100:103], v[52:55], v[144:147]
  ds_read_b64_tr_b16 v[122:123], v8 offset:2048
  v_cvt_pk_bf16_f32 v32, v32, v33
  v_mfma_f32_16x16x32_bf16 v[208:211], v[96:99], v[56:59], 0
  ds_read_b64_tr_b16 v[124:125], v8 offset:16384
  v_cvt_pk_bf16_f32 v33, v34, v35
  v_mfma_f32_16x16x32_bf16 v[208:211], v[100:103], v[60:63], v[208:211]
  ds_read_b64_tr_b16 v[126:127], v8 offset:18432
  s_waitcnt lgkmcnt(8)
  v_mfma_f32_16x16x32_bf16 v[148:151], v[104:107], v[48:51], 0
  ds_read_b64_tr_b16 v[96:97], v1 offset:256
  v_cvt_pk_bf16_f32 v34, v36, v37
  v_mfma_f32_16x16x32_bf16 v[148:151], v[108:111], v[52:55], v[148:151]
  ds_read_b64_tr_b16 v[98:99], v1 offset:2304
  v_cvt_pk_bf16_f32 v35, v38, v39
  v_mfma_f32_16x16x32_bf16 v[212:215], v[104:107], v[56:59], 0
  ds_read_b64_tr_b16 v[100:101], v1 offset:16640
  buffer_store_dwordx4 v[32:35], v0, s[20:23], s55 offen offset:0 sc1
  v_mfma_f32_16x16x32_bf16 v[212:215], v[108:111], v[60:63], v[212:215]
  ds_read_b64_tr_b16 v[102:103], v1 offset:18688
  s_waitcnt lgkmcnt(8)
  v_mfma_f32_16x16x32_bf16 v[152:155], v[112:115], v[48:51], 0
  ds_read_b64_tr_b16 v[104:105], v2 offset:256
  v_accvgpr_read_b32 v40, a104
  v_mfma_f32_16x16x32_bf16 v[152:155], v[116:119], v[52:55], v[152:155]
  ds_read_b64_tr_b16 v[106:107], v2 offset:2304
  v_accvgpr_read_b32 v41, a105
  v_mfma_f32_16x16x32_bf16 v[216:219], v[112:115], v[56:59], 0
  ds_read_b64_tr_b16 v[108:109], v2 offset:16640
  v_accvgpr_read_b32 v42, a106
  v_mfma_f32_16x16x32_bf16 v[216:219], v[116:119], v[60:63], v[216:219]
  ds_read_b64_tr_b16 v[110:111], v2 offset:18688
  s_waitcnt lgkmcnt(8)
  v_mfma_f32_16x16x32_bf16 v[156:159], v[120:123], v[48:51], 0
  ds_read_b64_tr_b16 v[112:113], v3 offset:256
  v_accvgpr_read_b32 v43, a107
  v_mfma_f32_16x16x32_bf16 v[156:159], v[124:127], v[52:55], v[156:159]
  ds_read_b64_tr_b16 v[114:115], v3 offset:2304
  v_accvgpr_read_b32 v44, a108
  v_mfma_f32_16x16x32_bf16 v[220:223], v[120:123], v[56:59], 0
  ds_read_b64_tr_b16 v[116:117], v3 offset:16640
  v_accvgpr_read_b32 v45, a109
  v_mfma_f32_16x16x32_bf16 v[220:223], v[124:127], v[60:63], v[220:223]
  ds_read_b64_tr_b16 v[118:119], v3 offset:18688
  s_waitcnt lgkmcnt(8)
  v_mfma_f32_16x16x32_bf16 v[160:163], v[96:99], v[48:51], 0
  ds_read_b64_tr_b16 v[120:121], v4 offset:256
  v_accvgpr_read_b32 v46, a110
  v_mfma_f32_16x16x32_bf16 v[160:163], v[100:103], v[52:55], v[160:163]
  ds_read_b64_tr_b16 v[122:123], v4 offset:2304
  v_accvgpr_read_b32 v47, a111
  v_mfma_f32_16x16x32_bf16 v[224:227], v[96:99], v[56:59], 0
  ds_read_b64_tr_b16 v[124:125], v4 offset:16640
  v_cvt_pk_bf16_f32 v40, v40, v41
  v_mfma_f32_16x16x32_bf16 v[224:227], v[100:103], v[60:63], v[224:227]
  ds_read_b64_tr_b16 v[126:127], v4 offset:18688
  s_waitcnt lgkmcnt(8)
  v_mfma_f32_16x16x32_bf16 v[164:167], v[104:107], v[48:51], 0
  ds_read_b64_tr_b16 v[96:97], v5 offset:256
  v_cvt_pk_bf16_f32 v41, v42, v43
  v_mfma_f32_16x16x32_bf16 v[164:167], v[108:111], v[52:55], v[164:167]
  ds_read_b64_tr_b16 v[98:99], v5 offset:2304
  v_cvt_pk_bf16_f32 v42, v44, v45
  v_mfma_f32_16x16x32_bf16 v[228:231], v[104:107], v[56:59], 0
  ds_read_b64_tr_b16 v[100:101], v5 offset:16640
  v_cvt_pk_bf16_f32 v43, v46, v47
  v_mfma_f32_16x16x32_bf16 v[228:231], v[108:111], v[60:63], v[228:231]
  ds_read_b64_tr_b16 v[102:103], v5 offset:18688
  s_waitcnt lgkmcnt(8)
  v_mfma_f32_16x16x32_bf16 v[168:171], v[112:115], v[48:51], 0
  ds_read_b64_tr_b16 v[104:105], v6 offset:256
  buffer_store_dwordx4 v[40:43], v0, s[20:23], s55 offen offset:1024 sc1
  v_mfma_f32_16x16x32_bf16 v[168:171], v[116:119], v[52:55], v[168:171]
  s_nop 0
  ds_read_b64_tr_b16 v[106:107], v6 offset:2304
  v_mfma_f32_16x16x32_bf16 v[232:235], v[112:115], v[56:59], 0
  ds_read_b64_tr_b16 v[108:109], v6 offset:16640
  v_accvgpr_read_b32 v32, a112
  v_mfma_f32_16x16x32_bf16 v[232:235], v[116:119], v[60:63], v[232:235]
  ds_read_b64_tr_b16 v[110:111], v6 offset:18688
  s_waitcnt lgkmcnt(8)
  v_mfma_f32_16x16x32_bf16 v[172:175], v[120:123], v[48:51], 0
  ds_read_b64_tr_b16 v[112:113], v7 offset:256
  v_accvgpr_read_b32 v33, a113
  v_mfma_f32_16x16x32_bf16 v[172:175], v[124:127], v[52:55], v[172:175]
  ds_read_b64_tr_b16 v[114:115], v7 offset:2304
  v_accvgpr_read_b32 v34, a114
  v_mfma_f32_16x16x32_bf16 v[236:239], v[120:123], v[56:59], 0
  ds_read_b64_tr_b16 v[116:117], v7 offset:16640
  v_accvgpr_read_b32 v35, a115
  v_mfma_f32_16x16x32_bf16 v[236:239], v[124:127], v[60:63], v[236:239]
  ds_read_b64_tr_b16 v[118:119], v7 offset:18688
  s_waitcnt lgkmcnt(8)
  v_mfma_f32_16x16x32_bf16 v[176:179], v[96:99], v[48:51], 0
  ds_read_b64_tr_b16 v[120:121], v8 offset:256
  v_accvgpr_read_b32 v36, a116
  v_mfma_f32_16x16x32_bf16 v[176:179], v[100:103], v[52:55], v[176:179]
  ds_read_b64_tr_b16 v[122:123], v8 offset:2304
  v_accvgpr_read_b32 v37, a117
  v_mfma_f32_16x16x32_bf16 v[240:243], v[96:99], v[56:59], 0
  ds_read_b64_tr_b16 v[124:125], v8 offset:16640
  s_waitcnt vmcnt(28)
  v_accvgpr_read_b32 v38, a118
  v_mfma_f32_16x16x32_bf16 v[240:243], v[100:103], v[60:63], v[240:243]
  ds_read_b64_tr_b16 v[126:127], v8 offset:18688
  s_waitcnt lgkmcnt(8)
  v_mfma_f32_16x16x32_bf16 v[180:183], v[104:107], v[48:51], 0
  s_barrier
  ds_read_b64_tr_b16 v[96:97], v1 offset:32768
  v_mfma_f32_16x16x32_bf16 v[180:183], v[108:111], v[52:55], v[180:183]
  ds_read_b64_tr_b16 v[98:99], v1 offset:34816
  v_accvgpr_read_b32 v39, a119
  v_cvt_pk_bf16_f32 v32, v32, v33
  v_mfma_f32_16x16x32_bf16 v[244:247], v[104:107], v[56:59], 0
  ds_read_b64_tr_b16 v[100:101], v1 offset:49152
  v_cvt_pk_bf16_f32 v33, v34, v35
  v_mfma_f32_16x16x32_bf16 v[244:247], v[108:111], v[60:63], v[244:247]
  ds_read_b64_tr_b16 v[102:103], v1 offset:51200
  s_waitcnt lgkmcnt(8)
  v_mfma_f32_16x16x32_bf16 v[184:187], v[112:115], v[48:51], 0
  ds_read_b64_tr_b16 v[104:105], v2 offset:32768
  v_cvt_pk_bf16_f32 v34, v36, v37
  v_mfma_f32_16x16x32_bf16 v[184:187], v[116:119], v[52:55], v[184:187]
  ds_read_b64_tr_b16 v[106:107], v2 offset:34816
  v_cvt_pk_bf16_f32 v35, v38, v39
  v_mfma_f32_16x16x32_bf16 v[248:251], v[112:115], v[56:59], 0
  ds_read_b64_tr_b16 v[108:109], v2 offset:49152
  buffer_store_dwordx4 v[32:35], v0, s[20:23], s55 offen offset:2048 sc1
  v_mfma_f32_16x16x32_bf16 v[248:251], v[116:119], v[60:63], v[248:251]
  ds_read_b64_tr_b16 v[110:111], v2 offset:51200
  s_waitcnt lgkmcnt(8)
  v_mfma_f32_16x16x32_bf16 v[188:191], v[120:123], v[48:51], 0
  ds_read_b64_tr_b16 v[112:113], v3 offset:32768
  v_accvgpr_read_b32 v40, a120
  v_mfma_f32_16x16x32_bf16 v[188:191], v[124:127], v[52:55], v[188:191]
  ds_read_b64_tr_b16 v[114:115], v3 offset:34816
  v_accvgpr_read_b32 v41, a121
  v_mfma_f32_16x16x32_bf16 v[252:255], v[120:123], v[56:59], 0
  ds_read_b64_tr_b16 v[116:117], v3 offset:49152
  v_accvgpr_read_b32 v42, a122
  v_mfma_f32_16x16x32_bf16 v[252:255], v[124:127], v[60:63], v[252:255]
  ds_read_b64_tr_b16 v[118:119], v3 offset:51200
  s_waitcnt vmcnt(63) lgkmcnt(8)
  v_mfma_f32_16x16x32_bf16 v[128:131], v[96:99], v[64:67], v[128:131]
  ds_read_b64_tr_b16 v[120:121], v4 offset:32768
  v_accvgpr_read_b32 v43, a123
  v_mfma_f32_16x16x32_bf16 v[128:131], v[100:103], v[68:71], v[128:131]
  ds_read_b64_tr_b16 v[122:123], v4 offset:34816
  buffer_load_dwordx4 v[48:51], v0, s[20:23], s34 offen offset:2048 sc1
  v_mfma_f32_16x16x32_bf16 v[192:195], v[96:99], v[72:75], v[192:195]
  ds_read_b64_tr_b16 v[124:125], v4 offset:49152
  v_accvgpr_read_b32 v44, a124
  v_mfma_f32_16x16x32_bf16 v[192:195], v[100:103], v[76:79], v[192:195]
  ds_read_b64_tr_b16 v[126:127], v4 offset:51200
  s_waitcnt lgkmcnt(8)
  v_mfma_f32_16x16x32_bf16 v[132:135], v[104:107], v[64:67], v[132:135]
  ds_read_b64_tr_b16 v[96:97], v5 offset:32768
  v_accvgpr_read_b32 v45, a125
  v_mfma_f32_16x16x32_bf16 v[132:135], v[108:111], v[68:71], v[132:135]
  ds_read_b64_tr_b16 v[98:99], v5 offset:34816
  buffer_load_dwordx4 v[52:55], v0, s[20:23], s34 offen offset:3072 sc1
  v_mfma_f32_16x16x32_bf16 v[196:199], v[104:107], v[72:75], v[196:199]
  ds_read_b64_tr_b16 v[100:101], v5 offset:49152
  v_accvgpr_read_b32 v46, a126
  v_accvgpr_read_b32 v47, a127
  v_mfma_f32_16x16x32_bf16 v[196:199], v[108:111], v[76:79], v[196:199]
  ds_read_b64_tr_b16 v[102:103], v5 offset:51200
  s_waitcnt lgkmcnt(8)
  v_mfma_f32_16x16x32_bf16 v[136:139], v[112:115], v[64:67], v[136:139]
  ds_read_b64_tr_b16 v[104:105], v6 offset:32768
  v_cvt_pk_bf16_f32 v40, v40, v41
  v_mfma_f32_16x16x32_bf16 v[136:139], v[116:119], v[68:71], v[136:139]
  ds_read_b64_tr_b16 v[106:107], v6 offset:34816
  buffer_load_dwordx4 v[56:59], v0, s[20:23], s35 offen offset:2048 sc1
  v_mfma_f32_16x16x32_bf16 v[200:203], v[112:115], v[72:75], v[200:203]
  ds_read_b64_tr_b16 v[108:109], v6 offset:49152
  v_cvt_pk_bf16_f32 v41, v42, v43
  v_cvt_pk_bf16_f32 v42, v44, v45
  v_mfma_f32_16x16x32_bf16 v[200:203], v[116:119], v[76:79], v[200:203]
  ds_read_b64_tr_b16 v[110:111], v6 offset:51200
  s_waitcnt lgkmcnt(8)
  v_mfma_f32_16x16x32_bf16 v[140:143], v[120:123], v[64:67], v[140:143]
  ds_read_b64_tr_b16 v[112:113], v7 offset:32768
  v_cvt_pk_bf16_f32 v43, v46, v47
  v_mfma_f32_16x16x32_bf16 v[140:143], v[124:127], v[68:71], v[140:143]
  ds_read_b64_tr_b16 v[114:115], v7 offset:34816
  buffer_load_dwordx4 v[60:63], v0, s[20:23], s35 offen offset:3072 sc1
  v_mfma_f32_16x16x32_bf16 v[204:207], v[120:123], v[72:75], v[204:207]
  ds_read_b64_tr_b16 v[116:117], v7 offset:49152
  buffer_store_dwordx4 v[40:43], v0, s[20:23], s55 offen offset:3072 sc1
  s_add_u32 s55, s55, s57
  v_mfma_f32_16x16x32_bf16 v[204:207], v[124:127], v[76:79], v[204:207]
  ds_read_b64_tr_b16 v[118:119], v7 offset:51200
  s_waitcnt lgkmcnt(8)
  v_mfma_f32_16x16x32_bf16 v[144:147], v[96:99], v[64:67], v[144:147]
  ds_read_b64_tr_b16 v[120:121], v8 offset:32768
  v_accvgpr_read_b32 v32, a128
  v_accvgpr_read_b32 v33, a129
  v_mfma_f32_16x16x32_bf16 v[144:147], v[100:103], v[68:71], v[144:147]
  ds_read_b64_tr_b16 v[122:123], v8 offset:34816
  s_add_u32 s34, s34, 4096
  v_mfma_f32_16x16x32_bf16 v[208:211], v[96:99], v[72:75], v[208:211]
  ds_read_b64_tr_b16 v[124:125], v8 offset:49152
  v_accvgpr_read_b32 v34, a130
  v_mfma_f32_16x16x32_bf16 v[208:211], v[100:103], v[76:79], v[208:211]
  ds_read_b64_tr_b16 v[126:127], v8 offset:51200
  s_waitcnt lgkmcnt(8)
  v_mfma_f32_16x16x32_bf16 v[148:151], v[104:107], v[64:67], v[148:151]
  ds_read_b64_tr_b16 v[96:97], v1 offset:33024
  v_accvgpr_read_b32 v35, a131
  v_accvgpr_read_b32 v36, a132
  v_mfma_f32_16x16x32_bf16 v[148:151], v[108:111], v[68:71], v[148:151]
  ds_read_b64_tr_b16 v[98:99], v1 offset:35072
  s_add_u32 s35, s35, 4096
  v_mfma_f32_16x16x32_bf16 v[212:215], v[104:107], v[72:75], v[212:215]
  ds_read_b64_tr_b16 v[100:101], v1 offset:49408
  v_accvgpr_read_b32 v37, a133
  v_mfma_f32_16x16x32_bf16 v[212:215], v[108:111], v[76:79], v[212:215]
  ds_read_b64_tr_b16 v[102:103], v1 offset:51456
  s_waitcnt lgkmcnt(8)
  v_mfma_f32_16x16x32_bf16 v[152:155], v[112:115], v[64:67], v[152:155]
  ds_read_b64_tr_b16 v[104:105], v2 offset:33024
  v_accvgpr_read_b32 v38, a134
  v_accvgpr_read_b32 v39, a135
  v_mfma_f32_16x16x32_bf16 v[152:155], v[116:119], v[68:71], v[152:155]
  ds_read_b64_tr_b16 v[106:107], v2 offset:35072
  v_cvt_pk_bf16_f32 v32, v32, v33
  v_mfma_f32_16x16x32_bf16 v[216:219], v[112:115], v[72:75], v[216:219]
  ds_read_b64_tr_b16 v[108:109], v2 offset:49408
  v_cvt_pk_bf16_f32 v33, v34, v35
  v_mfma_f32_16x16x32_bf16 v[216:219], v[116:119], v[76:79], v[216:219]
  ds_read_b64_tr_b16 v[110:111], v2 offset:51456
  s_waitcnt lgkmcnt(8)
  v_mfma_f32_16x16x32_bf16 v[156:159], v[120:123], v[64:67], v[156:159]
  ds_read_b64_tr_b16 v[112:113], v3 offset:33024
  v_cvt_pk_bf16_f32 v34, v36, v37
  v_mfma_f32_16x16x32_bf16 v[156:159], v[124:127], v[68:71], v[156:159]
  ds_read_b64_tr_b16 v[114:115], v3 offset:35072
  v_cvt_pk_bf16_f32 v35, v38, v39
  v_mfma_f32_16x16x32_bf16 v[220:223], v[120:123], v[72:75], v[220:223]
  ds_read_b64_tr_b16 v[116:117], v3 offset:49408
  buffer_store_dwordx4 v[32:35], v0, s[20:23], s55 offen offset:0 sc1
  v_mfma_f32_16x16x32_bf16 v[220:223], v[124:127], v[76:79], v[220:223]
  ds_read_b64_tr_b16 v[118:119], v3 offset:51456
  s_waitcnt lgkmcnt(8)
  v_mfma_f32_16x16x32_bf16 v[160:163], v[96:99], v[64:67], v[160:163]
  ds_read_b64_tr_b16 v[120:121], v4 offset:33024
  v_accvgpr_read_b32 v40, a136
  v_mfma_f32_16x16x32_bf16 v[160:163], v[100:103], v[68:71], v[160:163]
  ds_read_b64_tr_b16 v[122:123], v4 offset:35072
  v_accvgpr_read_b32 v41, a137
  v_mfma_f32_16x16x32_bf16 v[224:227], v[96:99], v[72:75], v[224:227]
  ds_read_b64_tr_b16 v[124:125], v4 offset:49408
  v_accvgpr_read_b32 v42, a138
  v_mfma_f32_16x16x32_bf16 v[224:227], v[100:103], v[76:79], v[224:227]
  ds_read_b64_tr_b16 v[126:127], v4 offset:51456
  s_waitcnt lgkmcnt(8)
  v_mfma_f32_16x16x32_bf16 v[164:167], v[104:107], v[64:67], v[164:167]
  ds_read_b64_tr_b16 v[96:97], v5 offset:33024
  v_accvgpr_read_b32 v43, a139
  v_mfma_f32_16x16x32_bf16 v[164:167], v[108:111], v[68:71], v[164:167]
  ds_read_b64_tr_b16 v[98:99], v5 offset:35072
  v_accvgpr_read_b32 v44, a140
  v_mfma_f32_16x16x32_bf16 v[228:231], v[104:107], v[72:75], v[228:231]
  ds_read_b64_tr_b16 v[100:101], v5 offset:49408
  v_accvgpr_read_b32 v45, a141
  v_mfma_f32_16x16x32_bf16 v[228:231], v[108:111], v[76:79], v[228:231]
  ds_read_b64_tr_b16 v[102:103], v5 offset:51456
  s_waitcnt lgkmcnt(8)
  v_mfma_f32_16x16x32_bf16 v[168:171], v[112:115], v[64:67], v[168:171]
  ds_read_b64_tr_b16 v[104:105], v6 offset:33024
  v_accvgpr_read_b32 v46, a142
  v_mfma_f32_16x16x32_bf16 v[168:171], v[116:119], v[68:71], v[168:171]
  ds_read_b64_tr_b16 v[106:107], v6 offset:35072
  v_accvgpr_read_b32 v47, a143
  v_mfma_f32_16x16x32_bf16 v[232:235], v[112:115], v[72:75], v[232:235]
  ds_read_b64_tr_b16 v[108:109], v6 offset:49408
  v_cvt_pk_bf16_f32 v40, v40, v41
  v_mfma_f32_16x16x32_bf16 v[232:235], v[116:119], v[76:79], v[232:235]
  ds_read_b64_tr_b16 v[110:111], v6 offset:51456
  s_waitcnt lgkmcnt(8)
  v_mfma_f32_16x16x32_bf16 v[172:175], v[120:123], v[64:67], v[172:175]
  ds_read_b64_tr_b16 v[112:113], v7 offset:33024
  v_cvt_pk_bf16_f32 v41, v42, v43
  v_mfma_f32_16x16x32_bf16 v[172:175], v[124:127], v[68:71], v[172:175]
  ds_read_b64_tr_b16 v[114:115], v7 offset:35072
  v_cvt_pk_bf16_f32 v42, v44, v45
  v_mfma_f32_16x16x32_bf16 v[236:239], v[120:123], v[72:75], v[236:239]
  ds_read_b64_tr_b16 v[116:117], v7 offset:49408
  v_cvt_pk_bf16_f32 v43, v46, v47
  v_mfma_f32_16x16x32_bf16 v[236:239], v[124:127], v[76:79], v[236:239]
  ds_read_b64_tr_b16 v[118:119], v7 offset:51456
  s_waitcnt lgkmcnt(8)
  v_mfma_f32_16x16x32_bf16 v[176:179], v[96:99], v[64:67], v[176:179]
  ds_read_b64_tr_b16 v[120:121], v8 offset:33024
  buffer_store_dwordx4 v[40:43], v0, s[20:23], s55 offen offset:1024 sc1
  v_mfma_f32_16x16x32_bf16 v[176:179], v[100:103], v[68:71], v[176:179]
  ds_read_b64_tr_b16 v[122:123], v8 offset:35072
  v_add_u32 v1, 65536, v1
  v_mfma_f32_16x16x32_bf16 v[240:243], v[96:99], v[72:75], v[240:243]
  ds_read_b64_tr_b16 v[124:125], v8 offset:49408
  s_waitcnt vmcnt(63)
  v_accvgpr_read_b32 v32, a144
  v_mfma_f32_16x16x32_bf16 v[240:243], v[100:103], v[76:79], v[240:243]
  ds_read_b64_tr_b16 v[126:127], v8 offset:51456
  s_waitcnt lgkmcnt(8)
  v_accvgpr_read_b32 v33, a145
  v_mfma_f32_16x16x32_bf16 v[180:183], v[104:107], v[64:67], v[180:183]
  s_barrier
  ds_read_b64_tr_b16 v[96:97], v1 offset:0
  v_accvgpr_read_b32 v34, a146
  v_mfma_f32_16x16x32_bf16 v[180:183], v[108:111], v[68:71], v[180:183]
  ds_read_b64_tr_b16 v[98:99], v1 offset:2048
  v_add_u32 v2, 65536, v2
  v_mfma_f32_16x16x32_bf16 v[244:247], v[104:107], v[72:75], v[244:247]
  ds_read_b64_tr_b16 v[100:101], v1 offset:16384
  s_add_u32 s33, s60, 2621440
  v_accvgpr_read_b32 v35, a147
  v_mfma_f32_16x16x32_bf16 v[244:247], v[108:111], v[76:79], v[244:247]
  ds_read_b64_tr_b16 v[102:103], v1 offset:18432
  s_waitcnt lgkmcnt(8)
  v_accvgpr_read_b32 v36, a148
  v_mfma_f32_16x16x32_bf16 v[184:187], v[112:115], v[64:67], v[184:187]
  ds_read_b64_tr_b16 v[104:105], v2 offset:0
  s_add_u32 m0, s52, 65536
  v_accvgpr_read_b32 v37, a149
  v_mfma_f32_16x16x32_bf16 v[184:187], v[116:119], v[68:71], v[184:187]
  ds_read_b64_tr_b16 v[106:107], v2 offset:2048
  v_add_u32 v3, 65536, v3
  v_mfma_f32_16x16x32_bf16 v[248:251], v[112:115], v[72:75], v[248:251]
  ds_read_b64_tr_b16 v[108:109], v2 offset:16384
  buffer_load_dwordx4 v11, s[16:19], s33 offen offset:0  lds
  v_mfma_f32_16x16x32_bf16 v[248:251], v[116:119], v[76:79], v[248:251]
  ds_read_b64_tr_b16 v[110:111], v2 offset:18432
  s_waitcnt lgkmcnt(8)
  v_mfma_f32_16x16x32_bf16 v[188:191], v[120:123], v[64:67], v[188:191]
  ds_read_b64_tr_b16 v[112:113], v3 offset:0
  v_accvgpr_read_b32 v38, a150
  v_accvgpr_read_b32 v39, a151
  v_mfma_f32_16x16x32_bf16 v[188:191], v[124:127], v[68:71], v[188:191]
  ds_read_b64_tr_b16 v[114:115], v3 offset:2048
  v_add_u32 v4, 65536, v4
  v_cvt_pk_bf16_f32 v32, v32, v33
  v_mfma_f32_16x16x32_bf16 v[252:255], v[120:123], v[72:75], v[252:255]
  ds_read_b64_tr_b16 v[116:117], v3 offset:16384
  buffer_load_dwordx4 v12, s[16:19], s33 offen offset:1024  lds
  v_mfma_f32_16x16x32_bf16 v[252:255], v[124:127], v[76:79], v[252:255]
  ds_read_b64_tr_b16 v[118:119], v3 offset:18432
  s_waitcnt vmcnt(63) lgkmcnt(8)
  v_mfma_f32_16x16x32_bf16 v[128:131], v[96:99], v[80:83], v[128:131]
  ds_read_b64_tr_b16 v[120:121], v4 offset:0
  v_cvt_pk_bf16_f32 v33, v34, v35
  v_cvt_pk_bf16_f32 v34, v36, v37
  v_mfma_f32_16x16x32_bf16 v[128:131], v[100:103], v[84:87], v[128:131]
  ds_read_b64_tr_b16 v[122:123], v4 offset:2048
  v_add_u32 v5, 65536, v5
  v_cvt_pk_bf16_f32 v35, v38, v39
  v_mfma_f32_16x16x32_bf16 v[192:195], v[96:99], v[88:91], v[192:195]
  ds_read_b64_tr_b16 v[124:125], v4 offset:16384
  buffer_load_dwordx4 v[64:67], v0, s[20:23], s34 offen offset:0 sc1
  buffer_store_dwordx4 v[32:35], v0, s[20:23], s55 offen offset:2048 sc1
  v_mfma_f32_16x16x32_bf16 v[192:195], v[100:103], v[92:95], v[192:195]
  ds_read_b64_tr_b16 v[126:127], v4 offset:18432
  s_waitcnt lgkmcnt(8)
  v_mfma_f32_16x16x32_bf16 v[132:135], v[104:107], v[80:83], v[132:135]
  ds_read_b64_tr_b16 v[96:97], v5 offset:0
  buffer_load_dwordx4 v13, s[16:19], s33 offen offset:2048  lds
  v_accvgpr_read_b32 v40, a152
  v_mfma_f32_16x16x32_bf16 v[132:135], v[108:111], v[84:87], v[132:135]
  ds_read_b64_tr_b16 v[98:99], v5 offset:2048
  v_add_u32 v6, 65536, v6
  v_accvgpr_read_b32 v41, a153
  v_mfma_f32_16x16x32_bf16 v[196:199], v[104:107], v[88:91], v[196:199]
  ds_read_b64_tr_b16 v[100:101], v5 offset:16384
  buffer_load_dwordx4 v[68:71], v0, s[20:23], s34 offen offset:1024 sc1
  v_accvgpr_read_b32 v42, a154
  v_mfma_f32_16x16x32_bf16 v[196:199], v[108:111], v[92:95], v[196:199]
  ds_read_b64_tr_b16 v[102:103], v5 offset:18432
  s_waitcnt lgkmcnt(8)
  v_mfma_f32_16x16x32_bf16 v[136:139], v[112:115], v[80:83], v[136:139]
  ds_read_b64_tr_b16 v[104:105], v6 offset:0
  buffer_load_dwordx4 v14, s[16:19], s33 offen offset:3072  lds
  v_accvgpr_read_b32 v43, a155
  v_mfma_f32_16x16x32_bf16 v[136:139], v[116:119], v[84:87], v[136:139]
  ds_read_b64_tr_b16 v[106:107], v6 offset:2048
  v_add_u32 v7, 65536, v7
  v_accvgpr_read_b32 v44, a156
  v_mfma_f32_16x16x32_bf16 v[200:203], v[112:115], v[88:91], v[200:203]
  ds_read_b64_tr_b16 v[108:109], v6 offset:16384
  buffer_load_dwordx4 v[72:75], v0, s[20:23], s35 offen offset:0 sc1
  v_accvgpr_read_b32 v45, a157
  v_mfma_f32_16x16x32_bf16 v[200:203], v[116:119], v[92:95], v[200:203]
  ds_read_b64_tr_b16 v[110:111], v6 offset:18432
  s_waitcnt lgkmcnt(8)
  v_mfma_f32_16x16x32_bf16 v[140:143], v[120:123], v[80:83], v[140:143]
  ds_read_b64_tr_b16 v[112:113], v7 offset:0
  s_add_u32 m0, s52, 69632
  v_accvgpr_read_b32 v46, a158
  v_mfma_f32_16x16x32_bf16 v[140:143], v[124:127], v[84:87], v[140:143]
  ds_read_b64_tr_b16 v[114:115], v7 offset:2048
  v_add_u32 v8, 65536, v8
  v_accvgpr_read_b32 v47, a159
  v_mfma_f32_16x16x32_bf16 v[204:207], v[120:123], v[88:91], v[204:207]
  ds_read_b64_tr_b16 v[116:117], v7 offset:16384
  buffer_load_dwordx4 v[76:79], v0, s[20:23], s35 offen offset:1024 sc1
  v_cvt_pk_bf16_f32 v40, v40, v41
  v_mfma_f32_16x16x32_bf16 v[204:207], v[124:127], v[92:95], v[204:207]
  ds_read_b64_tr_b16 v[118:119], v7 offset:18432
  s_waitcnt lgkmcnt(8)
  v_mfma_f32_16x16x32_bf16 v[144:147], v[96:99], v[80:83], v[144:147]
  ds_read_b64_tr_b16 v[120:121], v8 offset:0
  buffer_load_dwordx4 v15, s[16:19], s33 offen offset:0  lds
  v_mfma_f32_16x16x32_bf16 v[144:147], v[100:103], v[84:87], v[144:147]
  ds_read_b64_tr_b16 v[122:123], v8 offset:2048
  v_cvt_pk_bf16_f32 v41, v42, v43
  v_mfma_f32_16x16x32_bf16 v[208:211], v[96:99], v[88:91], v[208:211]
  ds_read_b64_tr_b16 v[124:125], v8 offset:16384
  v_cvt_pk_bf16_f32 v42, v44, v45
  v_cvt_pk_bf16_f32 v43, v46, v47
  v_mfma_f32_16x16x32_bf16 v[208:211], v[100:103], v[92:95], v[208:211]
  ds_read_b64_tr_b16 v[126:127], v8 offset:18432
  s_waitcnt lgkmcnt(8)
  v_mfma_f32_16x16x32_bf16 v[148:151], v[104:107], v[80:83], v[148:151]
  ds_read_b64_tr_b16 v[96:97], v1 offset:256
  buffer_load_dwordx4 v16, s[16:19], s33 offen offset:1024  lds
  v_mfma_f32_16x16x32_bf16 v[148:151], v[108:111], v[84:87], v[148:151]
  ds_read_b64_tr_b16 v[98:99], v1 offset:2304
  buffer_store_dwordx4 v[40:43], v0, s[20:23], s55 offen offset:3072 sc1
  v_mfma_f32_16x16x32_bf16 v[212:215], v[104:107], v[88:91], v[212:215]
  ds_read_b64_tr_b16 v[100:101], v1 offset:16640
  s_add_u32 s55, s55, s56
  v_accvgpr_read_b32 v32, a160
  v_mfma_f32_16x16x32_bf16 v[212:215], v[108:111], v[92:95], v[212:215]
  ds_read_b64_tr_b16 v[102:103], v1 offset:18688
  s_waitcnt lgkmcnt(8)
  v_mfma_f32_16x16x32_bf16 v[152:155], v[112:115], v[80:83], v[152:155]
  ds_read_b64_tr_b16 v[104:105], v2 offset:256
  buffer_load_dwordx4 v17, s[16:19], s33 offen offset:2048  lds
  v_mfma_f32_16x16x32_bf16 v[152:155], v[116:119], v[84:87], v[152:155]
  ds_read_b64_tr_b16 v[106:107], v2 offset:2304
  v_accvgpr_read_b32 v33, a161
  v_accvgpr_read_b32 v34, a162
  v_mfma_f32_16x16x32_bf16 v[216:219], v[112:115], v[88:91], v[216:219]
  ds_read_b64_tr_b16 v[108:109], v2 offset:16640
  v_accvgpr_read_b32 v35, a163
  v_mfma_f32_16x16x32_bf16 v[216:219], v[116:119], v[92:95], v[216:219]
  ds_read_b64_tr_b16 v[110:111], v2 offset:18688
  s_waitcnt lgkmcnt(8)
  v_mfma_f32_16x16x32_bf16 v[156:159], v[120:123], v[80:83], v[156:159]
  ds_read_b64_tr_b16 v[112:113], v3 offset:256
  buffer_load_dwordx4 v18, s[16:19], s33 offen offset:3072  lds
  v_mfma_f32_16x16x32_bf16 v[156:159], v[124:127], v[84:87], v[156:159]
  ds_read_b64_tr_b16 v[114:115], v3 offset:2304
  v_accvgpr_read_b32 v36, a164
  v_accvgpr_read_b32 v37, a165
  v_mfma_f32_16x16x32_bf16 v[220:223], v[120:123], v[88:91], v[220:223]
  ds_read_b64_tr_b16 v[116:117], v3 offset:16640
  v_accvgpr_read_b32 v38, a166
  v_mfma_f32_16x16x32_bf16 v[220:223], v[124:127], v[92:95], v[220:223]
  ds_read_b64_tr_b16 v[118:119], v3 offset:18688
  s_waitcnt lgkmcnt(8)
  v_mfma_f32_16x16x32_bf16 v[160:163], v[96:99], v[80:83], v[160:163]
  ds_read_b64_tr_b16 v[120:121], v4 offset:256
  v_accvgpr_read_b32 v39, a167
  v_mfma_f32_16x16x32_bf16 v[160:163], v[100:103], v[84:87], v[160:163]
  ds_read_b64_tr_b16 v[122:123], v4 offset:2304
  v_cvt_pk_bf16_f32 v32, v32, v33
  v_mfma_f32_16x16x32_bf16 v[224:227], v[96:99], v[88:91], v[224:227]
  ds_read_b64_tr_b16 v[124:125], v4 offset:16640
  v_cvt_pk_bf16_f32 v33, v34, v35
  v_mfma_f32_16x16x32_bf16 v[224:227], v[100:103], v[92:95], v[224:227]
  ds_read_b64_tr_b16 v[126:127], v4 offset:18688
  s_waitcnt lgkmcnt(8)
  v_mfma_f32_16x16x32_bf16 v[164:167], v[104:107], v[80:83], v[164:167]
  ds_read_b64_tr_b16 v[96:97], v5 offset:256
  v_cvt_pk_bf16_f32 v34, v36, v37
  v_mfma_f32_16x16x32_bf16 v[164:167], v[108:111], v[84:87], v[164:167]
  ds_read_b64_tr_b16 v[98:99], v5 offset:2304
  v_cvt_pk_bf16_f32 v35, v38, v39
  v_mfma_f32_16x16x32_bf16 v[228:231], v[104:107], v[88:91], v[228:231]
  ds_read_b64_tr_b16 v[100:101], v5 offset:16640
  buffer_store_dwordx4 v[32:35], v0, s[20:23], s55 offen offset:0 sc1
  v_mfma_f32_16x16x32_bf16 v[228:231], v[108:111], v[92:95], v[228:231]
  ds_read_b64_tr_b16 v[102:103], v5 offset:18688
  s_waitcnt lgkmcnt(8)
  v_mfma_f32_16x16x32_bf16 v[168:171], v[112:115], v[80:83], v[168:171]
  ds_read_b64_tr_b16 v[104:105], v6 offset:256
  v_accvgpr_read_b32 v40, a168
  v_mfma_f32_16x16x32_bf16 v[168:171], v[116:119], v[84:87], v[168:171]
  ds_read_b64_tr_b16 v[106:107], v6 offset:2304
  v_accvgpr_read_b32 v41, a169
  v_mfma_f32_16x16x32_bf16 v[232:235], v[112:115], v[88:91], v[232:235]
  ds_read_b64_tr_b16 v[108:109], v6 offset:16640
  v_accvgpr_read_b32 v42, a170
  v_mfma_f32_16x16x32_bf16 v[232:235], v[116:119], v[92:95], v[232:235]
  ds_read_b64_tr_b16 v[110:111], v6 offset:18688
  s_waitcnt lgkmcnt(8)
  v_mfma_f32_16x16x32_bf16 v[172:175], v[120:123], v[80:83], v[172:175]
  ds_read_b64_tr_b16 v[112:113], v7 offset:256
  v_accvgpr_read_b32 v43, a171
  v_mfma_f32_16x16x32_bf16 v[172:175], v[124:127], v[84:87], v[172:175]
  ds_read_b64_tr_b16 v[114:115], v7 offset:2304
  v_accvgpr_read_b32 v44, a172
  v_mfma_f32_16x16x32_bf16 v[236:239], v[120:123], v[88:91], v[236:239]
  ds_read_b64_tr_b16 v[116:117], v7 offset:16640
  v_accvgpr_read_b32 v45, a173
  v_mfma_f32_16x16x32_bf16 v[236:239], v[124:127], v[92:95], v[236:239]
  ds_read_b64_tr_b16 v[118:119], v7 offset:18688
  s_waitcnt lgkmcnt(8)
  v_mfma_f32_16x16x32_bf16 v[176:179], v[96:99], v[80:83], v[176:179]
  ds_read_b64_tr_b16 v[120:121], v8 offset:256
  v_accvgpr_read_b32 v46, a174
  v_mfma_f32_16x16x32_bf16 v[176:179], v[100:103], v[84:87], v[176:179]
  ds_read_b64_tr_b16 v[122:123], v8 offset:2304
  v_subrev_u32 v1, 131072, v1
  v_accvgpr_read_b32 v47, a175
  v_mfma_f32_16x16x32_bf16 v[240:243], v[96:99], v[88:91], v[240:243]
  ds_read_b64_tr_b16 v[124:125], v8 offset:16640
  s_waitcnt vmcnt(38)
  v_cvt_pk_bf16_f32 v40, v40, v41
  v_mfma_f32_16x16x32_bf16 v[240:243], v[100:103], v[92:95], v[240:243]
  ds_read_b64_tr_b16 v[126:127], v8 offset:18688
  s_waitcnt lgkmcnt(8)
  v_mfma_f32_16x16x32_bf16 v[180:183], v[104:107], v[80:83], v[180:183]
  s_barrier
  ds_read_b64_tr_b16 v[96:97], v1 offset:0
  v_cvt_pk_bf16_f32 v41, v42, v43
  v_mfma_f32_16x16x32_bf16 v[180:183], v[108:111], v[84:87], v[180:183]
  ds_read_b64_tr_b16 v[98:99], v1 offset:2048
  v_subrev_u32 v2, 131072, v2
  v_cvt_pk_bf16_f32 v42, v44, v45
  v_mfma_f32_16x16x32_bf16 v[244:247], v[104:107], v[88:91], v[244:247]
  ds_read_b64_tr_b16 v[100:101], v1 offset:16384
  s_add_u32 s33, s60, 3145728
  v_cvt_pk_bf16_f32 v43, v46, v47
  v_mfma_f32_16x16x32_bf16 v[244:247], v[108:111], v[92:95], v[244:247]
  ds_read_b64_tr_b16 v[102:103], v1 offset:18432
  s_waitcnt lgkmcnt(8)
  v_mfma_f32_16x16x32_bf16 v[184:187], v[112:115], v[80:83], v[184:187]
  ds_read_b64_tr_b16 v[104:105], v2 offset:0
  s_add_u32 m0, s52, 98304
  buffer_store_dwordx4 v[40:43], v0, s[20:23], s55 offen offset:1024 sc1
  v_mfma_f32_16x16x32_bf16 v[184:187], v[116:119], v[84:87], v[184:187]
  ds_read_b64_tr_b16 v[106:107], v2 offset:2048
  v_subrev_u32 v3, 131072, v3
  v_mfma_f32_16x16x32_bf16 v[248:251], v[112:115], v[88:91], v[248:251]
  ds_read_b64_tr_b16 v[108:109], v2 offset:16384
  buffer_load_dwordx4 v11, s[16:19], s33 offen offset:0  lds
  v_mfma_f32_16x16x32_bf16 v[248:251], v[116:119], v[92:95], v[248:251]
  ds_read_b64_tr_b16 v[110:111], v2 offset:18432
  s_waitcnt lgkmcnt(8)
  v_mfma_f32_16x16x32_bf16 v[188:191], v[120:123], v[80:83], v[188:191]
  ds_read_b64_tr_b16 v[112:113], v3 offset:0
  v_accvgpr_read_b32 v32, a176
  v_accvgpr_read_b32 v33, a177
  v_mfma_f32_16x16x32_bf16 v[188:191], v[124:127], v[84:87], v[188:191]
  ds_read_b64_tr_b16 v[114:115], v3 offset:2048
  v_subrev_u32 v4, 131072, v4
  v_accvgpr_read_b32 v34, a178
  v_mfma_f32_16x16x32_bf16 v[252:255], v[120:123], v[88:91], v[252:255]
  ds_read_b64_tr_b16 v[116:117], v3 offset:16384
  buffer_load_dwordx4 v12, s[16:19], s33 offen offset:1024  lds
  v_mfma_f32_16x16x32_bf16 v[252:255], v[124:127], v[92:95], v[252:255]
  ds_read_b64_tr_b16 v[118:119], v3 offset:18432
  s_waitcnt vmcnt(21) lgkmcnt(8)
  v_mfma_f32_16x16x32_bf16 v[128:131], v[96:99], v[48:51], v[128:131]
  ds_read_b64_tr_b16 v[120:121], v4 offset:0
  v_accvgpr_read_b32 v35, a179
  v_accvgpr_read_b32 v36, a180
  v_mfma_f32_16x16x32_bf16 v[128:131], v[100:103], v[52:55], v[128:131]
  ds_read_b64_tr_b16 v[122:123], v4 offset:2048
  v_subrev_u32 v5, 131072, v5
  v_accvgpr_read_b32 v37, a181
  v_mfma_f32_16x16x32_bf16 v[192:195], v[96:99], v[56:59], v[192:195]
  ds_read_b64_tr_b16 v[124:125], v4 offset:16384
  buffer_load_dwordx4 v[80:83], v0, s[20:23], s34 offen offset:2048 sc1
  v_accvgpr_read_b32 v38, a182
  v_mfma_f32_16x16x32_bf16 v[192:195], v[100:103], v[60:63], v[192:195]
  ds_read_b64_tr_b16 v[126:127], v4 offset:18432
  s_waitcnt lgkmcnt(8)
  v_accvgpr_read_b32 v39, a183
  v_mfma_f32_16x16x32_bf16 v[132:135], v[104:107], v[48:51], v[132:135]
  ds_read_b64_tr_b16 v[96:97], v5 offset:0
  buffer_load_dwordx4 v13, s[16:19], s33 offen offset:2048  lds
  v_cvt_pk_bf16_f32 v32, v32, v33
  v_mfma_f32_16x16x32_bf16 v[132:135], v[108:111], v[52:55], v[132:135]
  ds_read_b64_tr_b16 v[98:99], v5 offset:2048
  v_subrev_u32 v6, 131072, v6
  v_mfma_f32_16x16x32_bf16 v[196:199], v[104:107], v[56:59], v[196:199]
  ds_read_b64_tr_b16 v[100:101], v5 offset:16384
  buffer_load_dwordx4 v[84:87], v0, s[20:23], s34 offen offset:3072 sc1
  v_cvt_pk_bf16_f32 v33, v34, v35
  v_mfma_f32_16x16x32_bf16 v[196:199], v[108:111], v[60:63], v[196:199]
  ds_read_b64_tr_b16 v[102:103], v5 offset:18432
  s_waitcnt lgkmcnt(8)
  v_cvt_pk_bf16_f32 v34, v36, v37
  v_mfma_f32_16x16x32_bf16 v[136:139], v[112:115], v[48:51], v[136:139]
  ds_read_b64_tr_b16 v[104:105], v6 offset:0
  buffer_load_dwordx4 v14, s[16:19], s33 offen offset:3072  lds
  v_cvt_pk_bf16_f32 v35, v38, v39
  v_mfma_f32_16x16x32_bf16 v[136:139], v[116:119], v[52:55], v[136:139]
  ds_read_b64_tr_b16 v[106:107], v6 offset:2048
  v_subrev_u32 v7, 131072, v7
  v_mfma_f32_16x16x32_bf16 v[200:203], v[112:115], v[56:59], v[200:203]
  ds_read_b64_tr_b16 v[108:109], v6 offset:16384
  buffer_load_dwordx4 v[88:91], v0, s[20:23], s35 offen offset:2048 sc1
  buffer_store_dwordx4 v[32:35], v0, s[20:23], s55 offen offset:2048 sc1
  v_mfma_f32_16x16x32_bf16 v[200:203], v[116:119], v[60:63], v[200:203]
  ds_read_b64_tr_b16 v[110:111], v6 offset:18432
  s_waitcnt lgkmcnt(8)
  v_mfma_f32_16x16x32_bf16 v[140:143], v[120:123], v[48:51], v[140:143]
  ds_read_b64_tr_b16 v[112:113], v7 offset:0
  s_add_u32 m0, s52, 102400
  v_accvgpr_read_b32 v40, a184
  v_mfma_f32_16x16x32_bf16 v[140:143], v[124:127], v[52:55], v[140:143]
  ds_read_b64_tr_b16 v[114:115], v7 offset:2048
  v_subrev_u32 v8, 131072, v8
  v_accvgpr_read_b32 v41, a185
  v_mfma_f32_16x16x32_bf16 v[204:207], v[120:123], v[56:59], v[204:207]
  ds_read_b64_tr_b16 v[116:117], v7 offset:16384
  buffer_load_dwordx4 v[92:95], v0, s[20:23], s35 offen offset:3072 sc1
  v_accvgpr_read_b32 v42, a186
  v_mfma_f32_16x16x32_bf16 v[204:207], v[124:127], v[60:63], v[204:207]
  ds_read_b64_tr_b16 v[118:119], v7 offset:18432
  s_waitcnt lgkmcnt(8)
  v_mfma_f32_16x16x32_bf16 v[144:147], v[96:99], v[48:51], v[144:147]
  ds_read_b64_tr_b16 v[120:121], v8 offset:0
  buffer_load_dwordx4 v15, s[16:19], s33 offen offset:0  lds
  v_mfma_f32_16x16x32_bf16 v[144:147], v[100:103], v[52:55], v[144:147]
  ds_read_b64_tr_b16 v[122:123], v8 offset:2048
  s_add_u32 s34, s34, 4096
  v_mfma_f32_16x16x32_bf16 v[208:211], v[96:99], v[56:59], v[208:211]
  ds_read_b64_tr_b16 v[124:125], v8 offset:16384
  v_accvgpr_read_b32 v43, a187
  v_accvgpr_read_b32 v44, a188
  v_mfma_f32_16x16x32_bf16 v[208:211], v[100:103], v[60:63], v[208:211]
  ds_read_b64_tr_b16 v[126:127], v8 offset:18432
  s_waitcnt lgkmcnt(8)
  v_accvgpr_read_b32 v45, a189
  v_mfma_f32_16x16x32_bf16 v[148:151], v[104:107], v[48:51], v[148:151]
  ds_read_b64_tr_b16 v[96:97], v1 offset:256
  buffer_load_dwordx4 v16, s[16:19], s33 offen offset:1024  lds
  v_mfma_f32_16x16x32_bf16 v[148:151], v[108:111], v[52:55], v[148:151]
  ds_read_b64_tr_b16 v[98:99], v1 offset:2304
  s_add_u32 s35, s35, 4096
  v_mfma_f32_16x16x32_bf16 v[212:215], v[104:107], v[56:59], v[212:215]
  ds_read_b64_tr_b16 v[100:101], v1 offset:16640
  v_accvgpr_read_b32 v46, a190
  v_accvgpr_read_b32 v47, a191
  v_mfma_f32_16x16x32_bf16 v[212:215], v[108:111], v[60:63], v[212:215]
  ds_read_b64_tr_b16 v[102:103], v1 offset:18688
  s_waitcnt lgkmcnt(8)
  v_cvt_pk_bf16_f32 v40, v40, v41
  v_mfma_f32_16x16x32_bf16 v[152:155], v[112:115], v[48:51], v[152:155]
  ds_read_b64_tr_b16 v[104:105], v2 offset:256
  buffer_load_dwordx4 v17, s[16:19], s33 offen offset:2048  lds
  v_mfma_f32_16x16x32_bf16 v[152:155], v[116:119], v[52:55], v[152:155]
  ds_read_b64_tr_b16 v[106:107], v2 offset:2304
  v_cvt_pk_bf16_f32 v41, v42, v43
  v_mfma_f32_16x16x32_bf16 v[216:219], v[112:115], v[56:59], v[216:219]
  ds_read_b64_tr_b16 v[108:109], v2 offset:16640
  v_cvt_pk_bf16_f32 v42, v44, v45
  v_cvt_pk_bf16_f32 v43, v46, v47
  v_mfma_f32_16x16x32_bf16 v[216:219], v[116:119], v[60:63], v[216:219]
  ds_read_b64_tr_b16 v[110:111], v2 offset:18688
  s_waitcnt lgkmcnt(8)
  v_mfma_f32_16x16x32_bf16 v[156:159], v[120:123], v[48:51], v[156:159]
  ds_read_b64_tr_b16 v[112:113], v3 offset:256
  buffer_load_dwordx4 v18, s[16:19], s33 offen offset:3072  lds
  v_mfma_f32_16x16x32_bf16 v[156:159], v[124:127], v[52:55], v[156:159]
  ds_read_b64_tr_b16 v[114:115], v3 offset:2304
  buffer_store_dwordx4 v[40:43], v0, s[20:23], s55 offen offset:3072 sc1
  v_mfma_f32_16x16x32_bf16 v[220:223], v[120:123], v[56:59], v[220:223]
  ds_read_b64_tr_b16 v[116:117], v3 offset:16640
  s_add_u32 s55, s55, s57
  v_mfma_f32_16x16x32_bf16 v[220:223], v[124:127], v[60:63], v[220:223]
  ds_read_b64_tr_b16 v[118:119], v3 offset:18688
  s_waitcnt lgkmcnt(8)
  v_mfma_f32_16x16x32_bf16 v[160:163], v[96:99], v[48:51], v[160:163]
  ds_read_b64_tr_b16 v[120:121], v4 offset:256
  v_accvgpr_read_b32 v32, a192
  v_accvgpr_read_b32 v33, a193
  v_mfma_f32_16x16x32_bf16 v[160:163], v[100:103], v[52:55], v[160:163]
  ds_read_b64_tr_b16 v[122:123], v4 offset:2304
  v_accvgpr_read_b32 v34, a194
  v_mfma_f32_16x16x32_bf16 v[224:227], v[96:99], v[56:59], v[224:227]
  ds_read_b64_tr_b16 v[124:125], v4 offset:16640
  v_accvgpr_read_b32 v35, a195
  v_mfma_f32_16x16x32_bf16 v[224:227], v[100:103], v[60:63], v[224:227]
  ds_read_b64_tr_b16 v[126:127], v4 offset:18688
  s_waitcnt lgkmcnt(8)
  v_mfma_f32_16x16x32_bf16 v[164:167], v[104:107], v[48:51], v[164:167]
  ds_read_b64_tr_b16 v[96:97], v5 offset:256
  v_accvgpr_read_b32 v36, a196
  v_mfma_f32_16x16x32_bf16 v[164:167], v[108:111], v[52:55], v[164:167]
  ds_read_b64_tr_b16 v[98:99], v5 offset:2304
  v_accvgpr_read_b32 v37, a197
  v_mfma_f32_16x16x32_bf16 v[228:231], v[104:107], v[56:59], v[228:231]
  ds_read_b64_tr_b16 v[100:101], v5 offset:16640
  v_accvgpr_read_b32 v38, a198
  v_mfma_f32_16x16x32_bf16 v[228:231], v[108:111], v[60:63], v[228:231]
  ds_read_b64_tr_b16 v[102:103], v5 offset:18688
  s_waitcnt lgkmcnt(8)
  v_mfma_f32_16x16x32_bf16 v[168:171], v[112:115], v[48:51], v[168:171]
  ds_read_b64_tr_b16 v[104:105], v6 offset:256
  v_accvgpr_read_b32 v39, a199
  v_mfma_f32_16x16x32_bf16 v[168:171], v[116:119], v[52:55], v[168:171]
  ds_read_b64_tr_b16 v[106:107], v6 offset:2304
  v_cvt_pk_bf16_f32 v32, v32, v33
  v_mfma_f32_16x16x32_bf16 v[232:235], v[112:115], v[56:59], v[232:235]
  ds_read_b64_tr_b16 v[108:109], v6 offset:16640
  v_cvt_pk_bf16_f32 v33, v34, v35
  v_mfma_f32_16x16x32_bf16 v[232:235], v[116:119], v[60:63], v[232:235]
  ds_read_b64_tr_b16 v[110:111], v6 offset:18688
  s_waitcnt lgkmcnt(8)
  v_mfma_f32_16x16x32_bf16 v[172:175], v[120:123], v[48:51], v[172:175]
  ds_read_b64_tr_b16 v[112:113], v7 offset:256
  v_cvt_pk_bf16_f32 v34, v36, v37
  v_mfma_f32_16x16x32_bf16 v[172:175], v[124:127], v[52:55], v[172:175]
  ds_read_b64_tr_b16 v[114:115], v7 offset:2304
  v_cvt_pk_bf16_f32 v35, v38, v39
  v_mfma_f32_16x16x32_bf16 v[236:239], v[120:123], v[56:59], v[236:239]
  ds_read_b64_tr_b16 v[116:117], v7 offset:16640
  buffer_store_dwordx4 v[32:35], v0, s[20:23], s55 offen offset:0 sc1
  v_mfma_f32_16x16x32_bf16 v[236:239], v[124:127], v[60:63], v[236:239]
  ds_read_b64_tr_b16 v[118:119], v7 offset:18688
  s_waitcnt lgkmcnt(8)
  v_mfma_f32_16x16x32_bf16 v[176:179], v[96:99], v[48:51], v[176:179]
  ds_read_b64_tr_b16 v[120:121], v8 offset:256
  v_accvgpr_read_b32 v40, a200
  v_mfma_f32_16x16x32_bf16 v[176:179], v[100:103], v[52:55], v[176:179]
  ds_read_b64_tr_b16 v[122:123], v8 offset:2304
  v_accvgpr_read_b32 v41, a201
  v_mfma_f32_16x16x32_bf16 v[240:243], v[96:99], v[56:59], v[240:243]
  ds_read_b64_tr_b16 v[124:125], v8 offset:16640
  s_waitcnt vmcnt(63)
  v_accvgpr_read_b32 v42, a202
  v_mfma_f32_16x16x32_bf16 v[240:243], v[100:103], v[60:63], v[240:243]
  ds_read_b64_tr_b16 v[126:127], v8 offset:18688
  s_waitcnt lgkmcnt(8)
  v_mfma_f32_16x16x32_bf16 v[180:183], v[104:107], v[48:51], v[180:183]
  s_barrier
  ds_read_b64_tr_b16 v[96:97], v1 offset:32768
  v_mfma_f32_16x16x32_bf16 v[180:183], v[108:111], v[52:55], v[180:183]
  ds_read_b64_tr_b16 v[98:99], v1 offset:34816
  v_accvgpr_read_b32 v43, a203
  v_mfma_f32_16x16x32_bf16 v[244:247], v[104:107], v[56:59], v[244:247]
  ds_read_b64_tr_b16 v[100:101], v1 offset:49152
  v_accvgpr_read_b32 v44, a204
  v_mfma_f32_16x16x32_bf16 v[244:247], v[108:111], v[60:63], v[244:247]
  ds_read_b64_tr_b16 v[102:103], v1 offset:51200
  s_waitcnt lgkmcnt(8)
  v_mfma_f32_16x16x32_bf16 v[184:187], v[112:115], v[48:51], v[184:187]
  ds_read_b64_tr_b16 v[104:105], v2 offset:32768
  v_accvgpr_read_b32 v45, a205
  v_mfma_f32_16x16x32_bf16 v[184:187], v[116:119], v[52:55], v[184:187]
  ds_read_b64_tr_b16 v[106:107], v2 offset:34816
  v_accvgpr_read_b32 v46, a206
  v_mfma_f32_16x16x32_bf16 v[248:251], v[112:115], v[56:59], v[248:251]
  ds_read_b64_tr_b16 v[108:109], v2 offset:49152
  v_accvgpr_read_b32 v47, a207
  v_mfma_f32_16x16x32_bf16 v[248:251], v[116:119], v[60:63], v[248:251]
  ds_read_b64_tr_b16 v[110:111], v2 offset:51200
  s_waitcnt lgkmcnt(8)
  v_mfma_f32_16x16x32_bf16 v[188:191], v[120:123], v[48:51], v[188:191]
  ds_read_b64_tr_b16 v[112:113], v3 offset:32768
  v_cvt_pk_bf16_f32 v40, v40, v41
  v_mfma_f32_16x16x32_bf16 v[188:191], v[124:127], v[52:55], v[188:191]
  ds_read_b64_tr_b16 v[114:115], v3 offset:34816
  v_cvt_pk_bf16_f32 v41, v42, v43
  v_mfma_f32_16x16x32_bf16 v[252:255], v[120:123], v[56:59], v[252:255]
  ds_read_b64_tr_b16 v[116:117], v3 offset:49152
  v_cvt_pk_bf16_f32 v42, v44, v45
  v_mfma_f32_16x16x32_bf16 v[252:255], v[124:127], v[60:63], v[252:255]
  ds_read_b64_tr_b16 v[118:119], v3 offset:51200
  s_waitcnt vmcnt(22) lgkmcnt(8)
  v_mfma_f32_16x16x32_bf16 v[128:131], v[96:99], v[64:67], v[128:131]
  ds_read_b64_tr_b16 v[120:121], v4 offset:32768
  v_cvt_pk_bf16_f32 v43, v46, v47
  v_mfma_f32_16x16x32_bf16 v[128:131], v[100:103], v[68:71], v[128:131]
  ds_read_b64_tr_b16 v[122:123], v4 offset:34816
  buffer_load_dwordx4 v[48:51], v0, s[20:23], s34 offen offset:0 sc1
  v_mfma_f32_16x16x32_bf16 v[192:195], v[96:99], v[72:75], v[192:195]
  ds_read_b64_tr_b16 v[124:125], v4 offset:49152
  buffer_store_dwordx4 v[40:43], v0, s[20:23], s55 offen offset:1024 sc1
  v_mfma_f32_16x16x32_bf16 v[192:195], v[100:103], v[76:79], v[192:195]
  ds_read_b64_tr_b16 v[126:127], v4 offset:51200
  s_waitcnt lgkmcnt(8)
  v_mfma_f32_16x16x32_bf16 v[132:135], v[104:107], v[64:67], v[132:135]
  ds_read_b64_tr_b16 v[96:97], v5 offset:32768
  v_accvgpr_read_b32 v32, a208
  v_accvgpr_read_b32 v33, a209
  v_mfma_f32_16x16x32_bf16 v[132:135], v[108:111], v[68:71], v[132:135]
  ds_read_b64_tr_b16 v[98:99], v5 offset:34816
  buffer_load_dwordx4 v[52:55], v0, s[20:23], s34 offen offset:1024 sc1
  v_mfma_f32_16x16x32_bf16 v[196:199], v[104:107], v[72:75], v[196:199]
  ds_read_b64_tr_b16 v[100:101], v5 offset:49152
  v_accvgpr_read_b32 v34, a210
  v_mfma_f32_16x16x32_bf16 v[196:199], v[108:111], v[76:79], v[196:199]
  ds_read_b64_tr_b16 v[102:103], v5 offset:51200
  s_waitcnt lgkmcnt(8)
  v_mfma_f32_16x16x32_bf16 v[136:139], v[112:115], v[64:67], v[136:139]
  ds_read_b64_tr_b16 v[104:105], v6 offset:32768
  v_accvgpr_read_b32 v35, a211
  v_accvgpr_read_b32 v36, a212
  v_mfma_f32_16x16x32_bf16 v[136:139], v[116:119], v[68:71], v[136:139]
  ds_read_b64_tr_b16 v[106:107], v6 offset:34816
  buffer_load_dwordx4 v[56:59], v0, s[20:23], s35 offen offset:0 sc1
  v_mfma_f32_16x16x32_bf16 v[200:203], v[112:115], v[72:75], v[200:203]
  ds_read_b64_tr_b16 v[108:109], v6 offset:49152
  v_accvgpr_read_b32 v37, a213
  v_mfma_f32_16x16x32_bf16 v[200:203], v[116:119], v[76:79], v[200:203]
  ds_read_b64_tr_b16 v[110:111], v6 offset:51200
  s_waitcnt lgkmcnt(8)
  v_mfma_f32_16x16x32_bf16 v[140:143], v[120:123], v[64:67], v[140:143]
  ds_read_b64_tr_b16 v[112:113], v7 offset:32768
  v_accvgpr_read_b32 v38, a214
  v_accvgpr_read_b32 v39, a215
  v_mfma_f32_16x16x32_bf16 v[140:143], v[124:127], v[68:71], v[140:143]
  ds_read_b64_tr_b16 v[114:115], v7 offset:34816
  buffer_load_dwordx4 v[60:63], v0, s[20:23], s35 offen offset:1024 sc1
  v_mfma_f32_16x16x32_bf16 v[204:207], v[120:123], v[72:75], v[204:207]
  ds_read_b64_tr_b16 v[116:117], v7 offset:49152
  v_cvt_pk_bf16_f32 v32, v32, v33
  v_mfma_f32_16x16x32_bf16 v[204:207], v[124:127], v[76:79], v[204:207]
  ds_read_b64_tr_b16 v[118:119], v7 offset:51200
  s_waitcnt lgkmcnt(8)
  v_mfma_f32_16x16x32_bf16 v[144:147], v[96:99], v[64:67], v[144:147]
  ds_read_b64_tr_b16 v[120:121], v8 offset:32768
  v_cvt_pk_bf16_f32 v33, v34, v35
  v_cvt_pk_bf16_f32 v34, v36, v37
  v_mfma_f32_16x16x32_bf16 v[144:147], v[100:103], v[68:71], v[144:147]
  ds_read_b64_tr_b16 v[122:123], v8 offset:34816
  v_cvt_pk_bf16_f32 v35, v38, v39
  v_mfma_f32_16x16x32_bf16 v[208:211], v[96:99], v[72:75], v[208:211]
  ds_read_b64_tr_b16 v[124:125], v8 offset:49152
  buffer_store_dwordx4 v[32:35], v0, s[20:23], s55 offen offset:2048 sc1
  v_mfma_f32_16x16x32_bf16 v[208:211], v[100:103], v[76:79], v[208:211]
  ds_read_b64_tr_b16 v[126:127], v8 offset:51200
  s_waitcnt lgkmcnt(8)
  v_mfma_f32_16x16x32_bf16 v[148:151], v[104:107], v[64:67], v[148:151]
  ds_read_b64_tr_b16 v[96:97], v1 offset:33024
  v_accvgpr_read_b32 v40, a216
  v_mfma_f32_16x16x32_bf16 v[148:151], v[108:111], v[68:71], v[148:151]
  ds_read_b64_tr_b16 v[98:99], v1 offset:35072
  v_accvgpr_read_b32 v41, a217
  v_mfma_f32_16x16x32_bf16 v[212:215], v[104:107], v[72:75], v[212:215]
  ds_read_b64_tr_b16 v[100:101], v1 offset:49408
  v_accvgpr_read_b32 v42, a218
  v_mfma_f32_16x16x32_bf16 v[212:215], v[108:111], v[76:79], v[212:215]
  ds_read_b64_tr_b16 v[102:103], v1 offset:51456
  s_waitcnt lgkmcnt(8)
  v_mfma_f32_16x16x32_bf16 v[152:155], v[112:115], v[64:67], v[152:155]
  ds_read_b64_tr_b16 v[104:105], v2 offset:33024
  v_accvgpr_read_b32 v43, a219
  v_mfma_f32_16x16x32_bf16 v[152:155], v[116:119], v[68:71], v[152:155]
  ds_read_b64_tr_b16 v[106:107], v2 offset:35072
  v_accvgpr_read_b32 v44, a220
  v_mfma_f32_16x16x32_bf16 v[216:219], v[112:115], v[72:75], v[216:219]
  ds_read_b64_tr_b16 v[108:109], v2 offset:49408
  v_accvgpr_read_b32 v45, a221
  v_mfma_f32_16x16x32_bf16 v[216:219], v[116:119], v[76:79], v[216:219]
  ds_read_b64_tr_b16 v[110:111], v2 offset:51456
  s_waitcnt lgkmcnt(8)
  v_mfma_f32_16x16x32_bf16 v[156:159], v[120:123], v[64:67], v[156:159]
  ds_read_b64_tr_b16 v[112:113], v3 offset:33024
  v_accvgpr_read_b32 v46, a222
  v_mfma_f32_16x16x32_bf16 v[156:159], v[124:127], v[68:71], v[156:159]
  ds_read_b64_tr_b16 v[114:115], v3 offset:35072
  v_accvgpr_read_b32 v47, a223
  v_mfma_f32_16x16x32_bf16 v[220:223], v[120:123], v[72:75], v[220:223]
  ds_read_b64_tr_b16 v[116:117], v3 offset:49408
  v_cvt_pk_bf16_f32 v40, v40, v41
  v_mfma_f32_16x16x32_bf16 v[220:223], v[124:127], v[76:79], v[220:223]
  ds_read_b64_tr_b16 v[118:119], v3 offset:51456
  s_waitcnt lgkmcnt(8)
  v_mfma_f32_16x16x32_bf16 v[160:163], v[96:99], v[64:67], v[160:163]
  ds_read_b64_tr_b16 v[120:121], v4 offset:33024
  v_cvt_pk_bf16_f32 v41, v42, v43
  v_mfma_f32_16x16x32_bf16 v[160:163], v[100:103], v[68:71], v[160:163]
  ds_read_b64_tr_b16 v[122:123], v4 offset:35072
  v_cvt_pk_bf16_f32 v42, v44, v45
  v_mfma_f32_16x16x32_bf16 v[224:227], v[96:99], v[72:75], v[224:227]
  ds_read_b64_tr_b16 v[124:125], v4 offset:49408
  v_cvt_pk_bf16_f32 v43, v46, v47
  v_mfma_f32_16x16x32_bf16 v[224:227], v[100:103], v[76:79], v[224:227]
  ds_read_b64_tr_b16 v[126:127], v4 offset:51456
  s_waitcnt lgkmcnt(8)
  v_mfma_f32_16x16x32_bf16 v[164:167], v[104:107], v[64:67], v[164:167]
  ds_read_b64_tr_b16 v[96:97], v5 offset:33024
  buffer_store_dwordx4 v[40:43], v0, s[20:23], s55 offen offset:3072 sc1
  v_mfma_f32_16x16x32_bf16 v[164:167], v[108:111], v[68:71], v[164:167]
  ds_read_b64_tr_b16 v[98:99], v5 offset:35072
  s_add_u32 s55, s55, s56
  v_mfma_f32_16x16x32_bf16 v[228:231], v[104:107], v[72:75], v[228:231]
  ds_read_b64_tr_b16 v[100:101], v5 offset:49408
  v_accvgpr_read_b32 v32, a224
  v_mfma_f32_16x16x32_bf16 v[228:231], v[108:111], v[76:79], v[228:231]
  ds_read_b64_tr_b16 v[102:103], v5 offset:51456
  s_waitcnt lgkmcnt(8)
  v_mfma_f32_16x16x32_bf16 v[168:171], v[112:115], v[64:67], v[168:171]
  ds_read_b64_tr_b16 v[104:105], v6 offset:33024
  v_accvgpr_read_b32 v33, a225
  v_mfma_f32_16x16x32_bf16 v[168:171], v[116:119], v[68:71], v[168:171]
  ds_read_b64_tr_b16 v[106:107], v6 offset:35072
  v_accvgpr_read_b32 v34, a226
  v_mfma_f32_16x16x32_bf16 v[232:235], v[112:115], v[72:75], v[232:235]
  ds_read_b64_tr_b16 v[108:109], v6 offset:49408
  v_accvgpr_read_b32 v35, a227
  v_mfma_f32_16x16x32_bf16 v[232:235], v[116:119], v[76:79], v[232:235]
  ds_read_b64_tr_b16 v[110:111], v6 offset:51456
  s_waitcnt lgkmcnt(8)
  v_mfma_f32_16x16x32_bf16 v[172:175], v[120:123], v[64:67], v[172:175]
  ds_read_b64_tr_b16 v[112:113], v7 offset:33024
  v_accvgpr_read_b32 v36, a228
  v_mfma_f32_16x16x32_bf16 v[172:175], v[124:127], v[68:71], v[172:175]
  ds_read_b64_tr_b16 v[114:115], v7 offset:35072
  v_accvgpr_read_b32 v37, a229
  v_mfma_f32_16x16x32_bf16 v[236:239], v[120:123], v[72:75], v[236:239]
  ds_read_b64_tr_b16 v[116:117], v7 offset:49408
  v_accvgpr_read_b32 v38, a230
  v_mfma_f32_16x16x32_bf16 v[236:239], v[124:127], v[76:79], v[236:239]
  ds_read_b64_tr_b16 v[118:119], v7 offset:51456
  s_waitcnt lgkmcnt(8)
  v_mfma_f32_16x16x32_bf16 v[176:179], v[96:99], v[64:67], v[176:179]
  ds_read_b64_tr_b16 v[120:121], v8 offset:33024
  v_accvgpr_read_b32 v39, a231
  v_cvt_pk_bf16_f32 v32, v32, v33
  v_mfma_f32_16x16x32_bf16 v[176:179], v[100:103], v[68:71], v[176:179]
  ds_read_b64_tr_b16 v[122:123], v8 offset:35072
  v_add_u32 v1, 65536, v1
  v_mfma_f32_16x16x32_bf16 v[240:243], v[96:99], v[72:75], v[240:243]
  ds_read_b64_tr_b16 v[124:125], v8 offset:49408
  s_waitcnt vmcnt(24)
  v_cvt_pk_bf16_f32 v33, v34, v35
  v_mfma_f32_16x16x32_bf16 v[240:243], v[100:103], v[76:79], v[240:243]
  ds_read_b64_tr_b16 v[126:127], v8 offset:51456
  s_waitcnt lgkmcnt(8)
  v_cvt_pk_bf16_f32 v34, v36, v37
  v_mfma_f32_16x16x32_bf16 v[180:183], v[104:107], v[64:67], v[180:183]
  s_barrier
  ds_read_b64_tr_b16 v[96:97], v1 offset:0
  v_mfma_f32_16x16x32_bf16 v[180:183], v[108:111], v[68:71], v[180:183]
  ds_read_b64_tr_b16 v[98:99], v1 offset:2048
  v_add_u32 v2, 65536, v2
  v_mfma_f32_16x16x32_bf16 v[244:247], v[104:107], v[72:75], v[244:247]
  ds_read_b64_tr_b16 v[100:101], v1 offset:16384
  v_cvt_pk_bf16_f32 v35, v38, v39
  v_mfma_f32_16x16x32_bf16 v[244:247], v[108:111], v[76:79], v[244:247]
  ds_read_b64_tr_b16 v[102:103], v1 offset:18432
  s_waitcnt lgkmcnt(8)
  v_mfma_f32_16x16x32_bf16 v[184:187], v[112:115], v[64:67], v[184:187]
  ds_read_b64_tr_b16 v[104:105], v2 offset:0
  buffer_store_dwordx4 v[32:35], v0, s[20:23], s55 offen offset:0 sc1
  v_mfma_f32_16x16x32_bf16 v[184:187], v[116:119], v[68:71], v[184:187]
  ds_read_b64_tr_b16 v[106:107], v2 offset:2048
  v_add_u32 v3, 65536, v3
  v_mfma_f32_16x16x32_bf16 v[248:251], v[112:115], v[72:75], v[248:251]
  ds_read_b64_tr_b16 v[108:109], v2 offset:16384
  v_accvgpr_read_b32 v40, a232
  v_accvgpr_read_b32 v41, a233
  v_mfma_f32_16x16x32_bf16 v[248:251], v[116:119], v[76:79], v[248:251]
  ds_read_b64_tr_b16 v[110:111], v2 offset:18432
  s_waitcnt lgkmcnt(8)
  v_mfma_f32_16x16x32_bf16 v[188:191], v[120:123], v[64:67], v[188:191]
  ds_read_b64_tr_b16 v[112:113], v3 offset:0
  v_accvgpr_read_b32 v42, a234
  v_mfma_f32_16x16x32_bf16 v[188:191], v[124:127], v[68:71], v[188:191]
  ds_read_b64_tr_b16 v[114:115], v3 offset:2048
  v_add_u32 v4, 65536, v4
  v_mfma_f32_16x16x32_bf16 v[252:255], v[120:123], v[72:75], v[252:255]
  ds_read_b64_tr_b16 v[116:117], v3 offset:16384
  v_accvgpr_read_b32 v43, a235
  v_accvgpr_read_b32 v44, a236
  v_mfma_f32_16x16x32_bf16 v[252:255], v[124:127], v[76:79], v[252:255]
  ds_read_b64_tr_b16 v[118:119], v3 offset:18432
  s_waitcnt vmcnt(14) lgkmcnt(8)
  v_mfma_f32_16x16x32_bf16 v[128:131], v[96:99], v[80:83], v[128:131]
  ds_read_b64_tr_b16 v[120:121], v4 offset:0
  v_accvgpr_read_b32 v45, a237
  v_mfma_f32_16x16x32_bf16 v[128:131], v[100:103], v[84:87], v[128:131]
  ds_read_b64_tr_b16 v[122:123], v4 offset:2048
  v_add_u32 v5, 65536, v5
  v_mfma_f32_16x16x32_bf16 v[192:195], v[96:99], v[88:91], v[192:195]
  ds_read_b64_tr_b16 v[124:125], v4 offset:16384
  v_accvgpr_read_b32 v46, a238
  v_accvgpr_read_b32 v47, a239
  v_mfma_f32_16x16x32_bf16 v[192:195], v[100:103], v[92:95], v[192:195]
  ds_read_b64_tr_b16 v[126:127], v4 offset:18432
  s_waitcnt lgkmcnt(8)
  v_mfma_f32_16x16x32_bf16 v[132:135], v[104:107], v[80:83], v[132:135]
  ds_read_b64_tr_b16 v[96:97], v5 offset:0
  v_cvt_pk_bf16_f32 v40, v40, v41
  v_mfma_f32_16x16x32_bf16 v[132:135], v[108:111], v[84:87], v[132:135]
  ds_read_b64_tr_b16 v[98:99], v5 offset:2048
  v_add_u32 v6, 65536, v6
  v_mfma_f32_16x16x32_bf16 v[196:199], v[104:107], v[88:91], v[196:199]
  ds_read_b64_tr_b16 v[100:101], v5 offset:16384
  v_cvt_pk_bf16_f32 v41, v42, v43
  v_cvt_pk_bf16_f32 v42, v44, v45
  v_mfma_f32_16x16x32_bf16 v[196:199], v[108:111], v[92:95], v[196:199]
  ds_read_b64_tr_b16 v[102:103], v5 offset:18432
  s_waitcnt lgkmcnt(8)
  v_mfma_f32_16x16x32_bf16 v[136:139], v[112:115], v[80:83], v[136:139]
  ds_read_b64_tr_b16 v[104:105], v6 offset:0
  v_cvt_pk_bf16_f32 v43, v46, v47
  v_mfma_f32_16x16x32_bf16 v[136:139], v[116:119], v[84:87], v[136:139]
  ds_read_b64_tr_b16 v[106:107], v6 offset:2048
  v_add_u32 v7, 65536, v7
  v_mfma_f32_16x16x32_bf16 v[200:203], v[112:115], v[88:91], v[200:203]
  ds_read_b64_tr_b16 v[108:109], v6 offset:16384
  buffer_store_dwordx4 v[40:43], v0, s[20:23], s55 offen offset:1024 sc1
  v_mfma_f32_16x16x32_bf16 v[200:203], v[116:119], v[92:95], v[200:203]
  ds_read_b64_tr_b16 v[110:111], v6 offset:18432
  s_waitcnt lgkmcnt(8)
  v_mfma_f32_16x16x32_bf16 v[140:143], v[120:123], v[80:83], v[140:143]
  ds_read_b64_tr_b16 v[112:113], v7 offset:0
  v_accvgpr_read_b32 v32, a240
  v_accvgpr_read_b32 v33, a241
  v_mfma_f32_16x16x32_bf16 v[140:143], v[124:127], v[84:87], v[140:143]
  ds_read_b64_tr_b16 v[114:115], v7 offset:2048
  v_add_u32 v8, 65536, v8
  v_mfma_f32_16x16x32_bf16 v[204:207], v[120:123], v[88:91], v[204:207]
  ds_read_b64_tr_b16 v[116:117], v7 offset:16384
  v_accvgpr_read_b32 v34, a242
  v_mfma_f32_16x16x32_bf16 v[204:207], v[124:127], v[92:95], v[204:207]
  ds_read_b64_tr_b16 v[118:119], v7 offset:18432
  s_waitcnt lgkmcnt(8)
  v_mfma_f32_16x16x32_bf16 v[144:147], v[96:99], v[80:83], v[144:147]
  ds_read_b64_tr_b16 v[120:121], v8 offset:0
  v_accvgpr_read_b32 v35, a243
  v_accvgpr_read_b32 v36, a244
  v_mfma_f32_16x16x32_bf16 v[144:147], v[100:103], v[84:87], v[144:147]
  ds_read_b64_tr_b16 v[122:123], v8 offset:2048
  v_accvgpr_read_b32 v37, a245
  v_mfma_f32_16x16x32_bf16 v[208:211], v[96:99], v[88:91], v[208:211]
  ds_read_b64_tr_b16 v[124:125], v8 offset:16384
  v_accvgpr_read_b32 v38, a246
  v_mfma_f32_16x16x32_bf16 v[208:211], v[100:103], v[92:95], v[208:211]
  ds_read_b64_tr_b16 v[126:127], v8 offset:18432
  s_waitcnt lgkmcnt(8)
  v_mfma_f32_16x16x32_bf16 v[148:151], v[104:107], v[80:83], v[148:151]
  ds_read_b64_tr_b16 v[96:97], v1 offset:256
  v_accvgpr_read_b32 v39, a247
  v_mfma_f32_16x16x32_bf16 v[148:151], v[108:111], v[84:87], v[148:151]
  ds_read_b64_tr_b16 v[98:99], v1 offset:2304
  v_cvt_pk_bf16_f32 v32, v32, v33
  v_mfma_f32_16x16x32_bf16 v[212:215], v[104:107], v[88:91], v[212:215]
  ds_read_b64_tr_b16 v[100:101], v1 offset:16640
  v_cvt_pk_bf16_f32 v33, v34, v35
  v_mfma_f32_16x16x32_bf16 v[212:215], v[108:111], v[92:95], v[212:215]
  ds_read_b64_tr_b16 v[102:103], v1 offset:18688
  s_waitcnt lgkmcnt(8)
  v_mfma_f32_16x16x32_bf16 v[152:155], v[112:115], v[80:83], v[152:155]
  ds_read_b64_tr_b16 v[104:105], v2 offset:256
  v_cvt_pk_bf16_f32 v34, v36, v37
  v_mfma_f32_16x16x32_bf16 v[152:155], v[116:119], v[84:87], v[152:155]
  ds_read_b64_tr_b16 v[106:107], v2 offset:2304
  v_cvt_pk_bf16_f32 v35, v38, v39
  v_mfma_f32_16x16x32_bf16 v[216:219], v[112:115], v[88:91], v[216:219]
  ds_read_b64_tr_b16 v[108:109], v2 offset:16640
  buffer_store_dwordx4 v[32:35], v0, s[20:23], s55 offen offset:2048 sc1
  v_mfma_f32_16x16x32_bf16 v[216:219], v[116:119], v[92:95], v[216:219]
  ds_read_b64_tr_b16 v[110:111], v2 offset:18688
  s_waitcnt lgkmcnt(8)
  v_mfma_f32_16x16x32_bf16 v[156:159], v[120:123], v[80:83], v[156:159]
  ds_read_b64_tr_b16 v[112:113], v3 offset:256
  v_accvgpr_read_b32 v40, a248
  v_mfma_f32_16x16x32_bf16 v[156:159], v[124:127], v[84:87], v[156:159]
  ds_read_b64_tr_b16 v[114:115], v3 offset:2304
  v_accvgpr_read_b32 v41, a249
  v_mfma_f32_16x16x32_bf16 v[220:223], v[120:123], v[88:91], v[220:223]
  ds_read_b64_tr_b16 v[116:117], v3 offset:16640
  v_accvgpr_read_b32 v42, a250
  v_mfma_f32_16x16x32_bf16 v[220:223], v[124:127], v[92:95], v[220:223]
  ds_read_b64_tr_b16 v[118:119], v3 offset:18688
  s_waitcnt lgkmcnt(8)
  v_mfma_f32_16x16x32_bf16 v[160:163], v[96:99], v[80:83], v[160:163]
  ds_read_b64_tr_b16 v[120:121], v4 offset:256
  v_accvgpr_read_b32 v43, a251
  v_mfma_f32_16x16x32_bf16 v[160:163], v[100:103], v[84:87], v[160:163]
  ds_read_b64_tr_b16 v[122:123], v4 offset:2304
  v_accvgpr_read_b32 v44, a252
  v_mfma_f32_16x16x32_bf16 v[224:227], v[96:99], v[88:91], v[224:227]
  ds_read_b64_tr_b16 v[124:125], v4 offset:16640
  v_accvgpr_read_b32 v45, a253
  v_mfma_f32_16x16x32_bf16 v[224:227], v[100:103], v[92:95], v[224:227]
  ds_read_b64_tr_b16 v[126:127], v4 offset:18688
  s_waitcnt lgkmcnt(8)
  v_mfma_f32_16x16x32_bf16 v[164:167], v[104:107], v[80:83], v[164:167]
  ds_read_b64_tr_b16 v[96:97], v5 offset:256
  v_accvgpr_read_b32 v46, a254
  v_mfma_f32_16x16x32_bf16 v[164:167], v[108:111], v[84:87], v[164:167]
  ds_read_b64_tr_b16 v[98:99], v5 offset:2304
  v_accvgpr_read_b32 v47, a255
  v_mfma_f32_16x16x32_bf16 v[228:231], v[104:107], v[88:91], v[228:231]
  ds_read_b64_tr_b16 v[100:101], v5 offset:16640
  v_cvt_pk_bf16_f32 v40, v40, v41
  v_mfma_f32_16x16x32_bf16 v[228:231], v[108:111], v[92:95], v[228:231]
  ds_read_b64_tr_b16 v[102:103], v5 offset:18688
  s_waitcnt lgkmcnt(8)
  v_mfma_f32_16x16x32_bf16 v[168:171], v[112:115], v[80:83], v[168:171]
  ds_read_b64_tr_b16 v[104:105], v6 offset:256
  v_cvt_pk_bf16_f32 v41, v42, v43
  v_mfma_f32_16x16x32_bf16 v[168:171], v[116:119], v[84:87], v[168:171]
  ds_read_b64_tr_b16 v[106:107], v6 offset:2304
  v_cvt_pk_bf16_f32 v42, v44, v45
  v_mfma_f32_16x16x32_bf16 v[232:235], v[112:115], v[88:91], v[232:235]
  ds_read_b64_tr_b16 v[108:109], v6 offset:16640
  v_cvt_pk_bf16_f32 v43, v46, v47
  v_mfma_f32_16x16x32_bf16 v[232:235], v[116:119], v[92:95], v[232:235]
  ds_read_b64_tr_b16 v[110:111], v6 offset:18688
  s_waitcnt lgkmcnt(8)
  v_mfma_f32_16x16x32_bf16 v[172:175], v[120:123], v[80:83], v[172:175]
  ds_read_b64_tr_b16 v[112:113], v7 offset:256
  buffer_store_dwordx4 v[40:43], v0, s[20:23], s55 offen offset:3072 sc1
  v_mfma_f32_16x16x32_bf16 v[172:175], v[124:127], v[84:87], v[172:175]
  ds_read_b64_tr_b16 v[114:115], v7 offset:2304
  s_add_u32 s55, s55, s57
  v_mfma_f32_16x16x32_bf16 v[236:239], v[120:123], v[88:91], v[236:239]
  ds_read_b64_tr_b16 v[116:117], v7 offset:16640
  v_mfma_f32_16x16x32_bf16 v[236:239], v[124:127], v[92:95], v[236:239]
  ds_read_b64_tr_b16 v[118:119], v7 offset:18688
  s_waitcnt lgkmcnt(8)
  v_mfma_f32_16x16x32_bf16 v[176:179], v[96:99], v[80:83], v[176:179]
  s_nop 0
  ds_read_b64_tr_b16 v[120:121], v8 offset:256
  v_mfma_f32_16x16x32_bf16 v[176:179], v[100:103], v[84:87], v[176:179]
  ds_read_b64_tr_b16 v[122:123], v8 offset:2304
  v_mfma_f32_16x16x32_bf16 v[240:243], v[96:99], v[88:91], v[240:243]
  ds_read_b64_tr_b16 v[124:125], v8 offset:16640
  s_waitcnt vmcnt(13)
  v_mfma_f32_16x16x32_bf16 v[240:243], v[100:103], v[92:95], v[240:243]
  ds_read_b64_tr_b16 v[126:127], v8 offset:18688
  s_waitcnt lgkmcnt(8)
  v_mfma_f32_16x16x32_bf16 v[180:183], v[104:107], v[80:83], v[180:183]
  s_barrier
  ds_read_b64_tr_b16 v[96:97], v1 offset:32768
  v_mfma_f32_16x16x32_bf16 v[180:183], v[108:111], v[84:87], v[180:183]
  s_nop 0
  ds_read_b64_tr_b16 v[98:99], v1 offset:34816
  v_mfma_f32_16x16x32_bf16 v[244:247], v[104:107], v[88:91], v[244:247]
  ds_read_b64_tr_b16 v[100:101], v1 offset:49152
  v_mfma_f32_16x16x32_bf16 v[244:247], v[108:111], v[92:95], v[244:247]
  ds_read_b64_tr_b16 v[102:103], v1 offset:51200
  s_waitcnt lgkmcnt(8)
  v_mfma_f32_16x16x32_bf16 v[184:187], v[112:115], v[80:83], v[184:187]
  s_nop 0
  ds_read_b64_tr_b16 v[104:105], v2 offset:32768
  v_mfma_f32_16x16x32_bf16 v[184:187], v[116:119], v[84:87], v[184:187]
  ds_read_b64_tr_b16 v[106:107], v2 offset:34816
  v_mfma_f32_16x16x32_bf16 v[248:251], v[112:115], v[88:91], v[248:251]
  ds_read_b64_tr_b16 v[108:109], v2 offset:49152
  v_mfma_f32_16x16x32_bf16 v[248:251], v[116:119], v[92:95], v[248:251]
  ds_read_b64_tr_b16 v[110:111], v2 offset:51200
  s_waitcnt lgkmcnt(8)
  v_mfma_f32_16x16x32_bf16 v[188:191], v[120:123], v[80:83], v[188:191]
  s_nop 0
  ds_read_b64_tr_b16 v[112:113], v3 offset:32768
  v_mfma_f32_16x16x32_bf16 v[188:191], v[124:127], v[84:87], v[188:191]
  ds_read_b64_tr_b16 v[114:115], v3 offset:34816
  v_mfma_f32_16x16x32_bf16 v[252:255], v[120:123], v[88:91], v[252:255]
  ds_read_b64_tr_b16 v[116:117], v3 offset:49152
  v_mfma_f32_16x16x32_bf16 v[252:255], v[124:127], v[92:95], v[252:255]
  ds_read_b64_tr_b16 v[118:119], v3 offset:51200
  s_waitcnt vmcnt(6) lgkmcnt(8)
  v_mfma_f32_16x16x32_bf16 v[128:131], v[96:99], v[48:51], v[128:131]
  s_nop 0
  ds_read_b64_tr_b16 v[120:121], v4 offset:32768
  v_mfma_f32_16x16x32_bf16 v[128:131], v[100:103], v[52:55], v[128:131]
  ds_read_b64_tr_b16 v[122:123], v4 offset:34816
  v_mfma_f32_16x16x32_bf16 v[192:195], v[96:99], v[56:59], v[192:195]
  ds_read_b64_tr_b16 v[124:125], v4 offset:49152
  v_mfma_f32_16x16x32_bf16 v[192:195], v[100:103], v[60:63], v[192:195]
  ds_read_b64_tr_b16 v[126:127], v4 offset:51200
  s_waitcnt lgkmcnt(8)
  v_mfma_f32_16x16x32_bf16 v[132:135], v[104:107], v[48:51], v[132:135]
  s_nop 0
  ds_read_b64_tr_b16 v[96:97], v5 offset:32768
  v_mfma_f32_16x16x32_bf16 v[132:135], v[108:111], v[52:55], v[132:135]
  ds_read_b64_tr_b16 v[98:99], v5 offset:34816
  v_mfma_f32_16x16x32_bf16 v[196:199], v[104:107], v[56:59], v[196:199]
  ds_read_b64_tr_b16 v[100:101], v5 offset:49152
  v_mfma_f32_16x16x32_bf16 v[196:199], v[108:111], v[60:63], v[196:199]
  ds_read_b64_tr_b16 v[102:103], v5 offset:51200
  s_waitcnt lgkmcnt(8)
  v_mfma_f32_16x16x32_bf16 v[136:139], v[112:115], v[48:51], v[136:139]
  s_nop 0
  ds_read_b64_tr_b16 v[104:105], v6 offset:32768
  v_mfma_f32_16x16x32_bf16 v[136:139], v[116:119], v[52:55], v[136:139]
  ds_read_b64_tr_b16 v[106:107], v6 offset:34816
  v_mfma_f32_16x16x32_bf16 v[200:203], v[112:115], v[56:59], v[200:203]
  ds_read_b64_tr_b16 v[108:109], v6 offset:49152
  v_mfma_f32_16x16x32_bf16 v[200:203], v[116:119], v[60:63], v[200:203]
  ds_read_b64_tr_b16 v[110:111], v6 offset:51200
  s_waitcnt lgkmcnt(8)
  v_cvt_pk_bf16_f32 v128, v128, v129
  v_mfma_f32_16x16x32_bf16 v[140:143], v[120:123], v[48:51], v[140:143]
  ds_read_b64_tr_b16 v[112:113], v7 offset:32768
  v_cvt_pk_bf16_f32 v129, v130, v131
  v_cvt_pk_bf16_f32 v130, v132, v133
  v_mfma_f32_16x16x32_bf16 v[140:143], v[124:127], v[52:55], v[140:143]
  ds_read_b64_tr_b16 v[114:115], v7 offset:34816
  v_cvt_pk_bf16_f32 v131, v134, v135
  buffer_store_dwordx4 v[128:131], v0, s[20:23], s58 offen offset:0 sc1
  v_mfma_f32_16x16x32_bf16 v[204:207], v[120:123], v[56:59], v[204:207]
  ds_read_b64_tr_b16 v[116:117], v7 offset:49152
  v_cvt_pk_bf16_f32 v192, v192, v193
  v_cvt_pk_bf16_f32 v193, v194, v195
  v_mfma_f32_16x16x32_bf16 v[204:207], v[124:127], v[60:63], v[204:207]
  ds_read_b64_tr_b16 v[118:119], v7 offset:51200
  s_waitcnt lgkmcnt(8)
  s_waitcnt vmcnt(1)
  v_mfma_f32_16x16x32_bf16 v[144:147], v[96:99], v[48:51], v[144:147]
  ds_read_b64_tr_b16 v[120:121], v8 offset:32768
  s_barrier
  v_cvt_pk_bf16_f32 v194, v196, v197
  v_mfma_f32_16x16x32_bf16 v[144:147], v[100:103], v[52:55], v[144:147]
  ds_read_b64_tr_b16 v[122:123], v8 offset:34816
  buffer_store_dword v22, v21, s[20:23], s48 offen sc0 sc1
  v_cvt_pk_bf16_f32 v195, v198, v199
  v_mfma_f32_16x16x32_bf16 v[208:211], v[96:99], v[56:59], v[208:211]
  ds_read_b64_tr_b16 v[124:125], v8 offset:49152
  buffer_store_dwordx4 v[192:195], v0, s[20:23], s59 offen offset:0 sc1
  v_mfma_f32_16x16x32_bf16 v[208:211], v[100:103], v[60:63], v[208:211]
  ds_read_b64_tr_b16 v[126:127], v8 offset:51200
  s_waitcnt lgkmcnt(8)
  v_cvt_pk_bf16_f32 v136, v136, v137
  v_mfma_f32_16x16x32_bf16 v[148:151], v[104:107], v[48:51], v[148:151]
  ds_read_b64_tr_b16 v[96:97], v1 offset:33024
  v_cvt_pk_bf16_f32 v137, v138, v139
  v_cvt_pk_bf16_f32 v138, v140, v141
  v_mfma_f32_16x16x32_bf16 v[148:151], v[108:111], v[52:55], v[148:151]
  ds_read_b64_tr_b16 v[98:99], v1 offset:35072
  v_cvt_pk_bf16_f32 v139, v142, v143
  buffer_store_dwordx4 v[136:139], v0, s[20:23], s58 offen offset:1024 sc1
  v_mfma_f32_16x16x32_bf16 v[212:215], v[104:107], v[56:59], v[212:215]
  ds_read_b64_tr_b16 v[100:101], v1 offset:49408
  v_cvt_pk_bf16_f32 v200, v200, v201
  v_cvt_pk_bf16_f32 v201, v202, v203
  v_mfma_f32_16x16x32_bf16 v[212:215], v[108:111], v[60:63], v[212:215]
  ds_read_b64_tr_b16 v[102:103], v1 offset:51456
  s_waitcnt lgkmcnt(8)
  v_cvt_pk_bf16_f32 v202, v204, v205
  v_mfma_f32_16x16x32_bf16 v[152:155], v[112:115], v[48:51], v[152:155]
  ds_read_b64_tr_b16 v[104:105], v2 offset:33024
  v_cvt_pk_bf16_f32 v203, v206, v207
  buffer_store_dwordx4 v[200:203], v0, s[20:23], s59 offen offset:1024 sc1
  v_mfma_f32_16x16x32_bf16 v[152:155], v[116:119], v[52:55], v[152:155]
  ds_read_b64_tr_b16 v[106:107], v2 offset:35072
  v_mfma_f32_16x16x32_bf16 v[216:219], v[112:115], v[56:59], v[216:219]
  ds_read_b64_tr_b16 v[108:109], v2 offset:49408
  v_mfma_f32_16x16x32_bf16 v[216:219], v[116:119], v[60:63], v[216:219]
  ds_read_b64_tr_b16 v[110:111], v2 offset:51456
  s_waitcnt lgkmcnt(8)
  v_cvt_pk_bf16_f32 v144, v144, v145
  v_mfma_f32_16x16x32_bf16 v[156:159], v[120:123], v[48:51], v[156:159]
  ds_read_b64_tr_b16 v[112:113], v3 offset:33024
  v_cvt_pk_bf16_f32 v145, v146, v147
  v_cvt_pk_bf16_f32 v146, v148, v149
  v_mfma_f32_16x16x32_bf16 v[156:159], v[124:127], v[52:55], v[156:159]
  ds_read_b64_tr_b16 v[114:115], v3 offset:35072
  v_cvt_pk_bf16_f32 v147, v150, v151
  buffer_store_dwordx4 v[144:147], v0, s[20:23], s58 offen offset:2048 sc1
  v_mfma_f32_16x16x32_bf16 v[220:223], v[120:123], v[56:59], v[220:223]
  ds_read_b64_tr_b16 v[116:117], v3 offset:49408
  v_cvt_pk_bf16_f32 v208, v208, v209
  v_cvt_pk_bf16_f32 v209, v210, v211
  v_mfma_f32_16x16x32_bf16 v[220:223], v[124:127], v[60:63], v[220:223]
  ds_read_b64_tr_b16 v[118:119], v3 offset:51456
  s_waitcnt lgkmcnt(8)
  v_cvt_pk_bf16_f32 v210, v212, v213
  v_mfma_f32_16x16x32_bf16 v[160:163], v[96:99], v[48:51], v[160:163]
  ds_read_b64_tr_b16 v[120:121], v4 offset:33024
  v_cvt_pk_bf16_f32 v211, v214, v215
  buffer_store_dwordx4 v[208:211], v0, s[20:23], s59 offen offset:2048 sc1
  v_mfma_f32_16x16x32_bf16 v[160:163], v[100:103], v[52:55], v[160:163]
  ds_read_b64_tr_b16 v[122:123], v4 offset:35072
  v_mfma_f32_16x16x32_bf16 v[224:227], v[96:99], v[56:59], v[224:227]
  ds_read_b64_tr_b16 v[124:125], v4 offset:49408
  v_mfma_f32_16x16x32_bf16 v[224:227], v[100:103], v[60:63], v[224:227]
  ds_read_b64_tr_b16 v[126:127], v4 offset:51456
  s_waitcnt lgkmcnt(8)
  v_cvt_pk_bf16_f32 v152, v152, v153
  v_mfma_f32_16x16x32_bf16 v[164:167], v[104:107], v[48:51], v[164:167]
  ds_read_b64_tr_b16 v[96:97], v5 offset:33024
  v_cvt_pk_bf16_f32 v153, v154, v155
  v_cvt_pk_bf16_f32 v154, v156, v157
  v_mfma_f32_16x16x32_bf16 v[164:167], v[108:111], v[52:55], v[164:167]
  ds_read_b64_tr_b16 v[98:99], v5 offset:35072
  v_cvt_pk_bf16_f32 v155, v158, v159
  buffer_store_dwordx4 v[152:155], v0, s[20:23], s58 offen offset:3072 sc1
  v_mfma_f32_16x16x32_bf16 v[228:231], v[104:107], v[56:59], v[228:231]
  ds_read_b64_tr_b16 v[100:101], v5 offset:49408
  s_add_u32 s58, s58, 4096
  v_cvt_pk_bf16_f32 v216, v216, v217
  v_mfma_f32_16x16x32_bf16 v[228:231], v[108:111], v[60:63], v[228:231]
  ds_read_b64_tr_b16 v[102:103], v5 offset:51456
  s_waitcnt lgkmcnt(8)
  v_cvt_pk_bf16_f32 v217, v218, v219
  v_mfma_f32_16x16x32_bf16 v[168:171], v[112:115], v[48:51], v[168:171]
  ds_read_b64_tr_b16 v[104:105], v6 offset:33024
  v_cvt_pk_bf16_f32 v218, v220, v221
  v_cvt_pk_bf16_f32 v219, v222, v223
  v_mfma_f32_16x16x32_bf16 v[168:171], v[116:119], v[52:55], v[168:171]
  ds_read_b64_tr_b16 v[106:107], v6 offset:35072
  buffer_store_dwordx4 v[216:219], v0, s[20:23], s59 offen offset:3072 sc1
  s_add_u32 s59, s59, 4096
  v_mfma_f32_16x16x32_bf16 v[232:235], v[112:115], v[56:59], v[232:235]
  ds_read_b64_tr_b16 v[108:109], v6 offset:49408
  v_mfma_f32_16x16x32_bf16 v[232:235], v[116:119], v[60:63], v[232:235]
  ds_read_b64_tr_b16 v[110:111], v6 offset:51456
  s_waitcnt lgkmcnt(8)
  v_cvt_pk_bf16_f32 v160, v160, v161
  v_mfma_f32_16x16x32_bf16 v[172:175], v[120:123], v[48:51], v[172:175]
  ds_read_b64_tr_b16 v[112:113], v7 offset:33024
  v_cvt_pk_bf16_f32 v161, v162, v163
  v_cvt_pk_bf16_f32 v162, v164, v165
  v_mfma_f32_16x16x32_bf16 v[172:175], v[124:127], v[52:55], v[172:175]
  ds_read_b64_tr_b16 v[114:115], v7 offset:35072
  v_cvt_pk_bf16_f32 v163, v166, v167
  buffer_store_dwordx4 v[160:163], v0, s[20:23], s58 offen offset:0 sc1
  v_mfma_f32_16x16x32_bf16 v[236:239], v[120:123], v[56:59], v[236:239]
  ds_read_b64_tr_b16 v[116:117], v7 offset:49408
  v_cvt_pk_bf16_f32 v224, v224, v225
  v_cvt_pk_bf16_f32 v225, v226, v227
  v_mfma_f32_16x16x32_bf16 v[236:239], v[124:127], v[60:63], v[236:239]
  ds_read_b64_tr_b16 v[118:119], v7 offset:51456
  s_waitcnt lgkmcnt(8)
  v_cvt_pk_bf16_f32 v226, v228, v229
  v_mfma_f32_16x16x32_bf16 v[176:179], v[96:99], v[48:51], v[176:179]
  ds_read_b64_tr_b16 v[120:121], v8 offset:33024
  v_cvt_pk_bf16_f32 v227, v230, v231
  buffer_store_dwordx4 v[224:227], v0, s[20:23], s59 offen offset:0 sc1
  v_mfma_f32_16x16x32_bf16 v[176:179], v[100:103], v[52:55], v[176:179]
  ds_read_b64_tr_b16 v[122:123], v8 offset:35072
  v_mfma_f32_16x16x32_bf16 v[240:243], v[96:99], v[56:59], v[240:243]
  ds_read_b64_tr_b16 v[124:125], v8 offset:49408
  v_mfma_f32_16x16x32_bf16 v[240:243], v[100:103], v[60:63], v[240:243]
  ds_read_b64_tr_b16 v[126:127], v8 offset:51456
  s_waitcnt lgkmcnt(8)
  v_cvt_pk_bf16_f32 v168, v168, v169
  v_mfma_f32_16x16x32_bf16 v[180:183], v[104:107], v[48:51], v[180:183]
  v_cvt_pk_bf16_f32 v169, v170, v171
  v_cvt_pk_bf16_f32 v170, v172, v173
  v_cvt_pk_bf16_f32 v171, v174, v175
  v_mfma_f32_16x16x32_bf16 v[180:183], v[108:111], v[52:55], v[180:183]
  buffer_store_dwordx4 v[168:171], v0, s[20:23], s58 offen offset:1024 sc1
  v_cvt_pk_bf16_f32 v232, v232, v233
  v_cvt_pk_bf16_f32 v233, v234, v235
  v_mfma_f32_16x16x32_bf16 v[244:247], v[104:107], v[56:59], v[244:247]
  v_cvt_pk_bf16_f32 v234, v236, v237
  v_cvt_pk_bf16_f32 v235, v238, v239
  buffer_store_dwordx4 v[232:235], v0, s[20:23], s59 offen offset:1024 sc1
  v_mfma_f32_16x16x32_bf16 v[244:247], v[108:111], v[60:63], v[244:247]
  s_waitcnt lgkmcnt(4)
  v_mfma_f32_16x16x32_bf16 v[184:187], v[112:115], v[48:51], v[184:187]
  buffer_load_dword v24, v23, s[20:23], s53 offen sc0 sc1
  v_mfma_f32_16x16x32_bf16 v[184:187], v[116:119], v[52:55], v[184:187]
  v_mfma_f32_16x16x32_bf16 v[248:251], v[112:115], v[56:59], v[248:251]
  v_mfma_f32_16x16x32_bf16 v[248:251], v[116:119], v[60:63], v[248:251]
  s_waitcnt lgkmcnt(0)
  v_cvt_pk_bf16_f32 v176, v176, v177
  v_cvt_pk_bf16_f32 v177, v178, v179
  v_mfma_f32_16x16x32_bf16 v[188:191], v[120:123], v[48:51], v[188:191]
  v_cvt_pk_bf16_f32 v178, v180, v181
  v_cvt_pk_bf16_f32 v179, v182, v183
  buffer_store_dwordx4 v[176:179], v0, s[20:23], s58 offen offset:2048 sc1
  v_mfma_f32_16x16x32_bf16 v[188:191], v[124:127], v[52:55], v[188:191]
  v_cvt_pk_bf16_f32 v240, v240, v241
  v_cvt_pk_bf16_f32 v241, v242, v243
  v_cvt_pk_bf16_f32 v242, v244, v245
  v_mfma_f32_16x16x32_bf16 v[252:255], v[120:123], v[56:59], v[252:255]
  v_cvt_pk_bf16_f32 v243, v246, v247
  buffer_store_dwordx4 v[240:243], v0, s[20:23], s59 offen offset:2048 sc1
  v_mfma_f32_16x16x32_bf16 v[252:255], v[124:127], v[60:63], v[252:255]
  s_nop 7
  v_cvt_pk_bf16_f32 v184, v184, v185
  v_cvt_pk_bf16_f32 v185, v186, v187
  v_cvt_pk_bf16_f32 v186, v188, v189
  v_cvt_pk_bf16_f32 v187, v190, v191
  buffer_store_dwordx4 v[184:187], v0, s[20:23], s58 offen offset:3072 sc1
  v_cvt_pk_bf16_f32 v248, v248, v249
  v_cvt_pk_bf16_f32 v249, v250, v251
  v_cvt_pk_bf16_f32 v250, v252, v253
  v_cvt_pk_bf16_f32 v251, v254, v255
  buffer_store_dwordx4 v[248:251], v0, s[20:23], s59 offen offset:3072 sc1
  s_waitcnt vmcnt(4)
  v_cmp_ne_u32 vcc, 1, v24
  s_mov_b32 m0, s52
  s_cbranch_vccnz L_k1_kvspin
L_k1_kvret:
  buffer_load_dwordx4 v19, s[20:23], s50 offen offset:0 sc1 lds
  buffer_load_dwordx4 v19, s[20:23], s50 offen offset:1024 sc1 lds
  buffer_load_dwordx4 v19, s[20:23], s50 offen offset:2048 sc1 lds
  buffer_load_dwordx4 v19, s[20:23], s50 offen offset:3072 sc1 lds
  s_add_u32 m0, s52, 4096
  s_nop 0
  buffer_load_dwordx4 v20, s[20:23], s50 offen offset:0 sc1 lds
  buffer_load_dwordx4 v20, s[20:23], s50 offen offset:1024 sc1 lds
  buffer_load_dwordx4 v20, s[20:23], s50 offen offset:2048 sc1 lds
  buffer_load_dwordx4 v20, s[20:23], s50 offen offset:3072 sc1 lds
L_k1_codeend:
  v_lshrrev_b32_e64 v0, 4, v0
  s_lshr_b32 s4, s2, 3
  s_load_dwordx2 s[32:33], s[0:1], 56
  s_and_b32 s46, s4, 7
  s_lshr_b32 s4, s4, 3
  s_and_b32 s47, s4, 1
  s_lshl_b32 s3, s46, 2
  s_lshr_b32 s6, 0xedb97531, s3
  s_and_b32 s6, s6, 15
  s_lshl_b32 s4, s45, 20
  s_add_u32 s7, s4, 20971520
  s_add_u32 s58, s46, 8
  s_sub_u32 s61, 7, s46
  s_lshl_b32 s60, s61, 1
  s_add_u32 s60, s60, 2
  s_mov_b32 s63, 32768
  s_cmp_eq_u32 s47, 0
  s_cbranch_scc1 L_k2_setB
  s_mov_b32 s57, s6
  s_lshl_b32 s3, s58, 1
  s_add_u32 s3, s3, 2
  s_sub_u32 s55, s3, s6
  s_mov_b32 s56, 2
  s_lshl_b32 s3, s3, 15
  s_add_u32 s51, s7, s3
  s_add_u32 s48, s7, 491520
  s_add_u32 s50, s7, 524288
  s_lshl_b32 s3, s6, 15
  s_add_u32 s3, s7, s3
  s_sub_u32 s49, s3, 32768
  s_mov_b32 s41, -32768
  s_cmp_eq_u32 s6, 0
  s_cselect_b32 s59, 1, 2
  s_branch L_k2_set
L_k2_setB:
  s_mov_b32 s41, 32768
  s_mov_b32 s57, 0
  s_mov_b32 s48, s7
  s_lshl_b32 s3, s60, 15
  s_add_u32 s51, s7, s3
  s_lshl_b32 s3, s6, 15
  s_add_u32 s49, s7, s3
  s_cmp_eq_u32 s6, 0
  s_cselect_b32 s59, 1, 0
  s_cselect_b32 s56, 2, 0
  s_cselect_b32 s55, s60, s6
  s_cselect_b32 s58, s61, s58
  s_cselect_b32 s49, s51, s49
  s_cselect_b32 s50, 2147483648, s7
L_k2_set:
  s_lshl_b32 s3, s45, 4
  s_add_u32 s3, s3, s58
  s_lshl_b32 s3, s3, 2
  s_add_u32 s3, s3, s44
  s_lshl_b32 s3, s3, 14
  s_add_u32 s64, s3, 54525952
  s_add_u32 s65, s64, 8192
  s_lshl_b32 s53, s44, 13
  s_mov_b32 s21, s53
  s_add_u32 s54, s53, 98304
  v_mov_b32 v40, v0
  v_lshlrev_b32 v3, 4, v0
  v_add_u32 v1, s53, v3
  v_add_u32 v2, 4096, v1
  v_add_u32 v5, 4096, v3
  v_mov_b32 v0, v3
  s_waitcnt lgkmcnt(0)
  s_mov_b32 s8, s42
  s_mov_b32 s9, s43
  s_mov_b32 s10, 268435456
  s_mov_b32 s11, 0x20000
  s_mov_b32 s40, s41
  s_mov_b32 s43, 2147549184
  s_lshl_b32 s3, s45, 4
  s_add_u32 s3, s3, s61
  s_lshl_b32 s3, s3, 2
  s_add_u32 s3, s3, s44
  s_lshl_b32 s3, s3, 14
  s_add_u32 s37, s3, 54525952
  s_cmp_eq_u32 s59, 0
  s_cselect_b32 s37, s37, 2147483648
  s_add_u32 s53, s53, 32768
  s_cmp_ge_u32 s53, 98304
  s_cselect_b32 s53, s21, s53
  s_add_u32 s52, s31, 16777216
  s_mov_b32 s31, s48
  s_add_u32 s48, s48, s40
  s_cmp_eq_u32 s48, s49
  s_cselect_b32 s40, s63, s40
  s_cselect_b32 s48, s50, s48
  s_cselect_b32 s49, s51, s49
  s_cselect_b32 s50, 2147483648, s50
  s_lshl_b32 s6, s45, 3
  s_add_u32 s6, s6, s46
  s_lshl_b32 s6, s6, 2
  s_add_u32 s6, s6, s44
  s_lshl_b32 s6, s6, 7
  s_add_u32 s6, s6, 8323072
  s_cmp_eq_u32 s47, 0
  s_cselect_b32 s5, 2147483648, s6
  s_add_u32 m0, s53, 0
  s_nop 0
  buffer_load_dwordx4 v1, s[8:11], s48 offen offset:0 sc1 lds
  s_mov_b32 s12, s38
  s_mov_b32 s13, s39
  s_mov_b32 s14, 3670016
  s_mov_b32 s15, 0x20000
  s_mov_b32 s34, 7340032
  s_mov_b32 s35, 0x20000
  s_mov_b32 s16, 0
  s_lshl_b32 s4, s45, 3
  s_add_u32 s4, s4, s46
  s_lshl_b32 s4, s4, 2
  buffer_load_dwordx4 v1, s[8:11], s48 offen offset:1024 sc1 lds
  s_add_u32 s4, s4, s44
  s_mul_i32 s4, s4, 17408
  s_add_u32 s62, s4, 8388608
  s_add_u32 s30, s62, 16384
  v_add_u32 v4, 98304, v3
  s_mov_b32 s36, 0
  v_mov_b32 v41, 0x3f803f80
  v_accvgpr_write_b32 a200, v41
  v_accvgpr_write_b32 a201, v41
  v_accvgpr_write_b32 a202, v41
  buffer_load_dwordx4 v1, s[8:11], s48 offen offset:2048 sc1 lds
  v_accvgpr_write_b32 a203, v41
  v_and_b32 v41, 15, v40
  v_lshrrev_b32 v42, 4, v40
  v_lshlrev_b32 v43, 2, v42
  v_sub_u32 v31, v41, v43
  s_lshl_b32 s3, s2, 1
  s_and_b32 s4, s44, 1
  s_add_u32 s3, s3, s4
  v_lshlrev_b32 v43, 7, v40
  v_mov_b32_e64 v44, 1073741824
  buffer_load_dwordx4 v1, s[8:11], s48 offen offset:3072 sc1 lds
  v_cmp_gt_u32 vcc, 8, v40
  v_lshrrev_b32 v45, 3, v40
  v_mul_u32_u24 v45, 896, v45
  v_cndmask_b32 v11, v44, v43, vcc
  v_lshlrev_b32 v46, 1, v42
  v_and_b32 v47, 7, v40
  v_xor_b32 v46, v46, v47
  v_lshl_add_u32 v45, v46, 4, v45
  v_accvgpr_write_b32 a204, v45
  v_add_u32 v45, 6144, v45
  s_add_u32 m0, s53, 4096
  s_nop 0
  buffer_load_dwordx4 v2, s[8:11], s48 offen offset:0 sc1 lds
  v_accvgpr_write_b32 a205, v45
  v_add_u32 v45, 6144, v45
  v_accvgpr_write_b32 a206, v45
  v_add_u32 v45, 6144, v45
  v_accvgpr_write_b32 a207, v45
  v_bfe_u32 v45, v40, 2, 2
  v_lshl_add_u32 v45, v42, 2, v45
  v_bfe_u32 v46, v45, 1, 2
  v_lshlrev_b32 v45, 7, v45
  v_and_b32_e64 v47, 3, v40
  buffer_load_dwordx4 v2, s[8:11], s48 offen offset:1024 sc1 lds
  v_lshl_add_u32 v45, v47, 3, v45
  v_xor_b32_e64 v47, 0, v46
  v_lshl_add_u32 v47, v47, 5, v45
  v_accvgpr_write_b32 a208, v47
  v_xor_b32_e64 v47, 1, v46
  v_lshl_add_u32 v47, v47, 5, v45
  v_accvgpr_write_b32 a209, v47
  v_xor_b32_e64 v47, 2, v46
  v_lshl_add_u32 v47, v47, 5, v45
  v_accvgpr_write_b32 a210, v47
  buffer_load_dwordx4 v2, s[8:11], s48 offen offset:2048 sc1 lds
  v_xor_b32_e64 v47, 3, v46
  v_lshl_add_u32 v47, v47, 5, v45
  v_accvgpr_write_b32 a211, v47
  v_cmp_gt_u32 vcc, 28, v40
  s_lshl_b32 s3, s45, 8
  s_lshl_b32 s4, s44, 6
  s_add_u32 s4, s3, s4
  s_mul_i32 s19, s4, 896
  s_add_u32 s20, s19, 28672
  v_cndmask_b32 v45, v44, v43, vcc
  buffer_load_dwordx4 v2, s[8:11], s48 offen offset:3072 sc1 lds
  s_lshr_b32 s4, s2, 3
  s_and_b32 s4, s4, 15
  s_lshl_b32 s4, s4, 2
  s_add_u32 s4, s4, s44
  s_lshl_b32 s4, s4, 2
  s_add_u32 s3, s3, s4
  s_mul_i32 s3, s3, 896
  v_add_u32 v45, s3, v45
  v_accvgpr_write_b32 a212, v45
  s_lshr_b32 s4, s2, 3
  s_lshl_b32 s4, s4, 2
  s_add_u32 s4, s4, s44
  s_mul_i32 s4, s4, 57344
  s_bfe_u32 s3, s2, 0x20001
  s_mul_i32 s3, s3, 896
  s_add_u32 s4, s4, s3
  s_and_b32 s3, s2, 1
  s_mul_i32 s3, s3, 384
  s_add_u32 s4, s4, s3
  v_lshrrev_b32_e64 v45, 2, v40
  v_mul_u32_u24 v45, 3584, v45
  v_and_b32_e64 v46, 3, v40
  v_lshl_add_u32 v45, v46, 7, v45
  v_add_u32_e64 v45, s4, v45
  v_accvgpr_write_b32 a213, v45
  s_add_u32 s53, s53, 32768
  s_cmp_ge_u32 s53, 98304
  s_cselect_b32 s53, s21, s53
  s_add_u32 s52, s31, 16777216
  s_mov_b32 s31, s48
  s_add_u32 s48, s48, s40
  s_cmp_eq_u32 s48, s49
  s_cselect_b32 s40, s63, s40
  s_cselect_b32 s48, s50, s48
  s_cselect_b32 s49, s51, s49
  s_cselect_b32 s50, 2147483648, s50
  v_accvgpr_write_b32 a192, 0
  v_accvgpr_write_b32 a193, 0
  v_accvgpr_write_b32 a194, 0
  v_accvgpr_write_b32 a195, 0
  v_accvgpr_write_b32 a196, 0
  v_accvgpr_write_b32 a197, 0
  v_accvgpr_write_b32 a198, 0
  v_accvgpr_write_b32 a199, 0
  v_mov_b32 v46, 0
  s_cmp_eq_u32 s59, 0
  s_cbranch_scc0 L_k2_noq
  v_accvgpr_write_b32 a216, v128
  v_accvgpr_write_b32 a217, v129
  v_accvgpr_write_b32 a218, v130
  v_accvgpr_write_b32 a219, v131
  v_accvgpr_write_b32 a220, v136
  v_accvgpr_write_b32 a221, v137
  v_accvgpr_write_b32 a222, v138
  v_accvgpr_write_b32 a223, v139
  v_accvgpr_write_b32 a224, v144
  v_accvgpr_write_b32 a225, v145
  v_accvgpr_write_b32 a226, v146
  v_accvgpr_write_b32 a227, v147
  v_accvgpr_write_b32 a228, v152
  v_accvgpr_write_b32 a229, v153
  v_accvgpr_write_b32 a230, v154
  v_accvgpr_write_b32 a231, v155
  v_accvgpr_write_b32 a232, v160
  v_accvgpr_write_b32 a233, v161
  v_accvgpr_write_b32 a234, v162
  v_accvgpr_write_b32 a235, v163
  v_accvgpr_write_b32 a236, v168
  v_accvgpr_write_b32 a237, v169
  v_accvgpr_write_b32 a238, v170
  v_accvgpr_write_b32 a239, v171
  v_accvgpr_write_b32 a240, v176
  v_accvgpr_write_b32 a241, v177
  v_accvgpr_write_b32 a242, v178
  v_accvgpr_write_b32 a243, v179
  v_accvgpr_write_b32 a244, v184
  v_accvgpr_write_b32 a245, v185
  v_accvgpr_write_b32 a246, v186
  v_accvgpr_write_b32 a247, v187
  v_accvgpr_write_b32 a248, v192
  v_accvgpr_write_b32 a249, v193
  v_accvgpr_write_b32 a250, v194
  v_accvgpr_write_b32 a251, v195
  v_accvgpr_write_b32 a252, v200
  v_accvgpr_write_b32 a253, v201
  v_accvgpr_write_b32 a254, v202
  v_accvgpr_write_b32 a255, v203
  v_mov_b64 v[64:65], v[208:209]
  v_mov_b64 v[66:67], v[210:211]
  v_mov_b64 v[68:69], v[216:217]
  v_mov_b64 v[70:71], v[218:219]
  v_mov_b64 v[72:73], v[224:225]
  v_mov_b64 v[74:75], v[226:227]
  v_mov_b64 v[76:77], v[232:233]
  v_mov_b64 v[78:79], v[234:235]
  v_mov_b64 v[80:81], v[240:241]
  v_mov_b64 v[82:83], v[242:243]
  v_mov_b64 v[84:85], v[248:249]
  v_mov_b64 v[86:87], v[250:251]
  v_mov_b64 v[128:129], 0
  v_mov_b64 v[130:131], 0
  v_mov_b64 v[132:133], 0
  v_mov_b64 v[134:135], 0
  v_mov_b64 v[136:137], 0
  v_mov_b64 v[138:139], 0
  v_mov_b64 v[140:141], 0
  v_mov_b64 v[142:143], 0
  v_mov_b64 v[144:145], 0
  v_mov_b64 v[146:147], 0
  v_mov_b64 v[148:149], 0
  v_mov_b64 v[150:151], 0
  v_mov_b64 v[152:153], 0
  v_mov_b64 v[154:155], 0
  v_mov_b64 v[156:157], 0
  v_mov_b64 v[158:159], 0
  v_mov_b64 v[160:161], 0
  v_mov_b64 v[162:163], 0
  v_mov_b64 v[164:165], 0
  v_mov_b64 v[166:167], 0
  v_mov_b64 v[168:169], 0
  v_mov_b64 v[170:171], 0
  v_mov_b64 v[172:173], 0
  v_mov_b64 v[174:175], 0
  v_mov_b64 v[176:177], 0
  v_mov_b64 v[178:179], 0
  v_mov_b64 v[180:181], 0
  v_mov_b64 v[182:183], 0
  v_mov_b64 v[184:185], 0
  v_mov_b64 v[186:187], 0
  v_mov_b64 v[188:189], 0
  v_mov_b64 v[190:191], 0
  v_mov_b64 v[192:193], 0
  v_mov_b64 v[194:195], 0
  v_mov_b64 v[196:197], 0
  v_mov_b64 v[198:199], 0
  v_mov_b64 v[200:201], 0
  v_mov_b64 v[202:203], 0
  v_mov_b64 v[204:205], 0
  v_mov_b64 v[206:207], 0
  v_mov_b64 v[208:209], 0
  v_mov_b64 v[210:211], 0
  v_mov_b64 v[212:213], 0
  v_mov_b64 v[214:215], 0
  v_mov_b64 v[216:217], 0
  v_mov_b64 v[218:219], 0
  v_mov_b64 v[220:221], 0
  v_mov_b64 v[222:223], 0
  v_mov_b64 v[224:225], 0
  v_mov_b64 v[226:227], 0
  v_mov_b64 v[228:229], 0
  v_mov_b64 v[230:231], 0
  v_mov_b64 v[232:233], 0
  v_mov_b64 v[234:235], 0
  v_mov_b64 v[236:237], 0
  v_mov_b64 v[238:239], 0
  v_mov_b64 v[240:241], 0
  v_mov_b64 v[242:243], 0
  v_mov_b64 v[244:245], 0
  v_mov_b64 v[246:247], 0
  v_mov_b64 v[248:249], 0
  v_mov_b64 v[250:251], 0
  v_mov_b64 v[252:253], 0
  v_mov_b64 v[254:255], 0
  s_mov_b32 s17, 0
L_k2_hp:
  buffer_load_dword v48, v46, s[8:11], s6 offen sc0 sc1
  s_add_u32 s17, s17, 1
  s_cmp_ge_u32 s17, 0x40000
  s_waitcnt vmcnt(0)
  s_cbranch_scc1 L_k2_hpx
  v_cmp_ne_u32 vcc, 1, v48
  s_nop 0
  s_cbranch_vccnz L_k2_hp
L_k2_hpx:
  buffer_load_dwordx4 a[128:131], v0, s[8:11], s64 offen offset:0 sc1
  buffer_load_dwordx4 a[132:135], v0, s[8:11], s64 offen offset:1024 sc1
  buffer_load_dwordx4 a[136:139], v0, s[8:11], s64 offen offset:2048 sc1
  buffer_load_dwordx4 a[140:143], v0, s[8:11], s64 offen offset:3072 sc1
  buffer_load_dwordx4 a[144:147], v5, s[8:11], s64 offen offset:0 sc1
  buffer_load_dwordx4 a[148:151], v5, s[8:11], s64 offen offset:1024 sc1
  buffer_load_dwordx4 a[152:155], v5, s[8:11], s64 offen offset:2048 sc1
  buffer_load_dwordx4 a[156:159], v5, s[8:11], s64 offen offset:3072 sc1
  buffer_load_dwordx4 a[160:163], v0, s[8:11], s65 offen offset:0 sc1
  buffer_load_dwordx4 a[164:167], v0, s[8:11], s65 offen offset:1024 sc1
  buffer_load_dwordx4 a[168:171], v0, s[8:11], s65 offen offset:2048 sc1
  buffer_load_dwordx4 a[172:175], v0, s[8:11], s65 offen offset:3072 sc1
  buffer_load_dwordx4 a[176:179], v5, s[8:11], s65 offen offset:0 sc1
  buffer_load_dwordx4 a[180:183], v5, s[8:11], s65 offen offset:1024 sc1
  buffer_load_dwordx4 a[184:187], v5, s[8:11], s65 offen offset:2048 sc1
  buffer_load_dwordx4 a[188:191], v5, s[8:11], s65 offen offset:3072 sc1
  s_waitcnt vmcnt(0)
  s_branch L_k2_hasq
L_k2_noq:
  v_min_u32 v48, 1, v40
  v_lshlrev_b32 v48, 30, v48
  v_mov_b32_e64 v49, 1
  s_waitcnt vmcnt(16)
  buffer_store_dword v49, v48, s[8:11], s5 offen sc0 sc1
  v_accvgpr_write_b32 a128, v128
  v_accvgpr_write_b32 a129, v129
  v_accvgpr_write_b32 a130, v130
  v_accvgpr_write_b32 a131, v131
  v_accvgpr_write_b32 a132, v136
  v_accvgpr_write_b32 a133, v137
  v_accvgpr_write_b32 a134, v138
  v_accvgpr_write_b32 a135, v139
  v_accvgpr_write_b32 a136, v144
  v_accvgpr_write_b32 a137, v145
  v_accvgpr_write_b32 a138, v146
  v_accvgpr_write_b32 a139, v147
  v_accvgpr_write_b32 a140, v152
  v_accvgpr_write_b32 a141, v153
  v_accvgpr_write_b32 a142, v154
  v_accvgpr_write_b32 a143, v155
  v_accvgpr_write_b32 a144, v160
  v_accvgpr_write_b32 a145, v161
  v_accvgpr_write_b32 a146, v162
  v_accvgpr_write_b32 a147, v163
  v_accvgpr_write_b32 a148, v168
  v_accvgpr_write_b32 a149, v169
  v_accvgpr_write_b32 a150, v170
  v_accvgpr_write_b32 a151, v171
  v_accvgpr_write_b32 a152, v176
  v_accvgpr_write_b32 a153, v177
  v_accvgpr_write_b32 a154, v178
  v_accvgpr_write_b32 a155, v179
  v_accvgpr_write_b32 a156, v184
  v_accvgpr_write_b32 a157, v185
  v_accvgpr_write_b32 a158, v186
  v_accvgpr_write_b32 a159, v187
  v_accvgpr_write_b32 a160, v192
  v_accvgpr_write_b32 a161, v193
  v_accvgpr_write_b32 a162, v194
  v_accvgpr_write_b32 a163, v195
  v_accvgpr_write_b32 a164, v200
  v_accvgpr_write_b32 a165, v201
  v_accvgpr_write_b32 a166, v202
  v_accvgpr_write_b32 a167, v203
  v_accvgpr_write_b32 a168, v208
  v_accvgpr_write_b32 a169, v209
  v_accvgpr_write_b32 a170, v210
  v_accvgpr_write_b32 a171, v211
  v_accvgpr_write_b32 a172, v216
  v_accvgpr_write_b32 a173, v217
  v_accvgpr_write_b32 a174, v218
  v_accvgpr_write_b32 a175, v219
  v_accvgpr_write_b32 a176, v224
  v_accvgpr_write_b32 a177, v225
  v_accvgpr_write_b32 a178, v226
  v_accvgpr_write_b32 a179, v227
  v_accvgpr_write_b32 a180, v232
  v_accvgpr_write_b32 a181, v233
  v_accvgpr_write_b32 a182, v234
  v_accvgpr_write_b32 a183, v235
  v_accvgpr_write_b32 a184, v240
  v_accvgpr_write_b32 a185, v241
  v_accvgpr_write_b32 a186, v242
  v_accvgpr_write_b32 a187, v243
  v_accvgpr_write_b32 a188, v248
  v_accvgpr_write_b32 a189, v249
  v_accvgpr_write_b32 a190, v250
  v_accvgpr_write_b32 a191, v251
  v_mov_b64 v[128:129], 0
  v_mov_b64 v[130:131], 0
  v_mov_b64 v[132:133], 0
  v_mov_b64 v[134:135], 0
  v_mov_b64 v[136:137], 0
  v_mov_b64 v[138:139], 0
  v_mov_b64 v[140:141], 0
  v_mov_b64 v[142:143], 0
  v_mov_b64 v[144:145], 0
  v_mov_b64 v[146:147], 0
  v_mov_b64 v[148:149], 0
  v_mov_b64 v[150:151], 0
  v_mov_b64 v[152:153], 0
  v_mov_b64 v[154:155], 0
  v_mov_b64 v[156:157], 0
  v_mov_b64 v[158:159], 0
  v_mov_b64 v[160:161], 0
  v_mov_b64 v[162:163], 0
  v_mov_b64 v[164:165], 0
  v_mov_b64 v[166:167], 0
  v_mov_b64 v[168:169], 0
  v_mov_b64 v[170:171], 0
  v_mov_b64 v[172:173], 0
  v_mov_b64 v[174:175], 0
  v_mov_b64 v[176:177], 0
  v_mov_b64 v[178:179], 0
  v_mov_b64 v[180:181], 0
  v_mov_b64 v[182:183], 0
  v_mov_b64 v[184:185], 0
  v_mov_b64 v[186:187], 0
  v_mov_b64 v[188:189], 0
  v_mov_b64 v[190:191], 0
  v_mov_b64 v[192:193], 0
  v_mov_b64 v[194:195], 0
  v_mov_b64 v[196:197], 0
  v_mov_b64 v[198:199], 0
  v_mov_b64 v[200:201], 0
  v_mov_b64 v[202:203], 0
  v_mov_b64 v[204:205], 0
  v_mov_b64 v[206:207], 0
  v_mov_b64 v[208:209], 0
  v_mov_b64 v[210:211], 0
  v_mov_b64 v[212:213], 0
  v_mov_b64 v[214:215], 0
  v_mov_b64 v[216:217], 0
  v_mov_b64 v[218:219], 0
  v_mov_b64 v[220:221], 0
  v_mov_b64 v[222:223], 0
  v_mov_b64 v[224:225], 0
  v_mov_b64 v[226:227], 0
  v_mov_b64 v[228:229], 0
  v_mov_b64 v[230:231], 0
  v_mov_b64 v[232:233], 0
  v_mov_b64 v[234:235], 0
  v_mov_b64 v[236:237], 0
  v_mov_b64 v[238:239], 0
  v_mov_b64 v[240:241], 0
  v_mov_b64 v[242:243], 0
  v_mov_b64 v[244:245], 0
  v_mov_b64 v[246:247], 0
  v_mov_b64 v[248:249], 0
  v_mov_b64 v[250:251], 0
  v_mov_b64 v[252:253], 0
  v_mov_b64 v[254:255], 0
  s_waitcnt vmcnt(9)
L_k2_hasq:
  s_barrier
  ds_read_b128 a[0:3], v3 offset:0
  ds_read_b128 a[4:7], v3 offset:1024
  ds_read_b128 a[8:11], v3 offset:2048
  ds_read_b128 a[12:15], v3 offset:3072
  ds_read_b128 a[16:19], v3 offset:4096
  ds_read_b128 a[20:23], v3 offset:5120
  ds_read_b128 a[24:27], v3 offset:6144
  ds_read_b128 a[28:31], v3 offset:7168
  s_lshl_b32 s3, s58, 7
  s_lshl_b32 s4, s44, 4
  s_add_u32 s5, s3, s4
  s_sub_u32 s3, s3, s4
  s_add_u32 s3, s3, 112
  v_add_u32 v8, s5, v31
  v_add_u32_e64 v9, s3, v31
  s_waitcnt lgkmcnt(0)
  v_mfma_f32_16x16x32_bf16 v[32:35], a[0:3], a[128:131], 0
  ds_read_b128 a[32:35], v3 offset:8192
  s_add_u32 m0, s54, 0
  v_mfma_f32_16x16x32_bf16 v[32:35], a[4:7], a[132:135], v[32:35]
  ds_read_b128 a[36:39], v3 offset:9216
  buffer_load_dwordx4 v1, s[8:11], s52 offen offset:0 sc1 lds
  v_mfma_f32_16x16x32_bf16 v[32:35], a[8:11], a[136:139], v[32:35]
  s_nop 0
  ds_read_b128 a[40:43], v3 offset:10240
  v_mfma_f32_16x16x32_bf16 v[32:35], a[12:15], a[140:143], v[32:35]
  ds_read_b128 a[44:47], v3 offset:11264
  v_mfma_f32_16x16x32_bf16 v[32:35], a[16:19], a[144:147], v[32:35]
  ds_read_b128 a[48:51], v3 offset:12288
  v_mfma_f32_16x16x32_bf16 v[32:35], a[20:23], a[148:151], v[32:35]
  ds_read_b128 a[52:55], v3 offset:13312
  buffer_load_dwordx4 v1, s[8:11], s52 offen offset:1024 sc1 lds
  v_mfma_f32_16x16x32_bf16 v[32:35], a[24:27], a[152:155], v[32:35]
  ds_read_b128 a[56:59], v3 offset:14336
  v_mfma_f32_16x16x32_bf16 v[32:35], a[28:31], a[156:159], v[32:35]
  ds_read_b128 a[60:63], v3 offset:15360
  v_mfma_f32_16x16x32_bf16 v[48:51], a[0:3], a[160:163], 0
  v_mfma_f32_16x16x32_bf16 v[48:51], a[4:7], a[164:167], v[48:51]
  ds_read_b128 a[0:3], v3 offset:16384
  buffer_load_dwordx4 v1, s[8:11], s52 offen offset:2048 sc1 lds
  v_mfma_f32_16x16x32_bf16 v[48:51], a[8:11], a[168:171], v[48:51]
  v_mfma_f32_16x16x32_bf16 v[48:51], a[12:15], a[172:175], v[48:51]
  ds_read_b128 a[4:7], v3 offset:17408
  v_mfma_f32_16x16x32_bf16 v[48:51], a[16:19], a[176:179], v[48:51]
  v_mfma_f32_16x16x32_bf16 v[48:51], a[20:23], a[180:183], v[48:51]
  ds_read_b128 a[8:11], v3 offset:18432
  buffer_load_dwordx4 v1, s[8:11], s52 offen offset:3072 sc1 lds
  v_mfma_f32_16x16x32_bf16 v[48:51], a[24:27], a[184:187], v[48:51]
  v_mfma_f32_16x16x32_bf16 v[48:51], a[28:31], a[188:191], v[48:51]
  s_waitcnt lgkmcnt(3)
  ds_read_b128 a[12:15], v3 offset:19456
  v_mfma_f32_16x16x32_bf16 v[36:39], a[32:35], a[128:131], 0
  s_nop 0
  s_add_u32 m0, s54, 4096
  v_mfma_f32_16x16x32_bf16 v[36:39], a[36:39], a[132:135], v[36:39]
  ds_read_b128 a[16:19], v3 offset:20480
  buffer_load_dwordx4 v2, s[8:11], s52 offen offset:0 sc1 lds
  v_mfma_f32_16x16x32_bf16 v[36:39], a[40:43], a[136:139], v[36:39]
  v_mfma_f32_16x16x32_bf16 v[36:39], a[44:47], a[140:143], v[36:39]
  ds_read_b128 a[20:23], v3 offset:21504
  v_mfma_f32_16x16x32_bf16 v[36:39], a[48:51], a[144:147], v[36:39]
  v_mfma_f32_16x16x32_bf16 v[36:39], a[52:55], a[148:151], v[36:39]
  ds_read_b128 a[24:27], v3 offset:22528
  buffer_load_dwordx4 v2, s[8:11], s52 offen offset:1024 sc1 lds
  v_mfma_f32_16x16x32_bf16 v[36:39], a[56:59], a[152:155], v[36:39]
  v_mfma_f32_16x16x32_bf16 v[36:39], a[60:63], a[156:159], v[36:39]
  ds_read_b128 a[28:31], v3 offset:23552
  v_mfma_f32_16x16x32_bf16 v[52:55], a[32:35], a[160:163], 0
  v_mfma_f32_16x16x32_bf16 v[52:55], a[36:39], a[164:167], v[52:55]
  ds_read_b128 a[32:35], v3 offset:24576
  buffer_load_dwordx4 v2, s[8:11], s52 offen offset:2048 sc1 lds
  v_mfma_f32_16x16x32_bf16 v[52:55], a[40:43], a[168:171], v[52:55]
  v_mfma_f32_16x16x32_bf16 v[52:55], a[44:47], a[172:175], v[52:55]
  ds_read_b128 a[36:39], v3 offset:25600
  v_mfma_f32_16x16x32_bf16 v[52:55], a[48:51], a[176:179], v[52:55]
  v_mfma_f32_16x16x32_bf16 v[52:55], a[52:55], a[180:183], v[52:55]
  ds_read_b128 a[40:43], v3 offset:26624
  buffer_load_dwordx4 v2, s[8:11], s52 offen offset:3072 sc1 lds
  v_mfma_f32_16x16x32_bf16 v[52:55], a[56:59], a[184:187], v[52:55]
  v_mfma_f32_16x16x32_bf16 v[52:55], a[60:63], a[188:191], v[52:55]
  s_waitcnt lgkmcnt(3)
  ds_read_b128 a[44:47], v3 offset:27648
  v_mfma_f32_16x16x32_bf16 v[40:43], a[0:3], a[128:131], 0
  s_nop 0
  s_xor_b32 s54, s54, 0x38000
  v_mfma_f32_16x16x32_bf16 v[40:43], a[4:7], a[132:135], v[40:43]
  ds_read_b128 a[48:51], v3 offset:28672
  v_mfma_f32_16x16x32_bf16 v[40:43], a[8:11], a[136:139], v[40:43]
  s_add_u32 m0, s53, 0
  s_nop 0
  v_mfma_f32_16x16x32_bf16 v[40:43], a[12:15], a[140:143], v[40:43]
  ds_read_b128 a[52:55], v3 offset:29696
  buffer_load_dwordx4 v1, s[8:11], s48 offen offset:0 sc1 lds
  v_mfma_f32_16x16x32_bf16 v[40:43], a[16:19], a[144:147], v[40:43]
  v_mfma_f32_16x16x32_bf16 v[40:43], a[20:23], a[148:151], v[40:43]
  ds_read_b128 a[56:59], v3 offset:30720
  v_mfma_f32_16x16x32_bf16 v[40:43], a[24:27], a[152:155], v[40:43]
  v_mfma_f32_16x16x32_bf16 v[40:43], a[28:31], a[156:159], v[40:43]
  ds_read_b128 a[60:63], v3 offset:31744
  buffer_load_dwordx4 v1, s[8:11], s48 offen offset:1024 sc1 lds
  v_mfma_f32_16x16x32_bf16 v[56:59], a[0:3], a[160:163], 0
  v_mfma_f32_16x16x32_bf16 v[56:59], a[4:7], a[164:167], v[56:59]
  v_mfma_f32_16x16x32_bf16 v[56:59], a[8:11], a[168:171], v[56:59]
  v_mfma_f32_16x16x32_bf16 v[56:59], a[12:15], a[172:175], v[56:59]
  buffer_load_dwordx4 v1, s[8:11], s48 offen offset:2048 sc1 lds
  v_mfma_f32_16x16x32_bf16 v[56:59], a[16:19], a[176:179], v[56:59]
  v_mfma_f32_16x16x32_bf16 v[56:59], a[20:23], a[180:183], v[56:59]
  v_mfma_f32_16x16x32_bf16 v[56:59], a[24:27], a[184:187], v[56:59]
  v_mfma_f32_16x16x32_bf16 v[56:59], a[28:31], a[188:191], v[56:59]
  s_waitcnt lgkmcnt(0)
  buffer_load_dwordx4 v1, s[8:11], s48 offen offset:3072 sc1 lds
  v_mfma_f32_16x16x32_bf16 v[44:47], a[32:35], a[128:131], 0
  s_nop 0
  v_mfma_f32_16x16x32_bf16 v[44:47], a[36:39], a[132:135], v[44:47]
  v_mfma_f32_16x16x32_bf16 v[44:47], a[40:43], a[136:139], v[44:47]
  s_add_u32 m0, s53, 4096
  v_mfma_f32_16x16x32_bf16 v[44:47], a[44:47], a[140:143], v[44:47]
  buffer_load_dwordx4 v2, s[8:11], s48 offen offset:0 sc1 lds
  v_mfma_f32_16x16x32_bf16 v[44:47], a[48:51], a[144:147], v[44:47]
  v_mfma_f32_16x16x32_bf16 v[44:47], a[52:55], a[148:151], v[44:47]
  v_mfma_f32_16x16x32_bf16 v[44:47], a[56:59], a[152:155], v[44:47]
  v_mfma_f32_16x16x32_bf16 v[44:47], a[60:63], a[156:159], v[44:47]
  buffer_load_dwordx4 v2, s[8:11], s48 offen offset:1024 sc1 lds
  v_mfma_f32_16x16x32_bf16 v[60:63], a[32:35], a[160:163], 0
  v_mfma_f32_16x16x32_bf16 v[60:63], a[36:39], a[164:167], v[60:63]
  v_mfma_f32_16x16x32_bf16 v[60:63], a[40:43], a[168:171], v[60:63]
  v_mfma_f32_16x16x32_bf16 v[60:63], a[44:47], a[172:175], v[60:63]
  buffer_load_dwordx4 v2, s[8:11], s48 offen offset:2048 sc1 lds
  v_mfma_f32_16x16x32_bf16 v[60:63], a[48:51], a[176:179], v[60:63]
  v_mfma_f32_16x16x32_bf16 v[60:63], a[52:55], a[180:183], v[60:63]
  v_mfma_f32_16x16x32_bf16 v[60:63], a[56:59], a[184:187], v[60:63]
  v_mfma_f32_16x16x32_bf16 v[60:63], a[60:63], a[188:191], v[60:63]
  buffer_load_dwordx4 v2, s[8:11], s48 offen offset:3072 sc1 lds
  s_nop 6
  s_add_u32 s37, s37, 8192
  buffer_store_dwordx4 v[64:67], v0, s[8:11], s37 offen offset:2048 sc1
  v_max3_f32 v24, v32, v33, v34
  v_max3_f32 v26, v48, v49, v50
  v_max3_f32 v24, v24, v35, v36
  v_max3_f32 v26, v26, v51, v52
  v_max3_f32 v24, v24, v37, v38
  v_max3_f32 v26, v26, v53, v54
  v_max3_f32 v24, v24, v39, v40
  v_max3_f32 v26, v26, v55, v56
  v_max3_f32 v24, v24, v41, v42
  v_max3_f32 v26, v26, v57, v58
  v_max3_f32 v24, v24, v43, v44
  v_max3_f32 v26, v26, v59, v60
  buffer_store_dwordx4 v[68:71], v0, s[8:11], s37 offen offset:3072 sc1
  v_max3_f32 v24, v24, v45, v46
  v_max3_f32 v26, v26, v61, v62
  v_max_f32 v24, v24, v47
  v_max_f32 v26, v26, v63
  v_mov_b32 v25, v24
  v_mov_b32 v27, v26
  s_nop 0
  v_permlane16_swap_b32 v24, v25
  v_permlane16_swap_b32 v26, v27
  v_max_f32 v24, v24, v25
  v_max_f32 v26, v26, v27
  v_mov_b32_e64 v25, v24
  buffer_store_dwordx4 v[72:75], v5, s[8:11], s37 offen offset:0 sc1
  v_mov_b32 v27, v26
  s_nop 0
  v_permlane32_swap_b32 v24, v25
  v_permlane32_swap_b32 v26, v27
  v_max_f32 v24, v24, v25
  v_max_f32 v26, v26, v27
  v_sub_f32 v24, 0xc1800000, v24
  v_sub_f32 v26, 0xc1800000, v26
  v_mov_b32 v25, v24
  v_mov_b32 v27, v26
  v_mov_b32 v6, v24
  v_mov_b32 v7, v26
  buffer_store_dwordx4 v[76:79], v5, s[8:11], s37 offen offset:1024 sc1
  v_pk_add_f32 v[16:17], v[32:33], v[24:25]
  v_pk_add_f32 v[18:19], v[34:35], v[24:25]
  v_pk_add_f32 v[20:21], v[36:37], v[24:25]
  v_pk_add_f32 v[22:23], v[38:39], v[24:25]
  v_exp_f32 v16, v16
  v_exp_f32 v17, v17
  v_exp_f32 v18, v18
  v_exp_f32 v19, v19
  v_exp_f32 v20, v20
  v_exp_f32 v21, v21
  v_exp_f32 v22, v22
  v_exp_f32 v23, v23
  buffer_store_dwordx4 v[80:83], v5, s[8:11], s37 offen offset:2048 sc1
  v_cvt_pk_bf16_f32 v96, v16, v17
  v_cvt_pk_bf16_f32 v97, v18, v19
  v_cvt_pk_bf16_f32 v98, v20, v21
  v_cvt_pk_bf16_f32 v99, v22, v23
  v_pk_add_f32 v[16:17], v[40:41], v[24:25]
  v_pk_add_f32 v[18:19], v[42:43], v[24:25]
  v_pk_add_f32 v[20:21], v[44:45], v[24:25]
  v_pk_add_f32 v[22:23], v[46:47], v[24:25]
  v_exp_f32 v16, v16
  v_exp_f32 v17, v17
  v_exp_f32 v18, v18
  v_exp_f32 v19, v19
  buffer_store_dwordx4 v[84:87], v5, s[8:11], s37 offen offset:3072 sc1
  v_exp_f32 v20, v20
  v_exp_f32 v21, v21
  v_exp_f32 v22, v22
  v_exp_f32 v23, v23
  v_cvt_pk_bf16_f32 v100, v16, v17
  v_cvt_pk_bf16_f32 v101, v18, v19
  v_cvt_pk_bf16_f32 v102, v20, v21
  v_cvt_pk_bf16_f32 v103, v22, v23
  v_pk_add_f32 v[16:17], v[48:49], v[26:27]
  v_pk_add_f32 v[18:19], v[50:51], v[26:27]
  v_pk_add_f32 v[20:21], v[52:53], v[26:27]
  v_pk_add_f32 v[22:23], v[54:55], v[26:27]
  v_exp_f32 v16, v16
  v_exp_f32 v17, v17
  v_exp_f32 v18, v18
  v_exp_f32 v19, v19
  v_exp_f32 v20, v20
  v_exp_f32 v21, v21
  v_exp_f32 v22, v22
  v_exp_f32 v23, v23
  v_cvt_pk_bf16_f32 v104, v16, v17
  v_cvt_pk_bf16_f32 v105, v18, v19
  v_cvt_pk_bf16_f32 v106, v20, v21
  v_cvt_pk_bf16_f32 v107, v22, v23
  v_pk_add_f32 v[16:17], v[56:57], v[26:27]
  v_pk_add_f32 v[18:19], v[58:59], v[26:27]
  v_pk_add_f32 v[20:21], v[60:61], v[26:27]
  v_pk_add_f32 v[22:23], v[62:63], v[26:27]
  v_exp_f32 v16, v16
  v_exp_f32 v17, v17
  v_exp_f32 v18, v18
  v_exp_f32 v19, v19
  v_exp_f32 v20, v20
  v_exp_f32 v21, v21
  v_exp_f32 v22, v22
  v_exp_f32 v23, v23
  v_cvt_pk_bf16_f32 v108, v16, v17
  v_cvt_pk_bf16_f32 v109, v18, v19
  v_cvt_pk_bf16_f32 v110, v20, v21
  v_cvt_pk_bf16_f32 v111, v22, v23
  v_mov_b64 v[64:65], v[24:25]
  v_mov_b64 v[66:67], v[24:25]
  v_mov_b64 v[68:69], v[24:25]
  v_mov_b64 v[70:71], v[24:25]
  v_mov_b64 v[72:73], v[24:25]
  v_mov_b64 v[74:75], v[24:25]
  v_mov_b64 v[76:77], v[24:25]
  v_mov_b64 v[78:79], v[24:25]
  v_mov_b64 v[80:81], v[26:27]
  v_mov_b64 v[82:83], v[26:27]
  v_mov_b64 v[84:85], v[26:27]
  v_mov_b64 v[86:87], v[26:27]
  v_mov_b64 v[88:89], v[26:27]
  v_mov_b64 v[90:91], v[26:27]
  v_mov_b64 v[92:93], v[26:27]
  v_mov_b64 v[94:95], v[26:27]
  s_add_u32 s53, s53, 32768
  s_cmp_ge_u32 s53, 98304
  s_cselect_b32 s53, s21, s53
  s_add_u32 s52, s31, 16777216
  s_mov_b32 s31, s48
  s_add_u32 s48, s48, s40
  s_cmp_eq_u32 s48, s49
  s_cselect_b32 s40, s63, s40
  s_cselect_b32 s48, s50, s48
  s_cselect_b32 s49, s51, s49
  s_cselect_b32 s50, 2147483648, s50
  s_add_u32 s36, s36, 32768
  s_cmp_eq_u32 s36, 98304
  s_cselect_b32 s36, 0, s36
  v_add_u32_e64 v3, s36, v0
  s_waitcnt vmcnt(14) lgkmcnt(0)
  s_barrier
  ds_read_b128 a[0:3], v3 offset:0
  ds_read_b128 a[4:7], v3 offset:1024
  ds_read_b128 a[8:11], v3 offset:2048
  ds_read_b128 a[12:15], v3 offset:3072
  ds_read_b128 a[16:19], v3 offset:4096
  ds_read_b128 a[20:23], v3 offset:5120
  ds_read_b128 a[24:27], v3 offset:6144
  ds_read_b128 a[28:31], v3 offset:7168
  s_sub_u32 s55, s55, 1
  s_add_u32 s57, s57, 1
  s_cmp_le_u32 s55, s56
  s_waitcnt lgkmcnt(0)
  s_cbranch_scc1 L_k2_spec0
L_k2_loop0:
  v_mfma_f32_16x16x32_bf16 v[32:35], a[0:3], a[128:131], v[64:67]
  s_nop 0
  ds_read_b128 a[32:35], v3 offset:8192
  v_mfma_f32_16x16x32_bf16 v[32:35], a[4:7], a[132:135], v[32:35]
  ds_read_b128 a[36:39], v3 offset:9216
  s_add_u32 m0, s54, 0
  v_mfma_f32_16x16x32_bf16 v[32:35], a[8:11], a[136:139], v[32:35]
  ds_read_b128 a[40:43], v3 offset:10240
  buffer_load_dwordx4 v1, s[8:11], s52 offen offset:0 sc1 lds
  v_mfma_f32_16x16x32_bf16 v[32:35], a[12:15], a[140:143], v[32:35]
  s_nop 0
  ds_read_b128 a[44:47], v3 offset:11264
  v_mfma_f32_16x16x32_bf16 v[32:35], a[16:19], a[144:147], v[32:35]
  ds_read_b128 a[48:51], v3 offset:12288
  v_mfma_f32_16x16x32_bf16 v[32:35], a[20:23], a[148:151], v[32:35]
  ds_read_b128 a[52:55], v3 offset:13312
  buffer_load_dwordx4 v1, s[8:11], s52 offen offset:1024 sc1 lds
  v_mfma_f32_16x16x32_bf16 v[32:35], a[24:27], a[152:155], v[32:35]
  ds_read_b128 a[56:59], v3 offset:14336
  v_mfma_f32_16x16x32_bf16 v[32:35], a[28:31], a[156:159], v[32:35]
  ds_read_b128 a[60:63], v3 offset:15360
  v_mfma_f32_16x16x32_bf16 v[48:51], a[0:3], a[160:163], v[80:83]
  buffer_load_dwordx4 v1, s[8:11], s52 offen offset:2048 sc1 lds
  v_mfma_f32_16x16x32_bf16 v[48:51], a[4:7], a[164:167], v[48:51]
  ds_read_b128 a[0:3], v3 offset:16384
  v_mfma_f32_16x16x32_bf16 v[48:51], a[8:11], a[168:171], v[48:51]
  ds_read_b128 a[4:7], v3 offset:17408
  v_mfma_f32_16x16x32_bf16 v[48:51], a[12:15], a[172:175], v[48:51]
  buffer_load_dwordx4 v1, s[8:11], s52 offen offset:3072 sc1 lds
  v_mfma_f32_16x16x32_bf16 v[48:51], a[16:19], a[176:179], v[48:51]
  v_exp_f32_e64 v16, v32
  v_mfma_f32_16x16x32_bf16 v[48:51], a[20:23], a[180:183], v[48:51]
  ds_read_b128 a[8:11], v3 offset:18432
  ds_read_b128 a[12:15], v3 offset:19456
  v_mfma_f32_16x16x32_bf16 v[48:51], a[24:27], a[184:187], v[48:51]
  s_add_u32 m0, s54, 4096
  v_mfma_f32_16x16x32_bf16 v[48:51], a[28:31], a[188:191], v[48:51]
  s_waitcnt lgkmcnt(4)
  ds_read_b128 a[16:19], v3 offset:20480
  v_mfma_f32_16x16x32_bf16 v[36:39], a[32:35], a[128:131], v[68:71]
  v_exp_f32 v17, v33
  v_mfma_f32_16x16x32_bf16 v[36:39], a[36:39], a[132:135], v[36:39]
  ds_read_b128 a[20:23], v3 offset:21504
  v_cvt_pk_bf16_f32 v112, v16, v17
  v_mfma_f32_16x16x32_bf16 v[36:39], a[40:43], a[136:139], v[36:39]
  ds_read_b128 a[24:27], v3 offset:22528
  buffer_load_dwordx4 v2, s[8:11], s52 offen offset:0 sc1 lds
  v_mfma_f32_16x16x32_bf16 v[36:39], a[44:47], a[140:143], v[36:39]
  v_exp_f32_e64 v18, v34
  v_mfma_f32_16x16x32_bf16 v[36:39], a[48:51], a[144:147], v[36:39]
  ds_read_b128 a[28:31], v3 offset:23552
  v_mfma_f32_16x16x32_bf16 v[36:39], a[52:55], a[148:151], v[36:39]
  buffer_load_dwordx4 v2, s[8:11], s52 offen offset:1024 sc1 lds
  v_mfma_f32_16x16x32_bf16 v[36:39], a[56:59], a[152:155], v[36:39]
  v_exp_f32_e64 v19, v35
  v_mfma_f32_16x16x32_bf16 v[36:39], a[60:63], a[156:159], v[36:39]
  v_cvt_pk_bf16_f32 v113, v18, v19
  v_mfma_f32_16x16x32_bf16 v[52:55], a[32:35], a[160:163], v[84:87]
  buffer_load_dwordx4 v2, s[8:11], s52 offen offset:2048 sc1 lds
  v_mfma_f32_16x16x32_bf16 v[52:55], a[36:39], a[164:167], v[52:55]
  v_exp_f32_e64 v20, v48
  v_mfma_f32_16x16x32_bf16 v[52:55], a[40:43], a[168:171], v[52:55]
  ds_read_b128 a[32:35], v3 offset:24576
  ds_read_b128 a[36:39], v3 offset:25600
  v_mfma_f32_16x16x32_bf16 v[52:55], a[44:47], a[172:175], v[52:55]
  buffer_load_dwordx4 v2, s[8:11], s52 offen offset:3072 sc1 lds
  v_mfma_f32_16x16x32_bf16 v[52:55], a[48:51], a[176:179], v[52:55]
  v_exp_f32_e64 v21, v49
  v_mfma_f32_16x16x32_bf16 v[52:55], a[52:55], a[180:183], v[52:55]
  ds_read_b128 a[40:43], v3 offset:26624
  ds_read_b128 a[44:47], v3 offset:27648
  v_mfma_f32_16x16x32_bf16 v[52:55], a[56:59], a[184:187], v[52:55]
  v_cvt_pk_bf16_f32 v120, v20, v21
  s_xor_b32 s54, s54, 0x38000
  v_mfma_f32_16x16x32_bf16 v[52:55], a[60:63], a[188:191], v[52:55]
  s_waitcnt lgkmcnt(4)
  ds_read_b128 a[48:51], v3 offset:28672
  v_mfma_f32_16x16x32_bf16 v[40:43], a[0:3], a[128:131], v[72:75]
  v_exp_f32 v22, v50
  v_mfma_f32_16x16x32_bf16 v[40:43], a[4:7], a[132:135], v[40:43]
  ds_read_b128 a[52:55], v3 offset:29696
  s_add_u32 m0, s53, 0
  v_mfma_f32_16x16x32_bf16 v[40:43], a[8:11], a[136:139], v[40:43]
  ds_read_b128 a[56:59], v3 offset:30720
  buffer_load_dwordx4 v1, s[8:11], s48 offen offset:0 sc1 lds
  v_mfma_f32_16x16x32_bf16 v[40:43], a[12:15], a[140:143], v[40:43]
  v_exp_f32 v23, v51
  v_mfma_f32_16x16x32_bf16 v[40:43], a[16:19], a[144:147], v[40:43]
  ds_read_b128 a[60:63], v3 offset:31744
  v_cvt_pk_bf16_f32 v121, v22, v23
  v_mfma_f32_16x16x32_bf16 v[40:43], a[20:23], a[148:151], v[40:43]
  v_mfma_f32_16x16x32_bf16 v[40:43], a[24:27], a[152:155], v[40:43]
  v_exp_f32_e64 v16, v36
  v_mfma_f32_16x16x32_bf16 v[40:43], a[28:31], a[156:159], v[40:43]
  buffer_load_dwordx4 v1, s[8:11], s48 offen offset:1024 sc1 lds
  v_mfma_f32_16x16x32_bf16 v[56:59], a[0:3], a[160:163], v[88:91]
  ds_read_b128 a[64:67], v4 offset:0
  v_mfma_f32_16x16x32_bf16 v[56:59], a[4:7], a[164:167], v[56:59]
  v_exp_f32_e64 v17, v37
  v_mfma_f32_16x16x32_bf16 v[56:59], a[8:11], a[168:171], v[56:59]
  ds_read_b128 a[68:71], v4 offset:16384
  v_cvt_pk_bf16_f32 v114, v16, v17
  v_mfma_f32_16x16x32_bf16 v[56:59], a[12:15], a[172:175], v[56:59]
  ds_read_b128 a[72:75], v4 offset:1024
  v_mfma_f32_16x16x32_bf16 v[56:59], a[16:19], a[176:179], v[56:59]
  v_exp_f32_e64 v18, v38
  v_mfma_f32_16x16x32_bf16 v[56:59], a[20:23], a[180:183], v[56:59]
  ds_read_b128 a[76:79], v4 offset:17408
  buffer_load_dwordx4 v1, s[8:11], s48 offen offset:2048 sc1 lds
  v_mfma_f32_16x16x32_bf16 v[56:59], a[24:27], a[184:187], v[56:59]
  ds_read_b128 a[80:83], v4 offset:2048
  v_mfma_f32_16x16x32_bf16 v[56:59], a[28:31], a[188:191], v[56:59]
  s_waitcnt lgkmcnt(5)
  ds_read_b128 a[84:87], v4 offset:18432
  v_mfma_f32_16x16x32_bf16 v[44:47], a[32:35], a[128:131], v[76:79]
  v_exp_f32 v19, v39
  v_mfma_f32_16x16x32_bf16 v[44:47], a[36:39], a[132:135], v[44:47]
  ds_read_b128 a[88:91], v4 offset:3072
  v_cvt_pk_bf16_f32 v115, v18, v19
  v_mfma_f32_16x16x32_bf16 v[44:47], a[40:43], a[136:139], v[44:47]
  ds_read_b128 a[92:95], v4 offset:19456
  buffer_load_dwordx4 v1, s[8:11], s48 offen offset:3072 sc1 lds
  v_mfma_f32_16x16x32_bf16 v[44:47], a[44:47], a[140:143], v[44:47]
  v_exp_f32_e64 v20, v52
  v_mfma_f32_16x16x32_bf16 v[44:47], a[48:51], a[144:147], v[44:47]
  ds_read_b128 a[96:99], v4 offset:4096
  v_mfma_f32_16x16x32_bf16 v[44:47], a[52:55], a[148:151], v[44:47]
  ds_read_b128 a[100:103], v4 offset:20480
  v_mfma_f32_16x16x32_bf16 v[44:47], a[56:59], a[152:155], v[44:47]
  v_exp_f32_e64 v21, v53
  v_mfma_f32_16x16x32_bf16 v[44:47], a[60:63], a[156:159], v[44:47]
  ds_read_b128 a[104:107], v4 offset:5120
  v_cvt_pk_bf16_f32 v122, v20, v21
  v_mfma_f32_16x16x32_bf16 v[60:63], a[32:35], a[160:163], v[92:95]
  ds_read_b128 a[108:111], v4 offset:21504
  s_add_u32 m0, s53, 4096
  v_mfma_f32_16x16x32_bf16 v[60:63], a[36:39], a[164:167], v[60:63]
  v_exp_f32_e64 v22, v54
  v_mfma_f32_16x16x32_bf16 v[60:63], a[40:43], a[168:171], v[60:63]
  ds_read_b128 a[112:115], v4 offset:6144
  buffer_load_dwordx4 v2, s[8:11], s48 offen offset:0 sc1 lds
  v_mfma_f32_16x16x32_bf16 v[60:63], a[44:47], a[172:175], v[60:63]
  ds_read_b128 a[116:119], v4 offset:22528
  v_mfma_f32_16x16x32_bf16 v[60:63], a[48:51], a[176:179], v[60:63]
  v_exp_f32_e64 v23, v55
  v_mfma_f32_16x16x32_bf16 v[60:63], a[52:55], a[180:183], v[60:63]
  ds_read_b128 a[120:123], v4 offset:7168
  v_cvt_pk_bf16_f32 v123, v22, v23
  v_mfma_f32_16x16x32_bf16 v[60:63], a[56:59], a[184:187], v[60:63]
  ds_read_b128 a[124:127], v4 offset:23552
  v_mfma_f32_16x16x32_bf16 v[60:63], a[60:63], a[188:191], v[60:63]
  v_exp_f32_e64 v16, v40
  v_mfma_f32_16x16x32_bf16 a[192:195], a[200:203], v[96:99], a[192:195]
  buffer_load_dwordx4 v2, s[8:11], s48 offen offset:1024 sc1 lds
  v_mfma_f32_16x16x32_bf16 a[192:195], a[200:203], v[100:103], a[192:195]
  v_mfma_f32_16x16x32_bf16 a[196:199], a[200:203], v[104:107], a[196:199]
  v_exp_f32_e64 v17, v41
  v_mfma_f32_16x16x32_bf16 a[196:199], a[200:203], v[108:111], a[196:199]
  s_waitcnt lgkmcnt(8)
  v_cvt_pk_bf16_f32 v116, v16, v17
  v_mfma_f32_16x16x32_bf16 v[128:131], a[64:67], v[96:99], v[128:131]
  s_nop 0
  v_mfma_f32_16x16x32_bf16 v[128:131], a[68:71], v[100:103], v[128:131]
  v_exp_f32_e64 v18, v42
  v_mfma_f32_16x16x32_bf16 v[192:195], a[68:71], v[108:111], v[192:195]
  ds_read_b128 a[68:71], v4 offset:24576
  buffer_load_dwordx4 v2, s[8:11], s48 offen offset:2048 sc1 lds
  v_mfma_f32_16x16x32_bf16 v[192:195], a[64:67], v[104:107], v[192:195]
  ds_read_b128 a[64:67], v4 offset:8192
  v_mfma_f32_16x16x32_bf16 v[196:199], a[72:75], v[104:107], v[196:199]
  v_exp_f32_e64 v19, v43
  v_mfma_f32_16x16x32_bf16 v[196:199], a[76:79], v[108:111], v[196:199]
  v_cvt_pk_bf16_f32 v117, v18, v19
  v_mfma_f32_16x16x32_bf16 v[132:135], a[76:79], v[100:103], v[132:135]
  ds_read_b128 a[76:79], v4 offset:25600
  v_mfma_f32_16x16x32_bf16 v[132:135], a[72:75], v[96:99], v[132:135]
  v_exp_f32_e64 v20, v56
  v_mfma_f32_16x16x32_bf16 v[136:139], a[80:83], v[96:99], v[136:139]
  ds_read_b128 a[72:75], v4 offset:9216
  buffer_load_dwordx4 v2, s[8:11], s48 offen offset:3072 sc1 lds
  v_mfma_f32_16x16x32_bf16 v[136:139], a[84:87], v[100:103], v[136:139]
  v_mfma_f32_16x16x32_bf16 v[200:203], a[84:87], v[108:111], v[200:203]
  v_exp_f32_e64 v21, v57
  v_mfma_f32_16x16x32_bf16 v[200:203], a[80:83], v[104:107], v[200:203]
  ds_read_b128 a[84:87], v4 offset:26624
  ds_read_b128 a[80:83], v4 offset:10240
  v_mfma_f32_16x16x32_bf16 v[204:207], a[88:91], v[104:107], v[204:207]
  v_cvt_pk_bf16_f32 v124, v20, v21
  s_add_u32 s53, s53, 32768
  v_mfma_f32_16x16x32_bf16 v[204:207], a[92:95], v[108:111], v[204:207]
  v_exp_f32_e64 v22, v58
  v_mfma_f32_16x16x32_bf16 v[140:143], a[92:95], v[100:103], v[140:143]
  ds_read_b128 a[92:95], v4 offset:27648
  s_cmp_ge_u32 s53, 98304
  v_mfma_f32_16x16x32_bf16 v[140:143], a[88:91], v[96:99], v[140:143]
  s_waitcnt lgkmcnt(7)
  ds_read_b128 a[88:91], v4 offset:11264
  v_mfma_f32_16x16x32_bf16 v[144:147], a[96:99], v[96:99], v[144:147]
  v_exp_f32 v23, v59
  v_mfma_f32_16x16x32_bf16 v[144:147], a[100:103], v[100:103], v[144:147]
  v_cvt_pk_bf16_f32 v125, v22, v23
  s_cselect_b32 s53, s21, s53
  v_mfma_f32_16x16x32_bf16 v[208:211], a[100:103], v[108:111], v[208:211]
  ds_read_b128 a[100:103], v4 offset:28672
  s_add_u32 s52, s31, 16777216
  v_mfma_f32_16x16x32_bf16 v[208:211], a[96:99], v[104:107], v[208:211]
  v_exp_f32 v16, v44
  v_mfma_f32_16x16x32_bf16 v[212:215], a[104:107], v[104:107], v[212:215]
  ds_read_b128 a[96:99], v4 offset:12288
  s_mov_b32 s31, s48
  v_mfma_f32_16x16x32_bf16 v[212:215], a[108:111], v[108:111], v[212:215]
  s_add_u32 s48, s48, s40
  s_cmp_eq_u32 s48, s49
  v_mfma_f32_16x16x32_bf16 v[148:151], a[108:111], v[100:103], v[148:151]
  v_exp_f32 v17, v45
  v_mfma_f32_16x16x32_bf16 v[148:151], a[104:107], v[96:99], v[148:151]
  ds_read_b128 a[108:111], v4 offset:29696
  ds_read_b128 a[104:107], v4 offset:13312
  v_mfma_f32_16x16x32_bf16 v[152:155], a[112:115], v[96:99], v[152:155]
  v_cvt_pk_bf16_f32 v118, v16, v17
  s_cselect_b32 s40, s63, s40
  v_mfma_f32_16x16x32_bf16 v[152:155], a[116:119], v[100:103], v[152:155]
  v_exp_f32 v18, v46
  v_mfma_f32_16x16x32_bf16 v[216:219], a[116:119], v[108:111], v[216:219]
  ds_read_b128 a[116:119], v4 offset:30720
  s_cselect_b32 s48, s50, s48
  v_mfma_f32_16x16x32_bf16 v[216:219], a[112:115], v[104:107], v[216:219]
  ds_read_b128 a[112:115], v4 offset:14336
  s_cselect_b32 s49, s51, s49
  v_mfma_f32_16x16x32_bf16 v[220:223], a[120:123], v[104:107], v[220:223]
  v_exp_f32_e64 v19, v47
  v_mfma_f32_16x16x32_bf16 v[220:223], a[124:127], v[108:111], v[220:223]
  v_cvt_pk_bf16_f32 v119, v18, v19
  s_cselect_b32 s50, 2147483648, s50
  v_mfma_f32_16x16x32_bf16 v[156:159], a[124:127], v[100:103], v[156:159]
  ds_read_b128 a[124:127], v4 offset:31744
  s_add_u32 s36, s36, 32768
  v_mfma_f32_16x16x32_bf16 v[156:159], a[120:123], v[96:99], v[156:159]
  s_waitcnt lgkmcnt(11)
  ds_read_b128 a[120:123], v4 offset:15360
  v_mfma_f32_16x16x32_bf16 v[160:163], a[64:67], v[96:99], v[160:163]
  v_exp_f32 v20, v60
  v_mfma_f32_16x16x32_bf16 v[160:163], a[68:71], v[100:103], v[160:163]
  s_cmp_eq_u32 s36, 98304
  s_cselect_b32 s36, 0, s36
  v_mfma_f32_16x16x32_bf16 v[224:227], a[68:71], v[108:111], v[224:227]
  v_add_u32_e64 v3, s36, v0
  s_sub_u32 s55, s55, 1
  v_mfma_f32_16x16x32_bf16 v[224:227], a[64:67], v[104:107], v[224:227]
  v_exp_f32_e64 v21, v61
  v_mfma_f32_16x16x32_bf16 v[228:231], a[72:75], v[104:107], v[228:231]
  v_cvt_pk_bf16_f32 v126, v20, v21
  s_add_u32 s57, s57, 1
  v_mfma_f32_16x16x32_bf16 v[228:231], a[76:79], v[108:111], v[228:231]
  s_cmp_le_u32 s55, s56
  v_mfma_f32_16x16x32_bf16 v[164:167], a[76:79], v[100:103], v[164:167]
  v_exp_f32_e64 v22, v62
  v_mfma_f32_16x16x32_bf16 v[164:167], a[72:75], v[96:99], v[164:167]
  s_waitcnt lgkmcnt(8)
  s_nop 0
  v_mfma_f32_16x16x32_bf16 v[168:171], a[80:83], v[96:99], v[168:171]
  v_xor_b32 v4, 0x38000, v4
  v_mfma_f32_16x16x32_bf16 v[168:171], a[84:87], v[100:103], v[168:171]
  v_exp_f32_e64 v23, v63
  v_mfma_f32_16x16x32_bf16 v[232:235], a[84:87], v[108:111], v[232:235]
  v_cvt_pk_bf16_f32 v127, v22, v23
  v_mfma_f32_16x16x32_bf16 v[232:235], a[80:83], v[104:107], v[232:235]
  v_or3_b32 v10, v112, v113, v120
  v_mfma_f32_16x16x32_bf16 v[236:239], a[88:91], v[104:107], v[236:239]
  v_or3_b32 v10, v10, v121, v114
  v_mfma_f32_16x16x32_bf16 v[236:239], a[92:95], v[108:111], v[236:239]
  v_or3_b32 v10, v10, v115, v122
  v_mfma_f32_16x16x32_bf16 v[172:175], a[92:95], v[100:103], v[172:175]
  s_waitcnt vmcnt(8) lgkmcnt(0)
  s_barrier
  v_mfma_f32_16x16x32_bf16 v[172:175], a[88:91], v[96:99], v[172:175]
  ds_read_b128 a[0:3], v3 offset:0
  v_or3_b32 v10, v10, v123, v116
  v_mfma_f32_16x16x32_bf16 v[176:179], a[96:99], v[96:99], v[176:179]
  ds_read_b128 a[4:7], v3 offset:1024
  v_or3_b32 v10, v10, v117, v124
  v_mfma_f32_16x16x32_bf16 v[176:179], a[100:103], v[100:103], v[176:179]
  ds_read_b128 a[8:11], v3 offset:2048
  v_or3_b32 v10, v10, v125, v118
  v_mfma_f32_16x16x32_bf16 v[240:243], a[100:103], v[108:111], v[240:243]
  ds_read_b128 a[12:15], v3 offset:3072
  v_or3_b32 v10, v10, v119, v126
  v_mfma_f32_16x16x32_bf16 v[240:243], a[96:99], v[104:107], v[240:243]
  ds_read_b128 a[16:19], v3 offset:4096
  v_or_b32_e64 v10, v10, v127
  v_mfma_f32_16x16x32_bf16 v[244:247], a[104:107], v[104:107], v[244:247]
  ds_read_b128 a[20:23], v3 offset:5120
  v_and_b32 v10, 0x40004000, v10
  v_mfma_f32_16x16x32_bf16 v[244:247], a[108:111], v[108:111], v[244:247]
  ds_read_b128 a[24:27], v3 offset:6144
  v_cmp_ne_u32_e64 vcc, 0, v10
  v_mfma_f32_16x16x32_bf16 v[180:183], a[108:111], v[100:103], v[180:183]
  ds_read_b128 a[28:31], v3 offset:7168
  v_mfma_f32_16x16x32_bf16 v[180:183], a[104:107], v[96:99], v[180:183]
  v_mfma_f32_16x16x32_bf16 v[184:187], a[112:115], v[96:99], v[184:187]
  v_mfma_f32_16x16x32_bf16 v[184:187], a[116:119], v[100:103], v[184:187]
  v_mfma_f32_16x16x32_bf16 v[248:251], a[116:119], v[108:111], v[248:251]
  v_mfma_f32_16x16x32_bf16 v[248:251], a[112:115], v[104:107], v[248:251]
  v_mfma_f32_16x16x32_bf16 v[252:255], a[120:123], v[104:107], v[252:255]
  v_mfma_f32_16x16x32_bf16 v[252:255], a[124:127], v[108:111], v[252:255]
  v_mfma_f32_16x16x32_bf16 v[188:191], a[124:127], v[100:103], v[188:191]
  s_waitcnt lgkmcnt(0)
  s_nop 0
  v_mfma_f32_16x16x32_bf16 v[188:191], a[120:123], v[96:99], v[188:191]
  s_cbranch_vccnz L_k2_fix1
L_k2_fixret1:
  s_cbranch_scc1 L_k2_spec1
L_k2_loop1:
  v_mfma_f32_16x16x32_bf16 v[32:35], a[0:3], a[128:131], v[64:67]
  ds_read_b128 a[32:35], v3 offset:8192
  v_mfma_f32_16x16x32_bf16 v[32:35], a[4:7], a[132:135], v[32:35]
  ds_read_b128 a[36:39], v3 offset:9216
  s_add_u32 m0, s54, 0
  v_mfma_f32_16x16x32_bf16 v[32:35], a[8:11], a[136:139], v[32:35]
  ds_read_b128 a[40:43], v3 offset:10240
  buffer_load_dwordx4 v1, s[8:11], s52 offen offset:0 sc1 lds
  v_mfma_f32_16x16x32_bf16 v[32:35], a[12:15], a[140:143], v[32:35]
  s_nop 0
  ds_read_b128 a[44:47], v3 offset:11264
  v_mfma_f32_16x16x32_bf16 v[32:35], a[16:19], a[144:147], v[32:35]
  ds_read_b128 a[48:51], v3 offset:12288
  v_mfma_f32_16x16x32_bf16 v[32:35], a[20:23], a[148:151], v[32:35]
  ds_read_b128 a[52:55], v3 offset:13312
  buffer_load_dwordx4 v1, s[8:11], s52 offen offset:1024 sc1 lds
  v_mfma_f32_16x16x32_bf16 v[32:35], a[24:27], a[152:155], v[32:35]
  ds_read_b128 a[56:59], v3 offset:14336
  v_mfma_f32_16x16x32_bf16 v[32:35], a[28:31], a[156:159], v[32:35]
  ds_read_b128 a[60:63], v3 offset:15360
  v_mfma_f32_16x16x32_bf16 v[48:51], a[0:3], a[160:163], v[80:83]
  buffer_load_dwordx4 v1, s[8:11], s52 offen offset:2048 sc1 lds
  v_mfma_f32_16x16x32_bf16 v[48:51], a[4:7], a[164:167], v[48:51]
  ds_read_b128 a[0:3], v3 offset:16384
  v_mfma_f32_16x16x32_bf16 v[48:51], a[8:11], a[168:171], v[48:51]
  ds_read_b128 a[4:7], v3 offset:17408
  v_mfma_f32_16x16x32_bf16 v[48:51], a[12:15], a[172:175], v[48:51]
  buffer_load_dwordx4 v1, s[8:11], s52 offen offset:3072 sc1 lds
  v_mfma_f32_16x16x32_bf16 v[48:51], a[16:19], a[176:179], v[48:51]
  v_exp_f32_e64 v16, v32
  v_mfma_f32_16x16x32_bf16 v[48:51], a[20:23], a[180:183], v[48:51]
  ds_read_b128 a[8:11], v3 offset:18432
  ds_read_b128 a[12:15], v3 offset:19456
  v_mfma_f32_16x16x32_bf16 v[48:51], a[24:27], a[184:187], v[48:51]
  s_add_u32 m0, s54, 4096
  v_mfma_f32_16x16x32_bf16 v[48:51], a[28:31], a[188:191], v[48:51]
  s_waitcnt lgkmcnt(4)
  ds_read_b128 a[16:19], v3 offset:20480
  v_mfma_f32_16x16x32_bf16 v[36:39], a[32:35], a[128:131], v[68:71]
  v_exp_f32 v17, v33
  v_mfma_f32_16x16x32_bf16 v[36:39], a[36:39], a[132:135], v[36:39]
  ds_read_b128 a[20:23], v3 offset:21504
  v_cvt_pk_bf16_f32 v96, v16, v17
  v_mfma_f32_16x16x32_bf16 v[36:39], a[40:43], a[136:139], v[36:39]
  ds_read_b128 a[24:27], v3 offset:22528
  buffer_load_dwordx4 v2, s[8:11], s52 offen offset:0 sc1 lds
  v_mfma_f32_16x16x32_bf16 v[36:39], a[44:47], a[140:143], v[36:39]
  v_exp_f32_e64 v18, v34
  v_mfma_f32_16x16x32_bf16 v[36:39], a[48:51], a[144:147], v[36:39]
  ds_read_b128 a[28:31], v3 offset:23552
  v_mfma_f32_16x16x32_bf16 v[36:39], a[52:55], a[148:151], v[36:39]
  buffer_load_dwordx4 v2, s[8:11], s52 offen offset:1024 sc1 lds
  v_mfma_f32_16x16x32_bf16 v[36:39], a[56:59], a[152:155], v[36:39]
  v_exp_f32_e64 v19, v35
  v_mfma_f32_16x16x32_bf16 v[36:39], a[60:63], a[156:159], v[36:39]
  v_cvt_pk_bf16_f32 v97, v18, v19
  v_mfma_f32_16x16x32_bf16 v[52:55], a[32:35], a[160:163], v[84:87]
  buffer_load_dwordx4 v2, s[8:11], s52 offen offset:2048 sc1 lds
  v_mfma_f32_16x16x32_bf16 v[52:55], a[36:39], a[164:167], v[52:55]
  v_exp_f32_e64 v20, v48
  v_mfma_f32_16x16x32_bf16 v[52:55], a[40:43], a[168:171], v[52:55]
  ds_read_b128 a[32:35], v3 offset:24576
  ds_read_b128 a[36:39], v3 offset:25600
  v_mfma_f32_16x16x32_bf16 v[52:55], a[44:47], a[172:175], v[52:55]
  buffer_load_dwordx4 v2, s[8:11], s52 offen offset:3072 sc1 lds
  v_mfma_f32_16x16x32_bf16 v[52:55], a[48:51], a[176:179], v[52:55]
  v_exp_f32_e64 v21, v49
  v_mfma_f32_16x16x32_bf16 v[52:55], a[52:55], a[180:183], v[52:55]
  ds_read_b128 a[40:43], v3 offset:26624
  ds_read_b128 a[44:47], v3 offset:27648
  v_mfma_f32_16x16x32_bf16 v[52:55], a[56:59], a[184:187], v[52:55]
  v_cvt_pk_bf16_f32 v104, v20, v21
  s_xor_b32 s54, s54, 0x38000
  v_mfma_f32_16x16x32_bf16 v[52:55], a[60:63], a[188:191], v[52:55]
  s_waitcnt lgkmcnt(4)
  ds_read_b128 a[48:51], v3 offset:28672
  v_mfma_f32_16x16x32_bf16 v[40:43], a[0:3], a[128:131], v[72:75]
  v_exp_f32 v22, v50
  v_mfma_f32_16x16x32_bf16 v[40:43], a[4:7], a[132:135], v[40:43]
  ds_read_b128 a[52:55], v3 offset:29696
  s_add_u32 m0, s53, 0
  v_mfma_f32_16x16x32_bf16 v[40:43], a[8:11], a[136:139], v[40:43]
  ds_read_b128 a[56:59], v3 offset:30720
  buffer_load_dwordx4 v1, s[8:11], s48 offen offset:0 sc1 lds
  v_mfma_f32_16x16x32_bf16 v[40:43], a[12:15], a[140:143], v[40:43]
  v_exp_f32 v23, v51
  v_mfma_f32_16x16x32_bf16 v[40:43], a[16:19], a[144:147], v[40:43]
  ds_read_b128 a[60:63], v3 offset:31744
  v_cvt_pk_bf16_f32 v105, v22, v23
  v_mfma_f32_16x16x32_bf16 v[40:43], a[20:23], a[148:151], v[40:43]
  v_mfma_f32_16x16x32_bf16 v[40:43], a[24:27], a[152:155], v[40:43]
  v_exp_f32_e64 v16, v36
  v_mfma_f32_16x16x32_bf16 v[40:43], a[28:31], a[156:159], v[40:43]
  buffer_load_dwordx4 v1, s[8:11], s48 offen offset:1024 sc1 lds
  v_mfma_f32_16x16x32_bf16 v[56:59], a[0:3], a[160:163], v[88:91]
  ds_read_b128 a[64:67], v4 offset:0
  v_mfma_f32_16x16x32_bf16 v[56:59], a[4:7], a[164:167], v[56:59]
  v_exp_f32_e64 v17, v37
  v_mfma_f32_16x16x32_bf16 v[56:59], a[8:11], a[168:171], v[56:59]
  ds_read_b128 a[68:71], v4 offset:16384
  v_cvt_pk_bf16_f32 v98, v16, v17
  v_mfma_f32_16x16x32_bf16 v[56:59], a[12:15], a[172:175], v[56:59]
  ds_read_b128 a[72:75], v4 offset:1024
  v_mfma_f32_16x16x32_bf16 v[56:59], a[16:19], a[176:179], v[56:59]
  v_exp_f32_e64 v18, v38
  v_mfma_f32_16x16x32_bf16 v[56:59], a[20:23], a[180:183], v[56:59]
  ds_read_b128 a[76:79], v4 offset:17408
  buffer_load_dwordx4 v1, s[8:11], s48 offen offset:2048 sc1 lds
  v_mfma_f32_16x16x32_bf16 v[56:59], a[24:27], a[184:187], v[56:59]
  ds_read_b128 a[80:83], v4 offset:2048
  v_mfma_f32_16x16x32_bf16 v[56:59], a[28:31], a[188:191], v[56:59]
  s_waitcnt lgkmcnt(5)
  ds_read_b128 a[84:87], v4 offset:18432
  v_mfma_f32_16x16x32_bf16 v[44:47], a[32:35], a[128:131], v[76:79]
  v_exp_f32 v19, v39
  v_mfma_f32_16x16x32_bf16 v[44:47], a[36:39], a[132:135], v[44:47]
  ds_read_b128 a[88:91], v4 offset:3072
  v_cvt_pk_bf16_f32 v99, v18, v19
  v_mfma_f32_16x16x32_bf16 v[44:47], a[40:43], a[136:139], v[44:47]
  ds_read_b128 a[92:95], v4 offset:19456
  buffer_load_dwordx4 v1, s[8:11], s48 offen offset:3072 sc1 lds
  v_mfma_f32_16x16x32_bf16 v[44:47], a[44:47], a[140:143], v[44:47]
  v_exp_f32_e64 v20, v52
  v_mfma_f32_16x16x32_bf16 v[44:47], a[48:51], a[144:147], v[44:47]
  ds_read_b128 a[96:99], v4 offset:4096
  v_mfma_f32_16x16x32_bf16 v[44:47], a[52:55], a[148:151], v[44:47]
  ds_read_b128 a[100:103], v4 offset:20480
  v_mfma_f32_16x16x32_bf16 v[44:47], a[56:59], a[152:155], v[44:47]
  v_exp_f32_e64 v21, v53
  v_mfma_f32_16x16x32_bf16 v[44:47], a[60:63], a[156:159], v[44:47]
  ds_read_b128 a[104:107], v4 offset:5120
  v_cvt_pk_bf16_f32 v106, v20, v21
  v_mfma_f32_16x16x32_bf16 v[60:63], a[32:35], a[160:163], v[92:95]
  ds_read_b128 a[108:111], v4 offset:21504
  s_add_u32 m0, s53, 4096
  v_mfma_f32_16x16x32_bf16 v[60:63], a[36:39], a[164:167], v[60:63]
  v_exp_f32_e64 v22, v54
  v_mfma_f32_16x16x32_bf16 v[60:63], a[40:43], a[168:171], v[60:63]
  ds_read_b128 a[112:115], v4 offset:6144
  buffer_load_dwordx4 v2, s[8:11], s48 offen offset:0 sc1 lds
  v_mfma_f32_16x16x32_bf16 v[60:63], a[44:47], a[172:175], v[60:63]
  ds_read_b128 a[116:119], v4 offset:22528
  v_mfma_f32_16x16x32_bf16 v[60:63], a[48:51], a[176:179], v[60:63]
  v_exp_f32_e64 v23, v55
  v_mfma_f32_16x16x32_bf16 v[60:63], a[52:55], a[180:183], v[60:63]
  ds_read_b128 a[120:123], v4 offset:7168
  v_cvt_pk_bf16_f32 v107, v22, v23
  v_mfma_f32_16x16x32_bf16 v[60:63], a[56:59], a[184:187], v[60:63]
  ds_read_b128 a[124:127], v4 offset:23552
  v_mfma_f32_16x16x32_bf16 v[60:63], a[60:63], a[188:191], v[60:63]
  v_exp_f32_e64 v16, v40
  v_mfma_f32_16x16x32_bf16 a[192:195], a[200:203], v[112:115], a[192:195]
  buffer_load_dwordx4 v2, s[8:11], s48 offen offset:1024 sc1 lds
  v_mfma_f32_16x16x32_bf16 a[192:195], a[200:203], v[116:119], a[192:195]
  v_mfma_f32_16x16x32_bf16 a[196:199], a[200:203], v[120:123], a[196:199]
  v_exp_f32_e64 v17, v41
  v_mfma_f32_16x16x32_bf16 a[196:199], a[200:203], v[124:127], a[196:199]
  s_waitcnt lgkmcnt(8)
  v_cvt_pk_bf16_f32 v100, v16, v17
  v_mfma_f32_16x16x32_bf16 v[128:131], a[64:67], v[112:115], v[128:131]
  s_nop 0
  v_mfma_f32_16x16x32_bf16 v[128:131], a[68:71], v[116:119], v[128:131]
  v_exp_f32_e64 v18, v42
  v_mfma_f32_16x16x32_bf16 v[192:195], a[68:71], v[124:127], v[192:195]
  ds_read_b128 a[68:71], v4 offset:24576
  buffer_load_dwordx4 v2, s[8:11], s48 offen offset:2048 sc1 lds
  v_mfma_f32_16x16x32_bf16 v[192:195], a[64:67], v[120:123], v[192:195]
  ds_read_b128 a[64:67], v4 offset:8192
  v_mfma_f32_16x16x32_bf16 v[196:199], a[72:75], v[120:123], v[196:199]
  v_exp_f32_e64 v19, v43
  v_mfma_f32_16x16x32_bf16 v[196:199], a[76:79], v[124:127], v[196:199]
  v_cvt_pk_bf16_f32 v101, v18, v19
  v_mfma_f32_16x16x32_bf16 v[132:135], a[76:79], v[116:119], v[132:135]
  ds_read_b128 a[76:79], v4 offset:25600
  v_mfma_f32_16x16x32_bf16 v[132:135], a[72:75], v[112:115], v[132:135]
  v_exp_f32_e64 v20, v56
  v_mfma_f32_16x16x32_bf16 v[136:139], a[80:83], v[112:115], v[136:139]
  ds_read_b128 a[72:75], v4 offset:9216
  buffer_load_dwordx4 v2, s[8:11], s48 offen offset:3072 sc1 lds
  v_mfma_f32_16x16x32_bf16 v[136:139], a[84:87], v[116:119], v[136:139]
  v_mfma_f32_16x16x32_bf16 v[200:203], a[84:87], v[124:127], v[200:203]
  v_exp_f32_e64 v21, v57
  v_mfma_f32_16x16x32_bf16 v[200:203], a[80:83], v[120:123], v[200:203]
  ds_read_b128 a[84:87], v4 offset:26624
  ds_read_b128 a[80:83], v4 offset:10240
  v_mfma_f32_16x16x32_bf16 v[204:207], a[88:91], v[120:123], v[204:207]
  v_cvt_pk_bf16_f32 v108, v20, v21
  s_add_u32 s53, s53, 32768
  v_mfma_f32_16x16x32_bf16 v[204:207], a[92:95], v[124:127], v[204:207]
  v_exp_f32_e64 v22, v58
  v_mfma_f32_16x16x32_bf16 v[140:143], a[92:95], v[116:119], v[140:143]
  ds_read_b128 a[92:95], v4 offset:27648
  s_cmp_ge_u32 s53, 98304
  v_mfma_f32_16x16x32_bf16 v[140:143], a[88:91], v[112:115], v[140:143]
  s_waitcnt lgkmcnt(7)
  ds_read_b128 a[88:91], v4 offset:11264
  v_mfma_f32_16x16x32_bf16 v[144:147], a[96:99], v[112:115], v[144:147]
  v_exp_f32 v23, v59
  v_mfma_f32_16x16x32_bf16 v[144:147], a[100:103], v[116:119], v[144:147]
  v_cvt_pk_bf16_f32 v109, v22, v23
  s_cselect_b32 s53, s21, s53
  v_mfma_f32_16x16x32_bf16 v[208:211], a[100:103], v[124:127], v[208:211]
  ds_read_b128 a[100:103], v4 offset:28672
  s_add_u32 s52, s31, 16777216
  v_mfma_f32_16x16x32_bf16 v[208:211], a[96:99], v[120:123], v[208:211]
  v_exp_f32 v16, v44
  v_mfma_f32_16x16x32_bf16 v[212:215], a[104:107], v[120:123], v[212:215]
  ds_read_b128 a[96:99], v4 offset:12288
  s_mov_b32 s31, s48
  v_mfma_f32_16x16x32_bf16 v[212:215], a[108:111], v[124:127], v[212:215]
  s_add_u32 s48, s48, s40
  s_cmp_eq_u32 s48, s49
  v_mfma_f32_16x16x32_bf16 v[148:151], a[108:111], v[116:119], v[148:151]
  v_exp_f32 v17, v45
  v_mfma_f32_16x16x32_bf16 v[148:151], a[104:107], v[112:115], v[148:151]
  ds_read_b128 a[108:111], v4 offset:29696
  ds_read_b128 a[104:107], v4 offset:13312
  v_mfma_f32_16x16x32_bf16 v[152:155], a[112:115], v[112:115], v[152:155]
  v_cvt_pk_bf16_f32 v102, v16, v17
  s_cselect_b32 s40, s63, s40
  v_mfma_f32_16x16x32_bf16 v[152:155], a[116:119], v[116:119], v[152:155]
  v_exp_f32 v18, v46
  v_mfma_f32_16x16x32_bf16 v[216:219], a[116:119], v[124:127], v[216:219]
  ds_read_b128 a[116:119], v4 offset:30720
  s_cselect_b32 s48, s50, s48
  v_mfma_f32_16x16x32_bf16 v[216:219], a[112:115], v[120:123], v[216:219]
  ds_read_b128 a[112:115], v4 offset:14336
  s_cselect_b32 s49, s51, s49
  v_mfma_f32_16x16x32_bf16 v[220:223], a[120:123], v[120:123], v[220:223]
  v_exp_f32_e64 v19, v47
  v_mfma_f32_16x16x32_bf16 v[220:223], a[124:127], v[124:127], v[220:223]
  v_cvt_pk_bf16_f32 v103, v18, v19
  s_cselect_b32 s50, 2147483648, s50
  v_mfma_f32_16x16x32_bf16 v[156:159], a[124:127], v[116:119], v[156:159]
  ds_read_b128 a[124:127], v4 offset:31744
  s_add_u32 s36, s36, 32768
  v_mfma_f32_16x16x32_bf16 v[156:159], a[120:123], v[112:115], v[156:159]
  s_waitcnt lgkmcnt(11)
  ds_read_b128 a[120:123], v4 offset:15360
  v_mfma_f32_16x16x32_bf16 v[160:163], a[64:67], v[112:115], v[160:163]
  v_exp_f32 v20, v60
  v_mfma_f32_16x16x32_bf16 v[160:163], a[68:71], v[116:119], v[160:163]
  s_cmp_eq_u32 s36, 98304
  s_cselect_b32 s36, 0, s36
  v_mfma_f32_16x16x32_bf16 v[224:227], a[68:71], v[124:127], v[224:227]
  v_add_u32_e64 v3, s36, v0
  s_sub_u32 s55, s55, 1
  v_mfma_f32_16x16x32_bf16 v[224:227], a[64:67], v[120:123], v[224:227]
  v_exp_f32_e64 v21, v61
  v_mfma_f32_16x16x32_bf16 v[228:231], a[72:75], v[120:123], v[228:231]
  v_cvt_pk_bf16_f32 v110, v20, v21
  s_add_u32 s57, s57, 1
  v_mfma_f32_16x16x32_bf16 v[228:231], a[76:79], v[124:127], v[228:231]
  s_cmp_le_u32 s55, s56
  v_mfma_f32_16x16x32_bf16 v[164:167], a[76:79], v[116:119], v[164:167]
  v_exp_f32_e64 v22, v62
  v_mfma_f32_16x16x32_bf16 v[164:167], a[72:75], v[112:115], v[164:167]
  s_waitcnt lgkmcnt(8)
  s_nop 0
  v_mfma_f32_16x16x32_bf16 v[168:171], a[80:83], v[112:115], v[168:171]
  v_xor_b32 v4, 0x38000, v4
  v_mfma_f32_16x16x32_bf16 v[168:171], a[84:87], v[116:119], v[168:171]
  v_exp_f32_e64 v23, v63
  v_mfma_f32_16x16x32_bf16 v[232:235], a[84:87], v[124:127], v[232:235]
  v_cvt_pk_bf16_f32 v111, v22, v23
  v_mfma_f32_16x16x32_bf16 v[232:235], a[80:83], v[120:123], v[232:235]
  v_or3_b32 v10, v96, v97, v104
  v_mfma_f32_16x16x32_bf16 v[236:239], a[88:91], v[120:123], v[236:239]
  v_or3_b32 v10, v10, v105, v98
  v_mfma_f32_16x16x32_bf16 v[236:239], a[92:95], v[124:127], v[236:239]
  v_or3_b32 v10, v10, v99, v106
  v_mfma_f32_16x16x32_bf16 v[172:175], a[92:95], v[116:119], v[172:175]
  s_waitcnt vmcnt(8) lgkmcnt(0)
  s_barrier
  v_mfma_f32_16x16x32_bf16 v[172:175], a[88:91], v[112:115], v[172:175]
  ds_read_b128 a[0:3], v3 offset:0
  v_or3_b32 v10, v10, v107, v100
  v_mfma_f32_16x16x32_bf16 v[176:179], a[96:99], v[112:115], v[176:179]
  ds_read_b128 a[4:7], v3 offset:1024
  v_or3_b32 v10, v10, v101, v108
  v_mfma_f32_16x16x32_bf16 v[176:179], a[100:103], v[116:119], v[176:179]
  ds_read_b128 a[8:11], v3 offset:2048
  v_or3_b32 v10, v10, v109, v102
  v_mfma_f32_16x16x32_bf16 v[240:243], a[100:103], v[124:127], v[240:243]
  ds_read_b128 a[12:15], v3 offset:3072
  v_or3_b32 v10, v10, v103, v110
  v_mfma_f32_16x16x32_bf16 v[240:243], a[96:99], v[120:123], v[240:243]
  ds_read_b128 a[16:19], v3 offset:4096
  v_or_b32_e64 v10, v10, v111
  v_mfma_f32_16x16x32_bf16 v[244:247], a[104:107], v[120:123], v[244:247]
  ds_read_b128 a[20:23], v3 offset:5120
  v_and_b32 v10, 0x40004000, v10
  v_mfma_f32_16x16x32_bf16 v[244:247], a[108:111], v[124:127], v[244:247]
  ds_read_b128 a[24:27], v3 offset:6144
  v_cmp_ne_u32_e64 vcc, 0, v10
  v_mfma_f32_16x16x32_bf16 v[180:183], a[108:111], v[116:119], v[180:183]
  ds_read_b128 a[28:31], v3 offset:7168
  v_mfma_f32_16x16x32_bf16 v[180:183], a[104:107], v[112:115], v[180:183]
  v_mfma_f32_16x16x32_bf16 v[184:187], a[112:115], v[112:115], v[184:187]
  v_mfma_f32_16x16x32_bf16 v[184:187], a[116:119], v[116:119], v[184:187]
  v_mfma_f32_16x16x32_bf16 v[248:251], a[116:119], v[124:127], v[248:251]
  v_mfma_f32_16x16x32_bf16 v[248:251], a[112:115], v[120:123], v[248:251]
  v_mfma_f32_16x16x32_bf16 v[252:255], a[120:123], v[120:123], v[252:255]
  v_mfma_f32_16x16x32_bf16 v[252:255], a[124:127], v[124:127], v[252:255]
  v_mfma_f32_16x16x32_bf16 v[188:191], a[124:127], v[116:119], v[188:191]
  s_waitcnt lgkmcnt(0)
  s_nop 0
  v_mfma_f32_16x16x32_bf16 v[188:191], a[120:123], v[112:115], v[188:191]
  s_cbranch_vccnz L_k2_fix0
L_k2_fixret0:
  s_cbranch_scc1 L_k2_spec0
  s_branch L_k2_loop0
L_k2_spec0:
  s_cmp_eq_u32 s55, 0
  s_cbranch_scc1 L_k2_end0
  s_cmp_eq_u32 s55, 1
  s_cbranch_scc1 L_k2_last0
  s_getpc_b64 s[4:5]
L_cp_b0:
  s_add_u32 s4, s4, L_k2_last1-L_cp_b0
  s_addc_u32 s5, s5, (L_k2_last1-L_cp_b0)>>32
  s_lshr_b32 s3, s2, 3
  s_lshl_b32 s3, s3, 2
  s_add_u32 s3, s3, s44
  s_mul_i32 s3, s3, 384
  v_lshlrev_b32 v28, 3, v0
  v_min_u32 v28, 256, v28
  v_add_u32_e64 v28, s3, v28
  v_min_u32 v28, L_k2_codeend-L_k2_last1-4, v28
  global_load_dword v29, v28, s[4:5]
  v_accvgpr_read_b32 v27, a212
  buffer_load_dword v30, v27, s[12:15], 0 offen
  s_lshl_b32 s3, s57, 6
  v_mov_b32 v26, 0xf149f2ca
  v_subrev_u32 v24, s3, v8
  v_cmp_le_i32 s[22:23], 0, v24
  v_cmp_le_i32 s[24:25], 1, v24
  v_cmp_le_i32 s[26:27], 2, v24
  v_cmp_le_i32 s[28:29], 3, v24
  v_cndmask_b32 v64, v26, v6, s[22:23]
  v_cndmask_b32 v65, v26, v6, s[24:25]
  v_cndmask_b32 v66, v26, v6, s[26:27]
  v_cndmask_b32 v67, v26, v6, s[28:29]
  v_cmp_le_i32 s[22:23], 16, v24
  v_cmp_le_i32 s[24:25], 17, v24
  v_cmp_le_i32 s[26:27], 18, v24
  v_cmp_le_i32 s[28:29], 19, v24
  v_cndmask_b32 v68, v26, v6, s[22:23]
  v_cndmask_b32 v69, v26, v6, s[24:25]
  v_cndmask_b32 v70, v26, v6, s[26:27]
  v_cndmask_b32 v71, v26, v6, s[28:29]
  v_cmp_le_i32 s[22:23], 32, v24
  v_cmp_le_i32 s[24:25], 33, v24
  v_cmp_le_i32 s[26:27], 34, v24
  v_cmp_le_i32 s[28:29], 35, v24
  v_cndmask_b32 v72, v26, v6, s[22:23]
  v_cndmask_b32 v73, v26, v6, s[24:25]
  v_cndmask_b32 v74, v26, v6, s[26:27]
  v_cndmask_b32 v75, v26, v6, s[28:29]
  v_cmp_le_i32 s[22:23], 48, v24
  v_cmp_le_i32 s[24:25], 49, v24
  v_cmp_le_i32 s[26:27], 50, v24
  v_cmp_le_i32 s[28:29], 51, v24
  v_cndmask_b32 v76, v26, v6, s[22:23]
  v_cndmask_b32 v77, v26, v6, s[24:25]
  v_cndmask_b32 v78, v26, v6, s[26:27]
  v_cndmask_b32 v79, v26, v6, s[28:29]
  s_nop 0
  s_branch L_k2_loop0
L_k2_spec1:
  s_cmp_eq_u32 s55, 0
  s_cbranch_scc1 L_k2_end1
  s_cmp_eq_u32 s55, 1
  s_cbranch_scc1 L_k2_last1
  s_getpc_b64 s[4:5]
L_cp_b1:
  s_add_u32 s4, s4, L_k2_last1-L_cp_b1
  s_addc_u32 s5, s5, (L_k2_last1-L_cp_b1)>>32
  s_lshr_b32 s3, s2, 3
  s_lshl_b32 s3, s3, 2
  s_add_u32 s3, s3, s44
  s_mul_i32 s3, s3, 384
  v_lshlrev_b32_e64 v28, 3, v0
  v_min_u32 v28, 256, v28
  v_add_u32_e64 v28, s3, v28
  v_min_u32 v28, L_k2_codeend-L_k2_last1-4, v28
  global_load_dword v29, v28, s[4:5]
  v_accvgpr_read_b32 v27, a212
  buffer_load_dword v30, v27, s[12:15], 0 offen
  s_lshl_b32 s3, s57, 6
  v_mov_b32 v26, 0xf149f2ca
  v_subrev_u32 v24, s3, v8
  v_cmp_le_i32 s[22:23], 0, v24
  v_cmp_le_i32 s[24:25], 1, v24
  v_cmp_le_i32 s[26:27], 2, v24
  v_cmp_le_i32 s[28:29], 3, v24
  v_cndmask_b32 v64, v26, v6, s[22:23]
  v_cndmask_b32 v65, v26, v6, s[24:25]
  v_cndmask_b32 v66, v26, v6, s[26:27]
  v_cndmask_b32 v67, v26, v6, s[28:29]
  v_cmp_le_i32 s[22:23], 16, v24
  v_cmp_le_i32 s[24:25], 17, v24
  v_cmp_le_i32 s[26:27], 18, v24
  v_cmp_le_i32 s[28:29], 19, v24
  v_cndmask_b32 v68, v26, v6, s[22:23]
  v_cndmask_b32 v69, v26, v6, s[24:25]
  v_cndmask_b32 v70, v26, v6, s[26:27]
  v_cndmask_b32 v71, v26, v6, s[28:29]
  v_cmp_le_i32 s[22:23], 32, v24
  v_cmp_le_i32 s[24:25], 33, v24
  v_cmp_le_i32 s[26:27], 34, v24
  v_cmp_le_i32 s[28:29], 35, v24
  v_cndmask_b32 v72, v26, v6, s[22:23]
  v_cndmask_b32 v73, v26, v6, s[24:25]
  v_cndmask_b32 v74, v26, v6, s[26:27]
  v_cndmask_b32 v75, v26, v6, s[28:29]
  v_cmp_le_i32 s[22:23], 48, v24
  v_cmp_le_i32 s[24:25], 49, v24
  v_cmp_le_i32 s[26:27], 50, v24
  v_cmp_le_i32 s[28:29], 51, v24
  v_cndmask_b32 v76, v26, v6, s[22:23]
  v_cndmask_b32 v77, v26, v6, s[24:25]
  v_cndmask_b32 v78, v26, v6, s[26:27]
  v_cndmask_b32 v79, v26, v6, s[28:29]
  s_nop 0
  s_branch L_k2_loop1
L_k2_pub:
  s_mov_b32 s16, 0
  buffer_store_dwordx4 v[12:15], v0, s[8:11], s30 offen sc1
  s_branch L_k2_pubret
L_k2_spin:
  s_mov_b32 s17, 0
L_k2_spinl:
  buffer_load_dwordx4 v[12:15], v0, s[8:11], s30 offen sc1
  s_add_u32 s17, s17, 1
  s_cmp_ge_u32 s17, 0x40000
  s_waitcnt vmcnt(0)
  s_cbranch_scc1 L_k2_spinret
  v_min_u32 v28, v13, v15
  v_cmp_eq_u32 vcc, 0, v28
  s_nop 0
  s_cbranch_vccz L_k2_spinret
  s_sleep 2
  s_branch L_k2_spinl
L_k2_jmask:
  s_lshl_b32 s3, s57, 6
  v_mov_b32 v26, 0xf149f2ca
  v_subrev_u32 v24, s3, v8
  v_cmp_le_i32 s[22:23], 0, v24
  v_cmp_le_i32 s[24:25], 1, v24
  v_cmp_le_i32 s[26:27], 2, v24
  v_cmp_le_i32 s[28:29], 3, v24
  v_cndmask_b32 v32, v26, v32, s[22:23]
  v_cndmask_b32 v33, v26, v33, s[24:25]
  v_cndmask_b32 v34, v26, v34, s[26:27]
  v_cndmask_b32 v35, v26, v35, s[28:29]
  v_cmp_le_i32 s[22:23], 16, v24
  v_cmp_le_i32 s[24:25], 17, v24
  v_cmp_le_i32 s[26:27], 18, v24
  v_cmp_le_i32 s[28:29], 19, v24
  v_cndmask_b32 v36, v26, v36, s[22:23]
  v_cndmask_b32 v37, v26, v37, s[24:25]
  v_cndmask_b32 v38, v26, v38, s[26:27]
  v_cndmask_b32 v39, v26, v39, s[28:29]
  v_cmp_le_i32 s[22:23], 32, v24
  v_cmp_le_i32 s[24:25], 33, v24
  v_cmp_le_i32 s[26:27], 34, v24
  v_cmp_le_i32 s[28:29], 35, v24
  v_cndmask_b32 v40, v26, v40, s[22:23]
  v_cndmask_b32 v41, v26, v41, s[24:25]
  v_cndmask_b32 v42, v26, v42, s[26:27]
  v_cndmask_b32 v43, v26, v43, s[28:29]
  v_cmp_le_i32 s[22:23], 48, v24
  v_cmp_le_i32 s[24:25], 49, v24
  v_cmp_le_i32 s[26:27], 50, v24
  v_cmp_le_i32 s[28:29], 51, v24
  v_cndmask_b32 v44, v26, v44, s[22:23]
  v_cndmask_b32 v45, v26, v45, s[24:25]
  v_cndmask_b32 v46, v26, v46, s[26:27]
  v_cndmask_b32 v47, v26, v47, s[28:29]
  s_branch L_k2_jmaskret
L_k2_end1:
  v_mov_b32 v96, v112
  v_mov_b32 v97, v113
  v_mov_b32 v98, v114
  v_mov_b32 v99, v115
  v_mov_b32 v100, v116
  v_mov_b32 v101, v117
  v_mov_b32 v102, v118
  v_mov_b32 v103, v119
  v_mov_b32 v104, v120
  v_mov_b32 v105, v121
  v_mov_b32 v106, v122
  v_mov_b32 v107, v123
  v_mov_b32 v108, v124
  v_mov_b32 v109, v125
  v_mov_b32 v110, v126
  v_mov_b32 v111, v127
L_k2_end0:
  ds_read_b128 a[64:67], v4 offset:0
  ds_read_b128 a[68:71], v4 offset:16384
  ds_read_b128 a[72:75], v4 offset:1024
  ds_read_b128 a[76:79], v4 offset:17408
  ds_read_b128 a[80:83], v4 offset:2048
  ds_read_b128 a[84:87], v4 offset:18432
  ds_read_b128 a[88:91], v4 offset:3072
  ds_read_b128 a[92:95], v4 offset:19456
  s_mov_b32 s58, s61
  s_waitcnt vmcnt(0)
  s_lshl_b32 s3, s45, 4
  s_add_u32 s3, s3, s58
  s_lshl_b32 s3, s3, 2
  s_add_u32 s3, s3, s44
  s_lshl_b32 s3, s3, 14
  s_add_u32 s64, s3, 54525952
  s_add_u32 s65, s64, 8192
  v_mfma_f32_16x16x32_bf16 a[192:195], a[200:203], v[96:99], a[192:195]
  ds_read_b128 a[96:99], v4 offset:4096
  v_mfma_f32_16x16x32_bf16 a[192:195], a[200:203], v[100:103], a[192:195]
  ds_read_b128 a[100:103], v4 offset:20480
  buffer_load_dwordx4 a[168:171], v0, s[8:11], s65 offen offset:2048 sc1
  v_mfma_f32_16x16x32_bf16 a[196:199], a[200:203], v[104:107], a[196:199]
  ds_read_b128 a[104:107], v4 offset:5120
  v_mfma_f32_16x16x32_bf16 a[196:199], a[200:203], v[108:111], a[196:199]
  s_waitcnt lgkmcnt(9)
  ds_read_b128 a[108:111], v4 offset:21504
  v_mfma_f32_16x16x32_bf16 v[128:131], a[64:67], v[96:99], v[128:131]
  s_nop 0
  ds_read_b128 a[112:115], v4 offset:6144
  v_mfma_f32_16x16x32_bf16 v[128:131], a[68:71], v[100:103], v[128:131]
  ds_read_b128 a[116:119], v4 offset:22528
  buffer_load_dwordx4 a[172:175], v0, s[8:11], s65 offen offset:3072 sc1
  v_mfma_f32_16x16x32_bf16 v[192:195], a[68:71], v[108:111], v[192:195]
  ds_read_b128 a[120:123], v4 offset:7168
  ds_read_b128 a[68:71], v4 offset:24576
  v_mfma_f32_16x16x32_bf16 v[192:195], a[64:67], v[104:107], v[192:195]
  s_waitcnt lgkmcnt(8)
  ds_read_b128 a[124:127], v4 offset:23552
  v_mfma_f32_16x16x32_bf16 v[196:199], a[72:75], v[104:107], v[196:199]
  ds_read_b128 a[64:67], v4 offset:8192
  v_accvgpr_mov_b32 a128, a216
  v_mfma_f32_16x16x32_bf16 v[196:199], a[76:79], v[108:111], v[196:199]
  buffer_load_dwordx4 a[176:179], v5, s[8:11], s65 offen offset:0 sc1
  v_accvgpr_mov_b32 a129, a217
  v_mfma_f32_16x16x32_bf16 v[132:135], a[76:79], v[100:103], v[132:135]
  ds_read_b128 a[76:79], v4 offset:25600
  v_accvgpr_mov_b32 a130, a218
  v_mfma_f32_16x16x32_bf16 v[132:135], a[72:75], v[96:99], v[132:135]
  ds_read_b128 a[72:75], v4 offset:9216
  v_accvgpr_mov_b32 a131, a219
  v_mfma_f32_16x16x32_bf16 v[136:139], a[80:83], v[96:99], v[136:139]
  v_accvgpr_mov_b32 a132, a220
  v_accvgpr_mov_b32 a133, a221
  v_mfma_f32_16x16x32_bf16 v[136:139], a[84:87], v[100:103], v[136:139]
  buffer_load_dwordx4 a[180:183], v5, s[8:11], s65 offen offset:1024 sc1
  v_accvgpr_mov_b32 a134, a222
  v_mfma_f32_16x16x32_bf16 v[200:203], a[84:87], v[108:111], v[200:203]
  ds_read_b128 a[84:87], v4 offset:26624
  v_accvgpr_mov_b32 a135, a223
  v_mfma_f32_16x16x32_bf16 v[200:203], a[80:83], v[104:107], v[200:203]
  ds_read_b128 a[80:83], v4 offset:10240
  v_accvgpr_mov_b32 a136, a224
  v_mfma_f32_16x16x32_bf16 v[204:207], a[88:91], v[104:107], v[204:207]
  v_accvgpr_mov_b32 a137, a225
  v_accvgpr_mov_b32 a138, a226
  v_mfma_f32_16x16x32_bf16 v[204:207], a[92:95], v[108:111], v[204:207]
  buffer_load_dwordx4 a[184:187], v5, s[8:11], s65 offen offset:2048 sc1
  v_accvgpr_mov_b32 a139, a227
  v_mfma_f32_16x16x32_bf16 v[140:143], a[92:95], v[100:103], v[140:143]
  ds_read_b128 a[92:95], v4 offset:27648
  v_accvgpr_mov_b32 a140, a228
  v_mfma_f32_16x16x32_bf16 v[140:143], a[88:91], v[96:99], v[140:143]
  s_waitcnt lgkmcnt(11)
  ds_read_b128 a[88:91], v4 offset:11264
  v_mfma_f32_16x16x32_bf16 v[144:147], a[96:99], v[96:99], v[144:147]
  v_accvgpr_mov_b32 a141, a229
  v_accvgpr_mov_b32 a142, a230
  v_mfma_f32_16x16x32_bf16 v[144:147], a[100:103], v[100:103], v[144:147]
  buffer_load_dwordx4 a[188:191], v5, s[8:11], s65 offen offset:3072 sc1
  v_accvgpr_mov_b32 a143, a231
  v_mfma_f32_16x16x32_bf16 v[208:211], a[100:103], v[108:111], v[208:211]
  ds_read_b128 a[100:103], v4 offset:28672
  v_accvgpr_mov_b32 a144, a232
  v_mfma_f32_16x16x32_bf16 v[208:211], a[96:99], v[104:107], v[208:211]
  ds_read_b128 a[96:99], v4 offset:12288
  v_accvgpr_mov_b32 a145, a233
  v_mfma_f32_16x16x32_bf16 v[212:215], a[104:107], v[104:107], v[212:215]
  s_add_u32 m0, s54, 0
  v_accvgpr_mov_b32 a146, a234
  v_mfma_f32_16x16x32_bf16 v[212:215], a[108:111], v[108:111], v[212:215]
  buffer_load_dwordx4 v1, s[8:11], s52 offen offset:0 sc1 lds
  v_accvgpr_mov_b32 a147, a235
  v_mfma_f32_16x16x32_bf16 v[148:151], a[108:111], v[100:103], v[148:151]
  ds_read_b128 a[108:111], v4 offset:29696
  v_accvgpr_mov_b32 a148, a236
  v_mfma_f32_16x16x32_bf16 v[148:151], a[104:107], v[96:99], v[148:151]
  s_waitcnt lgkmcnt(10)
  ds_read_b128 a[104:107], v4 offset:13312
  v_mfma_f32_16x16x32_bf16 v[152:155], a[112:115], v[96:99], v[152:155]
  v_accvgpr_mov_b32 a149, a237
  v_accvgpr_mov_b32 a150, a238
  v_mfma_f32_16x16x32_bf16 v[152:155], a[116:119], v[100:103], v[152:155]
  buffer_load_dwordx4 v1, s[8:11], s52 offen offset:1024 sc1 lds
  v_accvgpr_mov_b32 a151, a239
  v_mfma_f32_16x16x32_bf16 v[216:219], a[116:119], v[108:111], v[216:219]
  ds_read_b128 a[116:119], v4 offset:30720
  v_accvgpr_mov_b32 a152, a240
  v_mfma_f32_16x16x32_bf16 v[216:219], a[112:115], v[104:107], v[216:219]
  ds_read_b128 a[112:115], v4 offset:14336
  v_accvgpr_mov_b32 a153, a241
  v_mfma_f32_16x16x32_bf16 v[220:223], a[120:123], v[104:107], v[220:223]
  v_accvgpr_mov_b32 a154, a242
  v_accvgpr_mov_b32 a155, a243
  v_mfma_f32_16x16x32_bf16 v[220:223], a[124:127], v[108:111], v[220:223]
  buffer_load_dwordx4 v1, s[8:11], s52 offen offset:2048 sc1 lds
  v_accvgpr_mov_b32 a156, a244
  v_mfma_f32_16x16x32_bf16 v[156:159], a[124:127], v[100:103], v[156:159]
  ds_read_b128 a[124:127], v4 offset:31744
  v_accvgpr_mov_b32 a157, a245
  v_mfma_f32_16x16x32_bf16 v[156:159], a[120:123], v[96:99], v[156:159]
  s_waitcnt lgkmcnt(11)
  ds_read_b128 a[120:123], v4 offset:15360
  v_mfma_f32_16x16x32_bf16 v[160:163], a[64:67], v[96:99], v[160:163]
  v_accvgpr_mov_b32 a158, a246
  v_accvgpr_mov_b32 a159, a247
  v_mfma_f32_16x16x32_bf16 v[160:163], a[68:71], v[100:103], v[160:163]
  buffer_load_dwordx4 v1, s[8:11], s52 offen offset:3072 sc1 lds
  v_accvgpr_mov_b32 a160, a248
  v_mfma_f32_16x16x32_bf16 v[224:227], a[68:71], v[108:111], v[224:227]
  v_accvgpr_mov_b32 a161, a249
  v_accvgpr_mov_b32 a162, a250
  v_mfma_f32_16x16x32_bf16 v[224:227], a[64:67], v[104:107], v[224:227]
  v_accvgpr_mov_b32 a163, a251
  v_accvgpr_mov_b32 a164, a252
  v_mfma_f32_16x16x32_bf16 v[228:231], a[72:75], v[104:107], v[228:231]
  s_add_u32 m0, s54, 4096
  v_accvgpr_mov_b32 a165, a253
  v_mfma_f32_16x16x32_bf16 v[228:231], a[76:79], v[108:111], v[228:231]
  buffer_load_dwordx4 v2, s[8:11], s52 offen offset:0 sc1 lds
  v_accvgpr_mov_b32 a166, a254
  v_mfma_f32_16x16x32_bf16 v[164:167], a[76:79], v[100:103], v[164:167]
  v_accvgpr_mov_b32 a167, a255
  s_nop 0
  v_mfma_f32_16x16x32_bf16 v[164:167], a[72:75], v[96:99], v[164:167]
  s_waitcnt lgkmcnt(8)
  s_nop 0
  v_mfma_f32_16x16x32_bf16 v[168:171], a[80:83], v[96:99], v[168:171]
  v_mfma_f32_16x16x32_bf16 v[168:171], a[84:87], v[100:103], v[168:171]
  buffer_load_dwordx4 v2, s[8:11], s52 offen offset:1024 sc1 lds
  v_mfma_f32_16x16x32_bf16 v[232:235], a[84:87], v[108:111], v[232:235]
  v_mfma_f32_16x16x32_bf16 v[232:235], a[80:83], v[104:107], v[232:235]
  v_mfma_f32_16x16x32_bf16 v[236:239], a[88:91], v[104:107], v[236:239]
  v_mfma_f32_16x16x32_bf16 v[236:239], a[92:95], v[108:111], v[236:239]
  buffer_load_dwordx4 v2, s[8:11], s52 offen offset:2048 sc1 lds
  v_mfma_f32_16x16x32_bf16 v[172:175], a[92:95], v[100:103], v[172:175]
  v_xor_b32 v4, 0x38000, v4
  v_mfma_f32_16x16x32_bf16 v[172:175], a[88:91], v[96:99], v[172:175]
  s_waitcnt lgkmcnt(4)
  s_nop 0
  v_mfma_f32_16x16x32_bf16 v[176:179], a[96:99], v[96:99], v[176:179]
  v_mfma_f32_16x16x32_bf16 v[176:179], a[100:103], v[100:103], v[176:179]
  buffer_load_dwordx4 v2, s[8:11], s52 offen offset:3072 sc1 lds
  v_mfma_f32_16x16x32_bf16 v[240:243], a[100:103], v[108:111], v[240:243]
  v_mfma_f32_16x16x32_bf16 v[240:243], a[96:99], v[104:107], v[240:243]
  v_mfma_f32_16x16x32_bf16 v[244:247], a[104:107], v[104:107], v[244:247]
  s_xor_b32 s54, s54, 0x38000
  v_mfma_f32_16x16x32_bf16 v[244:247], a[108:111], v[108:111], v[244:247]
  v_mfma_f32_16x16x32_bf16 v[180:183], a[108:111], v[100:103], v[180:183]
  v_mfma_f32_16x16x32_bf16 v[180:183], a[104:107], v[96:99], v[180:183]
  s_waitcnt lgkmcnt(0)
  s_nop 0
  v_mfma_f32_16x16x32_bf16 v[184:187], a[112:115], v[96:99], v[184:187]
  v_mfma_f32_16x16x32_bf16 v[184:187], a[116:119], v[100:103], v[184:187]
  v_mfma_f32_16x16x32_bf16 v[248:251], a[116:119], v[108:111], v[248:251]
  v_mfma_f32_16x16x32_bf16 v[248:251], a[112:115], v[104:107], v[248:251]
  v_mfma_f32_16x16x32_bf16 v[252:255], a[120:123], v[104:107], v[252:255]
  v_mfma_f32_16x16x32_bf16 v[252:255], a[124:127], v[108:111], v[252:255]
  v_mfma_f32_16x16x32_bf16 v[188:191], a[124:127], v[100:103], v[188:191]
  v_mfma_f32_16x16x32_bf16 v[188:191], a[120:123], v[96:99], v[188:191]
  v_mov_b32 v12, v6
  v_mov_b32 v14, v7
  v_accvgpr_read_b32 v13, a192
  v_accvgpr_read_b32 v15, a196
  s_mov_b32 s16, 1
  s_mov_b32 s59, 1
  s_mov_b32 s56, 2
  s_mov_b32 s57, 0
  s_mov_b32 s55, s60
  s_mov_b32 s37, s62
  s_mov_b32 s63, 32768
  s_sub_u32 s50, s43, 65536
  s_mov_b32 s51, s43
  v_cvt_pk_bf16_f32 v128, v128, v129
  v_cvt_pk_bf16_f32 v129, v130, v131
  v_cvt_pk_bf16_f32 v130, v132, v133
  v_cvt_pk_bf16_f32 v131, v134, v135
  v_cvt_pk_bf16_f32 v136, v136, v137
  v_cvt_pk_bf16_f32 v137, v138, v139
  v_cvt_pk_bf16_f32 v138, v140, v141
  v_cvt_pk_bf16_f32 v139, v142, v143
  v_cvt_pk_bf16_f32 v144, v144, v145
  v_cvt_pk_bf16_f32 v145, v146, v147
  v_cvt_pk_bf16_f32 v146, v148, v149
  v_cvt_pk_bf16_f32 v147, v150, v151
  v_cvt_pk_bf16_f32 v152, v152, v153
  v_cvt_pk_bf16_f32 v153, v154, v155
  v_cvt_pk_bf16_f32 v154, v156, v157
  v_cvt_pk_bf16_f32 v155, v158, v159
  v_cvt_pk_bf16_f32 v160, v160, v161
  v_cvt_pk_bf16_f32 v161, v162, v163
  v_cvt_pk_bf16_f32 v162, v164, v165
  v_cvt_pk_bf16_f32 v163, v166, v167
  v_cvt_pk_bf16_f32 v168, v168, v169
  v_cvt_pk_bf16_f32 v169, v170, v171
  v_cvt_pk_bf16_f32 v170, v172, v173
  v_cvt_pk_bf16_f32 v171, v174, v175
  v_cvt_pk_bf16_f32 v176, v176, v177
  v_cvt_pk_bf16_f32 v177, v178, v179
  v_cvt_pk_bf16_f32 v178, v180, v181
  v_cvt_pk_bf16_f32 v179, v182, v183
  v_cvt_pk_bf16_f32 v184, v184, v185
  v_cvt_pk_bf16_f32 v185, v186, v187
  v_cvt_pk_bf16_f32 v186, v188, v189
  v_cvt_pk_bf16_f32 v187, v190, v191
  v_cvt_pk_bf16_f32 v192, v192, v193
  v_cvt_pk_bf16_f32 v193, v194, v195
  v_cvt_pk_bf16_f32 v194, v196, v197
  v_cvt_pk_bf16_f32 v195, v198, v199
  v_cvt_pk_bf16_f32 v200, v200, v201
  v_cvt_pk_bf16_f32 v201, v202, v203
  v_cvt_pk_bf16_f32 v202, v204, v205
  v_cvt_pk_bf16_f32 v203, v206, v207
  v_cvt_pk_bf16_f32 v208, v208, v209
  v_cvt_pk_bf16_f32 v209, v210, v211
  v_cvt_pk_bf16_f32 v210, v212, v213
  v_cvt_pk_bf16_f32 v211, v214, v215
  v_cvt_pk_bf16_f32 v216, v216, v217
  v_cvt_pk_bf16_f32 v217, v218, v219
  v_cvt_pk_bf16_f32 v218, v220, v221
  v_cvt_pk_bf16_f32 v219, v222, v223
  v_cvt_pk_bf16_f32 v224, v224, v225
  v_cvt_pk_bf16_f32 v225, v226, v227
  v_cvt_pk_bf16_f32 v226, v228, v229
  v_cvt_pk_bf16_f32 v227, v230, v231
  v_cvt_pk_bf16_f32 v232, v232, v233
  v_cvt_pk_bf16_f32 v233, v234, v235
  v_cvt_pk_bf16_f32 v234, v236, v237
  v_cvt_pk_bf16_f32 v235, v238, v239
  v_cvt_pk_bf16_f32 v240, v240, v241
  v_cvt_pk_bf16_f32 v241, v242, v243
  v_cvt_pk_bf16_f32 v242, v244, v245
  v_cvt_pk_bf16_f32 v243, v246, v247
  v_cvt_pk_bf16_f32 v248, v248, v249
  v_cvt_pk_bf16_f32 v249, v250, v251
  v_cvt_pk_bf16_f32 v250, v252, v253
  v_cvt_pk_bf16_f32 v251, v254, v255
L_k2_job:
  s_lshl_b32 s3, s58, 7
  s_lshl_b32 s4, s44, 4
  s_add_u32 s5, s3, s4
  s_sub_u32 s3, s3, s4
  s_add_u32 s3, s3, 112
  v_add_u32 v8, s5, v31
  v_add_u32 v9, s3, v31
  s_waitcnt vmcnt(63) lgkmcnt(15)
  v_mfma_f32_16x16x32_bf16 v[32:35], a[0:3], a[128:131], 0
  ds_read_b128 a[32:35], v3 offset:8192
  v_accvgpr_write_b32 a192, 0
  v_mfma_f32_16x16x32_bf16 v[32:35], a[4:7], a[132:135], v[32:35]
  ds_read_b128 a[36:39], v3 offset:9216
  buffer_store_dwordx4 v[128:131], v0, s[8:11], s37 offen offset:0 sc1
  v_mfma_f32_16x16x32_bf16 v[32:35], a[8:11], a[136:139], v[32:35]
  ds_read_b128 a[40:43], v3 offset:10240
  v_accvgpr_write_b32 a193, 0
  v_mfma_f32_16x16x32_bf16 v[32:35], a[12:15], a[140:143], v[32:35]
  ds_read_b128 a[44:47], v3 offset:11264
  v_accvgpr_write_b32 a194, 0
  v_mfma_f32_16x16x32_bf16 v[32:35], a[16:19], a[144:147], v[32:35]
  ds_read_b128 a[48:51], v3 offset:12288
  v_accvgpr_write_b32 a195, 0
  v_mfma_f32_16x16x32_bf16 v[32:35], a[20:23], a[148:151], v[32:35]
  ds_read_b128 a[52:55], v3 offset:13312
  buffer_store_dwordx4 v[136:139], v0, s[8:11], s37 offen offset:1024 sc1
  v_mfma_f32_16x16x32_bf16 v[32:35], a[24:27], a[152:155], v[32:35]
  ds_read_b128 a[56:59], v3 offset:14336
  v_accvgpr_write_b32 a196, 0
  v_mfma_f32_16x16x32_bf16 v[32:35], a[28:31], a[156:159], v[32:35]
  s_waitcnt vmcnt(10)
  ds_read_b128 a[60:63], v3 offset:15360
  v_mfma_f32_16x16x32_bf16 v[48:51], a[0:3], a[160:163], 0
  v_accvgpr_write_b32 a197, 0
  v_accvgpr_write_b32 a198, 0
  v_mfma_f32_16x16x32_bf16 v[48:51], a[4:7], a[164:167], v[48:51]
  ds_read_b128 a[0:3], v3 offset:16384
  buffer_store_dwordx4 v[144:147], v0, s[8:11], s37 offen offset:2048 sc1
  v_mfma_f32_16x16x32_bf16 v[48:51], a[8:11], a[168:171], v[48:51]
  v_accvgpr_write_b32 a199, 0
  v_mov_b32 v132, 0
  v_mfma_f32_16x16x32_bf16 v[48:51], a[12:15], a[172:175], v[48:51]
  ds_read_b128 a[4:7], v3 offset:17408
  v_mov_b32_e64 v133, 0
  v_mfma_f32_16x16x32_bf16 v[48:51], a[16:19], a[176:179], v[48:51]
  v_mov_b32 v134, 0
  v_mov_b32 v135, 0
  v_mfma_f32_16x16x32_bf16 v[48:51], a[20:23], a[180:183], v[48:51]
  ds_read_b128 a[8:11], v3 offset:18432
  buffer_store_dwordx4 v[152:155], v0, s[8:11], s37 offen offset:3072 sc1
  v_mfma_f32_16x16x32_bf16 v[48:51], a[24:27], a[184:187], v[48:51]
  s_add_u32 s37, s37, 4096
  v_mov_b32_e64 v140, 0
  v_mfma_f32_16x16x32_bf16 v[48:51], a[28:31], a[188:191], v[48:51]
  s_waitcnt lgkmcnt(3)
  ds_read_b128 a[12:15], v3 offset:19456
  v_mfma_f32_16x16x32_bf16 v[36:39], a[32:35], a[128:131], 0
  buffer_store_dwordx4 v[160:163], v0, s[8:11], s37 offen offset:0 sc1
  v_mov_b32 v141, 0
  v_mfma_f32_16x16x32_bf16 v[36:39], a[36:39], a[132:135], v[36:39]
  ds_read_b128 a[16:19], v3 offset:20480
  v_mov_b32_e64 v142, 0
  v_mfma_f32_16x16x32_bf16 v[36:39], a[40:43], a[136:139], v[36:39]
  v_mov_b32 v143, 0
  v_mov_b32 v148, 0
  v_mfma_f32_16x16x32_bf16 v[36:39], a[44:47], a[140:143], v[36:39]
  ds_read_b128 a[20:23], v3 offset:21504
  v_mov_b32_e64 v149, 0
  v_mfma_f32_16x16x32_bf16 v[36:39], a[48:51], a[144:147], v[36:39]
  buffer_store_dwordx4 v[168:171], v0, s[8:11], s37 offen offset:1024 sc1
  v_mov_b32_e64 v150, 0
  v_mfma_f32_16x16x32_bf16 v[36:39], a[52:55], a[148:151], v[36:39]
  ds_read_b128 a[24:27], v3 offset:22528
  v_mov_b32_e64 v151, 0
  v_mfma_f32_16x16x32_bf16 v[36:39], a[56:59], a[152:155], v[36:39]
  v_mov_b32 v156, 0
  v_mov_b32 v157, 0
  v_mfma_f32_16x16x32_bf16 v[36:39], a[60:63], a[156:159], v[36:39]
  ds_read_b128 a[28:31], v3 offset:23552
  v_mov_b32_e64 v158, 0
  v_mfma_f32_16x16x32_bf16 v[52:55], a[32:35], a[160:163], 0
  buffer_store_dwordx4 v[176:179], v0, s[8:11], s37 offen offset:2048 sc1
  v_mov_b32_e64 v159, 0
  v_mfma_f32_16x16x32_bf16 v[52:55], a[36:39], a[164:167], v[52:55]
  ds_read_b128 a[32:35], v3 offset:24576
  v_mov_b32_e64 v164, 0
  v_mfma_f32_16x16x32_bf16 v[52:55], a[40:43], a[168:171], v[52:55]
  v_mov_b32 v165, 0
  v_mov_b32 v166, 0
  v_mfma_f32_16x16x32_bf16 v[52:55], a[44:47], a[172:175], v[52:55]
  ds_read_b128 a[36:39], v3 offset:25600
  v_mov_b32_e64 v167, 0
  v_mfma_f32_16x16x32_bf16 v[52:55], a[48:51], a[176:179], v[52:55]
  buffer_store_dwordx4 v[184:187], v0, s[8:11], s37 offen offset:3072 sc1
  s_add_u32 s37, s37, 4096
  v_mfma_f32_16x16x32_bf16 v[52:55], a[52:55], a[180:183], v[52:55]
  ds_read_b128 a[40:43], v3 offset:26624
  v_mov_b32_e64 v172, 0
  v_mfma_f32_16x16x32_bf16 v[52:55], a[56:59], a[184:187], v[52:55]
  v_mov_b32 v173, 0
  v_mov_b32 v174, 0
  v_mfma_f32_16x16x32_bf16 v[52:55], a[60:63], a[188:191], v[52:55]
  s_waitcnt lgkmcnt(3)
  ds_read_b128 a[44:47], v3 offset:27648
  v_mfma_f32_16x16x32_bf16 v[40:43], a[0:3], a[128:131], 0
  buffer_store_dwordx4 v[192:195], v0, s[8:11], s37 offen offset:0 sc1
  v_mov_b32 v175, 0
  v_mfma_f32_16x16x32_bf16 v[40:43], a[4:7], a[132:135], v[40:43]
  ds_read_b128 a[48:51], v3 offset:28672
  v_mov_b32_e64 v180, 0
  v_mfma_f32_16x16x32_bf16 v[40:43], a[8:11], a[136:139], v[40:43]
  v_mov_b32 v181, 0
  v_mov_b32 v182, 0
  v_mfma_f32_16x16x32_bf16 v[40:43], a[12:15], a[140:143], v[40:43]
  ds_read_b128 a[52:55], v3 offset:29696
  buffer_store_dwordx4 v[200:203], v0, s[8:11], s37 offen offset:1024 sc1
  v_mfma_f32_16x16x32_bf16 v[40:43], a[16:19], a[144:147], v[40:43]
  v_mov_b32 v183, 0
  v_mov_b32 v188, 0
  v_mfma_f32_16x16x32_bf16 v[40:43], a[20:23], a[148:151], v[40:43]
  ds_read_b128 a[56:59], v3 offset:30720
  v_mov_b32_e64 v189, 0
  v_mfma_f32_16x16x32_bf16 v[40:43], a[24:27], a[152:155], v[40:43]
  v_mov_b32 v190, 0
  v_mov_b32 v191, 0
  v_mfma_f32_16x16x32_bf16 v[40:43], a[28:31], a[156:159], v[40:43]
  ds_read_b128 a[60:63], v3 offset:31744
  buffer_store_dwordx4 v[208:211], v0, s[8:11], s37 offen offset:2048 sc1
  v_mfma_f32_16x16x32_bf16 v[56:59], a[0:3], a[160:163], 0
  v_mov_b32 v196, 0
  v_mov_b32 v197, 0
  v_mfma_f32_16x16x32_bf16 v[56:59], a[4:7], a[164:167], v[56:59]
  v_mov_b32 v198, 0
  v_mov_b32 v199, 0
  v_mfma_f32_16x16x32_bf16 v[56:59], a[8:11], a[168:171], v[56:59]
  v_mov_b32 v204, 0
  v_mov_b32 v205, 0
  v_mfma_f32_16x16x32_bf16 v[56:59], a[12:15], a[172:175], v[56:59]
  buffer_store_dwordx4 v[216:219], v0, s[8:11], s37 offen offset:3072 sc1
  s_add_u32 s37, s37, 4096
  v_mfma_f32_16x16x32_bf16 v[56:59], a[16:19], a[176:179], v[56:59]
  v_mov_b32 v206, 0
  v_mov_b32 v207, 0
  v_mfma_f32_16x16x32_bf16 v[56:59], a[20:23], a[180:183], v[56:59]
  v_mov_b32 v212, 0
  v_mov_b32 v213, 0
  v_mfma_f32_16x16x32_bf16 v[56:59], a[24:27], a[184:187], v[56:59]
  buffer_store_dwordx4 v[224:227], v0, s[8:11], s37 offen offset:0 sc1
  v_mov_b32_e64 v214, 0
  v_mfma_f32_16x16x32_bf16 v[56:59], a[28:31], a[188:191], v[56:59]
  s_waitcnt lgkmcnt(0)
  v_mov_b32 v215, 0
  v_mfma_f32_16x16x32_bf16 v[44:47], a[32:35], a[128:131], 0
  v_mov_b32 v220, 0
  v_mov_b32 v221, 0
  v_mfma_f32_16x16x32_bf16 v[44:47], a[36:39], a[132:135], v[44:47]
  v_mov_b32 v222, 0
  v_mov_b32 v223, 0
  v_mfma_f32_16x16x32_bf16 v[44:47], a[40:43], a[136:139], v[44:47]
  buffer_store_dwordx4 v[232:235], v0, s[8:11], s37 offen offset:1024 sc1
  v_mov_b32_e64 v228, 0
  v_mfma_f32_16x16x32_bf16 v[44:47], a[44:47], a[140:143], v[44:47]
  v_mov_b32 v229, 0
  v_mov_b32 v230, 0
  v_mfma_f32_16x16x32_bf16 v[44:47], a[48:51], a[144:147], v[44:47]
  v_mov_b32 v231, 0
  v_mov_b32 v236, 0
  v_mfma_f32_16x16x32_bf16 v[44:47], a[52:55], a[148:151], v[44:47]
  v_mov_b32 v237, 0
  v_mov_b32 v238, 0
  v_mfma_f32_16x16x32_bf16 v[44:47], a[56:59], a[152:155], v[44:47]
  buffer_store_dwordx4 v[240:243], v0, s[8:11], s37 offen offset:2048 sc1
  v_mov_b32_e64 v239, 0
  v_mfma_f32_16x16x32_bf16 v[44:47], a[60:63], a[156:159], v[44:47]
  v_mov_b32 v244, 0
  v_mov_b32 v245, 0
  v_mfma_f32_16x16x32_bf16 v[60:63], a[32:35], a[160:163], 0
  v_mov_b32 v246, 0
  v_mov_b32 v247, 0
  v_mfma_f32_16x16x32_bf16 v[60:63], a[36:39], a[164:167], v[60:63]
  v_mov_b32 v252, 0
  v_mov_b32 v253, 0
  v_mfma_f32_16x16x32_bf16 v[60:63], a[40:43], a[168:171], v[60:63]
  buffer_store_dwordx4 v[248:251], v0, s[8:11], s37 offen offset:3072 sc1
  s_add_u32 s37, s37, 4096
  v_mfma_f32_16x16x32_bf16 v[60:63], a[44:47], a[172:175], v[60:63]
  v_mov_b32 v254, 0
  v_mov_b32 v255, 0
  v_mfma_f32_16x16x32_bf16 v[60:63], a[48:51], a[176:179], v[60:63]
  v_mfma_f32_16x16x32_bf16 v[60:63], a[52:55], a[180:183], v[60:63]
  v_mfma_f32_16x16x32_bf16 v[60:63], a[56:59], a[184:187], v[60:63]
  v_mfma_f32_16x16x32_bf16 v[60:63], a[60:63], a[188:191], v[60:63]
  s_cmp_le_u32 s55, s56
  v_mov_b64 v[128:129], 0
  v_mov_b64 v[130:131], 0
  v_mov_b64 v[136:137], 0
  v_mov_b64 v[138:139], 0
  v_mov_b64 v[144:145], 0
  v_mov_b64 v[146:147], 0
  v_mov_b64 v[152:153], 0
  v_mov_b64 v[154:155], 0
  v_mov_b64 v[160:161], 0
  v_mov_b64 v[162:163], 0
  v_mov_b64 v[168:169], 0
  v_mov_b64 v[170:171], 0
  v_mov_b64 v[176:177], 0
  v_mov_b64 v[178:179], 0
  v_mov_b64 v[184:185], 0
  v_mov_b64 v[186:187], 0
  v_mov_b64 v[192:193], 0
  v_mov_b64 v[194:195], 0
  v_mov_b64 v[200:201], 0
  v_mov_b64 v[202:203], 0
  v_mov_b64 v[208:209], 0
  v_mov_b64 v[210:211], 0
  v_mov_b64 v[216:217], 0
  v_mov_b64 v[218:219], 0
  v_mov_b64 v[224:225], 0
  v_mov_b64 v[226:227], 0
  v_mov_b64 v[232:233], 0
  v_mov_b64 v[234:235], 0
  v_mov_b64 v[240:241], 0
  v_mov_b64 v[242:243], 0
  v_mov_b64 v[248:249], 0
  v_mov_b64 v[250:251], 0
  s_cbranch_scc1 L_k2_jmask
L_k2_jmaskret:
  s_add_u32 m0, s53, 0
  s_nop 0
  buffer_load_dwordx4 v1, s[8:11], s48 offen offset:0 sc1 lds
  v_max3_f32 v24, v32, v33, v34
  v_max3_f32 v26, v48, v49, v50
  v_max3_f32 v24, v24, v35, v36
  v_max3_f32 v26, v26, v51, v52
  v_max3_f32 v24, v24, v37, v38
  v_max3_f32 v26, v26, v53, v54
  v_max3_f32 v24, v24, v39, v40
  v_max3_f32 v26, v26, v55, v56
  v_max3_f32 v24, v24, v41, v42
  v_max3_f32 v26, v26, v57, v58
  v_max3_f32 v24, v24, v43, v44
  v_max3_f32 v26, v26, v59, v60
  buffer_load_dwordx4 v1, s[8:11], s48 offen offset:1024 sc1 lds
  v_max3_f32 v24, v24, v45, v46
  v_max3_f32 v26, v26, v61, v62
  v_max_f32 v24, v24, v47
  v_max_f32 v26, v26, v63
  v_mov_b32 v25, v24
  v_mov_b32 v27, v26
  s_nop 0
  v_permlane16_swap_b32 v24, v25
  v_permlane16_swap_b32 v26, v27
  v_max_f32 v24, v24, v25
  v_max_f32 v26, v26, v27
  v_mov_b32 v25, v24
  buffer_load_dwordx4 v1, s[8:11], s48 offen offset:2048 sc1 lds
  v_mov_b32 v27, v26
  s_nop 0
  v_permlane32_swap_b32 v24, v25
  v_permlane32_swap_b32 v26, v27
  v_max_f32 v24, v24, v25
  v_max_f32 v26, v26, v27
  v_sub_f32 v24, 0xc1800000, v24
  v_sub_f32 v26, 0xc1800000, v26
  v_mov_b32 v25, v24
  v_mov_b32 v27, v26
  v_mov_b32 v6, v24
  v_mov_b32 v7, v26
  buffer_load_dwordx4 v1, s[8:11], s48 offen offset:3072 sc1 lds
  v_pk_add_f32 v[16:17], v[32:33], v[24:25]
  v_pk_add_f32 v[18:19], v[34:35], v[24:25]
  v_pk_add_f32 v[20:21], v[36:37], v[24:25]
  v_pk_add_f32 v[22:23], v[38:39], v[24:25]
  v_exp_f32 v16, v16
  v_exp_f32 v17, v17
  v_exp_f32 v18, v18
  v_exp_f32 v19, v19
  v_exp_f32 v20, v20
  v_exp_f32 v21, v21
  v_exp_f32 v22, v22
  v_exp_f32 v23, v23
  s_add_u32 m0, s53, 4096
  s_nop 0
  buffer_load_dwordx4 v2, s[8:11], s48 offen offset:0 sc1 lds
  v_cvt_pk_bf16_f32 v96, v16, v17
  v_cvt_pk_bf16_f32 v97, v18, v19
  v_cvt_pk_bf16_f32 v98, v20, v21
  v_cvt_pk_bf16_f32 v99, v22, v23
  v_pk_add_f32 v[16:17], v[40:41], v[24:25]
  v_pk_add_f32 v[18:19], v[42:43], v[24:25]
  v_pk_add_f32 v[20:21], v[44:45], v[24:25]
  v_pk_add_f32 v[22:23], v[46:47], v[24:25]
  v_exp_f32 v16, v16
  v_exp_f32 v17, v17
  v_exp_f32 v18, v18
  v_exp_f32_e64 v19, v19
  buffer_load_dwordx4 v2, s[8:11], s48 offen offset:1024 sc1 lds
  v_exp_f32 v20, v20
  v_exp_f32 v21, v21
  v_exp_f32 v22, v22
  v_exp_f32 v23, v23
  v_cvt_pk_bf16_f32 v100, v16, v17
  v_cvt_pk_bf16_f32 v101, v18, v19
  v_cvt_pk_bf16_f32 v102, v20, v21
  v_cvt_pk_bf16_f32 v103, v22, v23
  v_pk_add_f32 v[16:17], v[48:49], v[26:27]
  v_pk_add_f32 v[18:19], v[50:51], v[26:27]
  v_pk_add_f32 v[20:21], v[52:53], v[26:27]
  v_pk_add_f32 v[22:23], v[54:55], v[26:27]
  buffer_load_dwordx4 v2, s[8:11], s48 offen offset:2048 sc1 lds
  v_exp_f32 v16, v16
  v_exp_f32 v17, v17
  v_exp_f32 v18, v18
  v_exp_f32 v19, v19
  v_exp_f32 v20, v20
  v_exp_f32 v21, v21
  v_exp_f32 v22, v22
  v_exp_f32 v23, v23
  v_cvt_pk_bf16_f32 v104, v16, v17
  v_cvt_pk_bf16_f32 v105, v18, v19
  v_cvt_pk_bf16_f32 v106, v20, v21
  v_cvt_pk_bf16_f32 v107, v22, v23
  buffer_load_dwordx4 v2, s[8:11], s48 offen offset:3072 sc1 lds
  v_pk_add_f32 v[16:17], v[56:57], v[26:27]
  v_pk_add_f32 v[18:19], v[58:59], v[26:27]
  v_pk_add_f32 v[20:21], v[60:61], v[26:27]
  v_pk_add_f32 v[22:23], v[62:63], v[26:27]
  v_exp_f32 v16, v16
  v_exp_f32 v17, v17
  v_exp_f32 v18, v18
  v_exp_f32 v19, v19
  v_exp_f32 v20, v20
  v_exp_f32 v21, v21
  v_exp_f32 v22, v22
  v_exp_f32 v23, v23
  s_add_u32 s53, s53, 32768
  s_cmp_ge_u32 s53, 98304
  s_cselect_b32 s53, s21, s53
  v_cvt_pk_bf16_f32 v108, v16, v17
  v_cvt_pk_bf16_f32 v109, v18, v19
  v_cvt_pk_bf16_f32 v110, v20, v21
  v_cvt_pk_bf16_f32 v111, v22, v23
  v_mov_b64 v[64:65], v[24:25]
  v_mov_b64 v[66:67], v[24:25]
  v_mov_b64 v[68:69], v[24:25]
  v_mov_b64 v[70:71], v[24:25]
  v_mov_b64 v[72:73], v[24:25]
  v_mov_b64 v[74:75], v[24:25]
  v_mov_b64 v[76:77], v[24:25]
  v_mov_b64 v[78:79], v[24:25]
  v_mov_b64 v[80:81], v[26:27]
  v_mov_b64 v[82:83], v[26:27]
  v_mov_b64 v[84:85], v[26:27]
  v_mov_b64 v[86:87], v[26:27]
  v_mov_b64 v[88:89], v[26:27]
  v_mov_b64 v[90:91], v[26:27]
  v_mov_b64 v[92:93], v[26:27]
  v_mov_b64 v[94:95], v[26:27]
  s_add_u32 s52, s31, 16777216
  s_mov_b32 s31, s48
  s_add_u32 s48, s48, s40
  s_cmp_eq_u32 s48, s49
  s_cselect_b32 s40, s63, s40
  s_cselect_b32 s48, s50, s48
  s_cselect_b32 s49, s51, s49
  s_cselect_b32 s50, 2147483648, s50
  s_add_u32 s36, s36, 32768
  s_cmp_eq_u32 s36, 98304
  s_cselect_b32 s36, 0, s36
  v_add_u32_e64 v3, s36, v0
  s_waitcnt vmcnt(8) lgkmcnt(0)
  s_barrier
  ds_read_b128 a[0:3], v3 offset:0
  ds_read_b128 a[4:7], v3 offset:1024
  ds_read_b128 a[8:11], v3 offset:2048
  ds_read_b128 a[12:15], v3 offset:3072
  ds_read_b128 a[16:19], v3 offset:4096
  ds_read_b128 a[20:23], v3 offset:5120
  ds_read_b128 a[24:27], v3 offset:6144
  ds_read_b128 a[28:31], v3 offset:7168
  s_cmp_eq_u32 s16, 0
  s_cbranch_scc0 L_k2_pub
L_k2_pubret:
  s_sub_u32 s55, s55, 1
  s_add_u32 s57, s57, 1
  s_cmp_le_u32 s55, s56
  s_waitcnt lgkmcnt(0)
  s_cbranch_scc1 L_k2_spec0
  s_branch L_k2_loop0
L_k2_last1:
  v_mov_b64 v[96:97], v[112:113]
  v_mov_b64 v[98:99], v[114:115]
  v_mov_b64 v[100:101], v[116:117]
  v_mov_b64 v[102:103], v[118:119]
  v_mov_b64 v[104:105], v[120:121]
  v_mov_b64 v[106:107], v[122:123]
  v_mov_b64 v[108:109], v[124:125]
  v_mov_b64 v[110:111], v[126:127]
L_k2_last0:
  ds_read_b128 a[32:35], v3 offset:8192
  ds_read_b128 a[36:39], v3 offset:9216
  ds_read_b128 a[40:43], v3 offset:10240
  ds_read_b128 a[44:47], v3 offset:11264
  ds_read_b128 a[48:51], v3 offset:12288
  ds_read_b128 a[52:55], v3 offset:13312
  ds_read_b128 a[56:59], v3 offset:14336
  ds_read_b128 a[60:63], v3 offset:15360
  s_cmp_eq_u32 s59, 2
  s_cbranch_scc0 L_k2_lastm0
L_k2_lastm1:
  buffer_load_dwordx4 v[12:15], v0, s[8:11], s30 offen sc1
  s_add_u32 m0, s54, 0
  s_nop 0
  buffer_load_dwordx4 v1, s[8:11], s52 offen offset:0 sc1 lds
  s_lshl_b32 s3, s57, 6
  v_mov_b32 v26, 0xf149f2ca
  v_subrev_u32 v25, s3, v9
  v_cmp_le_i32 s[22:23], 0, v25
  v_cmp_le_i32 s[24:25], 1, v25
  v_cmp_le_i32 s[26:27], 2, v25
  buffer_load_dwordx4 v1, s[8:11], s52 offen offset:1024 sc1 lds
  v_cmp_le_i32 s[28:29], 3, v25
  v_cndmask_b32 v80, v26, v7, s[22:23]
  v_cndmask_b32 v81, v26, v7, s[24:25]
  v_cndmask_b32 v82, v26, v7, s[26:27]
  v_cndmask_b32 v83, v26, v7, s[28:29]
  s_nop 1
  v_mfma_f32_16x16x32_bf16 v[48:51], a[0:3], a[160:163], v[80:83]
  v_cmp_le_i32 s[22:23], 16, v25
  v_cmp_le_i32 s[24:25], 17, v25
  ds_read_b128 a[128:131], v3 offset:16384
  v_mfma_f32_16x16x32_bf16 v[48:51], a[4:7], a[164:167], v[48:51]
  v_cmp_le_i32 s[26:27], 18, v25
  ds_read_b128 a[132:135], v3 offset:17408
  buffer_load_dwordx4 v1, s[8:11], s52 offen offset:2048 sc1 lds
  v_mfma_f32_16x16x32_bf16 v[48:51], a[8:11], a[168:171], v[48:51]
  v_cmp_le_i32 s[28:29], 19, v25
  ds_read_b128 a[136:139], v3 offset:18432
  v_mfma_f32_16x16x32_bf16 v[48:51], a[12:15], a[172:175], v[48:51]
  v_cndmask_b32 v84, v26, v7, s[22:23]
  v_cndmask_b32 v85, v26, v7, s[24:25]
  ds_read_b128 a[140:143], v3 offset:19456
  v_mfma_f32_16x16x32_bf16 v[48:51], a[16:19], a[176:179], v[48:51]
  v_cndmask_b32 v86, v26, v7, s[26:27]
  ds_read_b128 a[144:147], v3 offset:20480
  v_mfma_f32_16x16x32_bf16 v[48:51], a[20:23], a[180:183], v[48:51]
  v_cndmask_b32 v87, v26, v7, s[28:29]
  ds_read_b128 a[148:151], v3 offset:21504
  buffer_load_dwordx4 v1, s[8:11], s52 offen offset:3072 sc1 lds
  v_mfma_f32_16x16x32_bf16 v[48:51], a[24:27], a[184:187], v[48:51]
  s_nop 0
  ds_read_b128 a[152:155], v3 offset:22528
  v_mfma_f32_16x16x32_bf16 v[48:51], a[28:31], a[188:191], v[48:51]
  s_waitcnt lgkmcnt(7)
  ds_read_b128 a[156:159], v3 offset:23552
  v_mfma_f32_16x16x32_bf16 v[52:55], a[32:35], a[160:163], v[84:87]
  v_cmp_le_i32 s[22:23], 32, v25
  v_cmp_le_i32 s[24:25], 33, v25
  ds_read_b128 a[216:219], v3 offset:24576
  v_mfma_f32_16x16x32_bf16 v[52:55], a[36:39], a[164:167], v[52:55]
  v_cmp_le_i32 s[26:27], 34, v25
  ds_read_b128 a[220:223], v3 offset:25600
  s_add_u32 m0, s54, 4096
  v_mfma_f32_16x16x32_bf16 v[52:55], a[40:43], a[168:171], v[52:55]
  v_cmp_le_i32 s[28:29], 35, v25
  ds_read_b128 a[224:227], v3 offset:26624
  buffer_load_dwordx4 v2, s[8:11], s52 offen offset:0 sc1 lds
  v_mfma_f32_16x16x32_bf16 v[52:55], a[44:47], a[172:175], v[52:55]
  v_cndmask_b32 v88, v26, v7, s[22:23]
  v_cndmask_b32 v89, v26, v7, s[24:25]
  ds_read_b128 a[228:231], v3 offset:27648
  v_mfma_f32_16x16x32_bf16 v[52:55], a[48:51], a[176:179], v[52:55]
  v_cndmask_b32 v90, v26, v7, s[26:27]
  ds_read_b128 a[232:235], v3 offset:28672
  v_mfma_f32_16x16x32_bf16 v[52:55], a[52:55], a[180:183], v[52:55]
  v_cndmask_b32 v91, v26, v7, s[28:29]
  ds_read_b128 a[236:239], v3 offset:29696
  v_mfma_f32_16x16x32_bf16 v[52:55], a[56:59], a[184:187], v[52:55]
  ds_read_b128 a[240:243], v3 offset:30720
  buffer_load_dwordx4 v2, s[8:11], s52 offen offset:1024 sc1 lds
  v_mfma_f32_16x16x32_bf16 v[52:55], a[60:63], a[188:191], v[52:55]
  s_waitcnt lgkmcnt(7)
  ds_read_b128 a[244:247], v3 offset:31744
  v_mfma_f32_16x16x32_bf16 v[56:59], a[128:131], a[160:163], v[88:91]
  v_cmp_le_i32 s[22:23], 48, v25
  v_cmp_le_i32 s[24:25], 49, v25
  ds_read_b128 a[64:67], v4 offset:0
  v_mfma_f32_16x16x32_bf16 v[56:59], a[132:135], a[164:167], v[56:59]
  v_cmp_le_i32 s[26:27], 50, v25
  ds_read_b128 a[68:71], v4 offset:16384
  v_mfma_f32_16x16x32_bf16 v[56:59], a[136:139], a[168:171], v[56:59]
  v_cmp_le_i32 s[28:29], 51, v25
  ds_read_b128 a[72:75], v4 offset:1024
  buffer_load_dwordx4 v2, s[8:11], s52 offen offset:2048 sc1 lds
  v_mfma_f32_16x16x32_bf16 v[56:59], a[140:143], a[172:175], v[56:59]
  v_cndmask_b32 v92, v26, v7, s[22:23]
  v_cndmask_b32 v93, v26, v7, s[24:25]
  ds_read_b128 a[76:79], v4 offset:17408
  v_mfma_f32_16x16x32_bf16 v[56:59], a[144:147], a[176:179], v[56:59]
  v_cndmask_b32 v94, v26, v7, s[26:27]
  ds_read_b128 a[80:83], v4 offset:2048
  v_mfma_f32_16x16x32_bf16 v[56:59], a[148:151], a[180:183], v[56:59]
  v_cndmask_b32 v95, v26, v7, s[28:29]
  ds_read_b128 a[84:87], v4 offset:18432
  v_mfma_f32_16x16x32_bf16 v[56:59], a[152:155], a[184:187], v[56:59]
  ds_read_b128 a[88:91], v4 offset:3072
  buffer_load_dwordx4 v2, s[8:11], s52 offen offset:3072 sc1 lds
  v_mfma_f32_16x16x32_bf16 v[56:59], a[156:159], a[188:191], v[56:59]
  s_waitcnt lgkmcnt(7)
  ds_read_b128 a[92:95], v4 offset:19456
  v_mfma_f32_16x16x32_bf16 v[60:63], a[216:219], a[160:163], v[92:95]
  ds_read_b128 a[96:99], v4 offset:4096
  v_accvgpr_read_b32 v112, a204
  v_mfma_f32_16x16x32_bf16 v[60:63], a[220:223], a[164:167], v[60:63]
  ds_read_b128 a[100:103], v4 offset:20480
  s_xor_b32 s54, s54, 0x38000
  v_accvgpr_read_b32 v113, a205
  v_mfma_f32_16x16x32_bf16 v[60:63], a[224:227], a[168:171], v[60:63]
  ds_read_b128 a[104:107], v4 offset:5120
  v_accvgpr_read_b32 v114, a206
  v_mfma_f32_16x16x32_bf16 v[60:63], a[228:231], a[172:175], v[60:63]
  ds_read_b128 a[108:111], v4 offset:21504
  v_accvgpr_read_b32 v115, a207
  v_mfma_f32_16x16x32_bf16 v[60:63], a[232:235], a[176:179], v[60:63]
  s_nop 0
  ds_read_b128 a[112:115], v4 offset:6144
  v_mfma_f32_16x16x32_bf16 v[60:63], a[236:239], a[180:183], v[60:63]
  ds_read_b128 a[116:119], v4 offset:22528
  v_mfma_f32_16x16x32_bf16 v[60:63], a[240:243], a[184:187], v[60:63]
  ds_read_b128 a[120:123], v4 offset:7168
  v_mfma_f32_16x16x32_bf16 v[60:63], a[244:247], a[188:191], v[60:63]
  ds_read_b128 a[124:127], v4 offset:23552
  v_mfma_f32_16x16x32_bf16 a[192:195], a[200:203], v[96:99], a[192:195]
  v_mfma_f32_16x16x32_bf16 a[192:195], a[200:203], v[100:103], a[192:195]
  v_exp_f32_e64 v16, v48
  v_mfma_f32_16x16x32_bf16 a[196:199], a[200:203], v[104:107], a[196:199]
  v_mfma_f32_16x16x32_bf16 a[196:199], a[200:203], v[108:111], a[196:199]
  s_waitcnt lgkmcnt(8)
  s_nop 0
  v_mfma_f32_16x16x32_bf16 v[128:131], a[64:67], v[96:99], v[128:131]
  v_exp_f32_e64 v17, v49
  v_mfma_f32_16x16x32_bf16 v[128:131], a[68:71], v[100:103], v[128:131]
  s_waitcnt vmcnt(8)
  v_min_u32 v28, v13, v15
  v_mfma_f32_16x16x32_bf16 v[192:195], a[68:71], v[108:111], v[192:195]
  v_cmp_eq_u32 vcc, 0, v28
  ds_read_b128 a[68:71], v4 offset:24576
  v_mfma_f32_16x16x32_bf16 v[192:195], a[64:67], v[104:107], v[192:195]
  v_exp_f32 v18, v50
  v_mfma_f32_16x16x32_bf16 v[196:199], a[72:75], v[104:107], v[196:199]
  s_cbranch_vccnz L_k2_spin
L_k2_spinret:
  ds_read_b128 a[64:67], v4 offset:8192
  v_mfma_f32_16x16x32_bf16 v[196:199], a[76:79], v[108:111], v[196:199]
  s_nop 0
  v_cvt_pk_bf16_f32 v120, v16, v17
  v_mfma_f32_16x16x32_bf16 v[132:135], a[76:79], v[100:103], v[132:135]
  v_exp_f32_e64 v19, v51
  buffer_load_dwordx4 v[32:35], v0, s[8:11], s62 offen offset:0 sc1
  v_mfma_f32_16x16x32_bf16 v[132:135], a[72:75], v[96:99], v[132:135]
  ds_read_b128 a[76:79], v4 offset:25600
  ds_read_b128 a[72:75], v4 offset:9216
  v_mfma_f32_16x16x32_bf16 v[136:139], a[80:83], v[96:99], v[136:139]
  v_cvt_pk_bf16_f32 v121, v18, v19
  v_mfma_f32_16x16x32_bf16 v[136:139], a[84:87], v[100:103], v[136:139]
  v_exp_f32_e64 v20, v52
  v_mfma_f32_16x16x32_bf16 v[200:203], a[84:87], v[108:111], v[200:203]
  ds_read_b128 a[84:87], v4 offset:26624
  buffer_load_dwordx4 v[36:39], v0, s[8:11], s62 offen offset:1024 sc1
  v_mfma_f32_16x16x32_bf16 v[200:203], a[80:83], v[104:107], v[200:203]
  ds_read_b128 a[80:83], v4 offset:10240
  v_mfma_f32_16x16x32_bf16 v[204:207], a[88:91], v[104:107], v[204:207]
  v_exp_f32_e64 v21, v53
  v_mfma_f32_16x16x32_bf16 v[204:207], a[92:95], v[108:111], v[204:207]
  v_cvt_pk_bf16_f32 v122, v20, v21
  v_mfma_f32_16x16x32_bf16 v[140:143], a[92:95], v[100:103], v[140:143]
  ds_read_b128 a[92:95], v4 offset:27648
  buffer_load_dwordx4 v[40:43], v0, s[8:11], s62 offen offset:2048 sc1
  v_mfma_f32_16x16x32_bf16 v[140:143], a[88:91], v[96:99], v[140:143]
  s_waitcnt lgkmcnt(7)
  ds_read_b128 a[88:91], v4 offset:11264
  v_mfma_f32_16x16x32_bf16 v[144:147], a[96:99], v[96:99], v[144:147]
  v_exp_f32 v22, v54
  v_mfma_f32_16x16x32_bf16 v[144:147], a[100:103], v[100:103], v[144:147]
  v_mfma_f32_16x16x32_bf16 v[208:211], a[100:103], v[108:111], v[208:211]
  ds_read_b128 a[100:103], v4 offset:28672
  buffer_load_dwordx4 v[44:47], v0, s[8:11], s62 offen offset:3072 sc1
  v_mfma_f32_16x16x32_bf16 v[208:211], a[96:99], v[104:107], v[208:211]
  v_exp_f32_e64 v23, v55
  v_mfma_f32_16x16x32_bf16 v[212:215], a[104:107], v[104:107], v[212:215]
  ds_read_b128 a[96:99], v4 offset:12288
  v_cvt_pk_bf16_f32 v123, v22, v23
  v_mfma_f32_16x16x32_bf16 v[212:215], a[108:111], v[108:111], v[212:215]
  s_add_u32 s62, s62, 4096
  v_mfma_f32_16x16x32_bf16 v[148:151], a[108:111], v[100:103], v[148:151]
  v_exp_f32_e64 v16, v56
  buffer_load_dwordx4 v[64:67], v0, s[8:11], s62 offen offset:0 sc1
  v_mfma_f32_16x16x32_bf16 v[148:151], a[104:107], v[96:99], v[148:151]
  ds_read_b128 a[108:111], v4 offset:29696
  ds_read_b128 a[104:107], v4 offset:13312
  v_mfma_f32_16x16x32_bf16 v[152:155], a[112:115], v[96:99], v[152:155]
  v_accvgpr_read_b32 v116, a208
  v_mfma_f32_16x16x32_bf16 v[152:155], a[116:119], v[100:103], v[152:155]
  v_exp_f32_e64 v17, v57
  v_mfma_f32_16x16x32_bf16 v[216:219], a[116:119], v[108:111], v[216:219]
  ds_read_b128 a[116:119], v4 offset:30720
  v_cvt_pk_bf16_f32 v124, v16, v17
  buffer_load_dwordx4 v[68:71], v0, s[8:11], s62 offen offset:1024 sc1
  v_mfma_f32_16x16x32_bf16 v[216:219], a[112:115], v[104:107], v[216:219]
  ds_read_b128 a[112:115], v4 offset:14336
  v_accvgpr_read_b32 v117, a209
  v_mfma_f32_16x16x32_bf16 v[220:223], a[120:123], v[104:107], v[220:223]
  v_exp_f32_e64 v18, v58
  v_mfma_f32_16x16x32_bf16 v[220:223], a[124:127], v[108:111], v[220:223]
  v_accvgpr_read_b32 v118, a210
  v_mfma_f32_16x16x32_bf16 v[156:159], a[124:127], v[100:103], v[156:159]
  ds_read_b128 a[124:127], v4 offset:31744
  buffer_load_dwordx4 v[72:75], v0, s[8:11], s62 offen offset:2048 sc1
  v_mfma_f32_16x16x32_bf16 v[156:159], a[120:123], v[96:99], v[156:159]
  s_waitcnt lgkmcnt(11)
  ds_read_b128 a[120:123], v4 offset:15360
  v_mfma_f32_16x16x32_bf16 v[160:163], a[64:67], v[96:99], v[160:163]
  v_exp_f32 v19, v59
  v_mfma_f32_16x16x32_bf16 v[160:163], a[68:71], v[100:103], v[160:163]
  v_cvt_pk_bf16_f32 v125, v18, v19
  v_accvgpr_read_b32 v119, a211
  v_mfma_f32_16x16x32_bf16 v[224:227], a[68:71], v[108:111], v[224:227]
  buffer_load_dwordx4 v[76:79], v0, s[8:11], s62 offen offset:3072 sc1
  s_mul_i32 s5, s45, 1835008
  v_mfma_f32_16x16x32_bf16 v[224:227], a[64:67], v[104:107], v[224:227]
  v_exp_f32_e64 v20, v60
  v_mfma_f32_16x16x32_bf16 v[228:231], a[72:75], v[104:107], v[228:231]
  s_lshl_b32 s4, s58, 2
  s_add_u32 s4, s4, s44
  v_mfma_f32_16x16x32_bf16 v[228:231], a[76:79], v[108:111], v[228:231]
  s_add_u32 s62, s62, 4096
  v_mfma_f32_16x16x32_bf16 v[164:167], a[76:79], v[100:103], v[164:167]
  v_exp_f32_e64 v21, v61
  buffer_load_dwordx4 v[80:83], v0, s[8:11], s62 offen offset:0 sc1
  v_mfma_f32_16x16x32_bf16 v[164:167], a[72:75], v[96:99], v[164:167]
  s_waitcnt lgkmcnt(8)
  v_cvt_pk_bf16_f32 v126, v20, v21
  v_mfma_f32_16x16x32_bf16 v[168:171], a[80:83], v[96:99], v[168:171]
  s_mul_i32 s4, s4, 28672
  s_add_u32 s5, s5, s4
  v_mfma_f32_16x16x32_bf16 v[168:171], a[84:87], v[100:103], v[168:171]
  v_exp_f32_e64 v22, v62
  v_mfma_f32_16x16x32_bf16 v[232:235], a[84:87], v[108:111], v[232:235]
  v_xor_b32 v4, 0x38000, v4
  buffer_load_dwordx4 v[84:87], v0, s[8:11], s62 offen offset:1024 sc1
  v_mfma_f32_16x16x32_bf16 v[232:235], a[80:83], v[104:107], v[232:235]
  s_add_u32 s18, s5, 71303168
  v_mfma_f32_16x16x32_bf16 v[236:239], a[88:91], v[104:107], v[236:239]
  v_exp_f32_e64 v23, v63
  v_mfma_f32_16x16x32_bf16 v[236:239], a[92:95], v[108:111], v[236:239]
  v_cvt_pk_bf16_f32 v127, v22, v23
  v_mfma_f32_16x16x32_bf16 v[172:175], a[92:95], v[100:103], v[172:175]
  v_or3_b32 v10, v120, v121, v122
  buffer_load_dwordx4 v[88:91], v0, s[8:11], s62 offen offset:2048 sc1
  v_mfma_f32_16x16x32_bf16 v[172:175], a[88:91], v[96:99], v[172:175]
  s_waitcnt lgkmcnt(4)
  v_or3_b32 v10, v10, v123, v124
  v_mfma_f32_16x16x32_bf16 v[176:179], a[96:99], v[96:99], v[176:179]
  s_waitcnt vmcnt(11) lgkmcnt(0)
  s_barrier
  v_mfma_f32_16x16x32_bf16 v[176:179], a[100:103], v[100:103], v[176:179]
  ds_read_b128 a[64:67], v4 offset:0
  v_or3_b32 v10, v10, v125, v126
  v_mfma_f32_16x16x32_bf16 v[240:243], a[100:103], v[108:111], v[240:243]
  ds_read_b128 a[68:71], v4 offset:16384
  v_or_b32 v10, v10, v127
  buffer_load_dwordx4 v[92:95], v0, s[8:11], s62 offen offset:3072 sc1
  v_mfma_f32_16x16x32_bf16 v[240:243], a[96:99], v[104:107], v[240:243]
  ds_read_b128 a[72:75], v4 offset:1024
  v_and_b32 v10, 0x40004000, v10
  v_mfma_f32_16x16x32_bf16 v[244:247], a[104:107], v[104:107], v[244:247]
  ds_read_b128 a[76:79], v4 offset:17408
  v_cmp_ne_u32_e64 vcc, 0, v10
  v_mfma_f32_16x16x32_bf16 v[244:247], a[108:111], v[108:111], v[244:247]
  ds_read_b128 a[80:83], v4 offset:2048
  s_add_u32 s62, s62, 4096
  v_mfma_f32_16x16x32_bf16 v[180:183], a[108:111], v[100:103], v[180:183]
  ds_read_b128 a[84:87], v4 offset:18432
  v_mfma_f32_16x16x32_bf16 v[180:183], a[104:107], v[96:99], v[180:183]
  ds_read_b128 a[88:91], v4 offset:3072
  v_mfma_f32_16x16x32_bf16 v[184:187], a[112:115], v[96:99], v[184:187]
  ds_read_b128 a[92:95], v4 offset:19456
  v_mfma_f32_16x16x32_bf16 v[184:187], a[116:119], v[100:103], v[184:187]
  v_mfma_f32_16x16x32_bf16 v[248:251], a[116:119], v[108:111], v[248:251]
  v_mfma_f32_16x16x32_bf16 v[248:251], a[112:115], v[104:107], v[248:251]
  v_mfma_f32_16x16x32_bf16 v[252:255], a[120:123], v[104:107], v[252:255]
  v_mfma_f32_16x16x32_bf16 v[252:255], a[124:127], v[108:111], v[252:255]
  v_mfma_f32_16x16x32_bf16 v[188:191], a[124:127], v[100:103], v[188:191]
  v_mfma_f32_16x16x32_bf16 v[188:191], a[120:123], v[96:99], v[188:191]
  s_cbranch_vccnz L_k2_fixh
L_k2_fixhret1:
  ds_read_b128 a[96:99], v4 offset:4096
  ds_read_b128 a[100:103], v4 offset:20480
  ds_read_b128 a[104:107], v4 offset:5120
  ds_read_b128 a[108:111], v4 offset:21504
  ds_read_b128 a[112:115], v4 offset:6144
  ds_read_b128 a[116:119], v4 offset:22528
  ds_read_b128 a[120:123], v4 offset:7168
  ds_read_b128 a[124:127], v4 offset:23552
  v_mfma_f32_16x16x32_bf16 a[196:199], a[200:203], v[120:123], a[196:199]
  s_nop 0
  v_mfma_f32_16x16x32_bf16 a[196:199], a[200:203], v[124:127], a[196:199]
  s_waitcnt lgkmcnt(8)
  buffer_load_dwordx4 v[48:51], v0, s[8:11], s62 offen offset:0 sc1
  v_mfma_f32_16x16x32_bf16 v[192:195], a[64:67], v[120:123], v[192:195]
  s_nop 0
  ds_read_b128 a[64:67], v4 offset:8192
  v_mfma_f32_16x16x32_bf16 v[192:195], a[68:71], v[124:127], v[192:195]
  ds_read_b128 a[68:71], v4 offset:24576
  v_mfma_f32_16x16x32_bf16 v[196:199], a[72:75], v[120:123], v[196:199]
  ds_read_b128 a[72:75], v4 offset:9216
  v_mfma_f32_16x16x32_bf16 v[196:199], a[76:79], v[124:127], v[196:199]
  ds_read_b128 a[76:79], v4 offset:25600
  buffer_load_dwordx4 v[52:55], v0, s[8:11], s62 offen offset:1024 sc1
  v_mfma_f32_16x16x32_bf16 v[200:203], a[80:83], v[120:123], v[200:203]
  ds_read_b128 a[80:83], v4 offset:10240
  v_mfma_f32_16x16x32_bf16 v[200:203], a[84:87], v[124:127], v[200:203]
  ds_read_b128 a[84:87], v4 offset:26624
  v_mfma_f32_16x16x32_bf16 v[204:207], a[88:91], v[120:123], v[204:207]
  ds_read_b128 a[88:91], v4 offset:11264
  v_mfma_f32_16x16x32_bf16 v[204:207], a[92:95], v[124:127], v[204:207]
  s_waitcnt lgkmcnt(7)
  ds_read_b128 a[92:95], v4 offset:27648
  v_mfma_f32_16x16x32_bf16 v[208:211], a[96:99], v[120:123], v[208:211]
  ds_read_b128 a[96:99], v4 offset:12288
  buffer_load_dwordx4 v[56:59], v0, s[8:11], s62 offen offset:2048 sc1
  v_mfma_f32_16x16x32_bf16 v[208:211], a[100:103], v[124:127], v[208:211]
  s_nop 0
  ds_read_b128 a[100:103], v4 offset:28672
  v_mfma_f32_16x16x32_bf16 v[212:215], a[104:107], v[120:123], v[212:215]
  ds_read_b128 a[104:107], v4 offset:13312
  v_mfma_f32_16x16x32_bf16 v[212:215], a[108:111], v[124:127], v[212:215]
  ds_read_b128 a[108:111], v4 offset:29696
  v_mfma_f32_16x16x32_bf16 v[216:219], a[112:115], v[120:123], v[216:219]
  ds_read_b128 a[112:115], v4 offset:14336
  buffer_load_dwordx4 v[60:63], v0, s[8:11], s62 offen offset:3072 sc1
  v_mfma_f32_16x16x32_bf16 v[216:219], a[116:119], v[124:127], v[216:219]
  ds_read_b128 a[116:119], v4 offset:30720
  v_mfma_f32_16x16x32_bf16 v[220:223], a[120:123], v[120:123], v[220:223]
  ds_read_b128 a[120:123], v4 offset:15360
  v_mfma_f32_16x16x32_bf16 v[220:223], a[124:127], v[124:127], v[220:223]
  s_waitcnt lgkmcnt(11)
  ds_read_b128 a[124:127], v4 offset:31744
  v_mfma_f32_16x16x32_bf16 v[224:227], a[64:67], v[120:123], v[224:227]
  s_add_u32 s62, s62, 4096
  s_add_u32 m0, s21, 0
  v_mfma_f32_16x16x32_bf16 v[224:227], a[68:71], v[124:127], v[224:227]
  buffer_load_dwordx4 v112, s[12:15], s19 offen offset:0 lds
  v_mfma_f32_16x16x32_bf16 v[228:231], a[72:75], v[120:123], v[228:231]
  v_mfma_f32_16x16x32_bf16 v[228:231], a[76:79], v[124:127], v[228:231]
  s_waitcnt lgkmcnt(8)
  s_nop 0
  v_mfma_f32_16x16x32_bf16 v[232:235], a[80:83], v[120:123], v[232:235]
  v_mfma_f32_16x16x32_bf16 v[232:235], a[84:87], v[124:127], v[232:235]
  buffer_load_dwordx4 v113, s[12:15], s19 offen offset:1024 lds
  v_mfma_f32_16x16x32_bf16 v[236:239], a[88:91], v[120:123], v[236:239]
  v_mfma_f32_16x16x32_bf16 v[236:239], a[92:95], v[124:127], v[236:239]
  s_waitcnt lgkmcnt(4)
  s_nop 0
  v_mfma_f32_16x16x32_bf16 v[240:243], a[96:99], v[120:123], v[240:243]
  v_mfma_f32_16x16x32_bf16 v[240:243], a[100:103], v[124:127], v[240:243]
  buffer_load_dwordx4 v114, s[12:15], s19 offen offset:2048 lds
  v_mfma_f32_16x16x32_bf16 v[244:247], a[104:107], v[120:123], v[244:247]
  v_mfma_f32_16x16x32_bf16 v[244:247], a[108:111], v[124:127], v[244:247]
  s_waitcnt lgkmcnt(0)
  s_nop 0
  v_mfma_f32_16x16x32_bf16 v[248:251], a[112:115], v[120:123], v[248:251]
  v_mfma_f32_16x16x32_bf16 v[248:251], a[116:119], v[124:127], v[248:251]
  buffer_load_dwordx4 v115, s[12:15], s19 offen offset:3072 lds
  v_mfma_f32_16x16x32_bf16 v[252:255], a[120:123], v[120:123], v[252:255]
  v_mfma_f32_16x16x32_bf16 v[252:255], a[124:127], v[124:127], v[252:255]
  s_barrier
  s_add_u32 m0, s21, 4096
  s_nop 0
  buffer_load_dwordx4 v112, s[12:15], s20 offen offset:0 lds
  v_accvgpr_read_b32 v96, a192
  v_accvgpr_read_b32 v97, a196
  v_min_f32 v98, v6, v12
  v_min_f32 v99, v7, v14
  v_sub_f32 v100, v98, v6
  v_sub_f32 v101, v99, v7
  v_sub_f32 v102, v98, v12
  v_sub_f32 v103, v99, v14
  v_exp_f32 v100, v100
  v_exp_f32 v101, v101
  v_exp_f32 v102, v102
  v_exp_f32 v103, v103
  buffer_load_dwordx4 v113, s[12:15], s20 offen offset:1024 lds
  v_mul_f32 v96, v96, v100
  v_mul_f32 v97, v97, v101
  v_fmac_f32 v96, v13, v102
  v_fmac_f32 v97, v15, v103
  v_rcp_f32 v96, v96
  v_rcp_f32 v97, v97
  s_nop 0
  v_mul_f32 v24, v100, v96
  v_mul_f32 v25, v100, v96
  v_mul_f32 v12, v102, v96
  v_mul_f32 v13, v102, v96
  v_mul_f32 v26, v101, v97
  buffer_load_dwordx4 v114, s[12:15], s20 offen offset:2048 lds
  v_mul_f32 v27, v101, v97
  v_mul_f32 v14, v103, v97
  v_mul_f32_e64 v15, v103, v97
  v_pk_mul_f32 v[128:129], v[128:129], v[24:25]
  v_pk_mul_f32 v[130:131], v[130:131], v[24:25]
  v_pk_mul_f32 v[132:133], v[132:133], v[24:25]
  v_pk_mul_f32 v[134:135], v[134:135], v[24:25]
  s_waitcnt vmcnt(19)
  v_lshlrev_b32 v104, 16, v32
  v_and_b32 v105, 0xffff0000, v32
  v_lshlrev_b32_e64 v106, 16, v33
  v_and_b32 v107, 0xffff0000, v33
  buffer_load_dwordx4 v115, s[12:15], s20 offen offset:3072 lds
  v_lshlrev_b32_e64 v108, 16, v34
  v_and_b32 v109, 0xffff0000, v34
  v_lshlrev_b32_e64 v110, 16, v35
  v_and_b32 v111, 0xffff0000, v35
  v_pk_fma_f32 v[128:129], v[104:105], v[12:13], v[128:129]
  v_pk_fma_f32 v[130:131], v[106:107], v[12:13], v[130:131]
  v_pk_fma_f32 v[132:133], v[108:109], v[12:13], v[132:133]
  v_pk_fma_f32 v[134:135], v[110:111], v[12:13], v[134:135]
  v_cvt_pk_bf16_f32 v128, v128, v129
  v_cvt_pk_bf16_f32 v129, v130, v131
  v_cvt_pk_bf16_f32 v130, v132, v133
  v_cvt_pk_bf16_f32 v131, v134, v135
  s_add_u32 s19, s19, 128
  s_add_u32 s20, s20, 128
  s_add_u32 m0, s21, 32768
  s_nop 0
  buffer_load_dwordx4 v112, s[12:15], s19 offen offset:0 lds
  v_pk_mul_f32 v[136:137], v[136:137], v[24:25]
  v_pk_mul_f32 v[138:139], v[138:139], v[24:25]
  v_pk_mul_f32 v[140:141], v[140:141], v[24:25]
  v_pk_mul_f32 v[142:143], v[142:143], v[24:25]
  v_lshlrev_b32 v104, 16, v36
  v_and_b32 v105, 0xffff0000, v36
  v_lshlrev_b32_e64 v106, 16, v37
  v_and_b32 v107, 0xffff0000, v37
  v_lshlrev_b32_e64 v108, 16, v38
  v_and_b32 v109, 0xffff0000, v38
  v_lshlrev_b32_e64 v110, 16, v39
  v_and_b32 v111, 0xffff0000, v39
  buffer_load_dwordx4 v113, s[12:15], s19 offen offset:1024 lds
  v_pk_fma_f32 v[136:137], v[104:105], v[12:13], v[136:137]
  v_pk_fma_f32 v[138:139], v[106:107], v[12:13], v[138:139]
  v_pk_fma_f32 v[140:141], v[108:109], v[12:13], v[140:141]
  v_pk_fma_f32 v[142:143], v[110:111], v[12:13], v[142:143]
  v_cvt_pk_bf16_f32 v136, v136, v137
  v_cvt_pk_bf16_f32 v137, v138, v139
  v_cvt_pk_bf16_f32 v138, v140, v141
  v_cvt_pk_bf16_f32 v139, v142, v143
  v_pk_mul_f32 v[144:145], v[144:145], v[24:25]
  v_pk_mul_f32 v[146:147], v[146:147], v[24:25]
  v_pk_mul_f32 v[148:149], v[148:149], v[24:25]
  v_pk_mul_f32 v[150:151], v[150:151], v[24:25]
  buffer_load_dwordx4 v114, s[12:15], s19 offen offset:2048 lds
  v_lshlrev_b32_e64 v104, 16, v40
  v_and_b32 v105, 0xffff0000, v40
  v_lshlrev_b32_e64 v106, 16, v41
  v_and_b32 v107, 0xffff0000, v41
  v_lshlrev_b32_e64 v108, 16, v42
  v_and_b32 v109, 0xffff0000, v42
  v_lshlrev_b32_e64 v110, 16, v43
  v_and_b32 v111, 0xffff0000, v43
  v_pk_fma_f32 v[144:145], v[104:105], v[12:13], v[144:145]
  v_pk_fma_f32 v[146:147], v[106:107], v[12:13], v[146:147]
  v_pk_fma_f32 v[148:149], v[108:109], v[12:13], v[148:149]
  v_pk_fma_f32 v[150:151], v[110:111], v[12:13], v[150:151]
  buffer_load_dwordx4 v115, s[12:15], s19 offen offset:3072 lds
  v_cvt_pk_bf16_f32 v144, v144, v145
  v_cvt_pk_bf16_f32 v145, v146, v147
  v_cvt_pk_bf16_f32 v146, v148, v149
  v_cvt_pk_bf16_f32 v147, v150, v151
  v_pk_mul_f32 v[152:153], v[152:153], v[24:25]
  v_pk_mul_f32 v[154:155], v[154:155], v[24:25]
  v_pk_mul_f32 v[156:157], v[156:157], v[24:25]
  v_pk_mul_f32 v[158:159], v[158:159], v[24:25]
  v_lshlrev_b32_e64 v104, 16, v44
  v_and_b32 v105, 0xffff0000, v44
  v_lshlrev_b32_e64 v106, 16, v45
  v_and_b32 v107, 0xffff0000, v45
  s_add_u32 m0, s21, 36864
  s_nop 0
  buffer_load_dwordx4 v112, s[12:15], s20 offen offset:0 lds
  v_lshlrev_b32 v108, 16, v46
  v_and_b32 v109, 0xffff0000, v46
  v_lshlrev_b32_e64 v110, 16, v47
  v_and_b32 v111, 0xffff0000, v47
  v_pk_fma_f32 v[152:153], v[104:105], v[12:13], v[152:153]
  v_pk_fma_f32 v[154:155], v[106:107], v[12:13], v[154:155]
  v_pk_fma_f32 v[156:157], v[108:109], v[12:13], v[156:157]
  v_pk_fma_f32 v[158:159], v[110:111], v[12:13], v[158:159]
  v_cvt_pk_bf16_f32 v152, v152, v153
  v_cvt_pk_bf16_f32 v153, v154, v155
  v_cvt_pk_bf16_f32 v154, v156, v157
  v_cvt_pk_bf16_f32 v155, v158, v159
  buffer_load_dwordx4 v113, s[12:15], s20 offen offset:1024 lds
  v_pk_mul_f32 v[160:161], v[160:161], v[24:25]
  v_pk_mul_f32 v[162:163], v[162:163], v[24:25]
  v_pk_mul_f32 v[164:165], v[164:165], v[24:25]
  v_pk_mul_f32 v[166:167], v[166:167], v[24:25]
  s_waitcnt vmcnt(22)
  v_lshlrev_b32 v104, 16, v64
  v_and_b32 v105, 0xffff0000, v64
  v_lshlrev_b32_e64 v106, 16, v65
  v_and_b32 v107, 0xffff0000, v65
  v_lshlrev_b32_e64 v108, 16, v66
  v_and_b32 v109, 0xffff0000, v66
  v_lshlrev_b32_e64 v110, 16, v67
  buffer_load_dwordx4 v114, s[12:15], s20 offen offset:2048 lds
  v_and_b32 v111, 0xffff0000, v67
  v_pk_fma_f32 v[160:161], v[104:105], v[12:13], v[160:161]
  v_pk_fma_f32 v[162:163], v[106:107], v[12:13], v[162:163]
  v_pk_fma_f32 v[164:165], v[108:109], v[12:13], v[164:165]
  v_pk_fma_f32 v[166:167], v[110:111], v[12:13], v[166:167]
  v_cvt_pk_bf16_f32 v160, v160, v161
  v_cvt_pk_bf16_f32 v161, v162, v163
  v_cvt_pk_bf16_f32 v162, v164, v165
  v_cvt_pk_bf16_f32 v163, v166, v167
  v_pk_mul_f32 v[168:169], v[168:169], v[24:25]
  v_pk_mul_f32 v[170:171], v[170:171], v[24:25]
  v_pk_mul_f32 v[172:173], v[172:173], v[24:25]
  buffer_load_dwordx4 v115, s[12:15], s20 offen offset:3072 lds
  v_pk_mul_f32 v[174:175], v[174:175], v[24:25]
  v_lshlrev_b32_e64 v104, 16, v68
  v_and_b32 v105, 0xffff0000, v68
  v_lshlrev_b32_e64 v106, 16, v69
  v_and_b32 v107, 0xffff0000, v69
  v_lshlrev_b32_e64 v108, 16, v70
  v_and_b32 v109, 0xffff0000, v70
  v_lshlrev_b32_e64 v110, 16, v71
  v_and_b32 v111, 0xffff0000, v71
  v_pk_fma_f32 v[168:169], v[104:105], v[12:13], v[168:169]
  v_pk_fma_f32 v[170:171], v[106:107], v[12:13], v[170:171]
  v_pk_fma_f32 v[172:173], v[108:109], v[12:13], v[172:173]
  s_add_u32 s19, s19, 128
  s_add_u32 s20, s20, 128
  s_add_u32 m0, s21, 65536
  s_nop 0
  buffer_load_dwordx4 v112, s[12:15], s19 offen offset:0 lds
  v_pk_fma_f32 v[174:175], v[110:111], v[12:13], v[174:175]
  v_cvt_pk_bf16_f32 v168, v168, v169
  v_cvt_pk_bf16_f32 v169, v170, v171
  v_cvt_pk_bf16_f32 v170, v172, v173
  v_cvt_pk_bf16_f32 v171, v174, v175
  v_pk_mul_f32 v[176:177], v[176:177], v[24:25]
  v_pk_mul_f32 v[178:179], v[178:179], v[24:25]
  v_pk_mul_f32 v[180:181], v[180:181], v[24:25]
  v_pk_mul_f32 v[182:183], v[182:183], v[24:25]
  v_lshlrev_b32 v104, 16, v72
  v_and_b32 v105, 0xffff0000, v72
  v_lshlrev_b32_e64 v106, 16, v73
  buffer_load_dwordx4 v113, s[12:15], s19 offen offset:1024 lds
  v_and_b32 v107, 0xffff0000, v73
  v_lshlrev_b32_e64 v108, 16, v74
  v_and_b32 v109, 0xffff0000, v74
  v_lshlrev_b32_e64 v110, 16, v75
  v_and_b32 v111, 0xffff0000, v75
  v_pk_fma_f32 v[176:177], v[104:105], v[12:13], v[176:177]
  v_pk_fma_f32 v[178:179], v[106:107], v[12:13], v[178:179]
  v_pk_fma_f32 v[180:181], v[108:109], v[12:13], v[180:181]
  v_pk_fma_f32 v[182:183], v[110:111], v[12:13], v[182:183]
  v_cvt_pk_bf16_f32 v176, v176, v177
  v_cvt_pk_bf16_f32 v177, v178, v179
  v_cvt_pk_bf16_f32 v178, v180, v181
  buffer_load_dwordx4 v114, s[12:15], s19 offen offset:2048 lds
  v_cvt_pk_bf16_f32 v179, v182, v183
  v_pk_mul_f32 v[184:185], v[184:185], v[24:25]
  v_pk_mul_f32 v[186:187], v[186:187], v[24:25]
  v_pk_mul_f32 v[188:189], v[188:189], v[24:25]
  v_pk_mul_f32 v[190:191], v[190:191], v[24:25]
  v_lshlrev_b32_e64 v104, 16, v76
  v_and_b32 v105, 0xffff0000, v76
  v_lshlrev_b32_e64 v106, 16, v77
  v_and_b32 v107, 0xffff0000, v77
  v_lshlrev_b32_e64 v108, 16, v78
  v_and_b32 v109, 0xffff0000, v78
  v_lshlrev_b32_e64 v110, 16, v79
  buffer_load_dwordx4 v115, s[12:15], s19 offen offset:3072 lds
  v_and_b32 v111, 0xffff0000, v79
  v_pk_fma_f32 v[184:185], v[104:105], v[12:13], v[184:185]
  v_pk_fma_f32 v[186:187], v[106:107], v[12:13], v[186:187]
  v_pk_fma_f32 v[188:189], v[108:109], v[12:13], v[188:189]
  v_pk_fma_f32 v[190:191], v[110:111], v[12:13], v[190:191]
  v_cvt_pk_bf16_f32 v184, v184, v185
  v_cvt_pk_bf16_f32 v185, v186, v187
  v_cvt_pk_bf16_f32 v186, v188, v189
  v_cvt_pk_bf16_f32 v187, v190, v191
  v_pk_mul_f32 v[192:193], v[192:193], v[26:27]
  v_pk_mul_f32 v[194:195], v[194:195], v[26:27]
  v_pk_mul_f32 v[196:197], v[196:197], v[26:27]
  s_add_u32 m0, s21, 69632
  s_nop 0
  buffer_load_dwordx4 v112, s[12:15], s20 offen offset:0 lds
  v_pk_mul_f32 v[198:199], v[198:199], v[26:27]
  s_waitcnt vmcnt(25)
  v_lshlrev_b32_e64 v104, 16, v80
  v_and_b32 v105, 0xffff0000, v80
  v_lshlrev_b32_e64 v106, 16, v81
  v_and_b32 v107, 0xffff0000, v81
  v_lshlrev_b32_e64 v108, 16, v82
  v_and_b32 v109, 0xffff0000, v82
  v_lshlrev_b32_e64 v110, 16, v83
  v_and_b32 v111, 0xffff0000, v83
  v_pk_fma_f32 v[192:193], v[104:105], v[14:15], v[192:193]
  v_pk_fma_f32 v[194:195], v[106:107], v[14:15], v[194:195]
  buffer_load_dwordx4 v113, s[12:15], s20 offen offset:1024 lds
  v_pk_fma_f32 v[196:197], v[108:109], v[14:15], v[196:197]
  v_pk_fma_f32 v[198:199], v[110:111], v[14:15], v[198:199]
  v_cvt_pk_bf16_f32 v192, v192, v193
  v_cvt_pk_bf16_f32 v193, v194, v195
  v_cvt_pk_bf16_f32 v194, v196, v197
  v_cvt_pk_bf16_f32 v195, v198, v199
  v_pk_mul_f32 v[200:201], v[200:201], v[26:27]
  v_pk_mul_f32 v[202:203], v[202:203], v[26:27]
  v_pk_mul_f32 v[204:205], v[204:205], v[26:27]
  v_pk_mul_f32 v[206:207], v[206:207], v[26:27]
  v_lshlrev_b32_e64 v104, 16, v84
  v_and_b32 v105, 0xffff0000, v84
  buffer_load_dwordx4 v114, s[12:15], s20 offen offset:2048 lds
  v_lshlrev_b32_e64 v106, 16, v85
  v_and_b32 v107, 0xffff0000, v85
  v_lshlrev_b32_e64 v108, 16, v86
  v_and_b32 v109, 0xffff0000, v86
  v_lshlrev_b32_e64 v110, 16, v87
  v_and_b32 v111, 0xffff0000, v87
  v_pk_fma_f32 v[200:201], v[104:105], v[14:15], v[200:201]
  v_pk_fma_f32 v[202:203], v[106:107], v[14:15], v[202:203]
  v_pk_fma_f32 v[204:205], v[108:109], v[14:15], v[204:205]
  v_pk_fma_f32 v[206:207], v[110:111], v[14:15], v[206:207]
  v_cvt_pk_bf16_f32 v200, v200, v201
  v_cvt_pk_bf16_f32 v201, v202, v203
  buffer_load_dwordx4 v115, s[12:15], s20 offen offset:3072 lds
  v_cvt_pk_bf16_f32 v202, v204, v205
  v_cvt_pk_bf16_f32 v203, v206, v207
  v_pk_mul_f32 v[208:209], v[208:209], v[26:27]
  v_pk_mul_f32 v[210:211], v[210:211], v[26:27]
  v_pk_mul_f32 v[212:213], v[212:213], v[26:27]
  v_pk_mul_f32 v[214:215], v[214:215], v[26:27]
  v_lshlrev_b32_e64 v104, 16, v88
  v_and_b32 v105, 0xffff0000, v88
  v_lshlrev_b32_e64 v106, 16, v89
  v_and_b32 v107, 0xffff0000, v89
  v_lshlrev_b32_e64 v108, 16, v90
  v_and_b32 v109, 0xffff0000, v90
  s_add_u32 s19, s19, 128
  s_add_u32 s20, s20, 128
  s_add_u32 m0, s21, 98304
  s_nop 0
  buffer_load_dwordx4 v112, s[12:15], s19 offen offset:0 lds
  v_lshlrev_b32 v110, 16, v91
  v_and_b32 v111, 0xffff0000, v91
  v_pk_fma_f32 v[208:209], v[104:105], v[14:15], v[208:209]
  v_pk_fma_f32 v[210:211], v[106:107], v[14:15], v[210:211]
  v_pk_fma_f32 v[212:213], v[108:109], v[14:15], v[212:213]
  v_pk_fma_f32 v[214:215], v[110:111], v[14:15], v[214:215]
  v_cvt_pk_bf16_f32 v208, v208, v209
  v_cvt_pk_bf16_f32 v209, v210, v211
  v_cvt_pk_bf16_f32 v210, v212, v213
  v_cvt_pk_bf16_f32 v211, v214, v215
  v_pk_mul_f32 v[216:217], v[216:217], v[26:27]
  v_pk_mul_f32 v[218:219], v[218:219], v[26:27]
  buffer_load_dwordx4 v113, s[12:15], s19 offen offset:1024 lds
  v_pk_mul_f32 v[220:221], v[220:221], v[26:27]
  v_pk_mul_f32 v[222:223], v[222:223], v[26:27]
  v_lshlrev_b32_e64 v104, 16, v92
  v_and_b32 v105, 0xffff0000, v92
  v_lshlrev_b32_e64 v106, 16, v93
  v_and_b32 v107, 0xffff0000, v93
  v_lshlrev_b32_e64 v108, 16, v94
  v_and_b32 v109, 0xffff0000, v94
  v_lshlrev_b32_e64 v110, 16, v95
  v_and_b32 v111, 0xffff0000, v95
  v_pk_fma_f32 v[216:217], v[104:105], v[14:15], v[216:217]
  v_pk_fma_f32 v[218:219], v[106:107], v[14:15], v[218:219]
  buffer_load_dwordx4 v114, s[12:15], s19 offen offset:2048 lds
  v_pk_fma_f32 v[220:221], v[108:109], v[14:15], v[220:221]
  v_pk_fma_f32 v[222:223], v[110:111], v[14:15], v[222:223]
  v_cvt_pk_bf16_f32 v216, v216, v217
  v_cvt_pk_bf16_f32 v217, v218, v219
  v_cvt_pk_bf16_f32 v218, v220, v221
  v_cvt_pk_bf16_f32 v219, v222, v223
  v_pk_mul_f32 v[224:225], v[224:225], v[26:27]
  v_pk_mul_f32 v[226:227], v[226:227], v[26:27]
  v_pk_mul_f32 v[228:229], v[228:229], v[26:27]
  v_pk_mul_f32 v[230:231], v[230:231], v[26:27]
  s_waitcnt vmcnt(27)
  v_lshlrev_b32 v104, 16, v48
  buffer_load_dwordx4 v115, s[12:15], s19 offen offset:3072 lds
  v_and_b32 v105, 0xffff0000, v48
  v_lshlrev_b32_e64 v106, 16, v49
  v_and_b32 v107, 0xffff0000, v49
  v_lshlrev_b32_e64 v108, 16, v50
  v_and_b32 v109, 0xffff0000, v50
  v_lshlrev_b32_e64 v110, 16, v51
  v_and_b32 v111, 0xffff0000, v51
  v_pk_fma_f32 v[224:225], v[104:105], v[14:15], v[224:225]
  v_pk_fma_f32 v[226:227], v[106:107], v[14:15], v[226:227]
  v_pk_fma_f32 v[228:229], v[108:109], v[14:15], v[228:229]
  v_pk_fma_f32 v[230:231], v[110:111], v[14:15], v[230:231]
  v_cvt_pk_bf16_f32 v224, v224, v225
  s_add_u32 m0, s21, 102400
  s_nop 0
  buffer_load_dwordx4 v112, s[12:15], s20 offen offset:0 lds
  v_cvt_pk_bf16_f32 v225, v226, v227
  v_cvt_pk_bf16_f32 v226, v228, v229
  v_cvt_pk_bf16_f32 v227, v230, v231
  v_pk_mul_f32 v[232:233], v[232:233], v[26:27]
  v_pk_mul_f32 v[234:235], v[234:235], v[26:27]
  v_pk_mul_f32 v[236:237], v[236:237], v[26:27]
  v_pk_mul_f32 v[238:239], v[238:239], v[26:27]
  v_lshlrev_b32 v104, 16, v52
  v_and_b32 v105, 0xffff0000, v52
  v_lshlrev_b32_e64 v106, 16, v53
  v_and_b32 v107, 0xffff0000, v53
  v_lshlrev_b32_e64 v108, 16, v54
  buffer_load_dwordx4 v113, s[12:15], s20 offen offset:1024 lds
  v_and_b32 v109, 0xffff0000, v54
  v_lshlrev_b32_e64 v110, 16, v55
  v_and_b32 v111, 0xffff0000, v55
  v_pk_fma_f32 v[232:233], v[104:105], v[14:15], v[232:233]
  v_pk_fma_f32 v[234:235], v[106:107], v[14:15], v[234:235]
  v_pk_fma_f32 v[236:237], v[108:109], v[14:15], v[236:237]
  v_pk_fma_f32 v[238:239], v[110:111], v[14:15], v[238:239]
  v_cvt_pk_bf16_f32 v232, v232, v233
  v_cvt_pk_bf16_f32 v233, v234, v235
  v_cvt_pk_bf16_f32 v234, v236, v237
  v_cvt_pk_bf16_f32 v235, v238, v239
  v_pk_mul_f32 v[240:241], v[240:241], v[26:27]
  buffer_load_dwordx4 v114, s[12:15], s20 offen offset:2048 lds
  v_pk_mul_f32 v[242:243], v[242:243], v[26:27]
  v_pk_mul_f32 v[244:245], v[244:245], v[26:27]
  v_pk_mul_f32 v[246:247], v[246:247], v[26:27]
  v_lshlrev_b32_e64 v104, 16, v56
  v_and_b32 v105, 0xffff0000, v56
  v_lshlrev_b32_e64 v106, 16, v57
  v_and_b32 v107, 0xffff0000, v57
  v_lshlrev_b32_e64 v108, 16, v58
  v_and_b32 v109, 0xffff0000, v58
  v_lshlrev_b32_e64 v110, 16, v59
  v_and_b32 v111, 0xffff0000, v59
  v_pk_fma_f32 v[240:241], v[104:105], v[14:15], v[240:241]
  buffer_load_dwordx4 v115, s[12:15], s20 offen offset:3072 lds
  v_pk_fma_f32 v[242:243], v[106:107], v[14:15], v[242:243]
  v_pk_fma_f32 v[244:245], v[108:109], v[14:15], v[244:245]
  v_pk_fma_f32 v[246:247], v[110:111], v[14:15], v[246:247]
  v_cvt_pk_bf16_f32 v240, v240, v241
  v_cvt_pk_bf16_f32 v241, v242, v243
  v_cvt_pk_bf16_f32 v242, v244, v245
  v_cvt_pk_bf16_f32 v243, v246, v247
  v_pk_mul_f32 v[248:249], v[248:249], v[26:27]
  v_pk_mul_f32 v[250:251], v[250:251], v[26:27]
  v_pk_mul_f32 v[252:253], v[252:253], v[26:27]
  v_pk_mul_f32 v[254:255], v[254:255], v[26:27]
  v_lshlrev_b32_e64 v104, 16, v60
  s_add_u32 s19, s19, 128
  s_add_u32 s20, s20, 128
  v_and_b32 v105, 0xffff0000, v60
  v_lshlrev_b32_e64 v106, 16, v61
  v_and_b32 v107, 0xffff0000, v61
  v_lshlrev_b32_e64 v108, 16, v62
  v_and_b32 v109, 0xffff0000, v62
  v_lshlrev_b32_e64 v110, 16, v63
  v_and_b32 v111, 0xffff0000, v63
  v_pk_fma_f32 v[248:249], v[104:105], v[14:15], v[248:249]
  v_pk_fma_f32 v[250:251], v[106:107], v[14:15], v[250:251]
  v_pk_fma_f32 v[252:253], v[108:109], v[14:15], v[252:253]
  v_pk_fma_f32 v[254:255], v[110:111], v[14:15], v[254:255]
  v_cvt_pk_bf16_f32 v248, v248, v249
  v_cvt_pk_bf16_f32 v249, v250, v251
  v_cvt_pk_bf16_f32 v250, v252, v253
  v_cvt_pk_bf16_f32 v251, v254, v255
  s_branch L_k2_oproj
L_k2_lastm0:
  s_add_u32 m0, s54, 0
  s_nop 0
  buffer_load_dwordx4 v1, s[8:11], s52 offen offset:0 sc1 lds
  s_lshl_b32 s3, s57, 6
  v_mov_b32 v26, 0xf149f2ca
  v_subrev_u32_e64 v25, s3, v9
  v_cmp_le_i32 s[22:23], 0, v25
  v_cmp_le_i32 s[24:25], 1, v25
  v_cmp_le_i32 s[26:27], 2, v25
  buffer_load_dwordx4 v1, s[8:11], s52 offen offset:1024 sc1 lds
  v_cmp_le_i32 s[28:29], 3, v25
  v_cndmask_b32 v80, v26, v7, s[22:23]
  v_cndmask_b32 v81, v26, v7, s[24:25]
  v_cndmask_b32 v82, v26, v7, s[26:27]
  v_cndmask_b32 v83, v26, v7, s[28:29]
  s_nop 1
  v_mfma_f32_16x16x32_bf16 v[48:51], a[0:3], a[160:163], v[80:83]
  v_cmp_le_i32 s[22:23], 16, v25
  v_cmp_le_i32 s[24:25], 17, v25
  ds_read_b128 a[128:131], v3 offset:16384
  v_mfma_f32_16x16x32_bf16 v[48:51], a[4:7], a[164:167], v[48:51]
  v_cmp_le_i32 s[26:27], 18, v25
  ds_read_b128 a[132:135], v3 offset:17408
  buffer_load_dwordx4 v1, s[8:11], s52 offen offset:2048 sc1 lds
  v_mfma_f32_16x16x32_bf16 v[48:51], a[8:11], a[168:171], v[48:51]
  v_cmp_le_i32 s[28:29], 19, v25
  ds_read_b128 a[136:139], v3 offset:18432
  v_mfma_f32_16x16x32_bf16 v[48:51], a[12:15], a[172:175], v[48:51]
  v_cndmask_b32 v84, v26, v7, s[22:23]
  v_cndmask_b32 v85, v26, v7, s[24:25]
  ds_read_b128 a[140:143], v3 offset:19456
  v_mfma_f32_16x16x32_bf16 v[48:51], a[16:19], a[176:179], v[48:51]
  v_cndmask_b32 v86, v26, v7, s[26:27]
  ds_read_b128 a[144:147], v3 offset:20480
  v_mfma_f32_16x16x32_bf16 v[48:51], a[20:23], a[180:183], v[48:51]
  v_cndmask_b32 v87, v26, v7, s[28:29]
  ds_read_b128 a[148:151], v3 offset:21504
  buffer_load_dwordx4 v1, s[8:11], s52 offen offset:3072 sc1 lds
  v_mfma_f32_16x16x32_bf16 v[48:51], a[24:27], a[184:187], v[48:51]
  s_nop 0
  ds_read_b128 a[152:155], v3 offset:22528
  v_mfma_f32_16x16x32_bf16 v[48:51], a[28:31], a[188:191], v[48:51]
  s_waitcnt lgkmcnt(7)
  ds_read_b128 a[156:159], v3 offset:23552
  v_mfma_f32_16x16x32_bf16 v[52:55], a[32:35], a[160:163], v[84:87]
  v_cmp_le_i32 s[22:23], 32, v25
  v_cmp_le_i32 s[24:25], 33, v25
  ds_read_b128 a[216:219], v3 offset:24576
  v_mfma_f32_16x16x32_bf16 v[52:55], a[36:39], a[164:167], v[52:55]
  v_cmp_le_i32 s[26:27], 34, v25
  ds_read_b128 a[220:223], v3 offset:25600
  s_add_u32 m0, s54, 4096
  v_mfma_f32_16x16x32_bf16 v[52:55], a[40:43], a[168:171], v[52:55]
  v_cmp_le_i32 s[28:29], 35, v25
  ds_read_b128 a[224:227], v3 offset:26624
  buffer_load_dwordx4 v2, s[8:11], s52 offen offset:0 sc1 lds
  v_mfma_f32_16x16x32_bf16 v[52:55], a[44:47], a[172:175], v[52:55]
  v_cndmask_b32 v88, v26, v7, s[22:23]
  v_cndmask_b32 v89, v26, v7, s[24:25]
  ds_read_b128 a[228:231], v3 offset:27648
  v_mfma_f32_16x16x32_bf16 v[52:55], a[48:51], a[176:179], v[52:55]
  v_cndmask_b32 v90, v26, v7, s[26:27]
  ds_read_b128 a[232:235], v3 offset:28672
  v_mfma_f32_16x16x32_bf16 v[52:55], a[52:55], a[180:183], v[52:55]
  v_cndmask_b32 v91, v26, v7, s[28:29]
  ds_read_b128 a[236:239], v3 offset:29696
  v_mfma_f32_16x16x32_bf16 v[52:55], a[56:59], a[184:187], v[52:55]
  ds_read_b128 a[240:243], v3 offset:30720
  buffer_load_dwordx4 v2, s[8:11], s52 offen offset:1024 sc1 lds
  v_mfma_f32_16x16x32_bf16 v[52:55], a[60:63], a[188:191], v[52:55]
  s_waitcnt lgkmcnt(7)
  ds_read_b128 a[244:247], v3 offset:31744
  v_mfma_f32_16x16x32_bf16 v[56:59], a[128:131], a[160:163], v[88:91]
  v_cmp_le_i32 s[22:23], 48, v25
  v_cmp_le_i32 s[24:25], 49, v25
  ds_read_b128 a[64:67], v4 offset:0
  v_mfma_f32_16x16x32_bf16 v[56:59], a[132:135], a[164:167], v[56:59]
  v_cmp_le_i32 s[26:27], 50, v25
  ds_read_b128 a[68:71], v4 offset:16384
  v_mfma_f32_16x16x32_bf16 v[56:59], a[136:139], a[168:171], v[56:59]
  v_cmp_le_i32 s[28:29], 51, v25
  ds_read_b128 a[72:75], v4 offset:1024
  buffer_load_dwordx4 v2, s[8:11], s52 offen offset:2048 sc1 lds
  v_mfma_f32_16x16x32_bf16 v[56:59], a[140:143], a[172:175], v[56:59]
  v_cndmask_b32 v92, v26, v7, s[22:23]
  v_cndmask_b32 v93, v26, v7, s[24:25]
  ds_read_b128 a[76:79], v4 offset:17408
  v_mfma_f32_16x16x32_bf16 v[56:59], a[144:147], a[176:179], v[56:59]
  v_cndmask_b32 v94, v26, v7, s[26:27]
  ds_read_b128 a[80:83], v4 offset:2048
  v_mfma_f32_16x16x32_bf16 v[56:59], a[148:151], a[180:183], v[56:59]
  v_cndmask_b32 v95, v26, v7, s[28:29]
  ds_read_b128 a[84:87], v4 offset:18432
  v_mfma_f32_16x16x32_bf16 v[56:59], a[152:155], a[184:187], v[56:59]
  ds_read_b128 a[88:91], v4 offset:3072
  buffer_load_dwordx4 v2, s[8:11], s52 offen offset:3072 sc1 lds
  v_mfma_f32_16x16x32_bf16 v[56:59], a[156:159], a[188:191], v[56:59]
  s_waitcnt lgkmcnt(7)
  ds_read_b128 a[92:95], v4 offset:19456
  v_mfma_f32_16x16x32_bf16 v[60:63], a[216:219], a[160:163], v[92:95]
  ds_read_b128 a[96:99], v4 offset:4096
  v_accvgpr_read_b32 v112, a204
  v_mfma_f32_16x16x32_bf16 v[60:63], a[220:223], a[164:167], v[60:63]
  ds_read_b128 a[100:103], v4 offset:20480
  s_xor_b32 s54, s54, 0x38000
  v_accvgpr_read_b32 v113, a205
  v_mfma_f32_16x16x32_bf16 v[60:63], a[224:227], a[168:171], v[60:63]
  ds_read_b128 a[104:107], v4 offset:5120
  v_accvgpr_read_b32 v114, a206
  v_mfma_f32_16x16x32_bf16 v[60:63], a[228:231], a[172:175], v[60:63]
  ds_read_b128 a[108:111], v4 offset:21504
  v_accvgpr_read_b32 v115, a207
  v_mfma_f32_16x16x32_bf16 v[60:63], a[232:235], a[176:179], v[60:63]
  s_nop 0
  ds_read_b128 a[112:115], v4 offset:6144
  v_mfma_f32_16x16x32_bf16 v[60:63], a[236:239], a[180:183], v[60:63]
  ds_read_b128 a[116:119], v4 offset:22528
  v_mfma_f32_16x16x32_bf16 v[60:63], a[240:243], a[184:187], v[60:63]
  ds_read_b128 a[120:123], v4 offset:7168
  v_mfma_f32_16x16x32_bf16 v[60:63], a[244:247], a[188:191], v[60:63]
  ds_read_b128 a[124:127], v4 offset:23552
  v_mfma_f32_16x16x32_bf16 a[192:195], a[200:203], v[96:99], a[192:195]
  v_mfma_f32_16x16x32_bf16 a[192:195], a[200:203], v[100:103], a[192:195]
  v_exp_f32_e64 v16, v48
  v_mfma_f32_16x16x32_bf16 a[196:199], a[200:203], v[104:107], a[196:199]
  v_mfma_f32_16x16x32_bf16 a[196:199], a[200:203], v[108:111], a[196:199]
  s_waitcnt lgkmcnt(8)
  s_nop 0
  v_mfma_f32_16x16x32_bf16 v[128:131], a[64:67], v[96:99], v[128:131]
  v_exp_f32_e64 v17, v49
  v_mfma_f32_16x16x32_bf16 v[128:131], a[68:71], v[100:103], v[128:131]
  s_waitcnt vmcnt(8)
  s_barrier
  v_mfma_f32_16x16x32_bf16 v[192:195], a[68:71], v[108:111], v[192:195]
  ds_read_b128 a[68:71], v4 offset:24576
  v_cvt_pk_bf16_f32 v120, v16, v17
  s_add_u32 m0, s21, 0
  v_mfma_f32_16x16x32_bf16 v[192:195], a[64:67], v[104:107], v[192:195]
  v_exp_f32 v18, v50
  buffer_load_dwordx4 v112, s[12:15], s19 offen offset:0 lds
  v_mfma_f32_16x16x32_bf16 v[196:199], a[72:75], v[104:107], v[196:199]
  ds_read_b128 a[64:67], v4 offset:8192
  v_mfma_f32_16x16x32_bf16 v[196:199], a[76:79], v[108:111], v[196:199]
  v_mfma_f32_16x16x32_bf16 v[132:135], a[76:79], v[100:103], v[132:135]
  v_exp_f32_e64 v19, v51
  v_mfma_f32_16x16x32_bf16 v[132:135], a[72:75], v[96:99], v[132:135]
  ds_read_b128 a[76:79], v4 offset:25600
  ds_read_b128 a[72:75], v4 offset:9216
  buffer_load_dwordx4 v113, s[12:15], s19 offen offset:1024 lds
  v_mfma_f32_16x16x32_bf16 v[136:139], a[80:83], v[96:99], v[136:139]
  v_cvt_pk_bf16_f32 v121, v18, v19
  v_mfma_f32_16x16x32_bf16 v[136:139], a[84:87], v[100:103], v[136:139]
  v_exp_f32_e64 v20, v52
  v_mfma_f32_16x16x32_bf16 v[200:203], a[84:87], v[108:111], v[200:203]
  ds_read_b128 a[84:87], v4 offset:26624
  v_mfma_f32_16x16x32_bf16 v[200:203], a[80:83], v[104:107], v[200:203]
  ds_read_b128 a[80:83], v4 offset:10240
  buffer_load_dwordx4 v114, s[12:15], s19 offen offset:2048 lds
  v_mfma_f32_16x16x32_bf16 v[204:207], a[88:91], v[104:107], v[204:207]
  v_exp_f32_e64 v21, v53
  v_mfma_f32_16x16x32_bf16 v[204:207], a[92:95], v[108:111], v[204:207]
  v_cvt_pk_bf16_f32 v122, v20, v21
  v_mfma_f32_16x16x32_bf16 v[140:143], a[92:95], v[100:103], v[140:143]
  ds_read_b128 a[92:95], v4 offset:27648
  v_mfma_f32_16x16x32_bf16 v[140:143], a[88:91], v[96:99], v[140:143]
  s_waitcnt lgkmcnt(7)
  ds_read_b128 a[88:91], v4 offset:11264
  buffer_load_dwordx4 v115, s[12:15], s19 offen offset:3072 lds
  v_mfma_f32_16x16x32_bf16 v[144:147], a[96:99], v[96:99], v[144:147]
  v_exp_f32 v22, v54
  v_mfma_f32_16x16x32_bf16 v[144:147], a[100:103], v[100:103], v[144:147]
  v_mfma_f32_16x16x32_bf16 v[208:211], a[100:103], v[108:111], v[208:211]
  ds_read_b128 a[100:103], v4 offset:28672
  s_add_u32 m0, s21, 4096
  v_mfma_f32_16x16x32_bf16 v[208:211], a[96:99], v[104:107], v[208:211]
  v_exp_f32_e64 v23, v55
  buffer_load_dwordx4 v112, s[12:15], s20 offen offset:0 lds
  v_mfma_f32_16x16x32_bf16 v[212:215], a[104:107], v[104:107], v[212:215]
  ds_read_b128 a[96:99], v4 offset:12288
  v_cvt_pk_bf16_f32 v123, v22, v23
  v_mfma_f32_16x16x32_bf16 v[212:215], a[108:111], v[108:111], v[212:215]
  v_mfma_f32_16x16x32_bf16 v[148:151], a[108:111], v[100:103], v[148:151]
  v_exp_f32_e64 v16, v56
  v_mfma_f32_16x16x32_bf16 v[148:151], a[104:107], v[96:99], v[148:151]
  ds_read_b128 a[108:111], v4 offset:29696
  ds_read_b128 a[104:107], v4 offset:13312
  buffer_load_dwordx4 v113, s[12:15], s20 offen offset:1024 lds
  v_mfma_f32_16x16x32_bf16 v[152:155], a[112:115], v[96:99], v[152:155]
  v_accvgpr_read_b32 v116, a208
  v_mfma_f32_16x16x32_bf16 v[152:155], a[116:119], v[100:103], v[152:155]
  v_exp_f32_e64 v17, v57
  v_mfma_f32_16x16x32_bf16 v[216:219], a[116:119], v[108:111], v[216:219]
  ds_read_b128 a[116:119], v4 offset:30720
  v_cvt_pk_bf16_f32 v124, v16, v17
  v_mfma_f32_16x16x32_bf16 v[216:219], a[112:115], v[104:107], v[216:219]
  ds_read_b128 a[112:115], v4 offset:14336
  buffer_load_dwordx4 v114, s[12:15], s20 offen offset:2048 lds
  v_mfma_f32_16x16x32_bf16 v[220:223], a[120:123], v[104:107], v[220:223]
  v_exp_f32_e64 v18, v58
  v_mfma_f32_16x16x32_bf16 v[220:223], a[124:127], v[108:111], v[220:223]
  v_accvgpr_read_b32 v117, a209
  v_accvgpr_read_b32 v118, a210
  v_mfma_f32_16x16x32_bf16 v[156:159], a[124:127], v[100:103], v[156:159]
  ds_read_b128 a[124:127], v4 offset:31744
  v_accvgpr_read_b32 v119, a211
  v_mfma_f32_16x16x32_bf16 v[156:159], a[120:123], v[96:99], v[156:159]
  s_waitcnt lgkmcnt(11)
  ds_read_b128 a[120:123], v4 offset:15360
  buffer_load_dwordx4 v115, s[12:15], s20 offen offset:3072 lds
  v_mfma_f32_16x16x32_bf16 v[160:163], a[64:67], v[96:99], v[160:163]
  v_exp_f32 v19, v59
  v_mfma_f32_16x16x32_bf16 v[160:163], a[68:71], v[100:103], v[160:163]
  v_cvt_pk_bf16_f32 v125, v18, v19
  s_mul_i32 s5, s45, 1835008
  v_mfma_f32_16x16x32_bf16 v[224:227], a[68:71], v[108:111], v[224:227]
  s_add_u32 s19, s19, 128
  s_add_u32 s20, s20, 128
  s_add_u32 m0, s21, 32768
  v_mfma_f32_16x16x32_bf16 v[224:227], a[64:67], v[104:107], v[224:227]
  v_exp_f32_e64 v20, v60
  buffer_load_dwordx4 v112, s[12:15], s19 offen offset:0 lds
  v_mfma_f32_16x16x32_bf16 v[228:231], a[72:75], v[104:107], v[228:231]
  s_lshl_b32 s4, s58, 2
  s_add_u32 s4, s4, s44
  v_mfma_f32_16x16x32_bf16 v[228:231], a[76:79], v[108:111], v[228:231]
  v_mfma_f32_16x16x32_bf16 v[164:167], a[76:79], v[100:103], v[164:167]
  v_exp_f32_e64 v21, v61
  v_mfma_f32_16x16x32_bf16 v[164:167], a[72:75], v[96:99], v[164:167]
  s_waitcnt lgkmcnt(8)
  v_cvt_pk_bf16_f32 v126, v20, v21
  buffer_load_dwordx4 v113, s[12:15], s19 offen offset:1024 lds
  v_mfma_f32_16x16x32_bf16 v[168:171], a[80:83], v[96:99], v[168:171]
  s_mul_i32 s4, s4, 28672
  s_add_u32 s5, s5, s4
  v_mfma_f32_16x16x32_bf16 v[168:171], a[84:87], v[100:103], v[168:171]
  v_exp_f32_e64 v22, v62
  v_mfma_f32_16x16x32_bf16 v[232:235], a[84:87], v[108:111], v[232:235]
  v_xor_b32 v4, 0x38000, v4
  s_add_u32 s18, s5, 71303168
  v_mfma_f32_16x16x32_bf16 v[232:235], a[80:83], v[104:107], v[232:235]
  buffer_load_dwordx4 v114, s[12:15], s19 offen offset:2048 lds
  v_mfma_f32_16x16x32_bf16 v[236:239], a[88:91], v[104:107], v[236:239]
  v_exp_f32_e64 v23, v63
  v_mfma_f32_16x16x32_bf16 v[236:239], a[92:95], v[108:111], v[236:239]
  v_cvt_pk_bf16_f32 v127, v22, v23
  v_mfma_f32_16x16x32_bf16 v[172:175], a[92:95], v[100:103], v[172:175]
  v_or3_b32 v10, v120, v121, v122
  v_mfma_f32_16x16x32_bf16 v[172:175], a[88:91], v[96:99], v[172:175]
  s_waitcnt lgkmcnt(4)
  v_or3_b32 v10, v10, v123, v124
  buffer_load_dwordx4 v115, s[12:15], s19 offen offset:3072 lds
  v_mfma_f32_16x16x32_bf16 v[176:179], a[96:99], v[96:99], v[176:179]
  s_waitcnt vmcnt(12) lgkmcnt(0)
  s_barrier
  v_mfma_f32_16x16x32_bf16 v[176:179], a[100:103], v[100:103], v[176:179]
  ds_read_b128 a[64:67], v4 offset:0
  v_or3_b32 v10, v10, v125, v126
  v_mfma_f32_16x16x32_bf16 v[240:243], a[100:103], v[108:111], v[240:243]
  ds_read_b128 a[68:71], v4 offset:16384
  v_or_b32 v10, v10, v127
  s_add_u32 m0, s21, 36864
  v_mfma_f32_16x16x32_bf16 v[240:243], a[96:99], v[104:107], v[240:243]
  ds_read_b128 a[72:75], v4 offset:1024
  v_and_b32 v10, 0x40004000, v10
  buffer_load_dwordx4 v112, s[12:15], s20 offen offset:0 lds
  v_mfma_f32_16x16x32_bf16 v[244:247], a[104:107], v[104:107], v[244:247]
  ds_read_b128 a[76:79], v4 offset:17408
  v_cmp_ne_u32_e64 vcc, 0, v10
  v_mfma_f32_16x16x32_bf16 v[244:247], a[108:111], v[108:111], v[244:247]
  ds_read_b128 a[80:83], v4 offset:2048
  v_mfma_f32_16x16x32_bf16 v[180:183], a[108:111], v[100:103], v[180:183]
  ds_read_b128 a[84:87], v4 offset:18432
  v_mfma_f32_16x16x32_bf16 v[180:183], a[104:107], v[96:99], v[180:183]
  ds_read_b128 a[88:91], v4 offset:3072
  buffer_load_dwordx4 v113, s[12:15], s20 offen offset:1024 lds
  v_mfma_f32_16x16x32_bf16 v[184:187], a[112:115], v[96:99], v[184:187]
  ds_read_b128 a[92:95], v4 offset:19456
  v_mfma_f32_16x16x32_bf16 v[184:187], a[116:119], v[100:103], v[184:187]
  v_mfma_f32_16x16x32_bf16 v[248:251], a[116:119], v[108:111], v[248:251]
  v_mfma_f32_16x16x32_bf16 v[248:251], a[112:115], v[104:107], v[248:251]
  v_mfma_f32_16x16x32_bf16 v[252:255], a[120:123], v[104:107], v[252:255]
  v_mfma_f32_16x16x32_bf16 v[252:255], a[124:127], v[108:111], v[252:255]
  v_mfma_f32_16x16x32_bf16 v[188:191], a[124:127], v[100:103], v[188:191]
  v_mfma_f32_16x16x32_bf16 v[188:191], a[120:123], v[96:99], v[188:191]
  s_cbranch_vccnz L_k2_fixh
L_k2_fixhret0:
  ds_read_b128 a[96:99], v4 offset:4096
  ds_read_b128 a[100:103], v4 offset:20480
  ds_read_b128 a[104:107], v4 offset:5120
  ds_read_b128 a[108:111], v4 offset:21504
  ds_read_b128 a[112:115], v4 offset:6144
  ds_read_b128 a[116:119], v4 offset:22528
  ds_read_b128 a[120:123], v4 offset:7168
  ds_read_b128 a[124:127], v4 offset:23552
  v_mfma_f32_16x16x32_bf16 a[196:199], a[200:203], v[120:123], a[196:199]
  s_nop 0
  v_mfma_f32_16x16x32_bf16 a[196:199], a[200:203], v[124:127], a[196:199]
  s_waitcnt lgkmcnt(8)
  buffer_load_dwordx4 v114, s[12:15], s20 offen offset:2048 lds
  v_mfma_f32_16x16x32_bf16 v[192:195], a[64:67], v[120:123], v[192:195]
  s_nop 0
  ds_read_b128 a[64:67], v4 offset:8192
  v_mfma_f32_16x16x32_bf16 v[192:195], a[68:71], v[124:127], v[192:195]
  ds_read_b128 a[68:71], v4 offset:24576
  v_mfma_f32_16x16x32_bf16 v[196:199], a[72:75], v[120:123], v[196:199]
  ds_read_b128 a[72:75], v4 offset:9216
  v_mfma_f32_16x16x32_bf16 v[196:199], a[76:79], v[124:127], v[196:199]
  ds_read_b128 a[76:79], v4 offset:25600
  buffer_load_dwordx4 v115, s[12:15], s20 offen offset:3072 lds
  v_mfma_f32_16x16x32_bf16 v[200:203], a[80:83], v[120:123], v[200:203]
  ds_read_b128 a[80:83], v4 offset:10240
  v_mfma_f32_16x16x32_bf16 v[200:203], a[84:87], v[124:127], v[200:203]
  ds_read_b128 a[84:87], v4 offset:26624
  v_mfma_f32_16x16x32_bf16 v[204:207], a[88:91], v[120:123], v[204:207]
  ds_read_b128 a[88:91], v4 offset:11264
  s_add_u32 s19, s19, 128
  v_mfma_f32_16x16x32_bf16 v[204:207], a[92:95], v[124:127], v[204:207]
  s_waitcnt lgkmcnt(7)
  ds_read_b128 a[92:95], v4 offset:27648
  v_mfma_f32_16x16x32_bf16 v[208:211], a[96:99], v[120:123], v[208:211]
  ds_read_b128 a[96:99], v4 offset:12288
  s_add_u32 s20, s20, 128
  v_mfma_f32_16x16x32_bf16 v[208:211], a[100:103], v[124:127], v[208:211]
  ds_read_b128 a[100:103], v4 offset:28672
  s_add_u32 m0, s21, 65536
  v_mfma_f32_16x16x32_bf16 v[212:215], a[104:107], v[120:123], v[212:215]
  ds_read_b128 a[104:107], v4 offset:13312
  buffer_load_dwordx4 v112, s[12:15], s19 offen offset:0 lds
  v_mfma_f32_16x16x32_bf16 v[212:215], a[108:111], v[124:127], v[212:215]
  s_nop 0
  ds_read_b128 a[108:111], v4 offset:29696
  v_mfma_f32_16x16x32_bf16 v[216:219], a[112:115], v[120:123], v[216:219]
  ds_read_b128 a[112:115], v4 offset:14336
  v_mfma_f32_16x16x32_bf16 v[216:219], a[116:119], v[124:127], v[216:219]
  ds_read_b128 a[116:119], v4 offset:30720
  v_mfma_f32_16x16x32_bf16 v[220:223], a[120:123], v[120:123], v[220:223]
  ds_read_b128 a[120:123], v4 offset:15360
  buffer_load_dwordx4 v113, s[12:15], s19 offen offset:1024 lds
  v_mfma_f32_16x16x32_bf16 v[220:223], a[124:127], v[124:127], v[220:223]
  s_waitcnt lgkmcnt(11)
  ds_read_b128 a[124:127], v4 offset:31744
  v_mfma_f32_16x16x32_bf16 v[224:227], a[64:67], v[120:123], v[224:227]
  s_nop 0
  v_mfma_f32_16x16x32_bf16 v[224:227], a[68:71], v[124:127], v[224:227]
  v_mfma_f32_16x16x32_bf16 v[228:231], a[72:75], v[120:123], v[228:231]
  buffer_load_dwordx4 v114, s[12:15], s19 offen offset:2048 lds
  v_mfma_f32_16x16x32_bf16 v[228:231], a[76:79], v[124:127], v[228:231]
  s_waitcnt lgkmcnt(8)
  s_nop 0
  v_mfma_f32_16x16x32_bf16 v[232:235], a[80:83], v[120:123], v[232:235]
  v_mfma_f32_16x16x32_bf16 v[232:235], a[84:87], v[124:127], v[232:235]
  v_mfma_f32_16x16x32_bf16 v[236:239], a[88:91], v[120:123], v[236:239]
  buffer_load_dwordx4 v115, s[12:15], s19 offen offset:3072 lds
  v_mfma_f32_16x16x32_bf16 v[236:239], a[92:95], v[124:127], v[236:239]
  s_waitcnt lgkmcnt(4)
  s_nop 0
  v_mfma_f32_16x16x32_bf16 v[240:243], a[96:99], v[120:123], v[240:243]
  v_mfma_f32_16x16x32_bf16 v[240:243], a[100:103], v[124:127], v[240:243]
  s_add_u32 m0, s21, 69632
  v_mfma_f32_16x16x32_bf16 v[244:247], a[104:107], v[120:123], v[244:247]
  buffer_load_dwordx4 v112, s[12:15], s20 offen offset:0 lds
  v_mfma_f32_16x16x32_bf16 v[244:247], a[108:111], v[124:127], v[244:247]
  s_waitcnt lgkmcnt(0)
  s_nop 0
  v_mfma_f32_16x16x32_bf16 v[248:251], a[112:115], v[120:123], v[248:251]
  v_mfma_f32_16x16x32_bf16 v[248:251], a[116:119], v[124:127], v[248:251]
  v_mfma_f32_16x16x32_bf16 v[252:255], a[120:123], v[120:123], v[252:255]
  buffer_load_dwordx4 v113, s[12:15], s20 offen offset:1024 lds
  v_mfma_f32_16x16x32_bf16 v[252:255], a[124:127], v[124:127], v[252:255]
  s_barrier
  buffer_load_dwordx4 v114, s[12:15], s20 offen offset:2048 lds
  v_accvgpr_read_b32 v24, a192
  v_accvgpr_read_b32 v26, a196
  v_rcp_f32 v24, v24
  v_rcp_f32 v26, v26
  s_nop 0
  v_mov_b32 v25, v24
  v_mov_b32 v27, v26
  v_pk_mul_f32 v[128:129], v[128:129], v[24:25]
  v_pk_mul_f32 v[130:131], v[130:131], v[24:25]
  v_pk_mul_f32 v[132:133], v[132:133], v[24:25]
  v_pk_mul_f32 v[134:135], v[134:135], v[24:25]
  buffer_load_dwordx4 v115, s[12:15], s20 offen offset:3072 lds
  v_cvt_pk_bf16_f32 v128, v128, v129
  v_cvt_pk_bf16_f32 v129, v130, v131
  v_cvt_pk_bf16_f32 v130, v132, v133
  v_cvt_pk_bf16_f32 v131, v134, v135
  v_pk_mul_f32 v[136:137], v[136:137], v[24:25]
  v_pk_mul_f32 v[138:139], v[138:139], v[24:25]
  v_pk_mul_f32 v[140:141], v[140:141], v[24:25]
  v_pk_mul_f32 v[142:143], v[142:143], v[24:25]
  v_cvt_pk_bf16_f32 v136, v136, v137
  v_cvt_pk_bf16_f32 v137, v138, v139
  v_cvt_pk_bf16_f32 v138, v140, v141
  s_add_u32 s19, s19, 128
  s_add_u32 s20, s20, 128
  s_add_u32 m0, s21, 98304
  s_nop 0
  buffer_load_dwordx4 v112, s[12:15], s19 offen offset:0 lds
  v_cvt_pk_bf16_f32 v139, v142, v143
  v_pk_mul_f32 v[144:145], v[144:145], v[24:25]
  v_pk_mul_f32 v[146:147], v[146:147], v[24:25]
  v_pk_mul_f32 v[148:149], v[148:149], v[24:25]
  v_pk_mul_f32 v[150:151], v[150:151], v[24:25]
  v_cvt_pk_bf16_f32 v144, v144, v145
  v_cvt_pk_bf16_f32 v145, v146, v147
  v_cvt_pk_bf16_f32 v146, v148, v149
  v_cvt_pk_bf16_f32 v147, v150, v151
  v_pk_mul_f32 v[152:153], v[152:153], v[24:25]
  v_pk_mul_f32 v[154:155], v[154:155], v[24:25]
  buffer_load_dwordx4 v113, s[12:15], s19 offen offset:1024 lds
  v_pk_mul_f32 v[156:157], v[156:157], v[24:25]
  v_pk_mul_f32 v[158:159], v[158:159], v[24:25]
  v_cvt_pk_bf16_f32 v152, v152, v153
  v_cvt_pk_bf16_f32 v153, v154, v155
  v_cvt_pk_bf16_f32 v154, v156, v157
  v_cvt_pk_bf16_f32 v155, v158, v159
  v_pk_mul_f32 v[160:161], v[160:161], v[24:25]
  v_pk_mul_f32 v[162:163], v[162:163], v[24:25]
  v_pk_mul_f32 v[164:165], v[164:165], v[24:25]
  v_pk_mul_f32 v[166:167], v[166:167], v[24:25]
  v_cvt_pk_bf16_f32 v160, v160, v161
  buffer_load_dwordx4 v114, s[12:15], s19 offen offset:2048 lds
  v_cvt_pk_bf16_f32 v161, v162, v163
  v_cvt_pk_bf16_f32 v162, v164, v165
  v_cvt_pk_bf16_f32 v163, v166, v167
  v_pk_mul_f32 v[168:169], v[168:169], v[24:25]
  v_pk_mul_f32 v[170:171], v[170:171], v[24:25]
  v_pk_mul_f32 v[172:173], v[172:173], v[24:25]
  v_pk_mul_f32 v[174:175], v[174:175], v[24:25]
  v_cvt_pk_bf16_f32 v168, v168, v169
  v_cvt_pk_bf16_f32 v169, v170, v171
  v_cvt_pk_bf16_f32 v170, v172, v173
  v_cvt_pk_bf16_f32 v171, v174, v175
  buffer_load_dwordx4 v115, s[12:15], s19 offen offset:3072 lds
  v_pk_mul_f32 v[176:177], v[176:177], v[24:25]
  v_pk_mul_f32 v[178:179], v[178:179], v[24:25]
  v_pk_mul_f32 v[180:181], v[180:181], v[24:25]
  v_pk_mul_f32 v[182:183], v[182:183], v[24:25]
  v_cvt_pk_bf16_f32 v176, v176, v177
  v_cvt_pk_bf16_f32 v177, v178, v179
  v_cvt_pk_bf16_f32 v178, v180, v181
  v_cvt_pk_bf16_f32 v179, v182, v183
  v_pk_mul_f32 v[184:185], v[184:185], v[24:25]
  v_pk_mul_f32 v[186:187], v[186:187], v[24:25]
  v_pk_mul_f32 v[188:189], v[188:189], v[24:25]
  s_add_u32 m0, s21, 102400
  s_nop 0
  buffer_load_dwordx4 v112, s[12:15], s20 offen offset:0 lds
  v_pk_mul_f32 v[190:191], v[190:191], v[24:25]
  v_cvt_pk_bf16_f32 v184, v184, v185
  v_cvt_pk_bf16_f32 v185, v186, v187
  v_cvt_pk_bf16_f32 v186, v188, v189
  v_cvt_pk_bf16_f32 v187, v190, v191
  v_pk_mul_f32 v[192:193], v[192:193], v[26:27]
  v_pk_mul_f32 v[194:195], v[194:195], v[26:27]
  v_pk_mul_f32 v[196:197], v[196:197], v[26:27]
  v_pk_mul_f32 v[198:199], v[198:199], v[26:27]
  v_cvt_pk_bf16_f32 v192, v192, v193
  v_cvt_pk_bf16_f32 v193, v194, v195
  buffer_load_dwordx4 v113, s[12:15], s20 offen offset:1024 lds
  v_cvt_pk_bf16_f32 v194, v196, v197
  v_cvt_pk_bf16_f32 v195, v198, v199
  v_pk_mul_f32 v[200:201], v[200:201], v[26:27]
  v_pk_mul_f32 v[202:203], v[202:203], v[26:27]
  v_pk_mul_f32 v[204:205], v[204:205], v[26:27]
  v_pk_mul_f32 v[206:207], v[206:207], v[26:27]
  v_cvt_pk_bf16_f32 v200, v200, v201
  v_cvt_pk_bf16_f32 v201, v202, v203
  v_cvt_pk_bf16_f32 v202, v204, v205
  v_cvt_pk_bf16_f32 v203, v206, v207
  v_pk_mul_f32 v[208:209], v[208:209], v[26:27]
  buffer_load_dwordx4 v114, s[12:15], s20 offen offset:2048 lds
  v_pk_mul_f32 v[210:211], v[210:211], v[26:27]
  v_pk_mul_f32 v[212:213], v[212:213], v[26:27]
  v_pk_mul_f32 v[214:215], v[214:215], v[26:27]
  v_cvt_pk_bf16_f32 v208, v208, v209
  v_cvt_pk_bf16_f32 v209, v210, v211
  v_cvt_pk_bf16_f32 v210, v212, v213
  v_cvt_pk_bf16_f32 v211, v214, v215
  v_pk_mul_f32 v[216:217], v[216:217], v[26:27]
  v_pk_mul_f32 v[218:219], v[218:219], v[26:27]
  v_pk_mul_f32 v[220:221], v[220:221], v[26:27]
  v_pk_mul_f32 v[222:223], v[222:223], v[26:27]
  buffer_load_dwordx4 v115, s[12:15], s20 offen offset:3072 lds
  v_cvt_pk_bf16_f32 v216, v216, v217
  v_cvt_pk_bf16_f32 v217, v218, v219
  v_cvt_pk_bf16_f32 v218, v220, v221
  v_cvt_pk_bf16_f32 v219, v222, v223
  v_pk_mul_f32 v[224:225], v[224:225], v[26:27]
  v_pk_mul_f32 v[226:227], v[226:227], v[26:27]
  v_pk_mul_f32 v[228:229], v[228:229], v[26:27]
  v_pk_mul_f32 v[230:231], v[230:231], v[26:27]
  v_cvt_pk_bf16_f32 v224, v224, v225
  v_cvt_pk_bf16_f32 v225, v226, v227
  v_cvt_pk_bf16_f32 v226, v228, v229
  s_add_u32 s19, s19, 128
  s_add_u32 s20, s20, 128
  v_cvt_pk_bf16_f32 v227, v230, v231
  v_pk_mul_f32 v[232:233], v[232:233], v[26:27]
  v_pk_mul_f32 v[234:235], v[234:235], v[26:27]
  v_pk_mul_f32 v[236:237], v[236:237], v[26:27]
  v_pk_mul_f32 v[238:239], v[238:239], v[26:27]
  v_cvt_pk_bf16_f32 v232, v232, v233
  v_cvt_pk_bf16_f32 v233, v234, v235
  v_cvt_pk_bf16_f32 v234, v236, v237
  v_cvt_pk_bf16_f32 v235, v238, v239
  v_pk_mul_f32 v[240:241], v[240:241], v[26:27]
  v_pk_mul_f32 v[242:243], v[242:243], v[26:27]
  v_pk_mul_f32 v[244:245], v[244:245], v[26:27]
  v_pk_mul_f32 v[246:247], v[246:247], v[26:27]
  v_cvt_pk_bf16_f32 v240, v240, v241
  v_cvt_pk_bf16_f32 v241, v242, v243
  v_cvt_pk_bf16_f32 v242, v244, v245
  v_cvt_pk_bf16_f32 v243, v246, v247
  v_pk_mul_f32 v[248:249], v[248:249], v[26:27]
  v_pk_mul_f32 v[250:251], v[250:251], v[26:27]
  v_pk_mul_f32 v[252:253], v[252:253], v[26:27]
  v_pk_mul_f32 v[254:255], v[254:255], v[26:27]
  v_cvt_pk_bf16_f32 v248, v248, v249
  v_cvt_pk_bf16_f32 v249, v250, v251
  v_cvt_pk_bf16_f32 v250, v252, v253
  v_cvt_pk_bf16_f32 v251, v254, v255
L_k2_oproj:
  s_load_dwordx2 s[24:25], s[0:1], 0
  s_load_dwordx2 s[32:33], s[0:1], 56
  s_load_dwordx2 s[56:57], s[0:1], 64
  s_load_dwordx2 s[48:49], s[0:1], 72
  s_load_dwordx2 s[60:61], s[0:1], 80
  s_load_dwordx2 s[52:53], s[0:1], 88
  s_lshl_b32 s3, s44, 2
  s_sub_u32 s3, s45, s3
  v_lshrrev_b32 v59, 8, v0
  v_mov_b32 v60, 1073741824
  v_cmp_eq_u32 s[98:99], s3, v59
  s_nop 1
  v_cndmask_b32 v59, v0, v60, s[98:99]
  s_waitcnt vmcnt(24) lgkmcnt(0)
  s_barrier
  ds_read_b64_tr_b16 a[0:1], v116 offset:0
  ds_read_b64_tr_b16 a[2:3], v116 offset:2048
  ds_read_b64_tr_b16 a[4:5], v116 offset:4096
  ds_read_b64_tr_b16 a[6:7], v116 offset:6144
  ds_read_b64_tr_b16 a[8:9], v116 offset:8192
  ds_read_b64_tr_b16 a[10:11], v116 offset:10240
  ds_read_b64_tr_b16 a[12:13], v116 offset:12288
  ds_read_b64_tr_b16 a[14:15], v116 offset:14336
  ds_read_b64_tr_b16 a[16:17], v116 offset:16384
  ds_read_b64_tr_b16 a[18:19], v116 offset:18432
  ds_read_b64_tr_b16 a[20:21], v116 offset:20480
  ds_read_b64_tr_b16 a[22:23], v116 offset:22528
  ds_read_b64_tr_b16 a[24:25], v116 offset:24576
  ds_read_b64_tr_b16 a[26:27], v116 offset:26624
  ds_read_b64_tr_b16 a[28:29], v116 offset:28672
  ds_read_b64_tr_b16 a[30:31], v116 offset:30720
  ds_read_b64_tr_b16 a[32:33], v117 offset:0
  ds_read_b64_tr_b16 a[34:35], v117 offset:2048
  ds_read_b64_tr_b16 a[36:37], v117 offset:4096
  ds_read_b64_tr_b16 a[38:39], v117 offset:6144
  ds_read_b64_tr_b16 a[40:41], v117 offset:8192
  ds_read_b64_tr_b16 a[42:43], v117 offset:10240
  ds_read_b64_tr_b16 a[44:45], v117 offset:12288
  ds_read_b64_tr_b16 a[46:47], v117 offset:14336
  s_waitcnt lgkmcnt(8)
  v_mfma_f32_16x16x32_bf16 v[32:35], v[128:131], a[0:3], 0
  ds_read_b64_tr_b16 a[48:49], v117 offset:16384
  s_add_u32 m0, s21, 131072
  v_mfma_f32_16x16x32_bf16 v[32:35], v[136:139], a[4:7], v[32:35]
  ds_read_b64_tr_b16 a[50:51], v117 offset:18432
  buffer_load_dwordx4 v112, s[12:15], s19 offen offset:0 lds
  v_mfma_f32_16x16x32_bf16 v[32:35], v[144:147], a[8:11], v[32:35]
  ds_read_b64_tr_b16 a[52:53], v117 offset:20480
  v_lshrrev_b32_e64 v11, 4, v0
  v_mfma_f32_16x16x32_bf16 v[32:35], v[152:155], a[12:15], v[32:35]
  ds_read_b64_tr_b16 a[54:55], v117 offset:22528
  s_and_b32 s3, s2, 7
  v_mfma_f32_16x16x32_bf16 v[32:35], v[160:163], a[16:19], v[32:35]
  ds_read_b64_tr_b16 a[56:57], v117 offset:24576
  s_lshr_b32 s4, s2, 3
  v_mfma_f32_16x16x32_bf16 v[32:35], v[168:171], a[20:23], v[32:35]
  ds_read_b64_tr_b16 a[58:59], v117 offset:26624
  buffer_load_dwordx4 v113, s[12:15], s19 offen offset:1024 lds
  v_mfma_f32_16x16x32_bf16 v[32:35], v[176:179], a[24:27], v[32:35]
  ds_read_b64_tr_b16 a[60:61], v117 offset:28672
  s_and_b32 s5, s4, 7
  v_mfma_f32_16x16x32_bf16 v[32:35], v[184:187], a[28:31], v[32:35]
  ds_read_b64_tr_b16 a[62:63], v117 offset:30720
  s_bfe_u32 s6, s4, 0x10004
  v_mfma_f32_16x16x32_bf16 v[36:39], v[192:195], a[0:3], 0
  ds_read_b64_tr_b16 a[0:1], v118 offset:0
  s_lshl_b32 s6, s6, 3
  v_mfma_f32_16x16x32_bf16 v[36:39], v[200:203], a[4:7], v[36:39]
  ds_read_b64_tr_b16 a[2:3], v118 offset:2048
  buffer_load_dwordx4 v114, s[12:15], s19 offen offset:2048 lds
  v_mfma_f32_16x16x32_bf16 v[36:39], v[208:211], a[8:11], v[36:39]
  ds_read_b64_tr_b16 a[4:5], v118 offset:4096
  s_or_b32 s5, s5, s6
  v_mfma_f32_16x16x32_bf16 v[36:39], v[216:219], a[12:15], v[36:39]
  ds_read_b64_tr_b16 a[6:7], v118 offset:6144
  s_bfe_u32 s6, s4, 0x10003
  v_mfma_f32_16x16x32_bf16 v[36:39], v[224:227], a[16:19], v[36:39]
  ds_read_b64_tr_b16 a[8:9], v118 offset:8192
  s_xor_b32 s6, s6, 1
  v_mfma_f32_16x16x32_bf16 v[36:39], v[232:235], a[20:23], v[36:39]
  ds_read_b64_tr_b16 a[10:11], v118 offset:10240
  buffer_load_dwordx4 v115, s[12:15], s19 offen offset:3072 lds
  v_mfma_f32_16x16x32_bf16 v[36:39], v[240:243], a[24:27], v[36:39]
  ds_read_b64_tr_b16 a[12:13], v118 offset:12288
  s_lshl_b32 s6, s6, 4
  v_mfma_f32_16x16x32_bf16 v[36:39], v[248:251], a[28:31], v[36:39]
  s_waitcnt lgkmcnt(15)
  ds_read_b64_tr_b16 a[14:15], v118 offset:14336
  v_mfma_f32_16x16x32_bf16 v[40:43], v[128:131], a[32:35], 0
  ds_read_b64_tr_b16 a[16:17], v118 offset:16384
  s_add_u32 m0, s21, 135168
  v_mfma_f32_16x16x32_bf16 v[40:43], v[136:139], a[36:39], v[40:43]
  ds_read_b64_tr_b16 a[18:19], v118 offset:18432
  buffer_load_dwordx4 v112, s[12:15], s20 offen offset:0 lds
  v_mfma_f32_16x16x32_bf16 v[40:43], v[144:147], a[40:43], v[40:43]
  ds_read_b64_tr_b16 a[20:21], v118 offset:20480
  s_or_b32 s23, s5, s6
  v_mfma_f32_16x16x32_bf16 v[40:43], v[152:155], a[44:47], v[40:43]
  s_waitcnt lgkmcnt(11)
  ds_read_b64_tr_b16 a[22:23], v118 offset:22528
  s_and_b32 s5, s3, 1
  v_mfma_f32_16x16x32_bf16 v[40:43], v[160:163], a[48:51], v[40:43]
  ds_read_b64_tr_b16 a[24:25], v118 offset:24576
  v_cvt_pk_bf16_f32 v132, v32, v33
  v_mfma_f32_16x16x32_bf16 v[40:43], v[168:171], a[52:55], v[40:43]
  ds_read_b64_tr_b16 a[26:27], v118 offset:26624
  v_cvt_pk_bf16_f32 v133, v34, v35
  v_mfma_f32_16x16x32_bf16 v[40:43], v[176:179], a[56:59], v[40:43]
  ds_read_b64_tr_b16 a[28:29], v118 offset:28672
  v_cvt_pk_bf16_f32 v134, v36, v37
  v_mfma_f32_16x16x32_bf16 v[40:43], v[184:187], a[60:63], v[40:43]
  ds_read_b64_tr_b16 a[30:31], v118 offset:30720
  v_cvt_pk_bf16_f32 v135, v38, v39
  v_mfma_f32_16x16x32_bf16 v[44:47], v[192:195], a[32:35], 0
  ds_read_b64_tr_b16 a[32:33], v119 offset:0
  buffer_store_dwordx4 v[132:135], v59, s[8:11], s18 offen offset:0 sc1
  v_mfma_f32_16x16x32_bf16 v[44:47], v[200:203], a[36:39], v[44:47]
  ds_read_b64_tr_b16 a[34:35], v119 offset:2048
  buffer_load_dwordx4 v113, s[12:15], s20 offen offset:1024 lds
  v_mfma_f32_16x16x32_bf16 v[44:47], v[208:211], a[40:43], v[44:47]
  ds_read_b64_tr_b16 a[36:37], v119 offset:4096
  s_sub_u32 s6, 25, s5
  v_mfma_f32_16x16x32_bf16 v[44:47], v[216:219], a[44:47], v[44:47]
  ds_read_b64_tr_b16 a[38:39], v119 offset:6144
  s_cmp_lt_u32 s23, s6
  s_cselect_b32 s38, 1, 0
  v_mfma_f32_16x16x32_bf16 v[44:47], v[224:227], a[48:51], v[44:47]
  ds_read_b64_tr_b16 a[40:41], v119 offset:8192
  s_mul_i32 s5, s5, 25
  v_mfma_f32_16x16x32_bf16 v[44:47], v[232:235], a[52:55], v[44:47]
  ds_read_b64_tr_b16 a[42:43], v119 offset:10240
  buffer_load_dwordx4 v114, s[12:15], s20 offen offset:2048 lds
  v_mfma_f32_16x16x32_bf16 v[44:47], v[240:243], a[56:59], v[44:47]
  ds_read_b64_tr_b16 a[44:45], v119 offset:12288
  s_add_u32 s5, s5, s23
  v_mfma_f32_16x16x32_bf16 v[44:47], v[248:251], a[60:63], v[44:47]
  s_waitcnt lgkmcnt(15)
  ds_read_b64_tr_b16 a[46:47], v119 offset:14336
  v_mfma_f32_16x16x32_bf16 v[32:35], v[128:131], a[0:3], 0
  ds_read_b64_tr_b16 a[48:49], v119 offset:16384
  s_lshr_b32 s6, s3, 1
  v_mfma_f32_16x16x32_bf16 v[32:35], v[136:139], a[4:7], v[32:35]
  ds_read_b64_tr_b16 a[50:51], v119 offset:18432
  buffer_load_dwordx4 v115, s[12:15], s20 offen offset:3072 lds
  v_mfma_f32_16x16x32_bf16 v[32:35], v[144:147], a[8:11], v[32:35]
  ds_read_b64_tr_b16 a[52:53], v119 offset:20480
  s_mul_i32 s6, s6, 49
  v_mfma_f32_16x16x32_bf16 v[32:35], v[152:155], a[12:15], v[32:35]
  s_waitcnt lgkmcnt(11)
  ds_read_b64_tr_b16 a[54:55], v119 offset:22528
  s_add_u32 s5, s5, s6
  v_mfma_f32_16x16x32_bf16 v[32:35], v[160:163], a[16:19], v[32:35]
  ds_read_b64_tr_b16 a[56:57], v119 offset:24576
  v_cvt_pk_bf16_f32 v140, v40, v41
  s_mul_i32 s46, s5, 9363
  v_mfma_f32_16x16x32_bf16 v[32:35], v[168:171], a[20:23], v[32:35]
  ds_read_b64_tr_b16 a[58:59], v119 offset:26624
  v_cvt_pk_bf16_f32 v141, v42, v43
  s_lshr_b32 s46, s46, 16
  v_mfma_f32_16x16x32_bf16 v[32:35], v[176:179], a[24:27], v[32:35]
  ds_read_b64_tr_b16 a[60:61], v119 offset:28672
  v_cvt_pk_bf16_f32 v142, v44, v45
  s_mul_i32 s6, s46, 7
  v_mfma_f32_16x16x32_bf16 v[32:35], v[184:187], a[28:31], v[32:35]
  ds_read_b64_tr_b16 a[62:63], v119 offset:30720
  s_waitcnt vmcnt(25)
  v_mfma_f32_16x16x32_bf16 v[36:39], v[192:195], a[0:3], 0
  s_barrier
  ds_read_b64_tr_b16 a[0:1], v116 offset:32768
  v_mfma_f32_16x16x32_bf16 v[36:39], v[200:203], a[4:7], v[36:39]
  ds_read_b64_tr_b16 a[2:3], v116 offset:34816
  v_cvt_pk_bf16_f32 v143, v46, v47
  v_mfma_f32_16x16x32_bf16 v[36:39], v[208:211], a[8:11], v[36:39]
  ds_read_b64_tr_b16 a[4:5], v116 offset:36864
  buffer_store_dwordx4 v[140:143], v59, s[8:11], s18 offen offset:1024 sc1
  v_mfma_f32_16x16x32_bf16 v[36:39], v[216:219], a[12:15], v[36:39]
  ds_read_b64_tr_b16 a[6:7], v116 offset:38912
  s_add_u32 s19, s19, 128
  v_mfma_f32_16x16x32_bf16 v[36:39], v[224:227], a[16:19], v[36:39]
  ds_read_b64_tr_b16 a[8:9], v116 offset:40960
  s_add_u32 s20, s20, 128
  v_mfma_f32_16x16x32_bf16 v[36:39], v[232:235], a[20:23], v[36:39]
  ds_read_b64_tr_b16 a[10:11], v116 offset:43008
  s_sub_u32 s47, s5, s6
  v_mfma_f32_16x16x32_bf16 v[36:39], v[240:243], a[24:27], v[36:39]
  ds_read_b64_tr_b16 a[12:13], v116 offset:45056
  v_lshrrev_b32_e64 v12, 4, v11
  v_mfma_f32_16x16x32_bf16 v[36:39], v[248:251], a[28:31], v[36:39]
  s_waitcnt lgkmcnt(15)
  ds_read_b64_tr_b16 a[14:15], v116 offset:47104
  v_mfma_f32_16x16x32_bf16 v[40:43], v[128:131], a[32:35], 0
  ds_read_b64_tr_b16 a[16:17], v116 offset:49152
  v_lshrrev_b32 v52, 3, v11
  v_mfma_f32_16x16x32_bf16 v[40:43], v[136:139], a[36:39], v[40:43]
  ds_read_b64_tr_b16 a[18:19], v116 offset:51200
  v_mul_u32_u24 v52, 3584, v52
  v_mfma_f32_16x16x32_bf16 v[40:43], v[144:147], a[40:43], v[40:43]
  ds_read_b64_tr_b16 a[20:21], v116 offset:53248
  v_lshlrev_b32_e64 v53, 1, v12
  v_mfma_f32_16x16x32_bf16 v[40:43], v[152:155], a[44:47], v[40:43]
  s_waitcnt lgkmcnt(11)
  ds_read_b64_tr_b16 a[22:23], v116 offset:55296
  v_mfma_f32_16x16x32_bf16 v[40:43], v[160:163], a[48:51], v[40:43]
  ds_read_b64_tr_b16 a[24:25], v116 offset:57344
  v_cvt_pk_bf16_f32 v148, v32, v33
  v_mfma_f32_16x16x32_bf16 v[40:43], v[168:171], a[52:55], v[40:43]
  ds_read_b64_tr_b16 a[26:27], v116 offset:59392
  v_cvt_pk_bf16_f32 v149, v34, v35
  v_mfma_f32_16x16x32_bf16 v[40:43], v[176:179], a[56:59], v[40:43]
  ds_read_b64_tr_b16 a[28:29], v116 offset:61440
  v_cvt_pk_bf16_f32 v150, v36, v37
  v_mfma_f32_16x16x32_bf16 v[40:43], v[184:187], a[60:63], v[40:43]
  ds_read_b64_tr_b16 a[30:31], v116 offset:63488
  v_cvt_pk_bf16_f32 v151, v38, v39
  v_mfma_f32_16x16x32_bf16 v[44:47], v[192:195], a[32:35], 0
  ds_read_b64_tr_b16 a[32:33], v117 offset:32768
  buffer_store_dwordx4 v[148:151], v59, s[8:11], s18 offen offset:2048 sc1
  v_mfma_f32_16x16x32_bf16 v[44:47], v[200:203], a[36:39], v[44:47]
  ds_read_b64_tr_b16 a[34:35], v117 offset:34816
  v_and_b32 v54, 7, v11
  v_mfma_f32_16x16x32_bf16 v[44:47], v[208:211], a[40:43], v[44:47]
  ds_read_b64_tr_b16 a[36:37], v117 offset:36864
  v_xor_b32_e64 v53, v53, v54
  v_mfma_f32_16x16x32_bf16 v[44:47], v[216:219], a[44:47], v[44:47]
  ds_read_b64_tr_b16 a[38:39], v117 offset:38912
  v_lshl_add_u32 v1, v53, 4, v52
  v_mfma_f32_16x16x32_bf16 v[44:47], v[224:227], a[48:51], v[44:47]
  ds_read_b64_tr_b16 a[40:41], v117 offset:40960
  v_add_u32 v2, 27648, v1
  v_mfma_f32_16x16x32_bf16 v[44:47], v[232:235], a[52:55], v[44:47]
  ds_read_b64_tr_b16 a[42:43], v117 offset:43008
  v_add_u32 v3, 55296, v1
  v_mfma_f32_16x16x32_bf16 v[44:47], v[240:243], a[56:59], v[44:47]
  ds_read_b64_tr_b16 a[44:45], v117 offset:45056
  v_add_u32 v4, 82944, v1
  v_mfma_f32_16x16x32_bf16 v[44:47], v[248:251], a[60:63], v[44:47]
  s_waitcnt lgkmcnt(15)
  ds_read_b64_tr_b16 a[46:47], v117 offset:47104
  v_mfma_f32_16x16x32_bf16 v[32:35], v[128:131], a[0:3], 0
  ds_read_b64_tr_b16 a[48:49], v117 offset:49152
  s_mul_i32 s40, s44, 1835008
  v_mfma_f32_16x16x32_bf16 v[32:35], v[136:139], a[4:7], v[32:35]
  ds_read_b64_tr_b16 a[50:51], v117 offset:51200
  s_lshl_b32 s5, s46, 7
  v_mfma_f32_16x16x32_bf16 v[32:35], v[144:147], a[8:11], v[32:35]
  ds_read_b64_tr_b16 a[52:53], v117 offset:53248
  s_add_u32 s40, s40, s5
  v_mfma_f32_16x16x32_bf16 v[32:35], v[152:155], a[12:15], v[32:35]
  s_waitcnt lgkmcnt(11)
  ds_read_b64_tr_b16 a[54:55], v117 offset:55296
  s_cmp_eq_u32 s38, 0
  s_cselect_b32 s40, 0x80000000, s40
  v_mfma_f32_16x16x32_bf16 v[32:35], v[160:163], a[16:19], v[32:35]
  ds_read_b64_tr_b16 a[56:57], v117 offset:57344
  v_cvt_pk_bf16_f32 v156, v40, v41
  v_mfma_f32_16x16x32_bf16 v[32:35], v[168:171], a[20:23], v[32:35]
  ds_read_b64_tr_b16 a[58:59], v117 offset:59392
  v_cvt_pk_bf16_f32 v157, v42, v43
  v_mfma_f32_16x16x32_bf16 v[32:35], v[176:179], a[24:27], v[32:35]
  ds_read_b64_tr_b16 a[60:61], v117 offset:61440
  v_cvt_pk_bf16_f32 v158, v44, v45
  v_mfma_f32_16x16x32_bf16 v[32:35], v[184:187], a[28:31], v[32:35]
  ds_read_b64_tr_b16 a[62:63], v117 offset:63488
  v_cvt_pk_bf16_f32 v159, v46, v47
  v_mfma_f32_16x16x32_bf16 v[36:39], v[192:195], a[0:3], 0
  ds_read_b64_tr_b16 a[0:1], v118 offset:32768
  buffer_store_dwordx4 v[156:159], v59, s[8:11], s18 offen offset:3072 sc1
  v_mfma_f32_16x16x32_bf16 v[36:39], v[200:203], a[4:7], v[36:39]
  ds_read_b64_tr_b16 a[2:3], v118 offset:34816
  s_add_u32 s18, s18, 4096
  v_mfma_f32_16x16x32_bf16 v[36:39], v[208:211], a[8:11], v[36:39]
  ds_read_b64_tr_b16 a[4:5], v118 offset:36864
  s_mov_b32 s34, 7340032
  v_mfma_f32_16x16x32_bf16 v[36:39], v[216:219], a[12:15], v[36:39]
  ds_read_b64_tr_b16 a[6:7], v118 offset:38912
  s_mov_b32 s35, 0x20000
  v_mfma_f32_16x16x32_bf16 v[36:39], v[224:227], a[16:19], v[36:39]
  ds_read_b64_tr_b16 a[8:9], v118 offset:40960
  s_lshl_b32 s5, s3, 1
  v_mfma_f32_16x16x32_bf16 v[36:39], v[232:235], a[20:23], v[36:39]
  ds_read_b64_tr_b16 a[10:11], v118 offset:43008
  s_lshr_b32 s6, s4, 4
  v_mfma_f32_16x16x32_bf16 v[36:39], v[240:243], a[24:27], v[36:39]
  ds_read_b64_tr_b16 a[12:13], v118 offset:45056
  s_add_u32 s22, s5, s6
  v_mfma_f32_16x16x32_bf16 v[36:39], v[248:251], a[28:31], v[36:39]
  s_waitcnt lgkmcnt(15)
  ds_read_b64_tr_b16 a[14:15], v118 offset:47104
  v_mfma_f32_16x16x32_bf16 v[40:43], v[128:131], a[32:35], 0
  ds_read_b64_tr_b16 a[16:17], v118 offset:49152
  s_and_b32 s6, s4, 15
  v_mfma_f32_16x16x32_bf16 v[40:43], v[136:139], a[36:39], v[40:43]
  ds_read_b64_tr_b16 a[18:19], v118 offset:51200
  s_sub_u32 s7, 7, s6
  v_mfma_f32_16x16x32_bf16 v[40:43], v[144:147], a[40:43], v[40:43]
  ds_read_b64_tr_b16 a[20:21], v118 offset:53248
  s_cmp_ge_u32 s6, 8
  s_cselect_b32 s45, s6, s7
  v_mfma_f32_16x16x32_bf16 v[40:43], v[152:155], a[44:47], v[40:43]
  s_waitcnt lgkmcnt(11)
  ds_read_b64_tr_b16 a[22:23], v118 offset:55296
  v_mfma_f32_16x16x32_bf16 v[40:43], v[160:163], a[48:51], v[40:43]
  ds_read_b64_tr_b16 a[24:25], v118 offset:57344
  v_cvt_pk_bf16_f32 v164, v32, v33
  v_mfma_f32_16x16x32_bf16 v[40:43], v[168:171], a[52:55], v[40:43]
  ds_read_b64_tr_b16 a[26:27], v118 offset:59392
  v_cvt_pk_bf16_f32 v165, v34, v35
  v_mfma_f32_16x16x32_bf16 v[40:43], v[176:179], a[56:59], v[40:43]
  ds_read_b64_tr_b16 a[28:29], v118 offset:61440
  v_cvt_pk_bf16_f32 v166, v36, v37
  v_mfma_f32_16x16x32_bf16 v[40:43], v[184:187], a[60:63], v[40:43]
  ds_read_b64_tr_b16 a[30:31], v118 offset:63488
  v_cvt_pk_bf16_f32 v167, v38, v39
  v_mfma_f32_16x16x32_bf16 v[44:47], v[192:195], a[32:35], 0
  ds_read_b64_tr_b16 a[32:33], v119 offset:32768
  buffer_store_dwordx4 v[164:167], v59, s[8:11], s18 offen offset:0 sc1
  v_mfma_f32_16x16x32_bf16 v[44:47], v[200:203], a[36:39], v[44:47]
  ds_read_b64_tr_b16 a[34:35], v119 offset:34816
  s_lshr_b32 s6, s22, 2
  v_mfma_f32_16x16x32_bf16 v[44:47], v[208:211], a[40:43], v[44:47]
  ds_read_b64_tr_b16 a[36:37], v119 offset:36864
  s_and_b32 s5, s22, 3
  v_mfma_f32_16x16x32_bf16 v[44:47], v[216:219], a[44:47], v[44:47]
  ds_read_b64_tr_b16 a[38:39], v119 offset:38912
  s_lshl_b32 s7, s45, 2
  v_mfma_f32_16x16x32_bf16 v[44:47], v[224:227], a[48:51], v[44:47]
  ds_read_b64_tr_b16 a[40:41], v119 offset:40960
  s_add_u32 s7, s7, s6
  v_mfma_f32_16x16x32_bf16 v[44:47], v[232:235], a[52:55], v[44:47]
  ds_read_b64_tr_b16 a[42:43], v119 offset:43008
  s_mul_i32 s7, s7, 28672
  v_mfma_f32_16x16x32_bf16 v[44:47], v[240:243], a[56:59], v[44:47]
  ds_read_b64_tr_b16 a[44:45], v119 offset:45056
  s_lshl_b32 s28, s5, 8
  v_mfma_f32_16x16x32_bf16 v[44:47], v[248:251], a[60:63], v[44:47]
  s_waitcnt lgkmcnt(15)
  ds_read_b64_tr_b16 a[46:47], v119 offset:47104
  v_mfma_f32_16x16x32_bf16 v[32:35], v[128:131], a[0:3], 0
  ds_read_b64_tr_b16 a[48:49], v119 offset:49152
  s_add_u32 s65, s7, s28
  v_mfma_f32_16x16x32_bf16 v[32:35], v[136:139], a[4:7], v[32:35]
  ds_read_b64_tr_b16 a[50:51], v119 offset:51200
  s_lshl_b32 s28, s45, 7
  v_mfma_f32_16x16x32_bf16 v[32:35], v[144:147], a[8:11], v[32:35]
  ds_read_b64_tr_b16 a[52:53], v119 offset:53248
  s_lshl_b32 s5, s5, 2
  v_mfma_f32_16x16x32_bf16 v[32:35], v[152:155], a[12:15], v[32:35]
  s_waitcnt lgkmcnt(11)
  ds_read_b64_tr_b16 a[54:55], v119 offset:55296
  s_add_u32 s28, s28, s5
  v_mfma_f32_16x16x32_bf16 v[32:35], v[160:163], a[16:19], v[32:35]
  ds_read_b64_tr_b16 a[56:57], v119 offset:57344
  v_cvt_pk_bf16_f32 v172, v40, v41
  s_lshl_b32 s6, s6, 4
  v_mfma_f32_16x16x32_bf16 v[32:35], v[168:171], a[20:23], v[32:35]
  ds_read_b64_tr_b16 a[58:59], v119 offset:59392
  v_cvt_pk_bf16_f32 v173, v42, v43
  s_add_u32 s29, s28, s6
  v_mfma_f32_16x16x32_bf16 v[32:35], v[176:179], a[24:27], v[32:35]
  ds_read_b64_tr_b16 a[60:61], v119 offset:61440
  v_add_u32 v116, 0x10000, v116
  s_sub_u32 s30, s28, s6
  v_mfma_f32_16x16x32_bf16 v[32:35], v[184:187], a[28:31], v[32:35]
  ds_read_b64_tr_b16 a[62:63], v119 offset:63488
  s_waitcnt vmcnt(21)
  s_add_u32 s30, s30, 112
  v_mfma_f32_16x16x32_bf16 v[36:39], v[192:195], a[0:3], 0
  s_barrier
  ds_read_b64_tr_b16 a[0:1], v116 offset:0
  v_mfma_f32_16x16x32_bf16 v[36:39], v[200:203], a[4:7], v[36:39]
  ds_read_b64_tr_b16 a[2:3], v116 offset:2048
  v_cvt_pk_bf16_f32 v174, v44, v45
  v_mfma_f32_16x16x32_bf16 v[36:39], v[208:211], a[8:11], v[36:39]
  ds_read_b64_tr_b16 a[4:5], v116 offset:4096
  v_cvt_pk_bf16_f32 v175, v46, v47
  v_mfma_f32_16x16x32_bf16 v[36:39], v[216:219], a[12:15], v[36:39]
  ds_read_b64_tr_b16 a[6:7], v116 offset:6144
  buffer_store_dwordx4 v[172:175], v59, s[8:11], s18 offen offset:1024 sc1
  v_mfma_f32_16x16x32_bf16 v[36:39], v[224:227], a[16:19], v[36:39]
  ds_read_b64_tr_b16 a[8:9], v116 offset:8192
  s_add_u32 m0, s21, 0
  v_mfma_f32_16x16x32_bf16 v[36:39], v[232:235], a[20:23], v[36:39]
  ds_read_b64_tr_b16 a[10:11], v116 offset:10240
  buffer_load_dwordx4 v112, s[12:15], s19 offen offset:0 lds
  v_mfma_f32_16x16x32_bf16 v[36:39], v[240:243], a[24:27], v[36:39]
  ds_read_b64_tr_b16 a[12:13], v116 offset:12288
  s_mul_i32 s29, s29, 896
  v_mfma_f32_16x16x32_bf16 v[36:39], v[248:251], a[28:31], v[36:39]
  s_waitcnt lgkmcnt(15)
  ds_read_b64_tr_b16 a[14:15], v116 offset:14336
  v_mfma_f32_16x16x32_bf16 v[40:43], v[128:131], a[32:35], 0
  ds_read_b64_tr_b16 a[16:17], v116 offset:16384
  s_mul_i32 s30, s30, 896
  v_mfma_f32_16x16x32_bf16 v[40:43], v[136:139], a[36:39], v[40:43]
  ds_read_b64_tr_b16 a[18:19], v116 offset:18432
  buffer_load_dwordx4 v113, s[12:15], s19 offen offset:1024 lds
  v_mfma_f32_16x16x32_bf16 v[40:43], v[144:147], a[40:43], v[40:43]
  ds_read_b64_tr_b16 a[20:21], v116 offset:20480
  s_mul_i32 s5, s44, 112
  v_mfma_f32_16x16x32_bf16 v[40:43], v[152:155], a[44:47], v[40:43]
  s_waitcnt lgkmcnt(11)
  ds_read_b64_tr_b16 a[22:23], v116 offset:22528
  v_add_u32 v55, s5, v11
  v_mfma_f32_16x16x32_bf16 v[40:43], v[160:163], a[48:51], v[40:43]
  ds_read_b64_tr_b16 a[24:25], v116 offset:24576
  v_cvt_pk_bf16_f32 v180, v32, v33
  v_mov_b32_e64 v56, 1073741824
  v_mfma_f32_16x16x32_bf16 v[40:43], v[168:171], a[52:55], v[40:43]
  ds_read_b64_tr_b16 a[26:27], v116 offset:26624
  v_cvt_pk_bf16_f32 v181, v34, v35
  v_mfma_f32_16x16x32_bf16 v[40:43], v[176:179], a[56:59], v[40:43]
  ds_read_b64_tr_b16 a[28:29], v116 offset:28672
  v_add_u32 v117, 0x10000, v117
  v_mfma_f32_16x16x32_bf16 v[40:43], v[184:187], a[60:63], v[40:43]
  ds_read_b64_tr_b16 a[30:31], v116 offset:30720
  v_cvt_pk_bf16_f32 v182, v36, v37
  v_mfma_f32_16x16x32_bf16 v[44:47], v[192:195], a[32:35], 0
  ds_read_b64_tr_b16 a[32:33], v117 offset:0
  v_cvt_pk_bf16_f32 v183, v38, v39
  v_mfma_f32_16x16x32_bf16 v[44:47], v[200:203], a[36:39], v[44:47]
  ds_read_b64_tr_b16 a[34:35], v117 offset:2048
  buffer_store_dwordx4 v[180:183], v59, s[8:11], s18 offen offset:2048 sc1
  v_mfma_f32_16x16x32_bf16 v[44:47], v[208:211], a[40:43], v[44:47]
  ds_read_b64_tr_b16 a[36:37], v117 offset:4096
  buffer_load_dwordx4 v114, s[12:15], s19 offen offset:2048 lds
  v_mfma_f32_16x16x32_bf16 v[44:47], v[216:219], a[44:47], v[44:47]
  ds_read_b64_tr_b16 a[38:39], v117 offset:6144
  v_cmp_gt_u32 vcc, 48, v11
  v_mfma_f32_16x16x32_bf16 v[44:47], v[224:227], a[48:51], v[44:47]
  ds_read_b64_tr_b16 a[40:41], v117 offset:8192
  v_lshlrev_b32 v24, 1, v55
  v_mfma_f32_16x16x32_bf16 v[44:47], v[232:235], a[52:55], v[44:47]
  ds_read_b64_tr_b16 a[42:43], v117 offset:10240
  v_add_u32 v25, 128, v24
  v_mfma_f32_16x16x32_bf16 v[44:47], v[240:243], a[56:59], v[44:47]
  ds_read_b64_tr_b16 a[44:45], v117 offset:12288
  buffer_load_dwordx4 v115, s[12:15], s19 offen offset:3072 lds
  v_mfma_f32_16x16x32_bf16 v[44:47], v[248:251], a[60:63], v[44:47]
  s_waitcnt lgkmcnt(15)
  ds_read_b64_tr_b16 a[46:47], v117 offset:14336
  v_mfma_f32_16x16x32_bf16 v[32:35], v[128:131], a[0:3], 0
  ds_read_b64_tr_b16 a[48:49], v117 offset:16384
  s_mov_b32 s26, 1835008
  v_mfma_f32_16x16x32_bf16 v[32:35], v[136:139], a[4:7], v[32:35]
  ds_read_b64_tr_b16 a[50:51], v117 offset:18432
  s_add_u32 m0, s21, 4096
  s_mov_b32 s27, 0x20000
  v_mfma_f32_16x16x32_bf16 v[32:35], v[144:147], a[8:11], v[32:35]
  ds_read_b64_tr_b16 a[52:53], v117 offset:20480
  buffer_load_dwordx4 v112, s[12:15], s20 offen offset:0 lds
  v_cndmask_b32 v25, v56, v25, vcc
  v_mfma_f32_16x16x32_bf16 v[32:35], v[152:155], a[12:15], v[32:35]
  s_waitcnt lgkmcnt(11)
  ds_read_b64_tr_b16 a[54:55], v117 offset:22528
  s_lshl_b32 s45, s45, 4
  v_mfma_f32_16x16x32_bf16 v[32:35], v[160:163], a[16:19], v[32:35]
  ds_read_b64_tr_b16 a[56:57], v117 offset:24576
  v_cvt_pk_bf16_f32 v188, v40, v41
  buffer_load_ushort v96, v24, s[24:27], s29 offen offset:0
  v_mfma_f32_16x16x32_bf16 v[32:35], v[168:171], a[20:23], v[32:35]
  ds_read_b64_tr_b16 a[58:59], v117 offset:26624
  v_cvt_pk_bf16_f32 v189, v42, v43
  s_add_u32 s45, s45, s22
  v_mfma_f32_16x16x32_bf16 v[32:35], v[176:179], a[24:27], v[32:35]
  ds_read_b64_tr_b16 a[60:61], v117 offset:28672
  v_add_u32 v118, 0x10000, v118
  v_mfma_f32_16x16x32_bf16 v[32:35], v[184:187], a[28:31], v[32:35]
  ds_read_b64_tr_b16 a[62:63], v117 offset:30720
  v_cvt_pk_bf16_f32 v190, v44, v45
  v_mfma_f32_16x16x32_bf16 v[36:39], v[192:195], a[0:3], 0
  ds_read_b64_tr_b16 a[0:1], v118 offset:0
  v_cvt_pk_bf16_f32 v191, v46, v47
  v_mfma_f32_16x16x32_bf16 v[36:39], v[200:203], a[4:7], v[36:39]
  ds_read_b64_tr_b16 a[2:3], v118 offset:2048
  buffer_store_dwordx4 v[188:191], v59, s[8:11], s18 offen offset:3072 sc1
  v_mfma_f32_16x16x32_bf16 v[36:39], v[208:211], a[8:11], v[36:39]
  ds_read_b64_tr_b16 a[4:5], v118 offset:4096
  s_add_u32 s18, s18, 4096
  v_mfma_f32_16x16x32_bf16 v[36:39], v[216:219], a[12:15], v[36:39]
  ds_read_b64_tr_b16 a[6:7], v118 offset:6144
  buffer_load_dwordx4 v113, s[12:15], s20 offen offset:1024 lds
  v_mfma_f32_16x16x32_bf16 v[36:39], v[224:227], a[16:19], v[36:39]
  ds_read_b64_tr_b16 a[8:9], v118 offset:8192
  s_mul_i32 s5, s44, 7
  v_mfma_f32_16x16x32_bf16 v[36:39], v[232:235], a[20:23], v[36:39]
  ds_read_b64_tr_b16 a[10:11], v118 offset:10240
  v_mfma_f32_16x16x32_bf16 v[36:39], v[240:243], a[24:27], v[36:39]
  ds_read_b64_tr_b16 a[12:13], v118 offset:12288
  v_and_b32_e64 v13, 15, v11
  v_mfma_f32_16x16x32_bf16 v[36:39], v[248:251], a[28:31], v[36:39]
  s_waitcnt lgkmcnt(15)
  ds_read_b64_tr_b16 a[14:15], v118 offset:14336
  v_mfma_f32_16x16x32_bf16 v[40:43], v[128:131], a[32:35], 0
  ds_read_b64_tr_b16 a[16:17], v118 offset:16384
  buffer_load_dwordx4 v114, s[12:15], s20 offen offset:2048 lds
  v_mfma_f32_16x16x32_bf16 v[40:43], v[136:139], a[36:39], v[40:43]
  ds_read_b64_tr_b16 a[18:19], v118 offset:18432
  v_add_u32 v14, s5, v12
  v_mfma_f32_16x16x32_bf16 v[40:43], v[144:147], a[40:43], v[40:43]
  ds_read_b64_tr_b16 a[20:21], v118 offset:20480
  v_mfma_f32_16x16x32_bf16 v[40:43], v[152:155], a[44:47], v[40:43]
  s_waitcnt lgkmcnt(11)
  ds_read_b64_tr_b16 a[22:23], v118 offset:22528
  v_lshlrev_b32 v14, 10, v14
  v_mfma_f32_16x16x32_bf16 v[40:43], v[160:163], a[48:51], v[40:43]
  ds_read_b64_tr_b16 a[24:25], v118 offset:24576
  v_cvt_pk_bf16_f32 v196, v32, v33
  buffer_load_ushort v97, v24, s[24:27], s29 offen offset:896
  v_mfma_f32_16x16x32_bf16 v[40:43], v[168:171], a[52:55], v[40:43]
  ds_read_b64_tr_b16 a[26:27], v118 offset:26624
  v_cvt_pk_bf16_f32 v197, v34, v35
  v_mfma_f32_16x16x32_bf16 v[40:43], v[176:179], a[56:59], v[40:43]
  ds_read_b64_tr_b16 a[28:29], v118 offset:28672
  v_add_u32 v119, 0x10000, v119
  v_mfma_f32_16x16x32_bf16 v[40:43], v[184:187], a[60:63], v[40:43]
  ds_read_b64_tr_b16 a[30:31], v118 offset:30720
  v_cvt_pk_bf16_f32 v198, v36, v37
  v_mfma_f32_16x16x32_bf16 v[44:47], v[192:195], a[32:35], 0
  ds_read_b64_tr_b16 a[32:33], v119 offset:0
  v_cvt_pk_bf16_f32 v199, v38, v39
  v_mfma_f32_16x16x32_bf16 v[44:47], v[200:203], a[36:39], v[44:47]
  ds_read_b64_tr_b16 a[34:35], v119 offset:2048
  buffer_store_dwordx4 v[196:199], v59, s[8:11], s18 offen offset:0 sc1
  v_mfma_f32_16x16x32_bf16 v[44:47], v[208:211], a[40:43], v[44:47]
  ds_read_b64_tr_b16 a[36:37], v119 offset:4096
  buffer_load_dwordx4 v115, s[12:15], s20 offen offset:3072 lds
  v_mfma_f32_16x16x32_bf16 v[44:47], v[216:219], a[44:47], v[44:47]
  ds_read_b64_tr_b16 a[38:39], v119 offset:6144
  v_lshl_add_u32 v14, v13, 4, v14
  v_mfma_f32_16x16x32_bf16 v[44:47], v[224:227], a[48:51], v[44:47]
  ds_read_b64_tr_b16 a[40:41], v119 offset:8192
  v_mfma_f32_16x16x32_bf16 v[44:47], v[232:235], a[52:55], v[44:47]
  ds_read_b64_tr_b16 a[42:43], v119 offset:10240
  s_add_u32 s19, s19, 128
  v_mfma_f32_16x16x32_bf16 v[44:47], v[240:243], a[56:59], v[44:47]
  ds_read_b64_tr_b16 a[44:45], v119 offset:12288
  s_add_u32 s20, s20, 128
  v_mfma_f32_16x16x32_bf16 v[44:47], v[248:251], a[60:63], v[44:47]
  s_waitcnt lgkmcnt(15)
  ds_read_b64_tr_b16 a[46:47], v119 offset:14336
  v_mfma_f32_16x16x32_bf16 v[32:35], v[128:131], a[0:3], 0
  ds_read_b64_tr_b16 a[48:49], v119 offset:16384
  v_add_u32 v15, 4096, v14
  v_mfma_f32_16x16x32_bf16 v[32:35], v[136:139], a[4:7], v[32:35]
  s_nop 0
  ds_read_b64_tr_b16 a[50:51], v119 offset:18432
  v_mfma_f32_16x16x32_bf16 v[32:35], v[144:147], a[8:11], v[32:35]
  ds_read_b64_tr_b16 a[52:53], v119 offset:20480
  v_cndmask_b32 v15, v56, v15, vcc
  v_mfma_f32_16x16x32_bf16 v[32:35], v[152:155], a[12:15], v[32:35]
  s_waitcnt lgkmcnt(11)
  ds_read_b64_tr_b16 a[54:55], v119 offset:22528
  v_mfma_f32_16x16x32_bf16 v[32:35], v[160:163], a[16:19], v[32:35]
  ds_read_b64_tr_b16 a[56:57], v119 offset:24576
  v_cvt_pk_bf16_f32 v204, v40, v41
  s_add_u32 s31, s65, 71303168
  v_mfma_f32_16x16x32_bf16 v[32:35], v[168:171], a[20:23], v[32:35]
  ds_read_b64_tr_b16 a[58:59], v119 offset:26624
  v_cvt_pk_bf16_f32 v205, v42, v43
  buffer_load_ushort v98, v24, s[24:27], s29 offen offset:1792
  v_mfma_f32_16x16x32_bf16 v[32:35], v[176:179], a[24:27], v[32:35]
  ds_read_b64_tr_b16 a[60:61], v119 offset:28672
  v_cvt_pk_bf16_f32 v206, v44, v45
  s_mov_b32 s58, 3584
  v_mfma_f32_16x16x32_bf16 v[32:35], v[184:187], a[28:31], v[32:35]
  ds_read_b64_tr_b16 a[62:63], v119 offset:30720
  s_waitcnt vmcnt(28)
  v_mfma_f32_16x16x32_bf16 v[36:39], v[192:195], a[0:3], 0
  s_barrier
  ds_read_b64_tr_b16 a[0:1], v116 offset:32768
  v_mfma_f32_16x16x32_bf16 v[36:39], v[200:203], a[4:7], v[36:39]
  ds_read_b64_tr_b16 a[2:3], v116 offset:34816
  v_cvt_pk_bf16_f32 v207, v46, v47
  v_mfma_f32_16x16x32_bf16 v[36:39], v[208:211], a[8:11], v[36:39]
  ds_read_b64_tr_b16 a[4:5], v116 offset:36864
  buffer_store_dwordx4 v[204:207], v59, s[8:11], s18 offen offset:1024 sc1
  v_mfma_f32_16x16x32_bf16 v[36:39], v[216:219], a[12:15], v[36:39]
  ds_read_b64_tr_b16 a[6:7], v116 offset:38912
  s_add_u32 m0, s21, 32768
  v_mfma_f32_16x16x32_bf16 v[36:39], v[224:227], a[16:19], v[36:39]
  ds_read_b64_tr_b16 a[8:9], v116 offset:40960
  buffer_load_dwordx4 v112, s[12:15], s19 offen offset:0 lds
  v_mfma_f32_16x16x32_bf16 v[36:39], v[232:235], a[20:23], v[36:39]
  ds_read_b64_tr_b16 a[10:11], v116 offset:43008
  s_mov_b32 s59, 0x20000
  v_mfma_f32_16x16x32_bf16 v[36:39], v[240:243], a[24:27], v[36:39]
  ds_read_b64_tr_b16 a[12:13], v116 offset:45056
  v_mfma_f32_16x16x32_bf16 v[36:39], v[248:251], a[28:31], v[36:39]
  s_waitcnt lgkmcnt(15)
  ds_read_b64_tr_b16 a[14:15], v116 offset:47104
  v_mfma_f32_16x16x32_bf16 v[40:43], v[128:131], a[32:35], 0
  ds_read_b64_tr_b16 a[16:17], v116 offset:49152
  buffer_load_dwordx4 v113, s[12:15], s19 offen offset:1024 lds
  v_mfma_f32_16x16x32_bf16 v[40:43], v[136:139], a[36:39], v[40:43]
  ds_read_b64_tr_b16 a[18:19], v116 offset:51200
  s_mov_b32 s50, 7340032
  v_mfma_f32_16x16x32_bf16 v[40:43], v[144:147], a[40:43], v[40:43]
  s_nop 0
  ds_read_b64_tr_b16 a[20:21], v116 offset:53248
  v_mfma_f32_16x16x32_bf16 v[40:43], v[152:155], a[44:47], v[40:43]
  s_waitcnt lgkmcnt(11)
  ds_read_b64_tr_b16 a[22:23], v116 offset:55296
  s_mov_b32 s51, 0x20000
  v_mfma_f32_16x16x32_bf16 v[40:43], v[160:163], a[48:51], v[40:43]
  ds_read_b64_tr_b16 a[24:25], v116 offset:57344
  v_cvt_pk_bf16_f32 v212, v32, v33
  v_mfma_f32_16x16x32_bf16 v[40:43], v[168:171], a[52:55], v[40:43]
  ds_read_b64_tr_b16 a[26:27], v116 offset:59392
  v_cvt_pk_bf16_f32 v213, v34, v35
  v_mfma_f32_16x16x32_bf16 v[40:43], v[176:179], a[56:59], v[40:43]
  ds_read_b64_tr_b16 a[28:29], v116 offset:61440
  v_cvt_pk_bf16_f32 v214, v36, v37
  v_mfma_f32_16x16x32_bf16 v[40:43], v[184:187], a[60:63], v[40:43]
  ds_read_b64_tr_b16 a[30:31], v116 offset:63488
  v_cvt_pk_bf16_f32 v215, v38, v39
  v_mfma_f32_16x16x32_bf16 v[44:47], v[192:195], a[32:35], 0
  ds_read_b64_tr_b16 a[32:33], v117 offset:32768
  buffer_store_dwordx4 v[212:215], v59, s[8:11], s18 offen offset:2048 sc1
  v_mfma_f32_16x16x32_bf16 v[44:47], v[200:203], a[36:39], v[44:47]
  ds_read_b64_tr_b16 a[34:35], v117 offset:34816
  buffer_load_dwordx4 v114, s[12:15], s19 offen offset:2048 lds
  v_mfma_f32_16x16x32_bf16 v[44:47], v[208:211], a[40:43], v[44:47]
  ds_read_b64_tr_b16 a[36:37], v117 offset:36864
  s_mov_b32 s62, 4096
  v_mfma_f32_16x16x32_bf16 v[44:47], v[216:219], a[44:47], v[44:47]
  ds_read_b64_tr_b16 a[38:39], v117 offset:38912
  buffer_load_ushort v99, v24, s[24:27], s29 offen offset:2688
  v_mfma_f32_16x16x32_bf16 v[44:47], v[224:227], a[48:51], v[44:47]
  ds_read_b64_tr_b16 a[40:41], v117 offset:40960
  s_mov_b32 s63, 0x20000
  v_mfma_f32_16x16x32_bf16 v[44:47], v[232:235], a[52:55], v[44:47]
  ds_read_b64_tr_b16 a[42:43], v117 offset:43008
  buffer_load_dwordx4 v115, s[12:15], s19 offen offset:3072 lds
  v_mfma_f32_16x16x32_bf16 v[44:47], v[240:243], a[56:59], v[44:47]
  ds_read_b64_tr_b16 a[44:45], v117 offset:45056
  s_mov_b32 s54, 1835008
  v_mfma_f32_16x16x32_bf16 v[44:47], v[248:251], a[60:63], v[44:47]
  s_waitcnt lgkmcnt(15)
  ds_read_b64_tr_b16 a[46:47], v117 offset:47104
  v_mfma_f32_16x16x32_bf16 v[32:35], v[128:131], a[0:3], 0
  ds_read_b64_tr_b16 a[48:49], v117 offset:49152
  s_add_u32 m0, s21, 36864
  v_mfma_f32_16x16x32_bf16 v[32:35], v[136:139], a[4:7], v[32:35]
  ds_read_b64_tr_b16 a[50:51], v117 offset:51200
  buffer_load_dwordx4 v112, s[12:15], s20 offen offset:0 lds
  v_mfma_f32_16x16x32_bf16 v[32:35], v[144:147], a[8:11], v[32:35]
  ds_read_b64_tr_b16 a[52:53], v117 offset:53248
  s_mov_b32 s55, 0x20000
  v_mfma_f32_16x16x32_bf16 v[32:35], v[152:155], a[12:15], v[32:35]
  s_waitcnt lgkmcnt(11)
  ds_read_b64_tr_b16 a[54:55], v117 offset:55296
  v_mfma_f32_16x16x32_bf16 v[32:35], v[160:163], a[16:19], v[32:35]
  ds_read_b64_tr_b16 a[56:57], v117 offset:57344
  v_cvt_pk_bf16_f32 v220, v40, v41
  s_sub_u32 s5, 47, s23
  v_mfma_f32_16x16x32_bf16 v[32:35], v[168:171], a[20:23], v[32:35]
  ds_read_b64_tr_b16 a[58:59], v117 offset:59392
  v_cvt_pk_bf16_f32 v221, v42, v43
  v_mfma_f32_16x16x32_bf16 v[32:35], v[176:179], a[24:27], v[32:35]
  ds_read_b64_tr_b16 a[60:61], v117 offset:61440
  v_cvt_pk_bf16_f32 v222, v44, v45
  v_mfma_f32_16x16x32_bf16 v[32:35], v[184:187], a[28:31], v[32:35]
  ds_read_b64_tr_b16 a[62:63], v117 offset:63488
  v_cvt_pk_bf16_f32 v223, v46, v47
  v_mfma_f32_16x16x32_bf16 v[36:39], v[192:195], a[0:3], 0
  ds_read_b64_tr_b16 a[0:1], v118 offset:32768
  buffer_store_dwordx4 v[220:223], v59, s[8:11], s18 offen offset:3072 sc1
  v_mfma_f32_16x16x32_bf16 v[36:39], v[200:203], a[4:7], v[36:39]
  ds_read_b64_tr_b16 a[2:3], v118 offset:34816
  s_add_u32 s18, s18, 4096
  v_mfma_f32_16x16x32_bf16 v[36:39], v[208:211], a[8:11], v[36:39]
  ds_read_b64_tr_b16 a[4:5], v118 offset:36864
  buffer_load_dwordx4 v113, s[12:15], s20 offen offset:1024 lds
  v_mfma_f32_16x16x32_bf16 v[36:39], v[216:219], a[12:15], v[36:39]
  ds_read_b64_tr_b16 a[6:7], v118 offset:38912
  s_cmp_lt_u32 s23, 16
  s_cselect_b32 s23, s23, s5
  v_mfma_f32_16x16x32_bf16 v[36:39], v[224:227], a[16:19], v[36:39]
  ds_read_b64_tr_b16 a[8:9], v118 offset:40960
  buffer_load_ushort v100, v24, s[24:27], s30 offen offset:0
  v_mfma_f32_16x16x32_bf16 v[36:39], v[232:235], a[20:23], v[36:39]
  ds_read_b64_tr_b16 a[10:11], v118 offset:43008
  s_cmp_lt_u32 s23, 28
  s_cselect_b32 s39, 1, 0
  v_mfma_f32_16x16x32_bf16 v[36:39], v[240:243], a[24:27], v[36:39]
  ds_read_b64_tr_b16 a[12:13], v118 offset:45056
  buffer_load_dwordx4 v114, s[12:15], s20 offen offset:2048 lds
  v_mfma_f32_16x16x32_bf16 v[36:39], v[248:251], a[28:31], v[36:39]
  s_waitcnt lgkmcnt(15)
  ds_read_b64_tr_b16 a[14:15], v118 offset:47104
  v_mfma_f32_16x16x32_bf16 v[40:43], v[128:131], a[32:35], 0
  ds_read_b64_tr_b16 a[16:17], v118 offset:49152
  s_mul_i32 s5, s3, 28
  v_mfma_f32_16x16x32_bf16 v[40:43], v[136:139], a[36:39], v[40:43]
  ds_read_b64_tr_b16 a[18:19], v118 offset:51200
  v_mfma_f32_16x16x32_bf16 v[40:43], v[144:147], a[40:43], v[40:43]
  ds_read_b64_tr_b16 a[20:21], v118 offset:53248
  buffer_load_dwordx4 v115, s[12:15], s20 offen offset:3072 lds
  s_add_u32 s5, s5, s23
  v_mfma_f32_16x16x32_bf16 v[40:43], v[152:155], a[44:47], v[40:43]
  s_waitcnt lgkmcnt(11)
  ds_read_b64_tr_b16 a[22:23], v118 offset:55296
  v_mfma_f32_16x16x32_bf16 v[40:43], v[160:163], a[48:51], v[40:43]
  ds_read_b64_tr_b16 a[24:25], v118 offset:57344
  v_cvt_pk_bf16_f32 v228, v32, v33
  s_mul_i32 s36, s5, 9363
  v_mfma_f32_16x16x32_bf16 v[40:43], v[168:171], a[52:55], v[40:43]
  ds_read_b64_tr_b16 a[26:27], v118 offset:59392
  v_cvt_pk_bf16_f32 v229, v34, v35
  v_mfma_f32_16x16x32_bf16 v[40:43], v[176:179], a[56:59], v[40:43]
  ds_read_b64_tr_b16 a[28:29], v118 offset:61440
  v_cvt_pk_bf16_f32 v230, v36, v37
  v_mfma_f32_16x16x32_bf16 v[40:43], v[184:187], a[60:63], v[40:43]
  ds_read_b64_tr_b16 a[30:31], v118 offset:63488
  v_cvt_pk_bf16_f32 v231, v38, v39
  v_mfma_f32_16x16x32_bf16 v[44:47], v[192:195], a[32:35], 0
  ds_read_b64_tr_b16 a[32:33], v119 offset:32768
  buffer_store_dwordx4 v[228:231], v59, s[8:11], s18 offen offset:0 sc1
  v_mfma_f32_16x16x32_bf16 v[44:47], v[200:203], a[36:39], v[44:47]
  ds_read_b64_tr_b16 a[34:35], v119 offset:34816
  s_add_u32 s19, s19, 128
  v_mfma_f32_16x16x32_bf16 v[44:47], v[208:211], a[40:43], v[44:47]
  ds_read_b64_tr_b16 a[36:37], v119 offset:36864
  s_add_u32 s20, s20, 128
  v_mfma_f32_16x16x32_bf16 v[44:47], v[216:219], a[44:47], v[44:47]
  ds_read_b64_tr_b16 a[38:39], v119 offset:38912
  s_lshr_b32 s36, s36, 16
  v_mfma_f32_16x16x32_bf16 v[44:47], v[224:227], a[48:51], v[44:47]
  ds_read_b64_tr_b16 a[40:41], v119 offset:40960
  buffer_load_ushort v101, v24, s[24:27], s30 offen offset:896
  v_mfma_f32_16x16x32_bf16 v[44:47], v[232:235], a[52:55], v[44:47]
  ds_read_b64_tr_b16 a[42:43], v119 offset:43008
  s_mul_i32 s6, s36, 7
  v_mfma_f32_16x16x32_bf16 v[44:47], v[240:243], a[56:59], v[44:47]
  ds_read_b64_tr_b16 a[44:45], v119 offset:45056
  v_mfma_f32_16x16x32_bf16 v[44:47], v[248:251], a[60:63], v[44:47]
  s_waitcnt lgkmcnt(15)
  ds_read_b64_tr_b16 a[46:47], v119 offset:47104
  v_mfma_f32_16x16x32_bf16 v[32:35], v[128:131], a[0:3], 0
  ds_read_b64_tr_b16 a[48:49], v119 offset:49152
  s_sub_u32 s37, s5, s6
  v_mfma_f32_16x16x32_bf16 v[32:35], v[136:139], a[4:7], v[32:35]
  ds_read_b64_tr_b16 a[50:51], v119 offset:51200
  v_mfma_f32_16x16x32_bf16 v[32:35], v[144:147], a[8:11], v[32:35]
  ds_read_b64_tr_b16 a[52:53], v119 offset:53248
  s_lshl_b32 s64, s44, 15
  v_mfma_f32_16x16x32_bf16 v[32:35], v[152:155], a[12:15], v[32:35]
  s_waitcnt lgkmcnt(11)
  ds_read_b64_tr_b16 a[54:55], v119 offset:55296
  v_mfma_f32_16x16x32_bf16 v[32:35], v[160:163], a[16:19], v[32:35]
  ds_read_b64_tr_b16 a[56:57], v119 offset:57344
  v_cvt_pk_bf16_f32 v236, v40, v41
  v_lshrrev_b32_e64 v52, 5, v55
  v_mfma_f32_16x16x32_bf16 v[32:35], v[168:171], a[20:23], v[32:35]
  ds_read_b64_tr_b16 a[58:59], v119 offset:59392
  v_cvt_pk_bf16_f32 v237, v42, v43
  v_mfma_f32_16x16x32_bf16 v[32:35], v[176:179], a[24:27], v[32:35]
  ds_read_b64_tr_b16 a[60:61], v119 offset:61440
  v_add_u32 v116, 0x10000, v116
  v_mfma_f32_16x16x32_bf16 v[32:35], v[184:187], a[28:31], v[32:35]
  ds_read_b64_tr_b16 a[62:63], v119 offset:63488
  s_waitcnt vmcnt(34)
  v_mfma_f32_16x16x32_bf16 v[36:39], v[192:195], a[0:3], 0
  s_barrier
  ds_read_b64_tr_b16 a[0:1], v116 offset:0
  v_mfma_f32_16x16x32_bf16 v[36:39], v[200:203], a[4:7], v[36:39]
  ds_read_b64_tr_b16 a[2:3], v116 offset:2048
  v_cvt_pk_bf16_f32 v238, v44, v45
  v_mfma_f32_16x16x32_bf16 v[36:39], v[208:211], a[8:11], v[36:39]
  ds_read_b64_tr_b16 a[4:5], v116 offset:4096
  v_cvt_pk_bf16_f32 v239, v46, v47
  v_mfma_f32_16x16x32_bf16 v[36:39], v[216:219], a[12:15], v[36:39]
  ds_read_b64_tr_b16 a[6:7], v116 offset:6144
  buffer_store_dwordx4 v[236:239], v59, s[8:11], s18 offen offset:1024 sc1
  v_mfma_f32_16x16x32_bf16 v[36:39], v[224:227], a[16:19], v[36:39]
  ds_read_b64_tr_b16 a[8:9], v116 offset:8192
  v_bfe_u32 v53, v55, 2, 1
  v_mfma_f32_16x16x32_bf16 v[36:39], v[232:235], a[20:23], v[36:39]
  ds_read_b64_tr_b16 a[10:11], v116 offset:10240
  buffer_load_ushort v102, v24, s[24:27], s30 offen offset:1792
  v_mfma_f32_16x16x32_bf16 v[36:39], v[240:243], a[24:27], v[36:39]
  ds_read_b64_tr_b16 a[12:13], v116 offset:12288
  v_lshl_add_u32 v52, v52, 1, v53
  v_mfma_f32_16x16x32_bf16 v[36:39], v[248:251], a[28:31], v[36:39]
  s_waitcnt lgkmcnt(15)
  ds_read_b64_tr_b16 a[14:15], v116 offset:14336
  v_mfma_f32_16x16x32_bf16 v[40:43], v[128:131], a[32:35], 0
  ds_read_b64_tr_b16 a[16:17], v116 offset:16384
  v_bfe_u32 v53, v55, 3, 2
  v_mfma_f32_16x16x32_bf16 v[40:43], v[136:139], a[36:39], v[40:43]
  s_nop 0
  ds_read_b64_tr_b16 a[18:19], v116 offset:18432
  v_mfma_f32_16x16x32_bf16 v[40:43], v[144:147], a[40:43], v[40:43]
  ds_read_b64_tr_b16 a[20:21], v116 offset:20480
  v_and_b32_e64 v54, 3, v55
  v_mfma_f32_16x16x32_bf16 v[40:43], v[152:155], a[44:47], v[40:43]
  s_waitcnt lgkmcnt(11)
  ds_read_b64_tr_b16 a[22:23], v116 offset:22528
  v_mfma_f32_16x16x32_bf16 v[40:43], v[160:163], a[48:51], v[40:43]
  ds_read_b64_tr_b16 a[24:25], v116 offset:24576
  v_cvt_pk_bf16_f32 v244, v32, v33
  v_mfma_f32_16x16x32_bf16 v[40:43], v[168:171], a[52:55], v[40:43]
  ds_read_b64_tr_b16 a[26:27], v116 offset:26624
  v_cvt_pk_bf16_f32 v245, v34, v35
  v_mfma_f32_16x16x32_bf16 v[40:43], v[176:179], a[56:59], v[40:43]
  ds_read_b64_tr_b16 a[28:29], v116 offset:28672
  v_add_u32 v117, 0x10000, v117
  v_mfma_f32_16x16x32_bf16 v[40:43], v[184:187], a[60:63], v[40:43]
  ds_read_b64_tr_b16 a[30:31], v116 offset:30720
  v_cvt_pk_bf16_f32 v246, v36, v37
  v_mfma_f32_16x16x32_bf16 v[44:47], v[192:195], a[32:35], 0
  ds_read_b64_tr_b16 a[32:33], v117 offset:0
  v_cvt_pk_bf16_f32 v247, v38, v39
  v_mfma_f32_16x16x32_bf16 v[44:47], v[200:203], a[36:39], v[44:47]
  ds_read_b64_tr_b16 a[34:35], v117 offset:2048
  buffer_store_dwordx4 v[244:247], v59, s[8:11], s18 offen offset:2048 sc1
  v_mfma_f32_16x16x32_bf16 v[44:47], v[208:211], a[40:43], v[44:47]
  ds_read_b64_tr_b16 a[36:37], v117 offset:4096
  v_lshl_add_u32 v53, v53, 2, v54
  v_mfma_f32_16x16x32_bf16 v[44:47], v[216:219], a[44:47], v[44:47]
  s_nop 0
  ds_read_b64_tr_b16 a[38:39], v117 offset:6144
  v_mfma_f32_16x16x32_bf16 v[44:47], v[224:227], a[48:51], v[44:47]
  ds_read_b64_tr_b16 a[40:41], v117 offset:8192
  v_lshlrev_b32_e64 v53, 4, v53
  v_mfma_f32_16x16x32_bf16 v[44:47], v[232:235], a[52:55], v[44:47]
  ds_read_b64_tr_b16 a[42:43], v117 offset:10240
  buffer_load_ushort v103, v24, s[24:27], s30 offen offset:2688
  v_mfma_f32_16x16x32_bf16 v[44:47], v[240:243], a[56:59], v[44:47]
  ds_read_b64_tr_b16 a[44:45], v117 offset:12288
  v_lshl_add_u32 v26, v52, 10, v53
  v_mfma_f32_16x16x32_bf16 v[44:47], v[248:251], a[60:63], v[44:47]
  s_waitcnt lgkmcnt(15)
  ds_read_b64_tr_b16 a[46:47], v117 offset:14336
  v_mfma_f32_16x16x32_bf16 v[32:35], v[128:131], a[0:3], 0
  ds_read_b64_tr_b16 a[48:49], v117 offset:16384
  v_add_u32 v55, 64, v55
  v_mfma_f32_16x16x32_bf16 v[32:35], v[136:139], a[4:7], v[32:35]
  ds_read_b64_tr_b16 a[50:51], v117 offset:18432
  v_mfma_f32_16x16x32_bf16 v[32:35], v[144:147], a[8:11], v[32:35]
  ds_read_b64_tr_b16 a[52:53], v117 offset:20480
  v_lshrrev_b32_e64 v52, 5, v55
  v_mfma_f32_16x16x32_bf16 v[32:35], v[152:155], a[12:15], v[32:35]
  s_waitcnt lgkmcnt(11)
  ds_read_b64_tr_b16 a[54:55], v117 offset:22528
  v_mfma_f32_16x16x32_bf16 v[32:35], v[160:163], a[16:19], v[32:35]
  ds_read_b64_tr_b16 a[56:57], v117 offset:24576
  v_cvt_pk_bf16_f32 v252, v40, v41
  v_bfe_u32 v53, v55, 2, 1
  v_mfma_f32_16x16x32_bf16 v[32:35], v[168:171], a[20:23], v[32:35]
  ds_read_b64_tr_b16 a[58:59], v117 offset:26624
  v_cvt_pk_bf16_f32 v253, v42, v43
  v_mfma_f32_16x16x32_bf16 v[32:35], v[176:179], a[24:27], v[32:35]
  ds_read_b64_tr_b16 a[60:61], v117 offset:28672
  v_add_u32 v118, 0x10000, v118
  v_mfma_f32_16x16x32_bf16 v[32:35], v[184:187], a[28:31], v[32:35]
  ds_read_b64_tr_b16 a[62:63], v117 offset:30720
  v_cvt_pk_bf16_f32 v254, v44, v45
  v_mfma_f32_16x16x32_bf16 v[36:39], v[192:195], a[0:3], 0
  ds_read_b64_tr_b16 a[0:1], v118 offset:0
  v_cvt_pk_bf16_f32 v255, v46, v47
  v_mfma_f32_16x16x32_bf16 v[36:39], v[200:203], a[4:7], v[36:39]
  ds_read_b64_tr_b16 a[2:3], v118 offset:2048
  buffer_store_dwordx4 v[252:255], v59, s[8:11], s18 offen offset:3072 sc1
  v_mfma_f32_16x16x32_bf16 v[36:39], v[208:211], a[8:11], v[36:39]
  ds_read_b64_tr_b16 a[4:5], v118 offset:4096
  s_add_u32 s18, s18, 4096
  v_mfma_f32_16x16x32_bf16 v[36:39], v[216:219], a[12:15], v[36:39]
  ds_read_b64_tr_b16 a[6:7], v118 offset:6144
  v_lshl_add_u32 v52, v52, 1, v53
  v_mfma_f32_16x16x32_bf16 v[36:39], v[224:227], a[16:19], v[36:39]
  s_nop 0
  ds_read_b64_tr_b16 a[8:9], v118 offset:8192
  v_mfma_f32_16x16x32_bf16 v[36:39], v[232:235], a[20:23], v[36:39]
  ds_read_b64_tr_b16 a[10:11], v118 offset:10240
  v_bfe_u32 v53, v55, 3, 2
  v_mfma_f32_16x16x32_bf16 v[36:39], v[240:243], a[24:27], v[36:39]
  ds_read_b64_tr_b16 a[12:13], v118 offset:12288
  buffer_load_ushort v104, v25, s[24:27], s29 offen offset:0
  v_mfma_f32_16x16x32_bf16 v[36:39], v[248:251], a[28:31], v[36:39]
  s_waitcnt lgkmcnt(15)
  ds_read_b64_tr_b16 a[14:15], v118 offset:14336
  v_mfma_f32_16x16x32_bf16 v[40:43], v[128:131], a[32:35], 0
  ds_read_b64_tr_b16 a[16:17], v118 offset:16384
  v_and_b32 v54, 3, v55
  v_mfma_f32_16x16x32_bf16 v[40:43], v[136:139], a[36:39], v[40:43]
  ds_read_b64_tr_b16 a[18:19], v118 offset:18432
  v_mfma_f32_16x16x32_bf16 v[40:43], v[144:147], a[40:43], v[40:43]
  ds_read_b64_tr_b16 a[20:21], v118 offset:20480
  v_lshl_add_u32 v53, v53, 2, v54
  v_mfma_f32_16x16x32_bf16 v[40:43], v[152:155], a[44:47], v[40:43]
  s_waitcnt lgkmcnt(11)
  ds_read_b64_tr_b16 a[22:23], v118 offset:22528
  v_mfma_f32_16x16x32_bf16 v[40:43], v[160:163], a[48:51], v[40:43]
  ds_read_b64_tr_b16 a[24:25], v118 offset:24576
  v_cvt_pk_bf16_f32 v64, v32, v33
  v_mfma_f32_16x16x32_bf16 v[40:43], v[168:171], a[52:55], v[40:43]
  ds_read_b64_tr_b16 a[26:27], v118 offset:26624
  v_cvt_pk_bf16_f32 v65, v34, v35
  v_mfma_f32_16x16x32_bf16 v[40:43], v[176:179], a[56:59], v[40:43]
  ds_read_b64_tr_b16 a[28:29], v118 offset:28672
  v_add_u32 v119, 0x10000, v119
  v_mfma_f32_16x16x32_bf16 v[40:43], v[184:187], a[60:63], v[40:43]
  ds_read_b64_tr_b16 a[30:31], v118 offset:30720
  v_cvt_pk_bf16_f32 v66, v36, v37
  v_mfma_f32_16x16x32_bf16 v[44:47], v[192:195], a[32:35], 0
  ds_read_b64_tr_b16 a[32:33], v119 offset:0
  v_cvt_pk_bf16_f32 v67, v38, v39
  v_mfma_f32_16x16x32_bf16 v[44:47], v[200:203], a[36:39], v[44:47]
  ds_read_b64_tr_b16 a[34:35], v119 offset:2048
  buffer_store_dwordx4 v[64:67], v59, s[8:11], s18 offen offset:0 sc1
  v_mfma_f32_16x16x32_bf16 v[44:47], v[208:211], a[40:43], v[44:47]
  ds_read_b64_tr_b16 a[36:37], v119 offset:4096
  v_lshlrev_b32 v53, 4, v53
  v_mfma_f32_16x16x32_bf16 v[44:47], v[216:219], a[44:47], v[44:47]
  ds_read_b64_tr_b16 a[38:39], v119 offset:6144
  v_mfma_f32_16x16x32_bf16 v[44:47], v[224:227], a[48:51], v[44:47]
  ds_read_b64_tr_b16 a[40:41], v119 offset:8192
  v_lshl_add_u32 v27, v52, 10, v53
  v_mfma_f32_16x16x32_bf16 v[44:47], v[232:235], a[52:55], v[44:47]
  ds_read_b64_tr_b16 a[42:43], v119 offset:10240
  v_mfma_f32_16x16x32_bf16 v[44:47], v[240:243], a[56:59], v[44:47]
  ds_read_b64_tr_b16 a[44:45], v119 offset:12288
  v_cndmask_b32 v27, v56, v27, vcc
  v_mfma_f32_16x16x32_bf16 v[44:47], v[248:251], a[60:63], v[44:47]
  s_waitcnt lgkmcnt(15)
  ds_read_b64_tr_b16 a[46:47], v119 offset:14336
  v_mfma_f32_16x16x32_bf16 v[32:35], v[128:131], a[0:3], 0
  ds_read_b64_tr_b16 a[48:49], v119 offset:16384
  v_bfe_u32 v52, v11, 2, 2
  v_mfma_f32_16x16x32_bf16 v[32:35], v[136:139], a[4:7], v[32:35]
  ds_read_b64_tr_b16 a[50:51], v119 offset:18432
  buffer_load_ushort v105, v25, s[24:27], s29 offen offset:896
  v_mfma_f32_16x16x32_bf16 v[32:35], v[144:147], a[8:11], v[32:35]
  ds_read_b64_tr_b16 a[52:53], v119 offset:20480
  v_lshl_add_u32 v52, v12, 2, v52
  v_mfma_f32_16x16x32_bf16 v[32:35], v[152:155], a[12:15], v[32:35]
  s_waitcnt lgkmcnt(11)
  ds_read_b64_tr_b16 a[54:55], v119 offset:22528
  v_mfma_f32_16x16x32_bf16 v[32:35], v[160:163], a[16:19], v[32:35]
  ds_read_b64_tr_b16 a[56:57], v119 offset:24576
  v_cvt_pk_bf16_f32 v68, v40, v41
  v_bfe_u32 v53, v52, 1, 2
  v_mfma_f32_16x16x32_bf16 v[32:35], v[168:171], a[20:23], v[32:35]
  ds_read_b64_tr_b16 a[58:59], v119 offset:26624
  v_cvt_pk_bf16_f32 v69, v42, v43
  v_mfma_f32_16x16x32_bf16 v[32:35], v[176:179], a[24:27], v[32:35]
  ds_read_b64_tr_b16 a[60:61], v119 offset:28672
  v_subrev_u32 v116, 0x20000, v116
  v_mfma_f32_16x16x32_bf16 v[32:35], v[184:187], a[28:31], v[32:35]
  ds_read_b64_tr_b16 a[62:63], v119 offset:30720
  s_waitcnt vmcnt(24)
  v_mfma_f32_16x16x32_bf16 v[36:39], v[192:195], a[0:3], 0
  s_barrier
  ds_read_b64_tr_b16 a[0:1], v116 offset:0
  v_mfma_f32_16x16x32_bf16 v[36:39], v[200:203], a[4:7], v[36:39]
  ds_read_b64_tr_b16 a[2:3], v116 offset:2048
  v_cvt_pk_bf16_f32 v70, v44, v45
  v_mfma_f32_16x16x32_bf16 v[36:39], v[208:211], a[8:11], v[36:39]
  ds_read_b64_tr_b16 a[4:5], v116 offset:4096
  v_cvt_pk_bf16_f32 v71, v46, v47
  v_mfma_f32_16x16x32_bf16 v[36:39], v[216:219], a[12:15], v[36:39]
  ds_read_b64_tr_b16 a[6:7], v116 offset:6144
  buffer_store_dwordx4 v[68:71], v59, s[8:11], s18 offen offset:1024 sc1
  v_mfma_f32_16x16x32_bf16 v[36:39], v[224:227], a[16:19], v[36:39]
  ds_read_b64_tr_b16 a[8:9], v116 offset:8192
  v_lshlrev_b32 v52, 7, v52
  v_mfma_f32_16x16x32_bf16 v[36:39], v[232:235], a[20:23], v[36:39]
  ds_read_b64_tr_b16 a[10:11], v116 offset:10240
  v_mfma_f32_16x16x32_bf16 v[36:39], v[240:243], a[24:27], v[36:39]
  ds_read_b64_tr_b16 a[12:13], v116 offset:12288
  v_and_b32_e64 v54, 3, v11
  v_mfma_f32_16x16x32_bf16 v[36:39], v[248:251], a[28:31], v[36:39]
  s_waitcnt lgkmcnt(15)
  ds_read_b64_tr_b16 a[14:15], v116 offset:14336
  v_mfma_f32_16x16x32_bf16 v[40:43], v[128:131], a[32:35], 0
  ds_read_b64_tr_b16 a[16:17], v116 offset:16384
  v_lshl_add_u32 v52, v54, 3, v52
  v_mfma_f32_16x16x32_bf16 v[40:43], v[136:139], a[36:39], v[40:43]
  ds_read_b64_tr_b16 a[18:19], v116 offset:18432
  buffer_load_ushort v106, v25, s[24:27], s29 offen offset:1792
  v_mfma_f32_16x16x32_bf16 v[40:43], v[144:147], a[40:43], v[40:43]
  ds_read_b64_tr_b16 a[20:21], v116 offset:20480
  v_add_u32 v52, s64, v52
  v_mfma_f32_16x16x32_bf16 v[40:43], v[152:155], a[44:47], v[40:43]
  s_waitcnt lgkmcnt(11)
  ds_read_b64_tr_b16 a[22:23], v116 offset:22528
  v_mfma_f32_16x16x32_bf16 v[40:43], v[160:163], a[48:51], v[40:43]
  ds_read_b64_tr_b16 a[24:25], v116 offset:24576
  v_cvt_pk_bf16_f32 v72, v32, v33
  v_mfma_f32_16x16x32_bf16 v[40:43], v[168:171], a[52:55], v[40:43]
  ds_read_b64_tr_b16 a[26:27], v116 offset:26624
  v_cvt_pk_bf16_f32 v73, v34, v35
  v_mfma_f32_16x16x32_bf16 v[40:43], v[176:179], a[56:59], v[40:43]
  ds_read_b64_tr_b16 a[28:29], v116 offset:28672
  v_subrev_u32 v117, 0x20000, v117
  v_mfma_f32_16x16x32_bf16 v[40:43], v[184:187], a[60:63], v[40:43]
  ds_read_b64_tr_b16 a[30:31], v116 offset:30720
  v_cvt_pk_bf16_f32 v74, v36, v37
  v_mfma_f32_16x16x32_bf16 v[44:47], v[192:195], a[32:35], 0
  ds_read_b64_tr_b16 a[32:33], v117 offset:0
  v_cvt_pk_bf16_f32 v75, v38, v39
  v_mfma_f32_16x16x32_bf16 v[44:47], v[200:203], a[36:39], v[44:47]
  ds_read_b64_tr_b16 a[34:35], v117 offset:2048
  buffer_store_dwordx4 v[72:75], v59, s[8:11], s18 offen offset:2048 sc1
  v_mfma_f32_16x16x32_bf16 v[44:47], v[208:211], a[40:43], v[44:47]
  ds_read_b64_tr_b16 a[36:37], v117 offset:4096
  s_and_b32 s5, s44, 2
  v_mfma_f32_16x16x32_bf16 v[44:47], v[216:219], a[44:47], v[44:47]
  ds_read_b64_tr_b16 a[38:39], v117 offset:6144
  v_mfma_f32_16x16x32_bf16 v[44:47], v[224:227], a[48:51], v[44:47]
  ds_read_b64_tr_b16 a[40:41], v117 offset:8192
  v_xor_b32_e64 v53, s5, v53
  v_mfma_f32_16x16x32_bf16 v[44:47], v[232:235], a[52:55], v[44:47]
  ds_read_b64_tr_b16 a[42:43], v117 offset:10240
  v_mfma_f32_16x16x32_bf16 v[44:47], v[240:243], a[56:59], v[44:47]
  ds_read_b64_tr_b16 a[44:45], v117 offset:12288
  v_xor_b32_e64 v54, 0, v53
  v_mfma_f32_16x16x32_bf16 v[44:47], v[248:251], a[60:63], v[44:47]
  s_waitcnt lgkmcnt(15)
  ds_read_b64_tr_b16 a[46:47], v117 offset:14336
  v_mfma_f32_16x16x32_bf16 v[32:35], v[128:131], a[0:3], 0
  ds_read_b64_tr_b16 a[48:49], v117 offset:16384
  v_lshl_add_u32 v5, v54, 5, v52
  v_mfma_f32_16x16x32_bf16 v[32:35], v[136:139], a[4:7], v[32:35]
  ds_read_b64_tr_b16 a[50:51], v117 offset:18432
  buffer_load_ushort v107, v25, s[24:27], s29 offen offset:2688
  v_mfma_f32_16x16x32_bf16 v[32:35], v[144:147], a[8:11], v[32:35]
  ds_read_b64_tr_b16 a[52:53], v117 offset:20480
  v_xor_b32 v54, 1, v53
  v_mfma_f32_16x16x32_bf16 v[32:35], v[152:155], a[12:15], v[32:35]
  s_waitcnt lgkmcnt(11)
  ds_read_b64_tr_b16 a[54:55], v117 offset:22528
  v_mfma_f32_16x16x32_bf16 v[32:35], v[160:163], a[16:19], v[32:35]
  ds_read_b64_tr_b16 a[56:57], v117 offset:24576
  v_cvt_pk_bf16_f32 v76, v40, v41
  v_lshl_add_u32 v6, v54, 5, v52
  v_mfma_f32_16x16x32_bf16 v[32:35], v[168:171], a[20:23], v[32:35]
  ds_read_b64_tr_b16 a[58:59], v117 offset:26624
  v_cvt_pk_bf16_f32 v77, v42, v43
  v_mfma_f32_16x16x32_bf16 v[32:35], v[176:179], a[24:27], v[32:35]
  ds_read_b64_tr_b16 a[60:61], v117 offset:28672
  v_subrev_u32 v118, 0x20000, v118
  v_mfma_f32_16x16x32_bf16 v[32:35], v[184:187], a[28:31], v[32:35]
  ds_read_b64_tr_b16 a[62:63], v117 offset:30720
  v_cvt_pk_bf16_f32 v78, v44, v45
  v_mfma_f32_16x16x32_bf16 v[36:39], v[192:195], a[0:3], 0
  ds_read_b64_tr_b16 a[0:1], v118 offset:0
  v_cvt_pk_bf16_f32 v79, v46, v47
  v_mfma_f32_16x16x32_bf16 v[36:39], v[200:203], a[4:7], v[36:39]
  ds_read_b64_tr_b16 a[2:3], v118 offset:2048
  buffer_store_dwordx4 v[76:79], v59, s[8:11], s18 offen offset:3072 sc1
  v_mfma_f32_16x16x32_bf16 v[36:39], v[208:211], a[8:11], v[36:39]
  ds_read_b64_tr_b16 a[4:5], v118 offset:4096
  s_add_u32 s18, s18, 4096
  v_mfma_f32_16x16x32_bf16 v[36:39], v[216:219], a[12:15], v[36:39]
  ds_read_b64_tr_b16 a[6:7], v118 offset:6144
  v_xor_b32 v54, 2, v53
  v_mfma_f32_16x16x32_bf16 v[36:39], v[224:227], a[16:19], v[36:39]
  ds_read_b64_tr_b16 a[8:9], v118 offset:8192
  v_mfma_f32_16x16x32_bf16 v[36:39], v[232:235], a[20:23], v[36:39]
  ds_read_b64_tr_b16 a[10:11], v118 offset:10240
  v_lshl_add_u32 v7, v54, 5, v52
  v_mfma_f32_16x16x32_bf16 v[36:39], v[240:243], a[24:27], v[36:39]
  ds_read_b64_tr_b16 a[12:13], v118 offset:12288
  v_mfma_f32_16x16x32_bf16 v[36:39], v[248:251], a[28:31], v[36:39]
  s_waitcnt lgkmcnt(15)
  ds_read_b64_tr_b16 a[14:15], v118 offset:14336
  v_mfma_f32_16x16x32_bf16 v[40:43], v[128:131], a[32:35], 0
  ds_read_b64_tr_b16 a[16:17], v118 offset:16384
  v_xor_b32 v54, 3, v53
  v_mfma_f32_16x16x32_bf16 v[40:43], v[136:139], a[36:39], v[40:43]
  ds_read_b64_tr_b16 a[18:19], v118 offset:18432
  buffer_load_ushort v108, v25, s[24:27], s30 offen offset:0
  v_mfma_f32_16x16x32_bf16 v[40:43], v[144:147], a[40:43], v[40:43]
  ds_read_b64_tr_b16 a[20:21], v118 offset:20480
  v_lshl_add_u32 v8, v54, 5, v52
  v_mfma_f32_16x16x32_bf16 v[40:43], v[152:155], a[44:47], v[40:43]
  s_waitcnt lgkmcnt(11)
  ds_read_b64_tr_b16 a[22:23], v118 offset:22528
  v_mfma_f32_16x16x32_bf16 v[40:43], v[160:163], a[48:51], v[40:43]
  ds_read_b64_tr_b16 a[24:25], v118 offset:24576
  v_cvt_pk_bf16_f32 v80, v32, v33
  v_mfma_f32_16x16x32_bf16 v[40:43], v[168:171], a[52:55], v[40:43]
  ds_read_b64_tr_b16 a[26:27], v118 offset:26624
  v_cvt_pk_bf16_f32 v81, v34, v35
  v_mfma_f32_16x16x32_bf16 v[40:43], v[176:179], a[56:59], v[40:43]
  ds_read_b64_tr_b16 a[28:29], v118 offset:28672
  v_subrev_u32 v119, 0x20000, v119
  v_mfma_f32_16x16x32_bf16 v[40:43], v[184:187], a[60:63], v[40:43]
  ds_read_b64_tr_b16 a[30:31], v118 offset:30720
  v_cvt_pk_bf16_f32 v82, v36, v37
  v_mfma_f32_16x16x32_bf16 v[44:47], v[192:195], a[32:35], 0
  ds_read_b64_tr_b16 a[32:33], v119 offset:0
  v_cvt_pk_bf16_f32 v83, v38, v39
  v_mfma_f32_16x16x32_bf16 v[44:47], v[200:203], a[36:39], v[44:47]
  ds_read_b64_tr_b16 a[34:35], v119 offset:2048
  buffer_store_dwordx4 v[80:83], v59, s[8:11], s18 offen offset:0 sc1
  v_mfma_f32_16x16x32_bf16 v[44:47], v[208:211], a[40:43], v[44:47]
  ds_read_b64_tr_b16 a[36:37], v119 offset:4096
  s_and_b32 s5, s44, 1
  v_mfma_f32_16x16x32_bf16 v[44:47], v[216:219], a[44:47], v[44:47]
  ds_read_b64_tr_b16 a[38:39], v119 offset:6144
  v_mfma_f32_16x16x32_bf16 v[44:47], v[224:227], a[48:51], v[44:47]
  ds_read_b64_tr_b16 a[40:41], v119 offset:8192
  s_lshl_b32 s5, s5, 11
  v_mfma_f32_16x16x32_bf16 v[44:47], v[232:235], a[52:55], v[44:47]
  s_nop 0
  ds_read_b64_tr_b16 a[42:43], v119 offset:10240
  v_mfma_f32_16x16x32_bf16 v[44:47], v[240:243], a[56:59], v[44:47]
  ds_read_b64_tr_b16 a[44:45], v119 offset:12288
  v_add_u32_e64 v9, s5, v0
  v_mfma_f32_16x16x32_bf16 v[44:47], v[248:251], a[60:63], v[44:47]
  s_waitcnt lgkmcnt(15)
  ds_read_b64_tr_b16 a[46:47], v119 offset:14336
  v_mfma_f32_16x16x32_bf16 v[32:35], v[128:131], a[0:3], 0
  ds_read_b64_tr_b16 a[48:49], v119 offset:16384
  v_xor_b32 v10, 2048, v9
  v_mfma_f32_16x16x32_bf16 v[32:35], v[136:139], a[4:7], v[32:35]
  ds_read_b64_tr_b16 a[50:51], v119 offset:18432
  buffer_load_ushort v109, v25, s[24:27], s30 offen offset:896
  v_mfma_f32_16x16x32_bf16 v[32:35], v[144:147], a[8:11], v[32:35]
  ds_read_b64_tr_b16 a[52:53], v119 offset:20480
  v_add_u32 v57, s64, v0
  v_mfma_f32_16x16x32_bf16 v[32:35], v[152:155], a[12:15], v[32:35]
  s_waitcnt lgkmcnt(11)
  ds_read_b64_tr_b16 a[54:55], v119 offset:22528
  v_mfma_f32_16x16x32_bf16 v[32:35], v[160:163], a[16:19], v[32:35]
  ds_read_b64_tr_b16 a[56:57], v119 offset:24576
  v_cvt_pk_bf16_f32 v84, v40, v41
  v_min_u32 v57, 1, v57
  v_mfma_f32_16x16x32_bf16 v[32:35], v[168:171], a[20:23], v[32:35]
  ds_read_b64_tr_b16 a[58:59], v119 offset:26624
  v_cvt_pk_bf16_f32 v85, v42, v43
  v_mfma_f32_16x16x32_bf16 v[32:35], v[176:179], a[24:27], v[32:35]
  ds_read_b64_tr_b16 a[60:61], v119 offset:28672
  v_cvt_pk_bf16_f32 v86, v44, v45
  v_mfma_f32_16x16x32_bf16 v[32:35], v[184:187], a[28:31], v[32:35]
  ds_read_b64_tr_b16 a[62:63], v119 offset:30720
  s_waitcnt vmcnt(18)
  v_mfma_f32_16x16x32_bf16 v[36:39], v[192:195], a[0:3], 0
  s_barrier
  ds_read_b64_tr_b16 a[0:1], v116 offset:32768
  v_mfma_f32_16x16x32_bf16 v[36:39], v[200:203], a[4:7], v[36:39]
  ds_read_b64_tr_b16 a[2:3], v116 offset:34816
  v_cvt_pk_bf16_f32 v87, v46, v47
  v_mfma_f32_16x16x32_bf16 v[36:39], v[208:211], a[8:11], v[36:39]
  ds_read_b64_tr_b16 a[4:5], v116 offset:36864
  buffer_store_dwordx4 v[84:87], v59, s[8:11], s18 offen offset:1024 sc1
  v_mfma_f32_16x16x32_bf16 v[36:39], v[216:219], a[12:15], v[36:39]
  ds_read_b64_tr_b16 a[6:7], v116 offset:38912
  v_lshlrev_b32_e64 v57, 30, v57
  v_mfma_f32_16x16x32_bf16 v[36:39], v[224:227], a[16:19], v[36:39]
  ds_read_b64_tr_b16 a[8:9], v116 offset:40960
  v_mfma_f32_16x16x32_bf16 v[36:39], v[232:235], a[20:23], v[36:39]
  ds_read_b64_tr_b16 a[10:11], v116 offset:43008
  v_mov_b32_e64 v58, 1
  v_mfma_f32_16x16x32_bf16 v[36:39], v[240:243], a[24:27], v[36:39]
  ds_read_b64_tr_b16 a[12:13], v116 offset:45056
  v_mfma_f32_16x16x32_bf16 v[36:39], v[248:251], a[28:31], v[36:39]
  s_waitcnt lgkmcnt(15)
  ds_read_b64_tr_b16 a[14:15], v116 offset:47104
  v_mfma_f32_16x16x32_bf16 v[40:43], v[128:131], a[32:35], 0
  s_nop 0
  ds_read_b64_tr_b16 a[16:17], v116 offset:49152
  v_mfma_f32_16x16x32_bf16 v[40:43], v[136:139], a[36:39], v[40:43]
  ds_read_b64_tr_b16 a[18:19], v116 offset:51200
  buffer_load_ushort v110, v25, s[24:27], s30 offen offset:1792
  v_mfma_f32_16x16x32_bf16 v[40:43], v[144:147], a[40:43], v[40:43]
  ds_read_b64_tr_b16 a[20:21], v116 offset:53248
  v_mfma_f32_16x16x32_bf16 v[40:43], v[152:155], a[44:47], v[40:43]
  s_waitcnt lgkmcnt(11)
  ds_read_b64_tr_b16 a[22:23], v116 offset:55296
  v_mfma_f32_16x16x32_bf16 v[40:43], v[160:163], a[48:51], v[40:43]
  ds_read_b64_tr_b16 a[24:25], v116 offset:57344
  v_cvt_pk_bf16_f32 v88, v32, v33
  v_mfma_f32_16x16x32_bf16 v[40:43], v[168:171], a[52:55], v[40:43]
  ds_read_b64_tr_b16 a[26:27], v116 offset:59392
  v_cvt_pk_bf16_f32 v89, v34, v35
  v_mfma_f32_16x16x32_bf16 v[40:43], v[176:179], a[56:59], v[40:43]
  ds_read_b64_tr_b16 a[28:29], v116 offset:61440
  v_cvt_pk_bf16_f32 v90, v36, v37
  v_mfma_f32_16x16x32_bf16 v[40:43], v[184:187], a[60:63], v[40:43]
  ds_read_b64_tr_b16 a[30:31], v116 offset:63488
  v_cvt_pk_bf16_f32 v91, v38, v39
  v_mfma_f32_16x16x32_bf16 v[44:47], v[192:195], a[32:35], 0
  ds_read_b64_tr_b16 a[32:33], v117 offset:32768
  buffer_store_dwordx4 v[88:91], v59, s[8:11], s18 offen offset:2048 sc1
  v_mfma_f32_16x16x32_bf16 v[44:47], v[200:203], a[36:39], v[44:47]
  s_nop 0
  ds_read_b64_tr_b16 a[34:35], v117 offset:34816
  v_mfma_f32_16x16x32_bf16 v[44:47], v[208:211], a[40:43], v[44:47]
  ds_read_b64_tr_b16 a[36:37], v117 offset:36864
  v_mfma_f32_16x16x32_bf16 v[44:47], v[216:219], a[44:47], v[44:47]
  ds_read_b64_tr_b16 a[38:39], v117 offset:38912
  v_mfma_f32_16x16x32_bf16 v[44:47], v[224:227], a[48:51], v[44:47]
  ds_read_b64_tr_b16 a[40:41], v117 offset:40960
  v_mfma_f32_16x16x32_bf16 v[44:47], v[232:235], a[52:55], v[44:47]
  ds_read_b64_tr_b16 a[42:43], v117 offset:43008
  v_mfma_f32_16x16x32_bf16 v[44:47], v[240:243], a[56:59], v[44:47]
  ds_read_b64_tr_b16 a[44:45], v117 offset:45056
  v_mfma_f32_16x16x32_bf16 v[44:47], v[248:251], a[60:63], v[44:47]
  s_waitcnt lgkmcnt(15)
  ds_read_b64_tr_b16 a[46:47], v117 offset:47104
  v_mfma_f32_16x16x32_bf16 v[32:35], v[128:131], a[0:3], 0
  s_nop 0
  ds_read_b64_tr_b16 a[48:49], v117 offset:49152
  v_mfma_f32_16x16x32_bf16 v[32:35], v[136:139], a[4:7], v[32:35]
  ds_read_b64_tr_b16 a[50:51], v117 offset:51200
  buffer_load_ushort v111, v25, s[24:27], s30 offen offset:2688
  v_mfma_f32_16x16x32_bf16 v[32:35], v[144:147], a[8:11], v[32:35]
  ds_read_b64_tr_b16 a[52:53], v117 offset:53248
  v_mfma_f32_16x16x32_bf16 v[32:35], v[152:155], a[12:15], v[32:35]
  s_waitcnt lgkmcnt(11)
  ds_read_b64_tr_b16 a[54:55], v117 offset:55296
  v_mfma_f32_16x16x32_bf16 v[32:35], v[160:163], a[16:19], v[32:35]
  ds_read_b64_tr_b16 a[56:57], v117 offset:57344
  v_cvt_pk_bf16_f32 v92, v40, v41
  v_mfma_f32_16x16x32_bf16 v[32:35], v[168:171], a[20:23], v[32:35]
  ds_read_b64_tr_b16 a[58:59], v117 offset:59392
  v_cvt_pk_bf16_f32 v93, v42, v43
  v_mfma_f32_16x16x32_bf16 v[32:35], v[176:179], a[24:27], v[32:35]
  ds_read_b64_tr_b16 a[60:61], v117 offset:61440
  v_cvt_pk_bf16_f32 v94, v44, v45
  v_mfma_f32_16x16x32_bf16 v[32:35], v[184:187], a[28:31], v[32:35]
  ds_read_b64_tr_b16 a[62:63], v117 offset:63488
  v_cvt_pk_bf16_f32 v95, v46, v47
  v_mfma_f32_16x16x32_bf16 v[36:39], v[192:195], a[0:3], 0
  ds_read_b64_tr_b16 a[0:1], v118 offset:32768
  buffer_store_dwordx4 v[92:95], v59, s[8:11], s18 offen offset:3072 sc1
  v_mfma_f32_16x16x32_bf16 v[36:39], v[200:203], a[4:7], v[36:39]
  ds_read_b64_tr_b16 a[2:3], v118 offset:34816
  s_add_u32 s18, s18, 4096
  v_mfma_f32_16x16x32_bf16 v[36:39], v[208:211], a[8:11], v[36:39]
  s_nop 0
  ds_read_b64_tr_b16 a[4:5], v118 offset:36864
  v_mfma_f32_16x16x32_bf16 v[36:39], v[216:219], a[12:15], v[36:39]
  ds_read_b64_tr_b16 a[6:7], v118 offset:38912
  v_mfma_f32_16x16x32_bf16 v[36:39], v[224:227], a[16:19], v[36:39]
  ds_read_b64_tr_b16 a[8:9], v118 offset:40960
  v_mfma_f32_16x16x32_bf16 v[36:39], v[232:235], a[20:23], v[36:39]
  ds_read_b64_tr_b16 a[10:11], v118 offset:43008
  v_mfma_f32_16x16x32_bf16 v[36:39], v[240:243], a[24:27], v[36:39]
  ds_read_b64_tr_b16 a[12:13], v118 offset:45056
  v_mfma_f32_16x16x32_bf16 v[36:39], v[248:251], a[28:31], v[36:39]
  s_waitcnt lgkmcnt(15)
  ds_read_b64_tr_b16 a[14:15], v118 offset:47104
  v_mfma_f32_16x16x32_bf16 v[40:43], v[128:131], a[32:35], 0
  s_nop 0
  ds_read_b64_tr_b16 a[16:17], v118 offset:49152
  v_mfma_f32_16x16x32_bf16 v[40:43], v[136:139], a[36:39], v[40:43]
  ds_read_b64_tr_b16 a[18:19], v118 offset:51200
  v_mfma_f32_16x16x32_bf16 v[40:43], v[144:147], a[40:43], v[40:43]
  ds_read_b64_tr_b16 a[20:21], v118 offset:53248
  v_mfma_f32_16x16x32_bf16 v[40:43], v[152:155], a[44:47], v[40:43]
  s_waitcnt lgkmcnt(11)
  ds_read_b64_tr_b16 a[22:23], v118 offset:55296
  v_mfma_f32_16x16x32_bf16 v[40:43], v[160:163], a[48:51], v[40:43]
  ds_read_b64_tr_b16 a[24:25], v118 offset:57344
  v_cvt_pk_bf16_f32 v120, v32, v33
  v_mfma_f32_16x16x32_bf16 v[40:43], v[168:171], a[52:55], v[40:43]
  ds_read_b64_tr_b16 a[26:27], v118 offset:59392
  v_cvt_pk_bf16_f32 v121, v34, v35
  v_mfma_f32_16x16x32_bf16 v[40:43], v[176:179], a[56:59], v[40:43]
  ds_read_b64_tr_b16 a[28:29], v118 offset:61440
  v_cvt_pk_bf16_f32 v122, v36, v37
  v_mfma_f32_16x16x32_bf16 v[40:43], v[184:187], a[60:63], v[40:43]
  ds_read_b64_tr_b16 a[30:31], v118 offset:63488
  v_cvt_pk_bf16_f32 v123, v38, v39
  v_mfma_f32_16x16x32_bf16 v[44:47], v[192:195], a[32:35], 0
  ds_read_b64_tr_b16 a[32:33], v119 offset:32768
  buffer_store_dwordx4 v[120:123], v59, s[8:11], s18 offen offset:0 sc1
  v_mfma_f32_16x16x32_bf16 v[44:47], v[200:203], a[36:39], v[44:47]
  s_nop 0
  ds_read_b64_tr_b16 a[34:35], v119 offset:34816
  v_mfma_f32_16x16x32_bf16 v[44:47], v[208:211], a[40:43], v[44:47]
  ds_read_b64_tr_b16 a[36:37], v119 offset:36864
  v_mfma_f32_16x16x32_bf16 v[44:47], v[216:219], a[44:47], v[44:47]
  ds_read_b64_tr_b16 a[38:39], v119 offset:38912
  v_mfma_f32_16x16x32_bf16 v[44:47], v[224:227], a[48:51], v[44:47]
  ds_read_b64_tr_b16 a[40:41], v119 offset:40960
  v_mfma_f32_16x16x32_bf16 v[44:47], v[232:235], a[52:55], v[44:47]
  ds_read_b64_tr_b16 a[42:43], v119 offset:43008
  v_mfma_f32_16x16x32_bf16 v[44:47], v[240:243], a[56:59], v[44:47]
  ds_read_b64_tr_b16 a[44:45], v119 offset:45056
  v_mfma_f32_16x16x32_bf16 v[44:47], v[248:251], a[60:63], v[44:47]
  s_waitcnt lgkmcnt(15)
  ds_read_b64_tr_b16 a[46:47], v119 offset:47104
  v_mfma_f32_16x16x32_bf16 v[32:35], v[128:131], a[0:3], 0
  s_nop 0
  ds_read_b64_tr_b16 a[48:49], v119 offset:49152
  v_mfma_f32_16x16x32_bf16 v[32:35], v[136:139], a[4:7], v[32:35]
  ds_read_b64_tr_b16 a[50:51], v119 offset:51200
  v_mfma_f32_16x16x32_bf16 v[32:35], v[144:147], a[8:11], v[32:35]
  ds_read_b64_tr_b16 a[52:53], v119 offset:53248
  v_mfma_f32_16x16x32_bf16 v[32:35], v[152:155], a[12:15], v[32:35]
  s_waitcnt lgkmcnt(11)
  ds_read_b64_tr_b16 a[54:55], v119 offset:55296
  v_mfma_f32_16x16x32_bf16 v[32:35], v[160:163], a[16:19], v[32:35]
  ds_read_b64_tr_b16 a[56:57], v119 offset:57344
  v_cvt_pk_bf16_f32 v124, v40, v41
  v_mfma_f32_16x16x32_bf16 v[32:35], v[168:171], a[20:23], v[32:35]
  ds_read_b64_tr_b16 a[58:59], v119 offset:59392
  v_cvt_pk_bf16_f32 v125, v42, v43
  v_mfma_f32_16x16x32_bf16 v[32:35], v[176:179], a[24:27], v[32:35]
  ds_read_b64_tr_b16 a[60:61], v119 offset:61440
  v_cvt_pk_bf16_f32 v126, v44, v45
  v_mfma_f32_16x16x32_bf16 v[32:35], v[184:187], a[28:31], v[32:35]
  ds_read_b64_tr_b16 a[62:63], v119 offset:63488
  v_cvt_pk_bf16_f32 v127, v46, v47
  v_mfma_f32_16x16x32_bf16 v[36:39], v[192:195], a[0:3], 0
  s_nop 0
  buffer_store_dwordx4 v[124:127], v59, s[8:11], s18 offen offset:1024 sc1
  v_mfma_f32_16x16x32_bf16 v[36:39], v[200:203], a[4:7], v[36:39]
  v_mfma_f32_16x16x32_bf16 v[36:39], v[208:211], a[8:11], v[36:39]
  v_mfma_f32_16x16x32_bf16 v[36:39], v[216:219], a[12:15], v[36:39]
  v_mfma_f32_16x16x32_bf16 v[36:39], v[224:227], a[16:19], v[36:39]
  v_mfma_f32_16x16x32_bf16 v[36:39], v[232:235], a[20:23], v[36:39]
  v_mfma_f32_16x16x32_bf16 v[36:39], v[240:243], a[24:27], v[36:39]
  v_mfma_f32_16x16x32_bf16 v[36:39], v[248:251], a[28:31], v[36:39]
  s_waitcnt lgkmcnt(8)
  s_nop 0
  v_mfma_f32_16x16x32_bf16 v[40:43], v[128:131], a[32:35], 0
  v_mfma_f32_16x16x32_bf16 v[40:43], v[136:139], a[36:39], v[40:43]
  v_mfma_f32_16x16x32_bf16 v[40:43], v[144:147], a[40:43], v[40:43]
  v_mfma_f32_16x16x32_bf16 v[40:43], v[152:155], a[44:47], v[40:43]
  s_waitcnt lgkmcnt(0)
  v_cvt_pk_bf16_f32 v60, v32, v33
  v_mfma_f32_16x16x32_bf16 v[40:43], v[160:163], a[48:51], v[40:43]
  v_cvt_pk_bf16_f32 v61, v34, v35
  v_cvt_pk_bf16_f32 v62, v36, v37
  v_mfma_f32_16x16x32_bf16 v[40:43], v[168:171], a[52:55], v[40:43]
  v_cvt_pk_bf16_f32 v63, v38, v39
  buffer_store_dwordx4 v[60:63], v59, s[8:11], s18 offen offset:2048 sc1
  v_mfma_f32_16x16x32_bf16 v[40:43], v[176:179], a[56:59], v[40:43]
  s_nop 0
  v_mfma_f32_16x16x32_bf16 v[40:43], v[184:187], a[60:63], v[40:43]
  v_mfma_f32_16x16x32_bf16 v[44:47], v[192:195], a[32:35], 0
  v_mfma_f32_16x16x32_bf16 v[44:47], v[200:203], a[36:39], v[44:47]
  v_mfma_f32_16x16x32_bf16 v[44:47], v[208:211], a[40:43], v[44:47]
  v_mfma_f32_16x16x32_bf16 v[44:47], v[216:219], a[44:47], v[44:47]
  v_mfma_f32_16x16x32_bf16 v[44:47], v[224:227], a[48:51], v[44:47]
  v_mfma_f32_16x16x32_bf16 v[44:47], v[232:235], a[52:55], v[44:47]
  v_mfma_f32_16x16x32_bf16 v[44:47], v[240:243], a[56:59], v[44:47]
  v_mfma_f32_16x16x32_bf16 v[44:47], v[248:251], a[60:63], v[44:47]
  s_nop 7
  v_cvt_pk_bf16_f32 v48, v40, v41
  v_cvt_pk_bf16_f32 v49, v42, v43
  v_cvt_pk_bf16_f32 v50, v44, v45
  v_cvt_pk_bf16_f32 v51, v46, v47
  buffer_store_dwordx4 v[48:51], v59, s[8:11], s18 offen offset:3072 sc1
  s_add_u32 s18, s18, 4096
  v_lshlrev_b32 v22, 7, v13
  s_and_b32 s6, s45, 0xf0
  s_lshl_b32 s6, s6, 7
  s_add_u32 s6, s6, 8257536
  v_add_u32_e64 v52, s64, v0
  s_xor_b32 s41, s45, 0
  s_add_u32 s41, s41, 512
  s_barrier
  s_lshl_b32 s41, s41, 7
  s_add_u32 s41, s41, 8192000
  v_lshlrev_b32_e64 v20, 4, v13
  v_add_u32 v20, 132096, v20
  s_and_saveexec_b64 s[100:101], s[98:99]
  s_cbranch_execz L_k6_ow
  ds_write_b128 v20, v[132:135] offset:0
  ds_write_b128 v20, v[140:143] offset:256
  ds_write_b128 v20, v[148:151] offset:512
  ds_write_b128 v20, v[156:159] offset:768
  ds_write_b128 v20, v[164:167] offset:1024
  ds_write_b128 v20, v[172:175] offset:1280
  ds_write_b128 v20, v[180:183] offset:1536
  ds_write_b128 v20, v[188:191] offset:1792
  ds_write_b128 v20, v[196:199] offset:2048
  ds_write_b128 v20, v[204:207] offset:2304
  ds_write_b128 v20, v[212:215] offset:2560
  ds_write_b128 v20, v[220:223] offset:2816
  ds_write_b128 v20, v[228:231] offset:3072
  ds_write_b128 v20, v[236:239] offset:3328
  ds_write_b128 v20, v[244:247] offset:3584
  ds_write_b128 v20, v[252:255] offset:3840
  ds_write_b128 v20, v[64:67] offset:4096
  ds_write_b128 v20, v[68:71] offset:4352
  ds_write_b128 v20, v[72:75] offset:4608
  ds_write_b128 v20, v[76:79] offset:4864
  ds_write_b128 v20, v[80:83] offset:5120
  ds_write_b128 v20, v[84:87] offset:5376
  ds_write_b128 v20, v[88:91] offset:5632
  ds_write_b128 v20, v[92:95] offset:5888
  ds_write_b128 v20, v[120:123] offset:6144
  ds_write_b128 v20, v[124:127] offset:6400
  ds_write_b128 v20, v[60:63] offset:6656
  ds_write_b128 v20, v[48:51] offset:6912
L_k6_ow:
  s_mov_b64 exec, -1
  s_mul_i32 s5, s44, 1792
  s_add_u32 s5, s5, 132096
  v_add_u32 v20, s5, v0
  v_cmp_gt_u32 vcc, 48, v11
  s_waitcnt lgkmcnt(0)
  s_waitcnt vmcnt(0)
  s_barrier
  buffer_store_dword v58, v57, s[8:11], s41 offen sc0 sc1
  ds_read_b128 v[32:35], v20
  ds_read_b128 v[36:39], v20 offset:1024
  s_waitcnt lgkmcnt(0)
  v_cndmask_b32 v36, 0, v36, vcc
  v_cndmask_b32 v37, 0, v37, vcc
  v_cndmask_b32 v38, 0, v38, vcc
  v_cndmask_b32 v39, 0, v39, vcc
  s_add_u32 m0, s64, 0
  s_nop 0
  buffer_load_dwordx4 v1, s[32:35], s40 offen offset:0 lds
  buffer_load_dwordx4 v2, s[32:35], s40 offen offset:1024 lds
  buffer_load_dwordx4 v3, s[32:35], s40 offen offset:2048 lds
  buffer_load_dwordx4 v4, s[32:35], s40 offen offset:3072 lds
  s_add_u32 s40, s40, 114688
  s_add_u32 m0, s64, 4096
  s_nop 0
  buffer_load_dwordx4 v1, s[32:35], s40 offen offset:0 lds
  buffer_load_dwordx4 v2, s[32:35], s40 offen offset:1024 lds
  buffer_load_dwordx4 v3, s[32:35], s40 offen offset:2048 lds
  buffer_load_dwordx4 v4, s[32:35], s40 offen offset:3072 lds
  s_add_u32 s40, s40, 114688
  s_add_u32 m0, s64, 8192
  s_nop 0
  buffer_load_dwordx4 v1, s[32:35], s40 offen offset:0 lds
  buffer_load_dwordx4 v2, s[32:35], s40 offen offset:1024 lds
  buffer_load_dwordx4 v3, s[32:35], s40 offen offset:2048 lds
  buffer_load_dwordx4 v4, s[32:35], s40 offen offset:3072 lds
  s_add_u32 s40, s40, 114688
  s_add_u32 m0, s64, 12288
  s_nop 0
  buffer_load_dwordx4 v1, s[32:35], s40 offen offset:0 lds
  buffer_load_dwordx4 v2, s[32:35], s40 offen offset:1024 lds
  buffer_load_dwordx4 v3, s[32:35], s40 offen offset:2048 lds
  buffer_load_dwordx4 v4, s[32:35], s40 offen offset:3072 lds
  s_add_u32 s40, s40, 114688
  s_add_u32 m0, s64, 16384
  s_nop 0
  buffer_load_dwordx4 v1, s[32:35], s40 offen offset:0 lds
  buffer_load_dwordx4 v2, s[32:35], s40 offen offset:1024 lds
  buffer_load_dwordx4 v3, s[32:35], s40 offen offset:2048 lds
  buffer_load_dwordx4 v4, s[32:35], s40 offen offset:3072 lds
  s_add_u32 s40, s40, 114688
  s_add_u32 m0, s64, 20480
  s_nop 0
  buffer_load_dwordx4 v1, s[32:35], s40 offen offset:0 lds
  buffer_load_dwordx4 v2, s[32:35], s40 offen offset:1024 lds
  buffer_load_dwordx4 v3, s[32:35], s40 offen offset:2048 lds
  buffer_load_dwordx4 v4, s[32:35], s40 offen offset:3072 lds
  s_add_u32 s40, s40, 114688
  buffer_load_dword v23, v22, s[8:11], s6 offen sc0 sc1
  s_add_u32 m0, s64, 24576
  s_nop 0
  buffer_load_dwordx4 v1, s[32:35], s40 offen offset:0 lds
  buffer_load_dwordx4 v2, s[32:35], s40 offen offset:1024 lds
  buffer_load_dwordx4 v3, s[32:35], s40 offen offset:2048 lds
  buffer_load_dwordx4 v4, s[32:35], s40 offen offset:3072 lds
  s_add_u32 s40, s40, 114688
  s_add_u32 m0, s64, 28672
  s_nop 0
  buffer_load_dwordx4 v1, s[32:35], s40 offen offset:0 lds
  buffer_load_dwordx4 v2, s[32:35], s40 offen offset:1024 lds
  buffer_load_dwordx4 v3, s[32:35], s40 offen offset:2048 lds
  buffer_load_dwordx4 v4, s[32:35], s40 offen offset:3072 lds
  s_add_u32 s40, s40, 114688
  s_waitcnt vmcnt(8)
  v_cmp_ne_u32 vcc, 1, v23
  s_nop 0
  s_cbranch_vccnz L_k6_p0s
L_k6_p0x:
  s_cmp_eq_u32 s22, 0
  s_cselect_b32 s7, 0x80000000, s31
  buffer_load_dwordx4 v[128:131], v14, s[8:11], s7 offen sc1
  buffer_load_dwordx4 v[132:135], v15, s[8:11], s7 offen sc1
  s_add_u32 s31, s31, 1835008
  s_cmp_eq_u32 s22, 1
  s_cselect_b32 s7, 0x80000000, s31
  buffer_load_dwordx4 v[136:139], v14, s[8:11], s7 offen sc1
  buffer_load_dwordx4 v[140:143], v15, s[8:11], s7 offen sc1
  s_add_u32 s31, s31, 1835008
  s_cmp_eq_u32 s22, 2
  s_cselect_b32 s7, 0x80000000, s31
  buffer_load_dwordx4 v[144:147], v14, s[8:11], s7 offen sc1
  buffer_load_dwordx4 v[148:151], v15, s[8:11], s7 offen sc1
  s_add_u32 s31, s31, 1835008
  s_cmp_eq_u32 s22, 3
  s_cselect_b32 s7, 0x80000000, s31
  buffer_load_dwordx4 v[152:155], v14, s[8:11], s7 offen sc1
  buffer_load_dwordx4 v[156:159], v15, s[8:11], s7 offen sc1
  s_add_u32 s31, s31, 1835008
  s_cmp_eq_u32 s22, 4
  s_cselect_b32 s7, 0x80000000, s31
  buffer_load_dwordx4 v[160:163], v14, s[8:11], s7 offen sc1
  buffer_load_dwordx4 v[164:167], v15, s[8:11], s7 offen sc1
  s_add_u32 s31, s31, 1835008
  s_cmp_eq_u32 s22, 5
  s_cselect_b32 s7, 0x80000000, s31
  buffer_load_dwordx4 v[168:171], v14, s[8:11], s7 offen sc1
  buffer_load_dwordx4 v[172:175], v15, s[8:11], s7 offen sc1
  s_add_u32 s31, s31, 1835008
  s_cmp_eq_u32 s22, 6
  s_cselect_b32 s7, 0x80000000, s31
  buffer_load_dwordx4 v[176:179], v14, s[8:11], s7 offen sc1
  buffer_load_dwordx4 v[180:183], v15, s[8:11], s7 offen sc1
  s_add_u32 s31, s31, 1835008
  s_cmp_eq_u32 s22, 7
  s_cselect_b32 s7, 0x80000000, s31
  buffer_load_dwordx4 v[184:187], v14, s[8:11], s7 offen sc1
  buffer_load_dwordx4 v[188:191], v15, s[8:11], s7 offen sc1
  s_add_u32 s31, s31, 1835008
  s_cmp_eq_u32 s22, 8
  s_cselect_b32 s7, 0x80000000, s31
  buffer_load_dwordx4 v[192:195], v14, s[8:11], s7 offen sc1
  buffer_load_dwordx4 v[196:199], v15, s[8:11], s7 offen sc1
  s_add_u32 s31, s31, 1835008
  s_cmp_eq_u32 s22, 9
  s_cselect_b32 s7, 0x80000000, s31
  buffer_load_dwordx4 v[200:203], v14, s[8:11], s7 offen sc1
  buffer_load_dwordx4 v[204:207], v15, s[8:11], s7 offen sc1
  s_add_u32 s31, s31, 1835008
  s_cmp_eq_u32 s22, 10
  s_cselect_b32 s7, 0x80000000, s31
  buffer_load_dwordx4 v[208:211], v14, s[8:11], s7 offen sc1
  buffer_load_dwordx4 v[212:215], v15, s[8:11], s7 offen sc1
  s_add_u32 s31, s31, 1835008
  s_cmp_eq_u32 s22, 11
  s_cselect_b32 s7, 0x80000000, s31
  buffer_load_dwordx4 v[216:219], v14, s[8:11], s7 offen sc1
  buffer_load_dwordx4 v[220:223], v15, s[8:11], s7 offen sc1
  s_add_u32 s31, s31, 1835008
  s_cmp_eq_u32 s22, 12
  s_cselect_b32 s7, 0x80000000, s31
  buffer_load_dwordx4 v[224:227], v14, s[8:11], s7 offen sc1
  buffer_load_dwordx4 v[228:231], v15, s[8:11], s7 offen sc1
  s_add_u32 s31, s31, 1835008
  s_cmp_eq_u32 s22, 13
  s_cselect_b32 s7, 0x80000000, s31
  buffer_load_dwordx4 v[232:235], v14, s[8:11], s7 offen sc1
  buffer_load_dwordx4 v[236:239], v15, s[8:11], s7 offen sc1
  s_add_u32 s31, s31, 1835008
  s_cmp_eq_u32 s22, 14
  s_cselect_b32 s7, 0x80000000, s31
  buffer_load_dwordx4 v[240:243], v14, s[8:11], s7 offen sc1
  buffer_load_dwordx4 v[244:247], v15, s[8:11], s7 offen sc1
  s_add_u32 s31, s31, 1835008
  s_cmp_eq_u32 s22, 15
  s_cselect_b32 s7, 0x80000000, s31
  buffer_load_dwordx4 v[248:251], v14, s[8:11], s7 offen sc1
  buffer_load_dwordx4 v[252:255], v15, s[8:11], s7 offen sc1
  s_waitcnt vmcnt(32)
  ds_read_b64_tr_b16 a[0:1], v5 offset:0
  ds_read_b64_tr_b16 a[2:3], v5 offset:14336
  ds_read_b64_tr_b16 a[4:5], v6 offset:0
  ds_read_b64_tr_b16 a[6:7], v6 offset:14336
  ds_read_b64_tr_b16 a[8:9], v7 offset:0
  ds_read_b64_tr_b16 a[10:11], v7 offset:14336
  ds_read_b64_tr_b16 a[12:13], v8 offset:0
  ds_read_b64_tr_b16 a[14:15], v8 offset:14336
  ds_read_b64_tr_b16 a[16:17], v5 offset:2048
  ds_read_b64_tr_b16 a[18:19], v5 offset:12288
  ds_read_b64_tr_b16 a[20:21], v6 offset:2048
  ds_read_b64_tr_b16 a[22:23], v6 offset:12288
  ds_read_b64_tr_b16 a[24:25], v7 offset:2048
  ds_read_b64_tr_b16 a[26:27], v7 offset:12288
  ds_read_b64_tr_b16 a[28:29], v8 offset:2048
  ds_read_b64_tr_b16 a[30:31], v8 offset:12288
  ds_read_b64_tr_b16 a[32:33], v5 offset:4096
  ds_read_b64_tr_b16 a[34:35], v5 offset:10240
  ds_read_b64_tr_b16 a[36:37], v6 offset:4096
  ds_read_b64_tr_b16 a[38:39], v6 offset:10240
  ds_read_b64_tr_b16 a[40:41], v7 offset:4096
  ds_read_b64_tr_b16 a[42:43], v7 offset:10240
  ds_read_b64_tr_b16 a[44:45], v8 offset:4096
  ds_read_b64_tr_b16 a[46:47], v8 offset:10240
  ds_read_b64_tr_b16 a[48:49], v5 offset:6144
  ds_read_b64_tr_b16 a[50:51], v5 offset:8192
  ds_read_b64_tr_b16 a[52:53], v6 offset:6144
  ds_read_b64_tr_b16 a[54:55], v6 offset:8192
  ds_read_b64_tr_b16 a[56:57], v7 offset:6144
  ds_read_b64_tr_b16 a[58:59], v7 offset:8192
  ds_read_b64_tr_b16 a[60:61], v8 offset:6144
  ds_read_b64_tr_b16 a[62:63], v8 offset:8192
  ds_read_b64_tr_b16 a[64:65], v5 offset:16384
  ds_read_b64_tr_b16 a[66:67], v5 offset:30720
  ds_read_b64_tr_b16 a[68:69], v6 offset:16384
  ds_read_b64_tr_b16 a[70:71], v6 offset:30720
  ds_read_b64_tr_b16 a[72:73], v7 offset:16384
  ds_read_b64_tr_b16 a[74:75], v7 offset:30720
  ds_read_b64_tr_b16 a[76:77], v8 offset:16384
  ds_read_b64_tr_b16 a[78:79], v8 offset:30720
  ds_read_b64_tr_b16 a[80:81], v5 offset:18432
  ds_read_b64_tr_b16 a[82:83], v5 offset:28672
  ds_read_b64_tr_b16 a[84:85], v6 offset:18432
  ds_read_b64_tr_b16 a[86:87], v6 offset:28672
  ds_read_b64_tr_b16 a[88:89], v7 offset:18432
  ds_read_b64_tr_b16 a[90:91], v7 offset:28672
  ds_read_b64_tr_b16 a[92:93], v8 offset:18432
  ds_read_b64_tr_b16 a[94:95], v8 offset:28672
  ds_read_b64_tr_b16 a[96:97], v5 offset:20480
  ds_read_b64_tr_b16 a[98:99], v5 offset:26624
  ds_read_b64_tr_b16 a[100:101], v6 offset:20480
  ds_read_b64_tr_b16 a[102:103], v6 offset:26624
  ds_read_b64_tr_b16 a[104:105], v7 offset:20480
  ds_read_b64_tr_b16 a[106:107], v7 offset:26624
  ds_read_b64_tr_b16 a[108:109], v8 offset:20480
  ds_read_b64_tr_b16 a[110:111], v8 offset:26624
  ds_read_b64_tr_b16 a[112:113], v5 offset:22528
  ds_read_b64_tr_b16 a[114:115], v5 offset:24576
  ds_read_b64_tr_b16 a[116:117], v6 offset:22528
  ds_read_b64_tr_b16 a[118:119], v6 offset:24576
  ds_read_b64_tr_b16 a[120:121], v7 offset:22528
  ds_read_b64_tr_b16 a[122:123], v7 offset:24576
  ds_read_b64_tr_b16 a[124:125], v8 offset:22528
  ds_read_b64_tr_b16 a[126:127], v8 offset:24576
  s_waitcnt lgkmcnt(0)
  v_lshlrev_b32_e64 v64, 16, v32
  v_and_b32 v65, 0xffff0000, v32
  v_lshlrev_b32_e64 v66, 16, v33
  v_and_b32 v67, 0xffff0000, v33
  v_lshlrev_b32_e64 v68, 16, v34
  v_and_b32 v69, 0xffff0000, v34
  v_lshlrev_b32_e64 v70, 16, v35
  v_and_b32 v71, 0xffff0000, v35
  v_lshlrev_b32_e64 v72, 16, v36
  v_and_b32 v73, 0xffff0000, v36
  v_lshlrev_b32_e64 v74, 16, v37
  v_and_b32 v75, 0xffff0000, v37
  v_lshlrev_b32_e64 v76, 16, v38
  v_and_b32 v77, 0xffff0000, v38
  v_lshlrev_b32_e64 v78, 16, v39
  v_and_b32 v79, 0xffff0000, v39
  s_waitcnt vmcnt(30)
  v_lshlrev_b32 v80, 16, v128
  v_and_b32 v81, 0xffff0000, v128
  v_lshlrev_b32_e64 v82, 16, v129
  v_and_b32 v83, 0xffff0000, v129
  v_lshlrev_b32_e64 v84, 16, v130
  v_and_b32 v85, 0xffff0000, v130
  v_lshlrev_b32_e64 v86, 16, v131
  v_and_b32 v87, 0xffff0000, v131
  v_lshlrev_b32_e64 v88, 16, v132
  v_and_b32 v89, 0xffff0000, v132
  v_lshlrev_b32_e64 v90, 16, v133
  v_and_b32 v91, 0xffff0000, v133
  v_lshlrev_b32_e64 v92, 16, v134
  v_and_b32 v93, 0xffff0000, v134
  v_lshlrev_b32_e64 v94, 16, v135
  v_and_b32 v95, 0xffff0000, v135
  s_waitcnt vmcnt(28)
  v_lshlrev_b32 v112, 16, v136
  v_and_b32 v113, 0xffff0000, v136
  v_lshlrev_b32_e64 v114, 16, v137
  v_and_b32 v115, 0xffff0000, v137
  v_lshlrev_b32_e64 v116, 16, v138
  v_and_b32 v117, 0xffff0000, v138
  v_lshlrev_b32_e64 v118, 16, v139
  v_and_b32 v119, 0xffff0000, v139
  v_lshlrev_b32_e64 v120, 16, v140
  v_and_b32 v121, 0xffff0000, v140
  v_lshlrev_b32_e64 v122, 16, v141
  v_and_b32 v123, 0xffff0000, v141
  v_lshlrev_b32_e64 v124, 16, v142
  v_and_b32 v125, 0xffff0000, v142
  v_lshlrev_b32_e64 v126, 16, v143
  v_and_b32 v127, 0xffff0000, v143
  v_pk_add_f32 v[80:81], v[80:81], v[112:113]
  v_pk_add_f32 v[82:83], v[82:83], v[114:115]
  v_pk_add_f32 v[84:85], v[84:85], v[116:117]
  v_pk_add_f32 v[86:87], v[86:87], v[118:119]
  v_pk_add_f32 v[88:89], v[88:89], v[120:121]
  v_pk_add_f32 v[90:91], v[90:91], v[122:123]
  v_pk_add_f32 v[92:93], v[92:93], v[124:125]
  v_pk_add_f32 v[94:95], v[94:95], v[126:127]
  v_pk_add_f32 v[64:65], v[64:65], v[80:81]
  v_pk_add_f32 v[66:67], v[66:67], v[82:83]
  v_pk_add_f32 v[68:69], v[68:69], v[84:85]
  v_pk_add_f32 v[70:71], v[70:71], v[86:87]
  v_pk_add_f32 v[72:73], v[72:73], v[88:89]
  v_pk_add_f32 v[74:75], v[74:75], v[90:91]
  v_pk_add_f32 v[76:77], v[76:77], v[92:93]
  v_pk_add_f32 v[78:79], v[78:79], v[94:95]
  s_waitcnt vmcnt(26)
  v_lshlrev_b32 v80, 16, v144
  v_and_b32 v81, 0xffff0000, v144
  v_lshlrev_b32_e64 v82, 16, v145
  v_and_b32 v83, 0xffff0000, v145
  v_lshlrev_b32_e64 v84, 16, v146
  v_and_b32 v85, 0xffff0000, v146
  v_lshlrev_b32_e64 v86, 16, v147
  v_and_b32 v87, 0xffff0000, v147
  v_lshlrev_b32_e64 v88, 16, v148
  v_and_b32 v89, 0xffff0000, v148
  v_lshlrev_b32_e64 v90, 16, v149
  v_and_b32 v91, 0xffff0000, v149
  v_lshlrev_b32_e64 v92, 16, v150
  v_and_b32 v93, 0xffff0000, v150
  v_lshlrev_b32_e64 v94, 16, v151
  v_and_b32 v95, 0xffff0000, v151
  s_waitcnt vmcnt(24)
  v_lshlrev_b32 v112, 16, v152
  v_and_b32 v113, 0xffff0000, v152
  v_lshlrev_b32_e64 v114, 16, v153
  v_and_b32 v115, 0xffff0000, v153
  v_lshlrev_b32_e64 v116, 16, v154
  v_and_b32 v117, 0xffff0000, v154
  v_lshlrev_b32_e64 v118, 16, v155
  v_and_b32 v119, 0xffff0000, v155
  v_lshlrev_b32_e64 v120, 16, v156
  v_and_b32 v121, 0xffff0000, v156
  v_lshlrev_b32_e64 v122, 16, v157
  v_and_b32 v123, 0xffff0000, v157
  v_lshlrev_b32_e64 v124, 16, v158
  v_and_b32 v125, 0xffff0000, v158
  v_lshlrev_b32_e64 v126, 16, v159
  v_and_b32 v127, 0xffff0000, v159
  v_pk_add_f32 v[80:81], v[80:81], v[112:113]
  v_pk_add_f32 v[82:83], v[82:83], v[114:115]
  v_pk_add_f32 v[84:85], v[84:85], v[116:117]
  v_pk_add_f32 v[86:87], v[86:87], v[118:119]
  v_pk_add_f32 v[88:89], v[88:89], v[120:121]
  v_pk_add_f32 v[90:91], v[90:91], v[122:123]
  v_pk_add_f32 v[92:93], v[92:93], v[124:125]
  v_pk_add_f32 v[94:95], v[94:95], v[126:127]
  v_pk_add_f32 v[64:65], v[64:65], v[80:81]
  v_pk_add_f32 v[66:67], v[66:67], v[82:83]
  v_pk_add_f32 v[68:69], v[68:69], v[84:85]
  v_pk_add_f32 v[70:71], v[70:71], v[86:87]
  v_pk_add_f32 v[72:73], v[72:73], v[88:89]
  v_pk_add_f32 v[74:75], v[74:75], v[90:91]
  v_pk_add_f32 v[76:77], v[76:77], v[92:93]
  v_pk_add_f32 v[78:79], v[78:79], v[94:95]
  s_waitcnt vmcnt(22)
  v_lshlrev_b32 v80, 16, v160
  v_and_b32 v81, 0xffff0000, v160
  v_lshlrev_b32_e64 v82, 16, v161
  v_and_b32 v83, 0xffff0000, v161
  v_lshlrev_b32_e64 v84, 16, v162
  v_and_b32 v85, 0xffff0000, v162
  v_lshlrev_b32_e64 v86, 16, v163
  v_and_b32 v87, 0xffff0000, v163
  v_lshlrev_b32_e64 v88, 16, v164
  v_and_b32 v89, 0xffff0000, v164
  v_lshlrev_b32_e64 v90, 16, v165
  v_and_b32 v91, 0xffff0000, v165
  v_lshlrev_b32_e64 v92, 16, v166
  v_and_b32 v93, 0xffff0000, v166
  v_lshlrev_b32_e64 v94, 16, v167
  v_and_b32 v95, 0xffff0000, v167
  s_waitcnt vmcnt(20)
  v_lshlrev_b32 v112, 16, v168
  v_and_b32 v113, 0xffff0000, v168
  v_lshlrev_b32_e64 v114, 16, v169
  v_and_b32 v115, 0xffff0000, v169
  v_lshlrev_b32_e64 v116, 16, v170
  v_and_b32 v117, 0xffff0000, v170
  v_lshlrev_b32_e64 v118, 16, v171
  v_and_b32 v119, 0xffff0000, v171
  v_lshlrev_b32_e64 v120, 16, v172
  v_and_b32 v121, 0xffff0000, v172
  v_lshlrev_b32_e64 v122, 16, v173
  v_and_b32 v123, 0xffff0000, v173
  v_lshlrev_b32_e64 v124, 16, v174
  v_and_b32 v125, 0xffff0000, v174
  v_lshlrev_b32_e64 v126, 16, v175
  v_and_b32 v127, 0xffff0000, v175
  v_pk_add_f32 v[80:81], v[80:81], v[112:113]
  v_pk_add_f32 v[82:83], v[82:83], v[114:115]
  v_pk_add_f32 v[84:85], v[84:85], v[116:117]
  v_pk_add_f32 v[86:87], v[86:87], v[118:119]
  v_pk_add_f32 v[88:89], v[88:89], v[120:121]
  v_pk_add_f32 v[90:91], v[90:91], v[122:123]
  v_pk_add_f32 v[92:93], v[92:93], v[124:125]
  v_pk_add_f32 v[94:95], v[94:95], v[126:127]
  v_pk_add_f32 v[64:65], v[64:65], v[80:81]
  v_pk_add_f32 v[66:67], v[66:67], v[82:83]
  v_pk_add_f32 v[68:69], v[68:69], v[84:85]
  v_pk_add_f32 v[70:71], v[70:71], v[86:87]
  v_pk_add_f32 v[72:73], v[72:73], v[88:89]
  v_pk_add_f32 v[74:75], v[74:75], v[90:91]
  v_pk_add_f32 v[76:77], v[76:77], v[92:93]
  v_pk_add_f32 v[78:79], v[78:79], v[94:95]
  s_waitcnt vmcnt(18)
  v_lshlrev_b32 v80, 16, v176
  v_and_b32 v81, 0xffff0000, v176
  v_lshlrev_b32_e64 v82, 16, v177
  v_and_b32 v83, 0xffff0000, v177
  v_lshlrev_b32_e64 v84, 16, v178
  v_and_b32 v85, 0xffff0000, v178
  v_lshlrev_b32_e64 v86, 16, v179
  v_and_b32 v87, 0xffff0000, v179
  v_lshlrev_b32_e64 v88, 16, v180
  v_and_b32 v89, 0xffff0000, v180
  v_lshlrev_b32_e64 v90, 16, v181
  v_and_b32 v91, 0xffff0000, v181
  v_lshlrev_b32_e64 v92, 16, v182
  v_and_b32 v93, 0xffff0000, v182
  v_lshlrev_b32_e64 v94, 16, v183
  v_and_b32 v95, 0xffff0000, v183
  s_waitcnt vmcnt(16)
  v_lshlrev_b32 v112, 16, v184
  v_and_b32 v113, 0xffff0000, v184
  v_lshlrev_b32_e64 v114, 16, v185
  v_and_b32 v115, 0xffff0000, v185
  v_lshlrev_b32_e64 v116, 16, v186
  v_and_b32 v117, 0xffff0000, v186
  v_lshlrev_b32_e64 v118, 16, v187
  v_and_b32 v119, 0xffff0000, v187
  v_lshlrev_b32_e64 v120, 16, v188
  v_and_b32 v121, 0xffff0000, v188
  v_lshlrev_b32_e64 v122, 16, v189
  v_and_b32 v123, 0xffff0000, v189
  v_lshlrev_b32_e64 v124, 16, v190
  v_and_b32 v125, 0xffff0000, v190
  v_lshlrev_b32_e64 v126, 16, v191
  v_and_b32 v127, 0xffff0000, v191
  v_pk_add_f32 v[80:81], v[80:81], v[112:113]
  v_pk_add_f32 v[82:83], v[82:83], v[114:115]
  v_pk_add_f32 v[84:85], v[84:85], v[116:117]
  v_pk_add_f32 v[86:87], v[86:87], v[118:119]
  v_pk_add_f32 v[88:89], v[88:89], v[120:121]
  v_pk_add_f32 v[90:91], v[90:91], v[122:123]
  v_pk_add_f32 v[92:93], v[92:93], v[124:125]
  v_pk_add_f32 v[94:95], v[94:95], v[126:127]
  v_pk_add_f32 v[64:65], v[64:65], v[80:81]
  v_pk_add_f32 v[66:67], v[66:67], v[82:83]
  v_pk_add_f32 v[68:69], v[68:69], v[84:85]
  v_pk_add_f32 v[70:71], v[70:71], v[86:87]
  v_pk_add_f32 v[72:73], v[72:73], v[88:89]
  v_pk_add_f32 v[74:75], v[74:75], v[90:91]
  v_pk_add_f32 v[76:77], v[76:77], v[92:93]
  v_pk_add_f32 v[78:79], v[78:79], v[94:95]
  s_waitcnt vmcnt(14)
  v_lshlrev_b32 v80, 16, v192
  v_and_b32 v81, 0xffff0000, v192
  v_lshlrev_b32_e64 v82, 16, v193
  v_and_b32 v83, 0xffff0000, v193
  v_lshlrev_b32_e64 v84, 16, v194
  v_and_b32 v85, 0xffff0000, v194
  v_lshlrev_b32_e64 v86, 16, v195
  v_and_b32 v87, 0xffff0000, v195
  v_lshlrev_b32_e64 v88, 16, v196
  v_and_b32 v89, 0xffff0000, v196
  v_lshlrev_b32_e64 v90, 16, v197
  v_and_b32 v91, 0xffff0000, v197
  v_lshlrev_b32_e64 v92, 16, v198
  v_and_b32 v93, 0xffff0000, v198
  v_lshlrev_b32_e64 v94, 16, v199
  v_and_b32 v95, 0xffff0000, v199
  s_waitcnt vmcnt(12)
  v_lshlrev_b32 v112, 16, v200
  v_and_b32 v113, 0xffff0000, v200
  v_lshlrev_b32_e64 v114, 16, v201
  v_and_b32 v115, 0xffff0000, v201
  v_lshlrev_b32_e64 v116, 16, v202
  v_and_b32 v117, 0xffff0000, v202
  v_lshlrev_b32_e64 v118, 16, v203
  v_and_b32 v119, 0xffff0000, v203
  v_lshlrev_b32_e64 v120, 16, v204
  v_and_b32 v121, 0xffff0000, v204
  v_lshlrev_b32_e64 v122, 16, v205
  v_and_b32 v123, 0xffff0000, v205
  v_lshlrev_b32_e64 v124, 16, v206
  v_and_b32 v125, 0xffff0000, v206
  v_lshlrev_b32_e64 v126, 16, v207
  v_and_b32 v127, 0xffff0000, v207
  v_pk_add_f32 v[80:81], v[80:81], v[112:113]
  v_pk_add_f32 v[82:83], v[82:83], v[114:115]
  v_pk_add_f32 v[84:85], v[84:85], v[116:117]
  v_pk_add_f32 v[86:87], v[86:87], v[118:119]
  v_pk_add_f32 v[88:89], v[88:89], v[120:121]
  v_pk_add_f32 v[90:91], v[90:91], v[122:123]
  v_pk_add_f32 v[92:93], v[92:93], v[124:125]
  v_pk_add_f32 v[94:95], v[94:95], v[126:127]
  v_pk_add_f32 v[64:65], v[64:65], v[80:81]
  v_pk_add_f32 v[66:67], v[66:67], v[82:83]
  v_pk_add_f32 v[68:69], v[68:69], v[84:85]
  v_pk_add_f32 v[70:71], v[70:71], v[86:87]
  v_pk_add_f32 v[72:73], v[72:73], v[88:89]
  v_pk_add_f32 v[74:75], v[74:75], v[90:91]
  v_pk_add_f32 v[76:77], v[76:77], v[92:93]
  v_pk_add_f32 v[78:79], v[78:79], v[94:95]
  s_waitcnt vmcnt(10)
  v_lshlrev_b32 v80, 16, v208
  v_and_b32 v81, 0xffff0000, v208
  v_lshlrev_b32_e64 v82, 16, v209
  v_and_b32 v83, 0xffff0000, v209
  v_lshlrev_b32_e64 v84, 16, v210
  v_and_b32 v85, 0xffff0000, v210
  v_lshlrev_b32_e64 v86, 16, v211
  v_and_b32 v87, 0xffff0000, v211
  v_lshlrev_b32_e64 v88, 16, v212
  v_and_b32 v89, 0xffff0000, v212
  v_lshlrev_b32_e64 v90, 16, v213
  v_and_b32 v91, 0xffff0000, v213
  v_lshlrev_b32_e64 v92, 16, v214
  v_and_b32 v93, 0xffff0000, v214
  v_lshlrev_b32_e64 v94, 16, v215
  v_and_b32 v95, 0xffff0000, v215
  s_waitcnt vmcnt(8)
  v_lshlrev_b32 v112, 16, v216
  v_and_b32 v113, 0xffff0000, v216
  v_lshlrev_b32_e64 v114, 16, v217
  v_and_b32 v115, 0xffff0000, v217
  v_lshlrev_b32_e64 v116, 16, v218
  v_and_b32 v117, 0xffff0000, v218
  v_lshlrev_b32_e64 v118, 16, v219
  v_and_b32 v119, 0xffff0000, v219
  v_lshlrev_b32_e64 v120, 16, v220
  v_and_b32 v121, 0xffff0000, v220
  v_lshlrev_b32_e64 v122, 16, v221
  v_and_b32 v123, 0xffff0000, v221
  v_lshlrev_b32_e64 v124, 16, v222
  v_and_b32 v125, 0xffff0000, v222
  v_lshlrev_b32_e64 v126, 16, v223
  v_and_b32 v127, 0xffff0000, v223
  v_pk_add_f32 v[80:81], v[80:81], v[112:113]
  v_pk_add_f32 v[82:83], v[82:83], v[114:115]
  v_pk_add_f32 v[84:85], v[84:85], v[116:117]
  v_pk_add_f32 v[86:87], v[86:87], v[118:119]
  v_pk_add_f32 v[88:89], v[88:89], v[120:121]
  v_pk_add_f32 v[90:91], v[90:91], v[122:123]
  v_pk_add_f32 v[92:93], v[92:93], v[124:125]
  v_pk_add_f32 v[94:95], v[94:95], v[126:127]
  v_pk_add_f32 v[64:65], v[64:65], v[80:81]
  v_pk_add_f32 v[66:67], v[66:67], v[82:83]
  v_pk_add_f32 v[68:69], v[68:69], v[84:85]
  v_pk_add_f32 v[70:71], v[70:71], v[86:87]
  v_pk_add_f32 v[72:73], v[72:73], v[88:89]
  v_pk_add_f32 v[74:75], v[74:75], v[90:91]
  v_pk_add_f32 v[76:77], v[76:77], v[92:93]
  v_pk_add_f32 v[78:79], v[78:79], v[94:95]
  s_waitcnt vmcnt(6)
  v_lshlrev_b32 v80, 16, v224
  v_and_b32 v81, 0xffff0000, v224
  v_lshlrev_b32_e64 v82, 16, v225
  v_and_b32 v83, 0xffff0000, v225
  v_lshlrev_b32_e64 v84, 16, v226
  v_and_b32 v85, 0xffff0000, v226
  v_lshlrev_b32_e64 v86, 16, v227
  v_and_b32 v87, 0xffff0000, v227
  v_lshlrev_b32_e64 v88, 16, v228
  v_and_b32 v89, 0xffff0000, v228
  v_lshlrev_b32_e64 v90, 16, v229
  v_and_b32 v91, 0xffff0000, v229
  v_lshlrev_b32_e64 v92, 16, v230
  v_and_b32 v93, 0xffff0000, v230
  v_lshlrev_b32_e64 v94, 16, v231
  v_and_b32 v95, 0xffff0000, v231
  s_waitcnt vmcnt(4)
  v_lshlrev_b32 v112, 16, v232
  v_and_b32 v113, 0xffff0000, v232
  v_lshlrev_b32_e64 v114, 16, v233
  v_and_b32 v115, 0xffff0000, v233
  v_lshlrev_b32_e64 v116, 16, v234
  v_and_b32 v117, 0xffff0000, v234
  v_lshlrev_b32_e64 v118, 16, v235
  v_and_b32 v119, 0xffff0000, v235
  v_lshlrev_b32_e64 v120, 16, v236
  v_and_b32 v121, 0xffff0000, v236
  v_lshlrev_b32_e64 v122, 16, v237
  v_and_b32 v123, 0xffff0000, v237
  v_lshlrev_b32_e64 v124, 16, v238
  v_and_b32 v125, 0xffff0000, v238
  v_lshlrev_b32_e64 v126, 16, v239
  v_and_b32 v127, 0xffff0000, v239
  v_pk_add_f32 v[80:81], v[80:81], v[112:113]
  v_pk_add_f32 v[82:83], v[82:83], v[114:115]
  v_pk_add_f32 v[84:85], v[84:85], v[116:117]
  v_pk_add_f32 v[86:87], v[86:87], v[118:119]
  v_pk_add_f32 v[88:89], v[88:89], v[120:121]
  v_pk_add_f32 v[90:91], v[90:91], v[122:123]
  v_pk_add_f32 v[92:93], v[92:93], v[124:125]
  v_pk_add_f32 v[94:95], v[94:95], v[126:127]
  v_pk_add_f32 v[64:65], v[64:65], v[80:81]
  v_pk_add_f32 v[66:67], v[66:67], v[82:83]
  v_pk_add_f32 v[68:69], v[68:69], v[84:85]
  v_pk_add_f32 v[70:71], v[70:71], v[86:87]
  v_pk_add_f32 v[72:73], v[72:73], v[88:89]
  v_pk_add_f32 v[74:75], v[74:75], v[90:91]
  v_pk_add_f32 v[76:77], v[76:77], v[92:93]
  v_pk_add_f32 v[78:79], v[78:79], v[94:95]
  s_waitcnt vmcnt(2)
  v_lshlrev_b32 v80, 16, v240
  v_and_b32 v81, 0xffff0000, v240
  v_lshlrev_b32_e64 v82, 16, v241
  v_and_b32 v83, 0xffff0000, v241
  v_lshlrev_b32_e64 v84, 16, v242
  v_and_b32 v85, 0xffff0000, v242
  v_lshlrev_b32_e64 v86, 16, v243
  v_and_b32 v87, 0xffff0000, v243
  v_lshlrev_b32_e64 v88, 16, v244
  v_and_b32 v89, 0xffff0000, v244
  v_lshlrev_b32_e64 v90, 16, v245
  v_and_b32 v91, 0xffff0000, v245
  v_lshlrev_b32_e64 v92, 16, v246
  v_and_b32 v93, 0xffff0000, v246
  v_lshlrev_b32_e64 v94, 16, v247
  v_and_b32 v95, 0xffff0000, v247
  s_add_u32 m0, s64, 0
  s_nop 0
  buffer_load_dwordx4 v1, s[32:35], s40 offen offset:0 lds
  buffer_load_dwordx4 v2, s[32:35], s40 offen offset:1024 lds
  buffer_load_dwordx4 v3, s[32:35], s40 offen offset:2048 lds
  buffer_load_dwordx4 v4, s[32:35], s40 offen offset:3072 lds
  s_add_u32 s40, s40, 114688
  s_waitcnt vmcnt(4)
  v_lshlrev_b32 v112, 16, v248
  v_and_b32 v113, 0xffff0000, v248
  v_lshlrev_b32_e64 v114, 16, v249
  v_and_b32 v115, 0xffff0000, v249
  v_lshlrev_b32_e64 v116, 16, v250
  v_and_b32 v117, 0xffff0000, v250
  v_lshlrev_b32_e64 v118, 16, v251
  v_and_b32 v119, 0xffff0000, v251
  v_lshlrev_b32_e64 v120, 16, v252
  v_and_b32 v121, 0xffff0000, v252
  v_lshlrev_b32_e64 v122, 16, v253
  v_and_b32 v123, 0xffff0000, v253
  v_lshlrev_b32_e64 v124, 16, v254
  v_and_b32 v125, 0xffff0000, v254
  v_lshlrev_b32_e64 v126, 16, v255
  v_and_b32 v127, 0xffff0000, v255
  v_pk_add_f32 v[80:81], v[80:81], v[112:113]
  v_pk_add_f32 v[82:83], v[82:83], v[114:115]
  v_pk_add_f32 v[84:85], v[84:85], v[116:117]
  v_pk_add_f32 v[86:87], v[86:87], v[118:119]
  v_pk_add_f32 v[88:89], v[88:89], v[120:121]
  v_pk_add_f32 v[90:91], v[90:91], v[122:123]
  v_pk_add_f32 v[92:93], v[92:93], v[124:125]
  v_pk_add_f32 v[94:95], v[94:95], v[126:127]
  v_pk_add_f32 v[64:65], v[64:65], v[80:81]
  v_pk_add_f32 v[66:67], v[66:67], v[82:83]
  v_pk_add_f32 v[68:69], v[68:69], v[84:85]
  v_pk_add_f32 v[70:71], v[70:71], v[86:87]
  v_pk_add_f32 v[72:73], v[72:73], v[88:89]
  v_pk_add_f32 v[74:75], v[74:75], v[90:91]
  v_pk_add_f32 v[76:77], v[76:77], v[92:93]
  v_pk_add_f32 v[78:79], v[78:79], v[94:95]
  s_add_u32 m0, s64, 4096
  s_nop 0
  buffer_load_dwordx4 v1, s[32:35], s40 offen offset:0 lds
  buffer_load_dwordx4 v2, s[32:35], s40 offen offset:1024 lds
  buffer_load_dwordx4 v3, s[32:35], s40 offen offset:2048 lds
  buffer_load_dwordx4 v4, s[32:35], s40 offen offset:3072 lds
  s_add_u32 s40, s40, 114688
L_k6_sum:
  s_add_u32 m0, s64, 8192
  s_nop 0
  buffer_load_dwordx4 v1, s[32:35], s40 offen offset:0 lds
  v_cvt_pk_bf16_f32 v80, v64, v65
  v_cvt_pk_bf16_f32 v81, v66, v67
  v_cvt_pk_bf16_f32 v82, v68, v69
  v_cvt_pk_bf16_f32 v83, v70, v71
  v_cvt_pk_bf16_f32 v84, v72, v73
  v_cvt_pk_bf16_f32 v85, v74, v75
  v_cvt_pk_bf16_f32 v86, v76, v77
  v_cvt_pk_bf16_f32 v87, v78, v79
  buffer_load_dwordx4 v2, s[32:35], s40 offen offset:1024 lds
  v_lshlrev_b32 v96, 16, v96
  v_lshlrev_b32 v97, 16, v97
  v_lshlrev_b32 v98, 16, v98
  v_lshlrev_b32 v99, 16, v99
  v_lshlrev_b32 v100, 16, v100
  v_lshlrev_b32 v101, 16, v101
  v_lshlrev_b32 v102, 16, v102
  v_lshlrev_b32 v103, 16, v103
  buffer_load_dwordx4 v3, s[32:35], s40 offen offset:2048 lds
  v_lshlrev_b32 v104, 16, v104
  v_lshlrev_b32 v105, 16, v105
  v_lshlrev_b32 v106, 16, v106
  v_lshlrev_b32 v107, 16, v107
  v_lshlrev_b32 v108, 16, v108
  v_lshlrev_b32 v109, 16, v109
  v_lshlrev_b32 v110, 16, v110
  v_lshlrev_b32 v111, 16, v111
  buffer_load_dwordx4 v4, s[32:35], s40 offen offset:3072 lds
  v_lshlrev_b32_e64 v64, 16, v80
  v_and_b32 v65, 0xffff0000, v80
  v_lshlrev_b32_e64 v66, 16, v81
  v_and_b32 v67, 0xffff0000, v81
  v_lshlrev_b32_e64 v68, 16, v82
  v_and_b32 v69, 0xffff0000, v82
  v_lshlrev_b32_e64 v70, 16, v83
  v_and_b32 v71, 0xffff0000, v83
  s_add_u32 s40, s40, 114688
  s_add_u32 m0, s64, 12288
  s_nop 0
  buffer_load_dwordx4 v1, s[32:35], s40 offen offset:0 lds
  v_lshlrev_b32 v72, 16, v84
  v_and_b32 v73, 0xffff0000, v84
  v_lshlrev_b32_e64 v74, 16, v85
  v_and_b32 v75, 0xffff0000, v85
  v_lshlrev_b32_e64 v76, 16, v86
  v_and_b32 v77, 0xffff0000, v86
  v_lshlrev_b32_e64 v78, 16, v87
  v_and_b32 v79, 0xffff0000, v87
  buffer_load_dwordx4 v2, s[32:35], s40 offen offset:1024 lds
  v_pk_add_f32 v[64:65], v[64:65], v[96:97]
  v_pk_add_f32 v[66:67], v[66:67], v[98:99]
  v_pk_add_f32 v[68:69], v[68:69], v[100:101]
  v_pk_add_f32 v[70:71], v[70:71], v[102:103]
  v_pk_add_f32 v[72:73], v[72:73], v[104:105]
  v_pk_add_f32 v[74:75], v[74:75], v[106:107]
  v_pk_add_f32 v[76:77], v[76:77], v[108:109]
  v_pk_add_f32 v[78:79], v[78:79], v[110:111]
  buffer_load_dwordx4 v3, s[32:35], s40 offen offset:2048 lds
  v_cvt_pk_bf16_f32 v80, v64, v65
  v_cvt_pk_bf16_f32 v81, v66, v67
  v_cvt_pk_bf16_f32 v82, v68, v69
  v_cvt_pk_bf16_f32 v83, v70, v71
  v_cvt_pk_bf16_f32 v84, v72, v73
  v_cvt_pk_bf16_f32 v85, v74, v75
  v_cvt_pk_bf16_f32 v86, v76, v77
  v_cvt_pk_bf16_f32 v87, v78, v79
  buffer_load_dwordx4 v4, s[32:35], s40 offen offset:3072 lds
  s_add_u32 s5, s65, 2097152
  buffer_store_dwordx4 v[80:83], v26, s[8:11], s5 offen sc1
  buffer_store_dwordx4 v[84:87], v27, s[8:11], s5 offen sc1
  v_lshlrev_b32_e64 v96, 16, v80
  v_and_b32 v97, 0xffff0000, v80
  v_lshlrev_b32_e64 v98, 16, v81
  v_and_b32 v99, 0xffff0000, v81
  v_lshlrev_b32_e64 v100, 16, v82
  s_add_u32 s40, s40, 114688
  s_add_u32 m0, s64, 16384
  s_nop 0
  buffer_load_dwordx4 v1, s[32:35], s40 offen offset:0 lds
  v_and_b32 v101, 0xffff0000, v82
  v_lshlrev_b32 v102, 16, v83
  v_and_b32 v103, 0xffff0000, v83
  v_lshlrev_b32_e64 v104, 16, v84
  v_and_b32 v105, 0xffff0000, v84
  v_lshlrev_b32_e64 v106, 16, v85
  v_and_b32 v107, 0xffff0000, v85
  v_lshlrev_b32_e64 v108, 16, v86
  buffer_load_dwordx4 v2, s[32:35], s40 offen offset:1024 lds
  v_and_b32 v109, 0xffff0000, v86
  v_lshlrev_b32_e64 v110, 16, v87
  v_and_b32 v111, 0xffff0000, v87
  v_pk_add_f32 v[64:65], v[96:97], v[104:105]
  v_pk_add_f32 v[66:67], v[98:99], v[106:107]
  v_pk_add_f32 v[68:69], v[100:101], v[108:109]
  v_pk_add_f32 v[70:71], v[102:103], v[110:111]
  v_pk_mul_f32 v[72:73], v[96:97], v[96:97]
  buffer_load_dwordx4 v3, s[32:35], s40 offen offset:2048 lds
  v_pk_mul_f32 v[74:75], v[98:99], v[98:99]
  v_pk_mul_f32 v[76:77], v[100:101], v[100:101]
  v_pk_mul_f32 v[78:79], v[102:103], v[102:103]
  v_pk_fma_f32 v[72:73], v[104:105], v[104:105], v[72:73]
  v_pk_fma_f32 v[74:75], v[106:107], v[106:107], v[74:75]
  v_pk_fma_f32 v[76:77], v[108:109], v[108:109], v[76:77]
  v_pk_fma_f32 v[78:79], v[110:111], v[110:111], v[78:79]
  s_nop 0
  buffer_load_dwordx4 v4, s[32:35], s40 offen offset:3072 lds
  v_permlane32_swap_b32 v64, v72
  v_permlane32_swap_b32 v65, v73
  v_permlane32_swap_b32 v66, v74
  v_permlane32_swap_b32 v67, v75
  v_permlane32_swap_b32 v68, v76
  v_permlane32_swap_b32 v69, v77
  v_permlane32_swap_b32 v70, v78
  v_permlane32_swap_b32 v71, v79
  s_add_u32 s40, s40, 114688
  s_add_u32 m0, s64, 20480
  s_nop 0
  buffer_load_dwordx4 v1, s[32:35], s40 offen offset:0 lds
  v_add_f32 v64, v64, v72
  v_add_f32 v65, v65, v73
  v_add_f32 v66, v66, v74
  v_add_f32 v67, v67, v75
  v_add_f32 v68, v68, v76
  v_add_f32 v69, v69, v77
  v_add_f32 v70, v70, v78
  v_add_f32 v71, v71, v79
  buffer_load_dwordx4 v2, s[32:35], s40 offen offset:1024 lds
  v_permlane16_swap_b32 v64, v68
  v_permlane16_swap_b32 v65, v69
  v_permlane16_swap_b32 v66, v70
  v_permlane16_swap_b32 v67, v71
  v_add_f32 v64, v64, v68
  v_add_f32 v65, v65, v69
  v_add_f32 v66, v66, v70
  v_add_f32 v67, v67, v71
  buffer_load_dwordx4 v3, s[32:35], s40 offen offset:2048 lds
  v_add_f32_dpp v64, v64, v64 row_ror:8 row_mask:0xf bank_mask:0xf
  v_add_f32_dpp v65, v65, v65 row_ror:8 row_mask:0xf bank_mask:0xf
  v_add_f32_dpp v66, v66, v66 row_ror:8 row_mask:0xf bank_mask:0xf
  v_add_f32_dpp v67, v67, v67 row_ror:8 row_mask:0xf bank_mask:0xf
  v_add_f32_dpp v64, v64, v64 row_ror:4 row_mask:0xf bank_mask:0xf
  v_add_f32_dpp v65, v65, v65 row_ror:4 row_mask:0xf bank_mask:0xf
  v_add_f32_dpp v66, v66, v66 row_ror:4 row_mask:0xf bank_mask:0xf
  v_add_f32_dpp v67, v67, v67 row_ror:4 row_mask:0xf bank_mask:0xf
  buffer_load_dwordx4 v4, s[32:35], s40 offen offset:3072 lds
  v_add_f32_dpp v64, v64, v64 row_ror:2 row_mask:0xf bank_mask:0xf
  v_add_f32_dpp v65, v65, v65 row_ror:2 row_mask:0xf bank_mask:0xf
  v_add_f32_dpp v66, v66, v66 row_ror:2 row_mask:0xf bank_mask:0xf
  v_add_f32_dpp v67, v67, v67 row_ror:2 row_mask:0xf bank_mask:0xf
  v_add_f32_dpp v64, v64, v64 row_ror:1 row_mask:0xf bank_mask:0xf
  v_add_f32_dpp v65, v65, v65 row_ror:1 row_mask:0xf bank_mask:0xf
  v_add_f32_dpp v66, v66, v66 row_ror:1 row_mask:0xf bank_mask:0xf
  v_add_f32_dpp v67, v67, v67 row_ror:1 row_mask:0xf bank_mask:0xf
  s_add_u32 s40, s40, 114688
  s_add_u32 m0, s64, 24576
  s_nop 0
  buffer_load_dwordx4 v1, s[32:35], s40 offen offset:0 lds
  s_lshl_b32 s5, s44, 6
  s_add_u32 s5, s5, 131072
  v_lshl_add_u32 v20, v12, 4, s5
  ds_write_b128 v20, v[64:67]
  v_lshlrev_b32_e64 v20, 2, v13
  v_add_u32 v20, 131072, v20
  s_waitcnt lgkmcnt(0)
  s_barrier
  buffer_load_dwordx4 v2, s[32:35], s40 offen offset:1024 lds
  ds_read_b32 v64, v20 offset:0
  ds_read_b32 v65, v20 offset:64
  ds_read_b32 v66, v20 offset:128
  ds_read_b32 v67, v20 offset:192
  s_waitcnt lgkmcnt(0)
  v_add_f32 v64, v64, v65
  v_add_f32 v66, v66, v67
  v_add_f32 v64, v64, v66
  buffer_load_dwordx4 v3, s[32:35], s40 offen offset:2048 lds
  v_mul_f32 v64, 0x3b124925, v64
  s_nop 1
  v_mov_b32_dpp v65, v64 row_ror:8 row_mask:0xf bank_mask:0xf
  v_fma_f32 v65, -v64, v64, v65
  v_max_f32 v65, 0, v65
  v_add_f32 v66, 0x3727c5ac, v65
  v_rsq_f32 v66, v66
  s_nop 0
  buffer_load_dwordx4 v4, s[32:35], s40 offen offset:3072 lds
  v_mul_f32 v67, v66, v66
  v_mul_f32 v67, v67, v65
  v_add_f32 v67, 0x3727c5ac, v67
  v_rsq_f32 v67, v67
  s_nop 0
  v_mul_f32_e64 v66, v66, v67
  v_readlane_b32 s12, v64, 0
  v_readlane_b32 s13, v64, 1
  s_add_u32 s40, s40, 114688
  s_add_u32 m0, s64, 28672
  s_nop 0
  buffer_load_dwordx4 v1, s[32:35], s40 offen offset:0 lds
  v_readlane_b32 s14, v64, 2
  v_readlane_b32 s15, v64, 3
  v_readlane_b32 s16, v64, 4
  v_readlane_b32 s17, v64, 5
  v_readlane_b32 s18, v64, 6
  v_readlane_b32 s19, v64, 7
  v_readlane_b32 s20, v66, 0
  v_readlane_b32 s21, v66, 1
  buffer_load_dwordx4 v2, s[32:35], s40 offen offset:1024 lds
  v_readlane_b32 s22, v66, 2
  v_readlane_b32 s23, v66, 3
  v_readlane_b32 s24, v66, 4
  v_readlane_b32 s25, v66, 5
  v_readlane_b32 s26, v66, 6
  v_readlane_b32 s27, v66, 7
  v_subrev_f32 v96, s12, v96
  v_subrev_f32_e64 v97, s13, v97
  buffer_load_dwordx4 v3, s[32:35], s40 offen offset:2048 lds
  v_subrev_f32 v98, s14, v98
  v_subrev_f32 v99, s15, v99
  v_subrev_f32 v100, s16, v100
  v_subrev_f32 v101, s17, v101
  v_subrev_f32 v102, s18, v102
  v_subrev_f32 v103, s19, v103
  v_subrev_f32 v104, s12, v104
  v_subrev_f32 v105, s13, v105
  buffer_load_dwordx4 v4, s[32:35], s40 offen offset:3072 lds
  v_subrev_f32 v106, s14, v106
  v_subrev_f32 v107, s15, v107
  v_subrev_f32 v108, s16, v108
  v_subrev_f32 v109, s17, v109
  v_subrev_f32 v110, s18, v110
  v_subrev_f32 v111, s19, v111
  v_mul_f32 v96, s20, v96
  v_mul_f32 v97, s21, v97
  s_add_u32 s40, s40, 114688
  v_mul_f32 v98, s22, v98
  v_mul_f32 v99, s23, v99
  v_mul_f32 v100, s24, v100
  v_mul_f32 v101, s25, v101
  v_mul_f32 v102, s26, v102
  v_mul_f32 v103, s27, v103
  v_mul_f32 v104, s20, v104
  v_mul_f32 v105, s21, v105
  v_mul_f32 v106, s22, v106
  v_mul_f32 v107, s23, v107
  v_mul_f32 v108, s24, v108
  v_mul_f32 v109, s25, v109
  v_mul_f32 v110, s26, v110
  v_mul_f32 v111, s27, v111
  v_cvt_pk_bf16_f32 v88, v96, v97
  v_cvt_pk_bf16_f32 v89, v98, v99
  v_cvt_pk_bf16_f32 v90, v100, v101
  v_cvt_pk_bf16_f32 v91, v102, v103
  v_cvt_pk_bf16_f32 v92, v104, v105
  v_cvt_pk_bf16_f32 v93, v106, v107
  v_cvt_pk_bf16_f32 v94, v108, v109
  v_cvt_pk_bf16_f32 v95, v110, v111
  s_add_u32 s5, s65, 4194304
  buffer_store_dwordx4 v[88:91], v26, s[8:11], s5 offen sc1
  buffer_store_dwordx4 v[92:95], v27, s[8:11], s5 offen sc1
  s_waitcnt vmcnt(2)
  ds_read_b64_tr_b16 a[128:129], v5 offset:0
  ds_read_b64_tr_b16 a[130:131], v5 offset:14336
  ds_read_b64_tr_b16 a[132:133], v6 offset:0
  ds_read_b64_tr_b16 a[134:135], v6 offset:14336
  ds_read_b64_tr_b16 a[136:137], v7 offset:0
  ds_read_b64_tr_b16 a[138:139], v7 offset:14336
  ds_read_b64_tr_b16 a[140:141], v8 offset:0
  ds_read_b64_tr_b16 a[142:143], v8 offset:14336
  ds_read_b64_tr_b16 a[144:145], v5 offset:2048
  ds_read_b64_tr_b16 a[146:147], v5 offset:12288
  ds_read_b64_tr_b16 a[148:149], v6 offset:2048
  ds_read_b64_tr_b16 a[150:151], v6 offset:12288
  ds_read_b64_tr_b16 a[152:153], v7 offset:2048
  ds_read_b64_tr_b16 a[154:155], v7 offset:12288
  ds_read_b64_tr_b16 a[156:157], v8 offset:2048
  ds_read_b64_tr_b16 a[158:159], v8 offset:12288
  ds_read_b64_tr_b16 a[160:161], v5 offset:4096
  ds_read_b64_tr_b16 a[162:163], v5 offset:10240
  ds_read_b64_tr_b16 a[164:165], v6 offset:4096
  ds_read_b64_tr_b16 a[166:167], v6 offset:10240
  ds_read_b64_tr_b16 a[168:169], v7 offset:4096
  ds_read_b64_tr_b16 a[170:171], v7 offset:10240
  ds_read_b64_tr_b16 a[172:173], v8 offset:4096
  ds_read_b64_tr_b16 a[174:175], v8 offset:10240
  ds_read_b64_tr_b16 a[176:177], v5 offset:6144
  ds_read_b64_tr_b16 a[178:179], v5 offset:8192
  ds_read_b64_tr_b16 a[180:181], v6 offset:6144
  ds_read_b64_tr_b16 a[182:183], v6 offset:8192
  ds_read_b64_tr_b16 a[184:185], v7 offset:6144
  ds_read_b64_tr_b16 a[186:187], v7 offset:8192
  ds_read_b64_tr_b16 a[188:189], v8 offset:6144
  ds_read_b64_tr_b16 a[190:191], v8 offset:8192
  ds_read_b64_tr_b16 a[192:193], v5 offset:16384
  ds_read_b64_tr_b16 a[194:195], v5 offset:30720
  ds_read_b64_tr_b16 a[196:197], v6 offset:16384
  ds_read_b64_tr_b16 a[198:199], v6 offset:30720
  ds_read_b64_tr_b16 a[200:201], v7 offset:16384
  ds_read_b64_tr_b16 a[202:203], v7 offset:30720
  ds_read_b64_tr_b16 a[204:205], v8 offset:16384
  ds_read_b64_tr_b16 a[206:207], v8 offset:30720
  ds_read_b64_tr_b16 a[208:209], v5 offset:18432
  ds_read_b64_tr_b16 a[210:211], v5 offset:28672
  ds_read_b64_tr_b16 a[212:213], v6 offset:18432
  ds_read_b64_tr_b16 a[214:215], v6 offset:28672
  ds_read_b64_tr_b16 a[216:217], v7 offset:18432
  ds_read_b64_tr_b16 a[218:219], v7 offset:28672
  ds_read_b64_tr_b16 a[220:221], v8 offset:18432
  ds_read_b64_tr_b16 a[222:223], v8 offset:28672
  ds_read_b64_tr_b16 a[224:225], v5 offset:20480
  ds_read_b64_tr_b16 a[226:227], v5 offset:26624
  ds_read_b64_tr_b16 a[228:229], v6 offset:20480
  ds_read_b64_tr_b16 a[230:231], v6 offset:26624
  ds_read_b64_tr_b16 a[232:233], v7 offset:20480
  ds_read_b64_tr_b16 a[234:235], v7 offset:26624
  ds_read_b64_tr_b16 a[236:237], v8 offset:20480
  ds_read_b64_tr_b16 a[238:239], v8 offset:26624
  ds_read_b64_tr_b16 a[240:241], v5 offset:22528
  ds_read_b64_tr_b16 a[242:243], v5 offset:24576
  ds_read_b64_tr_b16 a[244:245], v6 offset:22528
  ds_read_b64_tr_b16 a[246:247], v6 offset:24576
  ds_read_b64_tr_b16 a[248:249], v7 offset:22528
  ds_read_b64_tr_b16 a[250:251], v7 offset:24576
  ds_read_b64_tr_b16 a[252:253], v8 offset:22528
  ds_read_b64_tr_b16 a[254:255], v8 offset:24576
  v_lshrrev_b32 v52, 3, v11
  v_mul_u32_u24 v52, 4096, v52
  v_lshlrev_b32 v53, 1, v12
  v_and_b32 v54, 7, v11
  v_xor_b32_e64 v53, v53, v54
  v_lshl_add_u32 v1, v53, 4, v52
  v_add_u32 v2, 31744, v1
  v_add_u32 v3, 63488, v1
  v_add_u32 v4, 95232, v1
  s_mul_i32 s40, s44, 1835008
  s_lshl_b32 s5, s36, 7
  s_add_u32 s40, s40, s5
  s_cmp_eq_u32 s39, 0
  s_cselect_b32 s40, 0x80000000, s40
  s_waitcnt lgkmcnt(0)
  s_mov_b32 s41, s45
  s_lshl_b32 s41, s41, 7
  s_add_u32 s41, s41, 8192000
  s_waitcnt vmcnt(0)
  s_barrier
  buffer_store_dword v58, v57, s[8:11], s41 offen sc0 sc1
  s_cmp_eq_u32 s38, 0
  s_cbranch_scc1 L_k6_skip1
  s_add_u32 m0, s64, 0
  s_nop 0
  buffer_load_dwordx4 v1, s[48:51], s40 offen offset:0 lds
  s_lshr_b32 s4, s44, 1
  s_lshl_b32 s5, s46, 7
  buffer_load_dwordx4 v2, s[48:51], s40 offen offset:1024 lds
  s_lshl_b32 s4, s4, 6
  s_add_u32 s5, s5, s4
  buffer_load_dwordx4 v3, s[48:51], s40 offen offset:2048 lds
  v_lshlrev_b32_e64 v20, 3, v12
  buffer_load_dwordx2 v[28:29], v20, s[56:59], s5 offen
  buffer_load_dwordx4 v4, s[48:51], s40 offen offset:3072 lds
  buffer_load_dwordx2 v[30:31], v20, s[56:59], s5 offen offset:32
  s_mul_i32 s42, s44, 458752
  s_add_u32 s40, s40, 131072
  s_add_u32 m0, s64, 4096
  s_nop 0
  buffer_load_dwordx4 v1, s[48:51], s40 offen offset:0 lds
  s_lshl_b32 s5, s47, 12
  s_add_u32 s42, s42, s5
  buffer_load_dwordx4 v2, s[48:51], s40 offen offset:1024 lds
  s_add_u32 s42, s42, 4194304
  v_lshlrev_b32 v22, 7, v11
  buffer_load_dwordx4 v3, s[48:51], s40 offen offset:2048 lds
  s_lshl_b32 s6, s44, 13
  s_add_u32 s6, s6, 8192000
  buffer_load_dwordx4 v4, s[48:51], s40 offen offset:3072 lds
  s_add_u32 s40, s40, 131072
  s_add_u32 m0, s64, 8192
  s_nop 0
  buffer_load_dwordx4 v1, s[48:51], s40 offen offset:0 lds
  buffer_load_dwordx4 v2, s[48:51], s40 offen offset:1024 lds
  buffer_load_dwordx4 v3, s[48:51], s40 offen offset:2048 lds
  buffer_load_dwordx4 v4, s[48:51], s40 offen offset:3072 lds
  s_add_u32 s40, s40, 131072
  s_add_u32 m0, s64, 12288
  s_nop 0
  buffer_load_dwordx4 v1, s[48:51], s40 offen offset:0 lds
  buffer_load_dwordx4 v2, s[48:51], s40 offen offset:1024 lds
  buffer_load_dwordx4 v3, s[48:51], s40 offen offset:2048 lds
  buffer_load_dwordx4 v4, s[48:51], s40 offen offset:3072 lds
  s_add_u32 s40, s40, 131072
  s_add_u32 m0, s64, 16384
  s_nop 0
  buffer_load_dwordx4 v1, s[48:51], s40 offen offset:0 lds
  buffer_load_dwordx4 v2, s[48:51], s40 offen offset:1024 lds
  buffer_load_dwordx4 v3, s[48:51], s40 offen offset:2048 lds
  buffer_load_dwordx4 v4, s[48:51], s40 offen offset:3072 lds
  s_add_u32 s40, s40, 131072
  buffer_load_dword v23, v22, s[8:11], s6 offen sc0 sc1
  s_add_u32 m0, s64, 20480
  s_nop 0
  buffer_load_dwordx4 v1, s[48:51], s40 offen offset:0 lds
  buffer_load_dwordx4 v2, s[48:51], s40 offen offset:1024 lds
  buffer_load_dwordx4 v3, s[48:51], s40 offen offset:2048 lds
  buffer_load_dwordx4 v4, s[48:51], s40 offen offset:3072 lds
  s_add_u32 s40, s40, 131072
  s_add_u32 m0, s64, 24576
  s_nop 0
  buffer_load_dwordx4 v1, s[48:51], s40 offen offset:0 lds
  buffer_load_dwordx4 v2, s[48:51], s40 offen offset:1024 lds
  buffer_load_dwordx4 v3, s[48:51], s40 offen offset:2048 lds
  buffer_load_dwordx4 v4, s[48:51], s40 offen offset:3072 lds
  s_add_u32 s40, s40, 131072
  s_waitcnt vmcnt(8)
  v_cmp_ne_u32 vcc, 1, v23
  s_nop 0
  s_cbranch_vccnz L_k6_p1s
L_k6_p1x:
  buffer_load_dwordx4 v[128:131], v9, s[8:11], s42 offen offset:0 sc1
  buffer_load_dwordx4 v[132:135], v9, s[8:11], s42 offen offset:1024 sc1
  buffer_load_dwordx4 v[136:139], v10, s[8:11], s42 offen offset:0 sc1
  buffer_load_dwordx4 v[140:143], v10, s[8:11], s42 offen offset:1024 sc1
  s_add_u32 s42, s42, 28672
  buffer_load_dwordx4 v[144:147], v9, s[8:11], s42 offen offset:0 sc1
  buffer_load_dwordx4 v[148:151], v9, s[8:11], s42 offen offset:1024 sc1
  buffer_load_dwordx4 v[152:155], v10, s[8:11], s42 offen offset:0 sc1
  buffer_load_dwordx4 v[156:159], v10, s[8:11], s42 offen offset:1024 sc1
  s_add_u32 s42, s42, 28672
  buffer_load_dwordx4 v[160:163], v9, s[8:11], s42 offen offset:0 sc1
  buffer_load_dwordx4 v[164:167], v9, s[8:11], s42 offen offset:1024 sc1
  buffer_load_dwordx4 v[168:171], v10, s[8:11], s42 offen offset:0 sc1
  buffer_load_dwordx4 v[172:175], v10, s[8:11], s42 offen offset:1024 sc1
  s_add_u32 s42, s42, 28672
  buffer_load_dwordx4 v[176:179], v9, s[8:11], s42 offen offset:0 sc1
  buffer_load_dwordx4 v[180:183], v9, s[8:11], s42 offen offset:1024 sc1
  buffer_load_dwordx4 v[184:187], v10, s[8:11], s42 offen offset:0 sc1
  buffer_load_dwordx4 v[188:191], v10, s[8:11], s42 offen offset:1024 sc1
  s_add_u32 s42, s42, 28672
  buffer_load_dwordx4 v[192:195], v9, s[8:11], s42 offen offset:0 sc1
  buffer_load_dwordx4 v[196:199], v9, s[8:11], s42 offen offset:1024 sc1
  buffer_load_dwordx4 v[200:203], v10, s[8:11], s42 offen offset:0 sc1
  buffer_load_dwordx4 v[204:207], v10, s[8:11], s42 offen offset:1024 sc1
  s_add_u32 s42, s42, 28672
  v_lshlrev_b32_e64 v32, 16, v28
  v_and_b32 v33, 0xffff0000, v28
  v_lshlrev_b32_e64 v34, 16, v29
  v_and_b32 v35, 0xffff0000, v29
  v_lshlrev_b32_e64 v36, 16, v30
  v_and_b32 v37, 0xffff0000, v30
  v_lshlrev_b32_e64 v38, 16, v31
  v_and_b32 v39, 0xffff0000, v31
  v_mov_b32 v40, 0xc0135761
  v_mov_b32_e64 v41, v40
  v_mov_b32 v42, 0xbdd2d3e8
  v_mov_b32 v43, v42
  v_mov_b32 v44, 1.0
  v_mov_b32_e64 v45, 1.0
  s_lshr_b32 s4, s44, 1
  s_lshl_b32 s7, s46, 1
  s_add_u32 s7, s7, s4
  s_mul_i32 s7, s7, 28
  s_lshl_b32 s4, s47, 2
  s_add_u32 s7, s7, s4
  s_and_b32 s4, s44, 1
  s_lshl_b32 s4, s4, 1
  s_add_u32 s7, s7, s4
  s_lshl_b32 s7, s7, 10
  s_add_u32 s7, s7, 6291456
  s_waitcnt vmcnt(16) lgkmcnt(0)
  v_mfma_f32_16x16x32_bf16 v[80:83], a[0:3], v[136:139], 0
  s_nop 0
  buffer_load_dwordx4 v[208:211], v9, s[8:11], s42 offen offset:0 sc1
  v_mfma_f32_16x16x32_bf16 v[88:91], a[0:3], v[140:143], 0
  v_mfma_f32_16x16x32_bf16 v[84:87], a[4:7], v[136:139], 0
  v_mfma_f32_16x16x32_bf16 v[92:95], a[4:7], v[140:143], 0
  v_mfma_f32_16x16x32_bf16 v[96:99], a[8:11], v[128:131], 0
  buffer_load_dwordx4 v[212:215], v9, s[8:11], s42 offen offset:1024 sc1
  v_mfma_f32_16x16x32_bf16 v[104:107], a[8:11], v[132:135], 0
  v_mfma_f32_16x16x32_bf16 v[100:103], a[12:15], v[128:131], 0
  v_mfma_f32_16x16x32_bf16 v[108:111], a[12:15], v[132:135], 0
  v_mfma_f32_16x16x32_bf16 v[112:115], a[8:11], v[136:139], 0
  buffer_load_dwordx4 v[216:219], v10, s[8:11], s42 offen offset:0 sc1
  v_mfma_f32_16x16x32_bf16 v[120:123], a[8:11], v[140:143], 0
  v_mfma_f32_16x16x32_bf16 v[116:119], a[12:15], v[136:139], 0
  v_mfma_f32_16x16x32_bf16 v[124:127], a[12:15], v[140:143], 0
  v_mfma_f32_16x16x32_bf16 v[64:67], a[0:3], v[128:131], 0
  buffer_load_dwordx4 v[220:223], v10, s[8:11], s42 offen offset:1024 sc1
  s_add_u32 s42, s42, 28672
  v_mfma_f32_16x16x32_bf16 v[72:75], a[0:3], v[132:135], 0
  v_mfma_f32_16x16x32_bf16 v[68:71], a[4:7], v[128:131], 0
  v_mfma_f32_16x16x32_bf16 v[76:79], a[4:7], v[132:135], 0
  s_waitcnt vmcnt(16)
  s_nop 0
  v_mfma_f32_16x16x32_bf16 v[80:83], a[16:19], v[152:155], v[80:83]
  buffer_load_dwordx4 v[224:227], v9, s[8:11], s42 offen offset:0 sc1
  v_mfma_f32_16x16x32_bf16 v[88:91], a[16:19], v[156:159], v[88:91]
  v_mfma_f32_16x16x32_bf16 v[84:87], a[20:23], v[152:155], v[84:87]
  v_mfma_f32_16x16x32_bf16 v[92:95], a[20:23], v[156:159], v[92:95]
  v_mfma_f32_16x16x32_bf16 v[96:99], a[24:27], v[144:147], v[96:99]
  buffer_load_dwordx4 v[228:231], v9, s[8:11], s42 offen offset:1024 sc1
  v_mfma_f32_16x16x32_bf16 v[104:107], a[24:27], v[148:151], v[104:107]
  v_mfma_f32_16x16x32_bf16 v[100:103], a[28:31], v[144:147], v[100:103]
  v_mfma_f32_16x16x32_bf16 v[108:111], a[28:31], v[148:151], v[108:111]
  v_mfma_f32_16x16x32_bf16 v[112:115], a[24:27], v[152:155], v[112:115]
  buffer_load_dwordx4 v[232:235], v10, s[8:11], s42 offen offset:0 sc1
  v_mfma_f32_16x16x32_bf16 v[120:123], a[24:27], v[156:159], v[120:123]
  v_mfma_f32_16x16x32_bf16 v[116:119], a[28:31], v[152:155], v[116:119]
  v_mfma_f32_16x16x32_bf16 v[124:127], a[28:31], v[156:159], v[124:127]
  v_mfma_f32_16x16x32_bf16 v[64:67], a[16:19], v[144:147], v[64:67]
  buffer_load_dwordx4 v[236:239], v10, s[8:11], s42 offen offset:1024 sc1
  s_add_u32 s42, s42, 28672
  v_mfma_f32_16x16x32_bf16 v[72:75], a[16:19], v[148:151], v[72:75]
  v_mfma_f32_16x16x32_bf16 v[68:71], a[20:23], v[144:147], v[68:71]
  v_mfma_f32_16x16x32_bf16 v[76:79], a[20:23], v[148:151], v[76:79]
  s_waitcnt vmcnt(12)
  s_nop 0
  v_mfma_f32_16x16x32_bf16 v[80:83], a[32:35], v[168:171], v[80:83]
  buffer_load_dwordx4 v[240:243], v9, s[8:11], s42 offen offset:0 sc1
  v_mfma_f32_16x16x32_bf16 v[80:83], a[48:51], v[184:187], v[80:83]
  v_mfma_f32_16x16x32_bf16 v[88:91], a[32:35], v[172:175], v[88:91]
  v_mfma_f32_16x16x32_bf16 v[88:91], a[48:51], v[188:191], v[88:91]
  v_mfma_f32_16x16x32_bf16 v[84:87], a[36:39], v[168:171], v[84:87]
  buffer_load_dwordx4 v[244:247], v9, s[8:11], s42 offen offset:1024 sc1
  v_mfma_f32_16x16x32_bf16 v[84:87], a[52:55], v[184:187], v[84:87]
  v_mfma_f32_16x16x32_bf16 v[92:95], a[36:39], v[172:175], v[92:95]
  v_mfma_f32_16x16x32_bf16 v[92:95], a[52:55], v[188:191], v[92:95]
  v_mfma_f32_16x16x32_bf16 v[96:99], a[40:43], v[160:163], v[96:99]
  buffer_load_dwordx4 v[248:251], v10, s[8:11], s42 offen offset:0 sc1
  v_mfma_f32_16x16x32_bf16 v[96:99], a[56:59], v[176:179], v[96:99]
  v_mfma_f32_16x16x32_bf16 v[104:107], a[40:43], v[164:167], v[104:107]
  v_mfma_f32_16x16x32_bf16 v[104:107], a[56:59], v[180:183], v[104:107]
  v_mfma_f32_16x16x32_bf16 v[100:103], a[44:47], v[160:163], v[100:103]
  buffer_load_dwordx4 v[252:255], v10, s[8:11], s42 offen offset:1024 sc1
  s_add_u32 s42, s42, 28672
  v_mfma_f32_16x16x32_bf16 v[100:103], a[60:63], v[176:179], v[100:103]
  v_mfma_f32_16x16x32_bf16 v[108:111], a[44:47], v[164:167], v[108:111]
  v_mfma_f32_16x16x32_bf16 v[108:111], a[60:63], v[180:183], v[108:111]
  v_mfma_f32_16x16x32_bf16 v[112:115], a[40:43], v[168:171], v[112:115]
  buffer_load_dwordx4 v[128:131], v9, s[8:11], s42 offen offset:0 sc1
  v_mfma_f32_16x16x32_bf16 v[112:115], a[56:59], v[184:187], v[112:115]
  v_mfma_f32_16x16x32_bf16 v[120:123], a[40:43], v[172:175], v[120:123]
  v_mfma_f32_16x16x32_bf16 v[120:123], a[56:59], v[188:191], v[120:123]
  v_mfma_f32_16x16x32_bf16 v[116:119], a[44:47], v[168:171], v[116:119]
  buffer_load_dwordx4 v[132:135], v9, s[8:11], s42 offen offset:1024 sc1
  v_mfma_f32_16x16x32_bf16 v[116:119], a[60:63], v[184:187], v[116:119]
  v_mfma_f32_16x16x32_bf16 v[124:127], a[44:47], v[172:175], v[124:127]
  v_mfma_f32_16x16x32_bf16 v[124:127], a[60:63], v[188:191], v[124:127]
  v_mfma_f32_16x16x32_bf16 v[64:67], a[32:35], v[160:163], v[64:67]
  buffer_load_dwordx4 v[136:139], v10, s[8:11], s42 offen offset:0 sc1
  v_mfma_f32_16x16x32_bf16 v[64:67], a[48:51], v[176:179], v[64:67]
  v_mfma_f32_16x16x32_bf16 v[72:75], a[32:35], v[164:167], v[72:75]
  v_mfma_f32_16x16x32_bf16 v[72:75], a[48:51], v[180:183], v[72:75]
  v_mfma_f32_16x16x32_bf16 v[68:71], a[36:39], v[160:163], v[68:71]
  buffer_load_dwordx4 v[140:143], v10, s[8:11], s42 offen offset:1024 sc1
  s_add_u32 s42, s42, 28672
  v_mfma_f32_16x16x32_bf16 v[68:71], a[52:55], v[176:179], v[68:71]
  v_mfma_f32_16x16x32_bf16 v[76:79], a[36:39], v[164:167], v[76:79]
  v_mfma_f32_16x16x32_bf16 v[76:79], a[52:55], v[180:183], v[76:79]
  s_waitcnt vmcnt(12)
  s_nop 0
  v_mfma_f32_16x16x32_bf16 v[80:83], a[64:67], v[200:203], v[80:83]
  buffer_load_dwordx4 v[144:147], v9, s[8:11], s42 offen offset:0 sc1
  v_mfma_f32_16x16x32_bf16 v[80:83], a[80:83], v[216:219], v[80:83]
  v_mfma_f32_16x16x32_bf16 v[88:91], a[64:67], v[204:207], v[88:91]
  v_mfma_f32_16x16x32_bf16 v[88:91], a[80:83], v[220:223], v[88:91]
  v_mfma_f32_16x16x32_bf16 v[84:87], a[68:71], v[200:203], v[84:87]
  buffer_load_dwordx4 v[148:151], v9, s[8:11], s42 offen offset:1024 sc1
  v_mfma_f32_16x16x32_bf16 v[84:87], a[84:87], v[216:219], v[84:87]
  v_mfma_f32_16x16x32_bf16 v[92:95], a[68:71], v[204:207], v[92:95]
  v_mfma_f32_16x16x32_bf16 v[92:95], a[84:87], v[220:223], v[92:95]
  v_mfma_f32_16x16x32_bf16 v[96:99], a[72:75], v[192:195], v[96:99]
  buffer_load_dwordx4 v[152:155], v10, s[8:11], s42 offen offset:0 sc1
  v_mfma_f32_16x16x32_bf16 v[96:99], a[88:91], v[208:211], v[96:99]
  v_mfma_f32_16x16x32_bf16 v[104:107], a[72:75], v[196:199], v[104:107]
  v_mfma_f32_16x16x32_bf16 v[104:107], a[88:91], v[212:215], v[104:107]
  v_mfma_f32_16x16x32_bf16 v[100:103], a[76:79], v[192:195], v[100:103]
  buffer_load_dwordx4 v[156:159], v10, s[8:11], s42 offen offset:1024 sc1
  s_add_u32 s42, s42, 28672
  v_mfma_f32_16x16x32_bf16 v[100:103], a[92:95], v[208:211], v[100:103]
  v_mfma_f32_16x16x32_bf16 v[108:111], a[76:79], v[196:199], v[108:111]
  v_mfma_f32_16x16x32_bf16 v[108:111], a[92:95], v[212:215], v[108:111]
  v_mfma_f32_16x16x32_bf16 v[112:115], a[72:75], v[200:203], v[112:115]
  buffer_load_dwordx4 v[160:163], v9, s[8:11], s42 offen offset:0 sc1
  v_mfma_f32_16x16x32_bf16 v[112:115], a[88:91], v[216:219], v[112:115]
  v_mfma_f32_16x16x32_bf16 v[120:123], a[72:75], v[204:207], v[120:123]
  v_mfma_f32_16x16x32_bf16 v[120:123], a[88:91], v[220:223], v[120:123]
  v_mfma_f32_16x16x32_bf16 v[116:119], a[76:79], v[200:203], v[116:119]
  buffer_load_dwordx4 v[164:167], v9, s[8:11], s42 offen offset:1024 sc1
  v_mfma_f32_16x16x32_bf16 v[116:119], a[92:95], v[216:219], v[116:119]
  v_mfma_f32_16x16x32_bf16 v[124:127], a[76:79], v[204:207], v[124:127]
  v_mfma_f32_16x16x32_bf16 v[124:127], a[92:95], v[220:223], v[124:127]
  v_mfma_f32_16x16x32_bf16 v[64:67], a[64:67], v[192:195], v[64:67]
  buffer_load_dwordx4 v[168:171], v10, s[8:11], s42 offen offset:0 sc1
  v_mfma_f32_16x16x32_bf16 v[64:67], a[80:83], v[208:211], v[64:67]
  v_mfma_f32_16x16x32_bf16 v[72:75], a[64:67], v[196:199], v[72:75]
  v_mfma_f32_16x16x32_bf16 v[72:75], a[80:83], v[212:215], v[72:75]
  v_mfma_f32_16x16x32_bf16 v[68:71], a[68:71], v[192:195], v[68:71]
  buffer_load_dwordx4 v[172:175], v10, s[8:11], s42 offen offset:1024 sc1
  s_add_u32 s42, s42, 28672
  v_mfma_f32_16x16x32_bf16 v[68:71], a[84:87], v[208:211], v[68:71]
  v_mfma_f32_16x16x32_bf16 v[76:79], a[68:71], v[196:199], v[76:79]
  v_mfma_f32_16x16x32_bf16 v[76:79], a[84:87], v[212:215], v[76:79]
  s_waitcnt vmcnt(12)
  s_nop 0
  v_mfma_f32_16x16x32_bf16 v[80:83], a[96:99], v[232:235], v[80:83]
  buffer_load_dwordx4 v[176:179], v9, s[8:11], s42 offen offset:0 sc1
  v_mfma_f32_16x16x32_bf16 v[80:83], a[112:115], v[248:251], v[80:83]
  v_mfma_f32_16x16x32_bf16 v[88:91], a[96:99], v[236:239], v[88:91]
  v_mfma_f32_16x16x32_bf16 v[88:91], a[112:115], v[252:255], v[88:91]
  v_mfma_f32_16x16x32_bf16 v[84:87], a[100:103], v[232:235], v[84:87]
  buffer_load_dwordx4 v[180:183], v9, s[8:11], s42 offen offset:1024 sc1
  s_lshl_b32 s5, s44, 13
  v_mfma_f32_16x16x32_bf16 v[84:87], a[116:119], v[248:251], v[84:87]
  s_nop 0
  s_add_u32 s5, s5, 131072
  v_mfma_f32_16x16x32_bf16 v[92:95], a[100:103], v[236:239], v[92:95]
  v_add_u32_e64 v20, s5, v0
  v_mfma_f32_16x16x32_bf16 v[92:95], a[116:119], v[252:255], v[92:95]
  s_add_u32 s5, s64, 28672
  v_mfma_f32_16x16x32_bf16 v[96:99], a[104:107], v[224:227], v[96:99]
  buffer_load_dwordx4 v[184:187], v10, s[8:11], s42 offen offset:0 sc1
  v_add_u32_e64 v21, s5, v0
  v_mfma_f32_16x16x32_bf16 v[96:99], a[120:123], v[240:243], v[96:99]
  v_xor_b32 v22, 0x2000, v20
  v_mfma_f32_16x16x32_bf16 v[104:107], a[104:107], v[228:231], v[104:107]
  v_xor_b32 v23, 0x4000, v20
  v_mfma_f32_16x16x32_bf16 v[104:107], a[120:123], v[244:247], v[104:107]
  v_xor_b32 v24, 0x18000, v21
  v_mfma_f32_16x16x32_bf16 v[100:103], a[108:111], v[224:227], v[100:103]
  buffer_load_dwordx4 v[188:191], v10, s[8:11], s42 offen offset:1024 sc1
  s_add_u32 s42, s42, 28672
  v_mfma_f32_16x16x32_bf16 v[100:103], a[124:127], v[240:243], v[100:103]
  v_mfma_f32_16x16x32_bf16 v[108:111], a[108:111], v[228:231], v[108:111]
  v_mfma_f32_16x16x32_bf16 v[108:111], a[124:127], v[244:247], v[108:111]
  v_mfma_f32_16x16x32_bf16 v[112:115], a[104:107], v[232:235], v[112:115]
  buffer_load_dwordx4 v[192:195], v9, s[8:11], s42 offen offset:0 sc1
  v_mfma_f32_16x16x32_bf16 v[112:115], a[120:123], v[248:251], v[112:115]
  v_mfma_f32_16x16x32_bf16 v[120:123], a[104:107], v[236:239], v[120:123]
  v_mfma_f32_16x16x32_bf16 v[120:123], a[120:123], v[252:255], v[120:123]
  v_mfma_f32_16x16x32_bf16 v[116:119], a[108:111], v[232:235], v[116:119]
  buffer_load_dwordx4 v[196:199], v9, s[8:11], s42 offen offset:1024 sc1
  v_mfma_f32_16x16x32_bf16 v[116:119], a[124:127], v[248:251], v[116:119]
  v_mfma_f32_16x16x32_bf16 v[124:127], a[108:111], v[236:239], v[124:127]
  v_mfma_f32_16x16x32_bf16 v[124:127], a[124:127], v[252:255], v[124:127]
  v_mfma_f32_16x16x32_bf16 v[64:67], a[96:99], v[224:227], v[64:67]
  buffer_load_dwordx4 v[200:203], v10, s[8:11], s42 offen offset:0 sc1
  v_mfma_f32_16x16x32_bf16 v[64:67], a[112:115], v[240:243], v[64:67]
  v_mfma_f32_16x16x32_bf16 v[72:75], a[96:99], v[228:231], v[72:75]
  v_mfma_f32_16x16x32_bf16 v[72:75], a[112:115], v[244:247], v[72:75]
  v_mfma_f32_16x16x32_bf16 v[68:71], a[100:103], v[224:227], v[68:71]
  buffer_load_dwordx4 v[204:207], v10, s[8:11], s42 offen offset:1024 sc1
  s_add_u32 s42, s42, 28672
  v_mfma_f32_16x16x32_bf16 v[68:71], a[116:119], v[240:243], v[68:71]
  v_mfma_f32_16x16x32_bf16 v[76:79], a[100:103], v[228:231], v[76:79]
  v_mfma_f32_16x16x32_bf16 v[76:79], a[116:119], v[244:247], v[76:79]
  s_waitcnt vmcnt(12)
  s_nop 0
  v_mfma_f32_16x16x32_bf16 v[80:83], a[128:131], v[136:139], v[80:83]
  buffer_load_dwordx4 v[208:211], v9, s[8:11], s42 offen offset:0 sc1
  v_mfma_f32_16x16x32_bf16 v[80:83], a[144:147], v[152:155], v[80:83]
  v_mfma_f32_16x16x32_bf16 v[88:91], a[128:131], v[140:143], v[88:91]
  ds_read_b64_tr_b16 a[0:1], v5 offset:0
  v_mfma_f32_16x16x32_bf16 v[88:91], a[144:147], v[156:159], v[88:91]
  v_mfma_f32_16x16x32_bf16 v[84:87], a[132:135], v[136:139], v[84:87]
  ds_read_b64_tr_b16 a[2:3], v5 offset:2048
  buffer_load_dwordx4 v[212:215], v9, s[8:11], s42 offen offset:1024 sc1
  v_mfma_f32_16x16x32_bf16 v[84:87], a[148:151], v[152:155], v[84:87]
  v_mfma_f32_16x16x32_bf16 v[92:95], a[132:135], v[140:143], v[92:95]
  ds_read_b64_tr_b16 a[4:5], v6 offset:0
  v_mfma_f32_16x16x32_bf16 v[92:95], a[148:151], v[156:159], v[92:95]
  v_mfma_f32_16x16x32_bf16 v[96:99], a[136:139], v[128:131], v[96:99]
  ds_read_b64_tr_b16 a[6:7], v6 offset:2048
  buffer_load_dwordx4 v[216:219], v10, s[8:11], s42 offen offset:0 sc1
  v_mfma_f32_16x16x32_bf16 v[96:99], a[152:155], v[144:147], v[96:99]
  v_mfma_f32_16x16x32_bf16 v[104:107], a[136:139], v[132:135], v[104:107]
  ds_read_b64_tr_b16 a[8:9], v7 offset:0
  v_mfma_f32_16x16x32_bf16 v[104:107], a[152:155], v[148:151], v[104:107]
  v_mfma_f32_16x16x32_bf16 v[100:103], a[140:143], v[128:131], v[100:103]
  ds_read_b64_tr_b16 a[10:11], v7 offset:2048
  buffer_load_dwordx4 v[220:223], v10, s[8:11], s42 offen offset:1024 sc1
  v_mfma_f32_16x16x32_bf16 v[100:103], a[156:159], v[144:147], v[100:103]
  s_add_u32 s42, s42, 28672
  v_mfma_f32_16x16x32_bf16 v[108:111], a[140:143], v[132:135], v[108:111]
  ds_read_b64_tr_b16 a[12:13], v8 offset:0
  v_mfma_f32_16x16x32_bf16 v[108:111], a[156:159], v[148:151], v[108:111]
  v_mfma_f32_16x16x32_bf16 v[112:115], a[136:139], v[136:139], v[112:115]
  ds_read_b64_tr_b16 a[14:15], v8 offset:2048
  buffer_load_dwordx4 v[224:227], v9, s[8:11], s42 offen offset:0 sc1
  v_mfma_f32_16x16x32_bf16 v[112:115], a[152:155], v[152:155], v[112:115]
  v_mfma_f32_16x16x32_bf16 v[120:123], a[136:139], v[140:143], v[120:123]
  ds_read_b64_tr_b16 a[16:17], v5 offset:4096
  v_mfma_f32_16x16x32_bf16 v[120:123], a[152:155], v[156:159], v[120:123]
  v_mfma_f32_16x16x32_bf16 v[116:119], a[140:143], v[136:139], v[116:119]
  ds_read_b64_tr_b16 a[18:19], v5 offset:6144
  buffer_load_dwordx4 v[228:231], v9, s[8:11], s42 offen offset:1024 sc1
  v_mfma_f32_16x16x32_bf16 v[116:119], a[156:159], v[152:155], v[116:119]
  v_mfma_f32_16x16x32_bf16 v[124:127], a[140:143], v[140:143], v[124:127]
  ds_read_b64_tr_b16 a[20:21], v6 offset:4096
  v_mfma_f32_16x16x32_bf16 v[124:127], a[156:159], v[156:159], v[124:127]
  v_mfma_f32_16x16x32_bf16 v[64:67], a[128:131], v[128:131], v[64:67]
  ds_read_b64_tr_b16 a[22:23], v6 offset:6144
  buffer_load_dwordx4 v[232:235], v10, s[8:11], s42 offen offset:0 sc1
  v_mfma_f32_16x16x32_bf16 v[64:67], a[144:147], v[144:147], v[64:67]
  v_mfma_f32_16x16x32_bf16 v[72:75], a[128:131], v[132:135], v[72:75]
  ds_read_b64_tr_b16 a[24:25], v7 offset:4096
  v_mfma_f32_16x16x32_bf16 v[72:75], a[144:147], v[148:151], v[72:75]
  v_mfma_f32_16x16x32_bf16 v[68:71], a[132:135], v[128:131], v[68:71]
  ds_read_b64_tr_b16 a[26:27], v7 offset:6144
  buffer_load_dwordx4 v[236:239], v10, s[8:11], s42 offen offset:1024 sc1
  v_mfma_f32_16x16x32_bf16 v[68:71], a[148:151], v[144:147], v[68:71]
  s_add_u32 s42, s42, 28672
  v_mfma_f32_16x16x32_bf16 v[76:79], a[132:135], v[132:135], v[76:79]
  ds_read_b64_tr_b16 a[28:29], v8 offset:4096
  v_mfma_f32_16x16x32_bf16 v[76:79], a[148:151], v[148:151], v[76:79]
  s_waitcnt vmcnt(12)
  s_nop 0
  v_mfma_f32_16x16x32_bf16 v[80:83], a[160:163], v[168:171], v[80:83]
  ds_read_b64_tr_b16 a[30:31], v8 offset:6144
  buffer_load_dwordx4 v[240:243], v9, s[8:11], s42 offen offset:0 sc1
  v_mfma_f32_16x16x32_bf16 v[80:83], a[176:179], v[184:187], v[80:83]
  v_mfma_f32_16x16x32_bf16 v[88:91], a[160:163], v[172:175], v[88:91]
  ds_read_b64_tr_b16 a[32:33], v5 offset:8192
  v_mfma_f32_16x16x32_bf16 v[88:91], a[176:179], v[188:191], v[88:91]
  v_mfma_f32_16x16x32_bf16 v[84:87], a[164:167], v[168:171], v[84:87]
  ds_read_b64_tr_b16 a[34:35], v5 offset:10240
  buffer_load_dwordx4 v[244:247], v9, s[8:11], s42 offen offset:1024 sc1
  v_mfma_f32_16x16x32_bf16 v[84:87], a[180:183], v[184:187], v[84:87]
  v_mfma_f32_16x16x32_bf16 v[92:95], a[164:167], v[172:175], v[92:95]
  ds_read_b64_tr_b16 a[36:37], v6 offset:8192
  v_mfma_f32_16x16x32_bf16 v[92:95], a[180:183], v[188:191], v[92:95]
  v_mfma_f32_16x16x32_bf16 v[96:99], a[168:171], v[160:163], v[96:99]
  ds_read_b64_tr_b16 a[38:39], v6 offset:10240
  buffer_load_dwordx4 v[248:251], v10, s[8:11], s42 offen offset:0 sc1
  v_mfma_f32_16x16x32_bf16 v[96:99], a[184:187], v[176:179], v[96:99]
  v_mfma_f32_16x16x32_bf16 v[104:107], a[168:171], v[164:167], v[104:107]
  ds_read_b64_tr_b16 a[40:41], v7 offset:8192
  v_mfma_f32_16x16x32_bf16 v[104:107], a[184:187], v[180:183], v[104:107]
  v_mfma_f32_16x16x32_bf16 v[100:103], a[172:175], v[160:163], v[100:103]
  ds_read_b64_tr_b16 a[42:43], v7 offset:10240
  buffer_load_dwordx4 v[252:255], v10, s[8:11], s42 offen offset:1024 sc1
  v_mfma_f32_16x16x32_bf16 v[100:103], a[188:191], v[176:179], v[100:103]
  s_add_u32 s42, s42, 28672
  v_mfma_f32_16x16x32_bf16 v[108:111], a[172:175], v[164:167], v[108:111]
  ds_read_b64_tr_b16 a[44:45], v8 offset:8192
  v_mfma_f32_16x16x32_bf16 v[108:111], a[188:191], v[180:183], v[108:111]
  v_mfma_f32_16x16x32_bf16 v[112:115], a[168:171], v[168:171], v[112:115]
  ds_read_b64_tr_b16 a[46:47], v8 offset:10240
  v_mfma_f32_16x16x32_bf16 v[112:115], a[184:187], v[184:187], v[112:115]
  v_mfma_f32_16x16x32_bf16 v[120:123], a[168:171], v[172:175], v[120:123]
  ds_read_b64_tr_b16 a[48:49], v5 offset:12288
  v_mfma_f32_16x16x32_bf16 v[120:123], a[184:187], v[188:191], v[120:123]
  v_mfma_f32_16x16x32_bf16 v[116:119], a[172:175], v[168:171], v[116:119]
  ds_read_b64_tr_b16 a[50:51], v5 offset:14336
  v_mfma_f32_16x16x32_bf16 v[116:119], a[188:191], v[184:187], v[116:119]
  v_mfma_f32_16x16x32_bf16 v[124:127], a[172:175], v[172:175], v[124:127]
  ds_read_b64_tr_b16 a[52:53], v6 offset:12288
  v_mfma_f32_16x16x32_bf16 v[124:127], a[188:191], v[188:191], v[124:127]
  v_mfma_f32_16x16x32_bf16 v[64:67], a[160:163], v[160:163], v[64:67]
  ds_read_b64_tr_b16 a[54:55], v6 offset:14336
  v_mfma_f32_16x16x32_bf16 v[64:67], a[176:179], v[176:179], v[64:67]
  v_mfma_f32_16x16x32_bf16 v[72:75], a[160:163], v[164:167], v[72:75]
  ds_read_b64_tr_b16 a[56:57], v7 offset:12288
  v_mfma_f32_16x16x32_bf16 v[72:75], a[176:179], v[180:183], v[72:75]
  v_mfma_f32_16x16x32_bf16 v[68:71], a[164:167], v[160:163], v[68:71]
  ds_read_b64_tr_b16 a[58:59], v7 offset:14336
  v_mfma_f32_16x16x32_bf16 v[68:71], a[180:183], v[176:179], v[68:71]
  v_mfma_f32_16x16x32_bf16 v[76:79], a[164:167], v[164:167], v[76:79]
  ds_read_b64_tr_b16 a[60:61], v8 offset:12288
  v_mfma_f32_16x16x32_bf16 v[76:79], a[180:183], v[180:183], v[76:79]
  s_waitcnt vmcnt(8)
  s_nop 0
  v_mfma_f32_16x16x32_bf16 v[80:83], a[192:195], v[200:203], v[80:83]
  ds_read_b64_tr_b16 a[62:63], v8 offset:14336
  v_mfma_f32_16x16x32_bf16 v[80:83], a[208:211], v[216:219], v[80:83]
  v_mfma_f32_16x16x32_bf16 v[88:91], a[192:195], v[204:207], v[88:91]
  ds_read_b64_tr_b16 a[64:65], v5 offset:16384
  v_mfma_f32_16x16x32_bf16 v[88:91], a[208:211], v[220:223], v[88:91]
  v_mfma_f32_16x16x32_bf16 v[84:87], a[196:199], v[200:203], v[84:87]
  ds_read_b64_tr_b16 a[66:67], v5 offset:18432
  v_mfma_f32_16x16x32_bf16 v[84:87], a[212:215], v[216:219], v[84:87]
  v_mfma_f32_16x16x32_bf16 v[92:95], a[196:199], v[204:207], v[92:95]
  ds_read_b64_tr_b16 a[68:69], v6 offset:16384
  v_mfma_f32_16x16x32_bf16 v[92:95], a[212:215], v[220:223], v[92:95]
  v_mfma_f32_16x16x32_bf16 v[96:99], a[200:203], v[192:195], v[96:99]
  ds_read_b64_tr_b16 a[70:71], v6 offset:18432
  v_mfma_f32_16x16x32_bf16 v[96:99], a[216:219], v[208:211], v[96:99]
  v_mfma_f32_16x16x32_bf16 v[104:107], a[200:203], v[196:199], v[104:107]
  ds_read_b64_tr_b16 a[72:73], v7 offset:16384
  v_mfma_f32_16x16x32_bf16 v[104:107], a[216:219], v[212:215], v[104:107]
  v_mfma_f32_16x16x32_bf16 v[100:103], a[204:207], v[192:195], v[100:103]
  ds_read_b64_tr_b16 a[74:75], v7 offset:18432
  v_mfma_f32_16x16x32_bf16 v[100:103], a[220:223], v[208:211], v[100:103]
  v_mfma_f32_16x16x32_bf16 v[108:111], a[204:207], v[196:199], v[108:111]
  ds_read_b64_tr_b16 a[76:77], v8 offset:16384
  v_mfma_f32_16x16x32_bf16 v[108:111], a[220:223], v[212:215], v[108:111]
  v_mfma_f32_16x16x32_bf16 v[112:115], a[200:203], v[200:203], v[112:115]
  ds_read_b64_tr_b16 a[78:79], v8 offset:18432
  v_mfma_f32_16x16x32_bf16 v[112:115], a[216:219], v[216:219], v[112:115]
  v_mfma_f32_16x16x32_bf16 v[120:123], a[200:203], v[204:207], v[120:123]
  ds_read_b64_tr_b16 a[80:81], v5 offset:20480
  v_mfma_f32_16x16x32_bf16 v[120:123], a[216:219], v[220:223], v[120:123]
  v_mfma_f32_16x16x32_bf16 v[116:119], a[204:207], v[200:203], v[116:119]
  ds_read_b64_tr_b16 a[82:83], v5 offset:22528
  v_mfma_f32_16x16x32_bf16 v[116:119], a[220:223], v[216:219], v[116:119]
  v_mfma_f32_16x16x32_bf16 v[124:127], a[204:207], v[204:207], v[124:127]
  ds_read_b64_tr_b16 a[84:85], v6 offset:20480
  v_mfma_f32_16x16x32_bf16 v[124:127], a[220:223], v[220:223], v[124:127]
  v_mfma_f32_16x16x32_bf16 v[64:67], a[192:195], v[192:195], v[64:67]
  ds_read_b64_tr_b16 a[86:87], v6 offset:22528
  v_mfma_f32_16x16x32_bf16 v[64:67], a[208:211], v[208:211], v[64:67]
  v_mfma_f32_16x16x32_bf16 v[72:75], a[192:195], v[196:199], v[72:75]
  ds_read_b64_tr_b16 a[88:89], v7 offset:20480
  v_mfma_f32_16x16x32_bf16 v[72:75], a[208:211], v[212:215], v[72:75]
  v_mfma_f32_16x16x32_bf16 v[68:71], a[196:199], v[192:195], v[68:71]
  ds_read_b64_tr_b16 a[90:91], v7 offset:22528
  v_mfma_f32_16x16x32_bf16 v[68:71], a[212:215], v[208:211], v[68:71]
  v_mfma_f32_16x16x32_bf16 v[76:79], a[196:199], v[196:199], v[76:79]
  ds_read_b64_tr_b16 a[92:93], v8 offset:20480
  v_mfma_f32_16x16x32_bf16 v[76:79], a[212:215], v[212:215], v[76:79]
  s_waitcnt vmcnt(4)
  s_nop 0
  v_mfma_f32_16x16x32_bf16 v[80:83], a[224:227], v[232:235], v[80:83]
  ds_read_b64_tr_b16 a[94:95], v8 offset:22528
  v_mfma_f32_16x16x32_bf16 v[88:91], a[224:227], v[236:239], v[88:91]
  v_mfma_f32_16x16x32_bf16 v[84:87], a[228:231], v[232:235], v[84:87]
  ds_read_b64_tr_b16 a[96:97], v5 offset:24576
  v_mfma_f32_16x16x32_bf16 v[92:95], a[228:231], v[236:239], v[92:95]
  v_mfma_f32_16x16x32_bf16 v[96:99], a[232:235], v[224:227], v[96:99]
  ds_read_b64_tr_b16 a[98:99], v5 offset:26624
  v_mfma_f32_16x16x32_bf16 v[104:107], a[232:235], v[228:231], v[104:107]
  v_mfma_f32_16x16x32_bf16 v[100:103], a[236:239], v[224:227], v[100:103]
  ds_read_b64_tr_b16 a[100:101], v6 offset:24576
  v_mfma_f32_16x16x32_bf16 v[108:111], a[236:239], v[228:231], v[108:111]
  v_mfma_f32_16x16x32_bf16 v[112:115], a[232:235], v[232:235], v[112:115]
  ds_read_b64_tr_b16 a[102:103], v6 offset:26624
  v_mfma_f32_16x16x32_bf16 v[120:123], a[232:235], v[236:239], v[120:123]
  v_mfma_f32_16x16x32_bf16 v[116:119], a[236:239], v[232:235], v[116:119]
  ds_read_b64_tr_b16 a[104:105], v7 offset:24576
  v_mfma_f32_16x16x32_bf16 v[124:127], a[236:239], v[236:239], v[124:127]
  v_mfma_f32_16x16x32_bf16 v[64:67], a[224:227], v[224:227], v[64:67]
  ds_read_b64_tr_b16 a[106:107], v7 offset:26624
  v_mfma_f32_16x16x32_bf16 v[72:75], a[224:227], v[228:231], v[72:75]
  v_mfma_f32_16x16x32_bf16 v[68:71], a[228:231], v[224:227], v[68:71]
  ds_read_b64_tr_b16 a[108:109], v8 offset:24576
  v_mfma_f32_16x16x32_bf16 v[76:79], a[228:231], v[228:231], v[76:79]
  s_waitcnt vmcnt(0)
  s_nop 0
  v_mfma_f32_16x16x32_bf16 v[80:83], a[240:243], v[248:251], v[80:83]
  ds_read_b64_tr_b16 a[110:111], v8 offset:26624
  v_mfma_f32_16x16x32_bf16 v[88:91], a[240:243], v[252:255], v[88:91]
  v_mfma_f32_16x16x32_bf16 v[84:87], a[244:247], v[248:251], v[84:87]
  v_mfma_f32_16x16x32_bf16 v[92:95], a[244:247], v[252:255], v[92:95]
  v_mfma_f32_16x16x32_bf16 v[96:99], a[248:251], v[240:243], v[96:99]
  v_mfma_f32_16x16x32_bf16 v[104:107], a[248:251], v[244:247], v[104:107]
  v_mfma_f32_16x16x32_bf16 v[100:103], a[252:255], v[240:243], v[100:103]
  v_mfma_f32_16x16x32_bf16 v[108:111], a[252:255], v[244:247], v[108:111]
  v_mfma_f32_16x16x32_bf16 v[112:115], a[248:251], v[248:251], v[112:115]
  ds_write_b128 v20, v[80:83] offset:0
  v_mfma_f32_16x16x32_bf16 v[120:123], a[248:251], v[252:255], v[120:123]
  ds_write_b128 v20, v[88:91] offset:2048
  v_mfma_f32_16x16x32_bf16 v[116:119], a[252:255], v[248:251], v[116:119]
  ds_write_b128 v20, v[84:87] offset:1024
  v_mfma_f32_16x16x32_bf16 v[124:127], a[252:255], v[252:255], v[124:127]
  ds_write_b128 v20, v[92:95] offset:3072
  v_mfma_f32_16x16x32_bf16 v[64:67], a[240:243], v[240:243], v[64:67]
  ds_write_b128 v20, v[96:99] offset:4096
  v_mfma_f32_16x16x32_bf16 v[72:75], a[240:243], v[244:247], v[72:75]
  ds_write_b128 v20, v[104:107] offset:6144
  v_mfma_f32_16x16x32_bf16 v[68:71], a[244:247], v[240:243], v[68:71]
  ds_write_b128 v20, v[100:103] offset:5120
  v_mfma_f32_16x16x32_bf16 v[76:79], a[244:247], v[244:247], v[76:79]
  ds_write_b128 v20, v[108:111] offset:7168
  ds_write_b128 v21, v[112:115] offset:0
  ds_write_b128 v21, v[116:119] offset:1024
  ds_write_b128 v21, v[120:123] offset:2048
  ds_write_b128 v21, v[124:127] offset:3072
  s_waitcnt lgkmcnt(0)
  s_barrier
  ds_read_b128 v[80:83], v22 offset:0
  ds_read_b128 v[84:87], v22 offset:1024
  ds_read_b128 v[88:91], v22 offset:2048
  ds_read_b128 v[92:95], v22 offset:3072
  ds_read_b128 v[96:99], v23 offset:4096
  ds_read_b128 v[100:103], v23 offset:5120
  ds_read_b128 v[104:107], v23 offset:6144
  ds_read_b128 v[108:111], v23 offset:7168
  ds_read_b128 v[112:115], v24 offset:0
  ds_read_b128 v[116:119], v24 offset:1024
  ds_read_b128 v[120:123], v24 offset:2048
  ds_read_b128 v[124:127], v24 offset:3072
  s_waitcnt lgkmcnt(8)
  v_pk_add_f32 v[64:65], v[64:65], v[80:81]
  v_pk_add_f32 v[66:67], v[66:67], v[82:83]
  v_pk_add_f32 v[68:69], v[68:69], v[84:85]
  v_pk_add_f32 v[70:71], v[70:71], v[86:87]
  v_pk_add_f32 v[72:73], v[72:73], v[88:89]
  v_pk_add_f32 v[74:75], v[74:75], v[90:91]
  v_pk_add_f32 v[76:77], v[76:77], v[92:93]
  v_pk_add_f32 v[78:79], v[78:79], v[94:95]
  s_waitcnt lgkmcnt(4)
  v_pk_add_f32 v[64:65], v[64:65], v[96:97]
  v_pk_add_f32 v[66:67], v[66:67], v[98:99]
  v_pk_add_f32 v[68:69], v[68:69], v[100:101]
  v_pk_add_f32 v[70:71], v[70:71], v[102:103]
  v_pk_add_f32 v[72:73], v[72:73], v[104:105]
  v_pk_add_f32 v[74:75], v[74:75], v[106:107]
  v_pk_add_f32 v[76:77], v[76:77], v[108:109]
  v_pk_add_f32 v[78:79], v[78:79], v[110:111]
  s_waitcnt lgkmcnt(0)
  v_pk_add_f32 v[64:65], v[64:65], v[112:113]
  v_pk_add_f32 v[66:67], v[66:67], v[114:115]
  v_pk_add_f32 v[68:69], v[68:69], v[116:117]
  v_pk_add_f32 v[70:71], v[70:71], v[118:119]
  v_pk_add_f32 v[72:73], v[72:73], v[120:121]
  v_pk_add_f32 v[74:75], v[74:75], v[122:123]
  v_pk_add_f32 v[76:77], v[76:77], v[124:125]
  v_pk_add_f32 v[78:79], v[78:79], v[126:127]
  v_pk_add_f32 v[64:65], v[64:65], v[32:33]
  v_pk_add_f32 v[66:67], v[66:67], v[34:35]
  v_pk_add_f32 v[68:69], v[68:69], v[36:37]
  v_pk_add_f32 v[70:71], v[70:71], v[38:39]
  v_pk_mul_f32 v[80:81], v[64:65], v[64:65]
  v_pk_mul_f32 v[82:83], v[66:67], v[66:67]
  v_pk_mul_f32 v[84:85], v[68:69], v[68:69]
  v_pk_mul_f32 v[86:87], v[70:71], v[70:71]
  v_pk_fma_f32 v[80:81], v[80:81], v[42:43], v[40:41]
  v_pk_fma_f32 v[82:83], v[82:83], v[42:43], v[40:41]
  v_pk_fma_f32 v[84:85], v[84:85], v[42:43], v[40:41]
  v_pk_fma_f32 v[86:87], v[86:87], v[42:43], v[40:41]
  v_pk_mul_f32 v[80:81], v[80:81], v[64:65]
  v_pk_mul_f32 v[82:83], v[82:83], v[66:67]
  v_pk_mul_f32 v[84:85], v[84:85], v[68:69]
  v_pk_mul_f32 v[86:87], v[86:87], v[70:71]
  v_exp_f32 v80, v80
  v_exp_f32 v81, v81
  v_exp_f32 v82, v82
  v_exp_f32 v83, v83
  v_exp_f32 v84, v84
  v_exp_f32 v85, v85
  v_exp_f32 v86, v86
  v_exp_f32_e64 v87, v87
  v_pk_add_f32 v[80:81], v[80:81], v[44:45]
  v_pk_add_f32 v[82:83], v[82:83], v[44:45]
  v_pk_add_f32 v[84:85], v[84:85], v[44:45]
  v_pk_add_f32 v[86:87], v[86:87], v[44:45]
  v_rcp_f32 v80, v80
  v_rcp_f32 v81, v81
  v_rcp_f32 v82, v82
  v_rcp_f32 v83, v83
  v_rcp_f32 v84, v84
  v_rcp_f32 v85, v85
  v_rcp_f32 v86, v86
  v_rcp_f32 v87, v87
  v_pk_mul_f32 v[64:65], v[64:65], v[80:81]
  v_pk_mul_f32 v[66:67], v[66:67], v[82:83]
  v_pk_mul_f32 v[68:69], v[68:69], v[84:85]
  v_pk_mul_f32 v[70:71], v[70:71], v[86:87]
  v_cvt_pk_bf16_f32 v64, v64, v65
  v_cvt_pk_bf16_f32 v65, v66, v67
  v_cvt_pk_bf16_f32 v66, v68, v69
  v_cvt_pk_bf16_f32 v67, v70, v71
  buffer_store_dwordx4 v[64:67], v0, s[8:11], s7 offen offset:0 sc1
  v_pk_add_f32 v[72:73], v[72:73], v[32:33]
  v_pk_add_f32 v[74:75], v[74:75], v[34:35]
  v_pk_add_f32 v[76:77], v[76:77], v[36:37]
  v_pk_add_f32 v[78:79], v[78:79], v[38:39]
  v_pk_mul_f32 v[88:89], v[72:73], v[72:73]
  v_pk_mul_f32 v[90:91], v[74:75], v[74:75]
  v_pk_mul_f32 v[92:93], v[76:77], v[76:77]
  v_pk_mul_f32 v[94:95], v[78:79], v[78:79]
  v_pk_fma_f32 v[88:89], v[88:89], v[42:43], v[40:41]
  v_pk_fma_f32 v[90:91], v[90:91], v[42:43], v[40:41]
  v_pk_fma_f32 v[92:93], v[92:93], v[42:43], v[40:41]
  v_pk_fma_f32 v[94:95], v[94:95], v[42:43], v[40:41]
  v_pk_mul_f32 v[88:89], v[88:89], v[72:73]
  v_pk_mul_f32 v[90:91], v[90:91], v[74:75]
  v_pk_mul_f32 v[92:93], v[92:93], v[76:77]
  v_pk_mul_f32 v[94:95], v[94:95], v[78:79]
  v_exp_f32 v88, v88
  v_exp_f32 v89, v89
  v_exp_f32 v90, v90
  v_exp_f32 v91, v91
  v_exp_f32 v92, v92
  v_exp_f32 v93, v93
  v_exp_f32 v94, v94
  v_exp_f32 v95, v95
  v_pk_add_f32 v[88:89], v[88:89], v[44:45]
  v_pk_add_f32 v[90:91], v[90:91], v[44:45]
  v_pk_add_f32 v[92:93], v[92:93], v[44:45]
  v_pk_add_f32 v[94:95], v[94:95], v[44:45]
  v_rcp_f32 v88, v88
  v_rcp_f32 v89, v89
  v_rcp_f32 v90, v90
  v_rcp_f32 v91, v91
  v_rcp_f32 v92, v92
  v_rcp_f32 v93, v93
  v_rcp_f32 v94, v94
  v_rcp_f32 v95, v95
  v_pk_mul_f32 v[72:73], v[72:73], v[88:89]
  v_pk_mul_f32 v[74:75], v[74:75], v[90:91]
  v_pk_mul_f32 v[76:77], v[76:77], v[92:93]
  v_pk_mul_f32 v[78:79], v[78:79], v[94:95]
  v_cvt_pk_bf16_f32 v72, v72, v73
  v_cvt_pk_bf16_f32 v73, v74, v75
  v_cvt_pk_bf16_f32 v74, v76, v77
  v_cvt_pk_bf16_f32 v75, v78, v79
  buffer_store_dwordx4 v[72:75], v0, s[8:11], s7 offen offset:1024 sc1
  s_mul_i32 s41, s47, 28
  s_add_u32 s41, s41, s46
  s_add_u32 s41, s41, 256
  s_lshl_b32 s41, s41, 7
  s_add_u32 s41, s41, 8192000
  s_waitcnt vmcnt(0)
  s_barrier
  buffer_store_dword v58, v57, s[8:11], s41 offen sc0 sc1
  s_branch L_k6_g2
L_k6_skip1:
  s_add_u32 m0, s64, 0
  s_nop 0
  buffer_load_dwordx4 v1, s[48:51], s40 offen offset:0 lds
  buffer_load_dwordx4 v2, s[48:51], s40 offen offset:1024 lds
  buffer_load_dwordx4 v3, s[48:51], s40 offen offset:2048 lds
  buffer_load_dwordx4 v4, s[48:51], s40 offen offset:3072 lds
  s_add_u32 s40, s40, 131072
  s_add_u32 m0, s64, 4096
  s_nop 0
  buffer_load_dwordx4 v1, s[48:51], s40 offen offset:0 lds
  buffer_load_dwordx4 v2, s[48:51], s40 offen offset:1024 lds
  buffer_load_dwordx4 v3, s[48:51], s40 offen offset:2048 lds
  buffer_load_dwordx4 v4, s[48:51], s40 offen offset:3072 lds
  s_add_u32 s40, s40, 131072
  s_add_u32 m0, s64, 8192
  s_nop 0
  buffer_load_dwordx4 v1, s[48:51], s40 offen offset:0 lds
  buffer_load_dwordx4 v2, s[48:51], s40 offen offset:1024 lds
  buffer_load_dwordx4 v3, s[48:51], s40 offen offset:2048 lds
  buffer_load_dwordx4 v4, s[48:51], s40 offen offset:3072 lds
  s_add_u32 s40, s40, 131072
  s_add_u32 m0, s64, 12288
  s_nop 0
  buffer_load_dwordx4 v1, s[48:51], s40 offen offset:0 lds
  buffer_load_dwordx4 v2, s[48:51], s40 offen offset:1024 lds
  buffer_load_dwordx4 v3, s[48:51], s40 offen offset:2048 lds
  buffer_load_dwordx4 v4, s[48:51], s40 offen offset:3072 lds
  s_add_u32 s40, s40, 131072
  s_add_u32 m0, s64, 16384
  s_nop 0
  buffer_load_dwordx4 v1, s[48:51], s40 offen offset:0 lds
  buffer_load_dwordx4 v2, s[48:51], s40 offen offset:1024 lds
  buffer_load_dwordx4 v3, s[48:51], s40 offen offset:2048 lds
  buffer_load_dwordx4 v4, s[48:51], s40 offen offset:3072 lds
  s_add_u32 s40, s40, 131072
  s_add_u32 m0, s64, 20480
  s_nop 0
  buffer_load_dwordx4 v1, s[48:51], s40 offen offset:0 lds
  buffer_load_dwordx4 v2, s[48:51], s40 offen offset:1024 lds
  buffer_load_dwordx4 v3, s[48:51], s40 offen offset:2048 lds
  buffer_load_dwordx4 v4, s[48:51], s40 offen offset:3072 lds
  s_add_u32 s40, s40, 131072
  s_add_u32 m0, s64, 24576
  s_nop 0
  buffer_load_dwordx4 v1, s[48:51], s40 offen offset:0 lds
  buffer_load_dwordx4 v2, s[48:51], s40 offen offset:1024 lds
  buffer_load_dwordx4 v3, s[48:51], s40 offen offset:2048 lds
  buffer_load_dwordx4 v4, s[48:51], s40 offen offset:3072 lds
  s_add_u32 s40, s40, 131072
  s_waitcnt vmcnt(0)
  ds_read_b64_tr_b16 a[0:1], v5 offset:0
  ds_read_b64_tr_b16 a[2:3], v5 offset:2048
  ds_read_b64_tr_b16 a[4:5], v6 offset:0
  ds_read_b64_tr_b16 a[6:7], v6 offset:2048
  ds_read_b64_tr_b16 a[8:9], v7 offset:0
  ds_read_b64_tr_b16 a[10:11], v7 offset:2048
  ds_read_b64_tr_b16 a[12:13], v8 offset:0
  ds_read_b64_tr_b16 a[14:15], v8 offset:2048
  ds_read_b64_tr_b16 a[16:17], v5 offset:4096
  ds_read_b64_tr_b16 a[18:19], v5 offset:6144
  ds_read_b64_tr_b16 a[20:21], v6 offset:4096
  ds_read_b64_tr_b16 a[22:23], v6 offset:6144
  ds_read_b64_tr_b16 a[24:25], v7 offset:4096
  ds_read_b64_tr_b16 a[26:27], v7 offset:6144
  ds_read_b64_tr_b16 a[28:29], v8 offset:4096
  ds_read_b64_tr_b16 a[30:31], v8 offset:6144
  ds_read_b64_tr_b16 a[32:33], v5 offset:8192
  ds_read_b64_tr_b16 a[34:35], v5 offset:10240
  ds_read_b64_tr_b16 a[36:37], v6 offset:8192
  ds_read_b64_tr_b16 a[38:39], v6 offset:10240
  ds_read_b64_tr_b16 a[40:41], v7 offset:8192
  ds_read_b64_tr_b16 a[42:43], v7 offset:10240
  ds_read_b64_tr_b16 a[44:45], v8 offset:8192
  ds_read_b64_tr_b16 a[46:47], v8 offset:10240
  ds_read_b64_tr_b16 a[48:49], v5 offset:12288
  ds_read_b64_tr_b16 a[50:51], v5 offset:14336
  ds_read_b64_tr_b16 a[52:53], v6 offset:12288
  ds_read_b64_tr_b16 a[54:55], v6 offset:14336
  ds_read_b64_tr_b16 a[56:57], v7 offset:12288
  ds_read_b64_tr_b16 a[58:59], v7 offset:14336
  ds_read_b64_tr_b16 a[60:61], v8 offset:12288
  ds_read_b64_tr_b16 a[62:63], v8 offset:14336
  ds_read_b64_tr_b16 a[64:65], v5 offset:16384
  ds_read_b64_tr_b16 a[66:67], v5 offset:18432
  ds_read_b64_tr_b16 a[68:69], v6 offset:16384
  ds_read_b64_tr_b16 a[70:71], v6 offset:18432
  ds_read_b64_tr_b16 a[72:73], v7 offset:16384
  ds_read_b64_tr_b16 a[74:75], v7 offset:18432
  ds_read_b64_tr_b16 a[76:77], v8 offset:16384
  ds_read_b64_tr_b16 a[78:79], v8 offset:18432
  ds_read_b64_tr_b16 a[80:81], v5 offset:20480
  ds_read_b64_tr_b16 a[82:83], v5 offset:22528
  ds_read_b64_tr_b16 a[84:85], v6 offset:20480
  ds_read_b64_tr_b16 a[86:87], v6 offset:22528
  ds_read_b64_tr_b16 a[88:89], v7 offset:20480
  ds_read_b64_tr_b16 a[90:91], v7 offset:22528
  ds_read_b64_tr_b16 a[92:93], v8 offset:20480
  ds_read_b64_tr_b16 a[94:95], v8 offset:22528
  ds_read_b64_tr_b16 a[96:97], v5 offset:24576
  ds_read_b64_tr_b16 a[98:99], v5 offset:26624
  ds_read_b64_tr_b16 a[100:101], v6 offset:24576
  ds_read_b64_tr_b16 a[102:103], v6 offset:26624
  ds_read_b64_tr_b16 a[104:105], v7 offset:24576
  ds_read_b64_tr_b16 a[106:107], v7 offset:26624
  ds_read_b64_tr_b16 a[108:109], v8 offset:24576
  ds_read_b64_tr_b16 a[110:111], v8 offset:26624
  s_waitcnt lgkmcnt(0)
L_k6_g2:
  s_cmp_eq_u32 s39, 0
  s_cbranch_scc1 L_k6_end
  s_add_u32 m0, s64, 0
  s_nop 0
  buffer_load_dwordx4 v1, s[48:51], s40 offen offset:0 lds
  s_mul_i32 s42, s44, 401408
  s_lshl_b32 s5, s37, 12
  s_add_u32 s42, s42, s5
  s_add_u32 s42, s42, 6291456
  buffer_load_dwordx4 v2, s[48:51], s40 offen offset:1024 lds
  v_min_u32 v22, 6, v11
  v_lshlrev_b32 v22, 7, v22
  s_lshl_b32 s6, s37, 2
  s_add_u32 s6, s6, s44
  buffer_load_dwordx4 v3, s[48:51], s40 offen offset:2048 lds
  s_mul_i32 s6, s6, 896
  s_add_u32 s6, s6, 8224768
  s_lshr_b32 s4, s44, 1
  s_lshl_b32 s5, s36, 6
  buffer_load_dwordx4 v4, s[48:51], s40 offen offset:3072 lds
  s_lshl_b32 s7, s4, 5
  s_add_u32 s5, s5, s7
  v_lshlrev_b32 v20, 1, v13
  s_lshl_b32 s7, s5, 1
  s_add_u32 s40, s40, 131072
  s_add_u32 m0, s64, 4096
  s_nop 0
  buffer_load_dwordx4 v1, s[48:51], s40 offen offset:0 lds
  buffer_load_ushort v28, v20, s[60:63], s7 offen
  buffer_load_ushort v29, v20, s[60:63], s7 offen offset:32
  v_mul_u32_u24 v20, 896, v13
  v_lshl_add_u32 v30, v12, 4, v20
  buffer_load_dwordx4 v2, s[48:51], s40 offen offset:1024 lds
  s_mul_i32 s5, s5, 896
  s_lshl_b32 s7, s37, 7
  s_add_u32 s5, s5, s7
  s_and_b32 s7, s44, 1
  buffer_load_dwordx4 v3, s[48:51], s40 offen offset:2048 lds
  s_lshl_b32 s7, s7, 6
  s_add_u32 s20, s5, s7
  s_add_u32 s21, s20, 14336
  s_and_b32 s5, s36, 1
  buffer_load_dwordx4 v4, s[48:51], s40 offen offset:3072 lds
  s_lshl_b32 s4, s4, 1
  s_mul_i32 s7, s5, 3
  s_xor_b32 s22, s4, s7
  s_xor_b32 s23, s22, 1
  s_add_u32 s40, s40, 131072
  s_add_u32 m0, s64, 8192
  s_nop 0
  buffer_load_dwordx4 v1, s[48:51], s40 offen offset:0 lds
  s_lshr_b32 s7, s36, 1
  s_lshl_b32 s7, s7, 2
  s_add_u32 s22, s22, s7
  s_add_u32 s23, s23, s7
  buffer_load_dwordx4 v2, s[48:51], s40 offen offset:1024 lds
  s_mul_i32 s22, s22, 28672
  s_mul_i32 s23, s23, 28672
  s_lshl_b32 s7, s37, 12
  s_add_u32 s7, s7, 2097152
  buffer_load_dwordx4 v3, s[48:51], s40 offen offset:2048 lds
  s_add_u32 s22, s22, s7
  s_add_u32 s23, s23, s7
  v_lshrrev_b32_e64 v20, 2, v13
  v_cmp_eq_u32 vcc, v20, v12
  buffer_load_dwordx4 v4, s[48:51], s40 offen offset:3072 lds
  v_and_b32 v20, 1, v13
  v_lshlrev_b32 v20, 4, v20
  v_mov_b32 v21, 0x3f80
  v_lshlrev_b32_e64 v21, v20, v21
  s_add_u32 s40, s40, 131072
  s_add_u32 m0, s64, 12288
  s_nop 0
  buffer_load_dwordx4 v1, s[48:51], s40 offen offset:0 lds
  v_cndmask_b32 v21, 0, v21, vcc
  v_bfe_u32 v20, v13, 1, 1
  s_lshl_b32 s5, s5, 1
  v_add_u32 v20, s5, v20
  buffer_load_dwordx4 v2, s[48:51], s40 offen offset:1024 lds
  v_cmp_eq_u32 s[24:25], 0, v20
  v_cmp_eq_u32 s[26:27], 1, v20
  v_cmp_eq_u32 s[28:29], 2, v20
  v_cmp_eq_u32 s[30:31], 3, v20
  buffer_load_dwordx4 v3, s[48:51], s40 offen offset:2048 lds
  v_cndmask_b32 v32, 0, v21, s[24:25]
  v_cndmask_b32 v33, 0, v21, s[26:27]
  v_cndmask_b32 v34, 0, v21, s[28:29]
  v_cndmask_b32 v35, 0, v21, s[30:31]
  buffer_load_dwordx4 v4, s[48:51], s40 offen offset:3072 lds
  s_add_u32 s40, s40, 131072
  s_add_u32 m0, s64, 16384
  s_nop 0
  buffer_load_dwordx4 v1, s[48:51], s40 offen offset:0 lds
  buffer_load_dwordx4 v2, s[48:51], s40 offen offset:1024 lds
  buffer_load_dwordx4 v3, s[48:51], s40 offen offset:2048 lds
  buffer_load_dwordx4 v4, s[48:51], s40 offen offset:3072 lds
  s_add_u32 s40, s40, 131072
  s_add_u32 m0, s64, 20480
  s_nop 0
  buffer_load_dwordx4 v1, s[48:51], s40 offen offset:0 lds
  buffer_load_dwordx4 v2, s[48:51], s40 offen offset:1024 lds
  buffer_load_dword v23, v22, s[8:11], s6 offen sc0 sc1
  buffer_load_dwordx4 v3, s[48:51], s40 offen offset:2048 lds
  buffer_load_dwordx4 v4, s[48:51], s40 offen offset:3072 lds
  s_add_u32 s40, s40, 131072
  s_add_u32 m0, s64, 24576
  s_nop 0
  buffer_load_dwordx4 v1, s[48:51], s40 offen offset:0 lds
  buffer_load_dwordx4 v2, s[48:51], s40 offen offset:1024 lds
  buffer_load_dwordx4 v3, s[48:51], s40 offen offset:2048 lds
  buffer_load_dwordx4 v4, s[48:51], s40 offen offset:3072 lds
  s_add_u32 s40, s40, 131072
  s_waitcnt vmcnt(6)
  v_cmp_ne_u32 vcc, 1, v23
  s_nop 0
  s_cbranch_vccnz L_k6_p2s
L_k6_p2x:
  buffer_load_dwordx4 v[128:131], v9, s[8:11], s42 offen offset:0 sc1
  buffer_load_dwordx4 v[132:135], v9, s[8:11], s42 offen offset:1024 sc1
  buffer_load_dwordx4 v[136:139], v10, s[8:11], s42 offen offset:0 sc1
  buffer_load_dwordx4 v[140:143], v10, s[8:11], s42 offen offset:1024 sc1
  s_add_u32 s42, s42, 28672
  buffer_load_dwordx4 v[144:147], v9, s[8:11], s42 offen offset:0 sc1
  buffer_load_dwordx4 v[148:151], v9, s[8:11], s42 offen offset:1024 sc1
  buffer_load_dwordx4 v[152:155], v10, s[8:11], s42 offen offset:0 sc1
  buffer_load_dwordx4 v[156:159], v10, s[8:11], s42 offen offset:1024 sc1
  s_add_u32 s42, s42, 28672
  buffer_load_dwordx4 v[160:163], v9, s[8:11], s42 offen offset:0 sc1
  buffer_load_dwordx4 v[164:167], v9, s[8:11], s42 offen offset:1024 sc1
  buffer_load_dwordx4 v[168:171], v10, s[8:11], s42 offen offset:0 sc1
  buffer_load_dwordx4 v[172:175], v10, s[8:11], s42 offen offset:1024 sc1
  s_add_u32 s42, s42, 28672
  buffer_load_dwordx4 v[176:179], v9, s[8:11], s42 offen offset:0 sc1
  buffer_load_dwordx4 v[180:183], v9, s[8:11], s42 offen offset:1024 sc1
  buffer_load_dwordx4 v[184:187], v10, s[8:11], s42 offen offset:0 sc1
  buffer_load_dwordx4 v[188:191], v10, s[8:11], s42 offen offset:1024 sc1
  s_add_u32 s42, s42, 28672
  buffer_load_dwordx4 v[192:195], v9, s[8:11], s42 offen offset:0 sc1
  buffer_load_dwordx4 v[196:199], v9, s[8:11], s42 offen offset:1024 sc1
  buffer_load_dwordx4 v[200:203], v10, s[8:11], s42 offen offset:0 sc1
  buffer_load_dwordx4 v[204:207], v10, s[8:11], s42 offen offset:1024 sc1
  s_add_u32 s42, s42, 28672
  v_lshlrev_b32 v28, 16, v28
  v_lshlrev_b32 v29, 16, v29
  s_waitcnt vmcnt(16) lgkmcnt(0)
  v_mfma_f32_16x16x32_bf16 v[80:83], v[136:139], a[0:3], 0
  ds_read_b64_tr_b16 a[112:113], v5 offset:0
  buffer_load_dwordx4 v[208:211], v9, s[8:11], s42 offen offset:0 sc1
  v_mfma_f32_16x16x32_bf16 v[84:87], v[140:143], a[0:3], 0
  ds_read_b64_tr_b16 a[114:115], v5 offset:2048
  v_mfma_f32_16x16x32_bf16 v[88:91], v[136:139], a[4:7], 0
  ds_read_b64_tr_b16 a[116:117], v6 offset:0
  v_mfma_f32_16x16x32_bf16 v[92:95], v[140:143], a[4:7], 0
  ds_read_b64_tr_b16 a[118:119], v6 offset:2048
  v_mfma_f32_16x16x32_bf16 v[96:99], v[128:131], a[8:11], 0
  ds_read_b64_tr_b16 a[120:121], v7 offset:0
  buffer_load_dwordx4 v[212:215], v9, s[8:11], s42 offen offset:1024 sc1
  v_mfma_f32_16x16x32_bf16 v[100:103], v[132:135], a[8:11], 0
  ds_read_b64_tr_b16 a[122:123], v7 offset:2048
  v_mfma_f32_16x16x32_bf16 v[104:107], v[128:131], a[12:15], 0
  ds_read_b64_tr_b16 a[124:125], v8 offset:0
  v_mfma_f32_16x16x32_bf16 v[108:111], v[132:135], a[12:15], 0
  ds_read_b64_tr_b16 a[126:127], v8 offset:2048
  v_mfma_f32_16x16x32_bf16 v[112:115], v[136:139], a[8:11], 0
  ds_read_b64_tr_b16 a[128:129], v5 offset:4096
  buffer_load_dwordx4 v[216:219], v10, s[8:11], s42 offen offset:0 sc1
  v_mfma_f32_16x16x32_bf16 v[116:119], v[140:143], a[8:11], 0
  ds_read_b64_tr_b16 a[130:131], v5 offset:6144
  v_mfma_f32_16x16x32_bf16 v[120:123], v[136:139], a[12:15], 0
  ds_read_b64_tr_b16 a[132:133], v6 offset:4096
  v_mfma_f32_16x16x32_bf16 v[124:127], v[140:143], a[12:15], 0
  ds_read_b64_tr_b16 a[134:135], v6 offset:6144
  v_mfma_f32_16x16x32_bf16 v[64:67], v[128:131], a[0:3], 0
  ds_read_b64_tr_b16 a[136:137], v7 offset:4096
  buffer_load_dwordx4 v[220:223], v10, s[8:11], s42 offen offset:1024 sc1
  v_mfma_f32_16x16x32_bf16 v[68:71], v[132:135], a[0:3], 0
  ds_read_b64_tr_b16 a[138:139], v7 offset:6144
  s_add_u32 s42, s42, 28672
  v_mfma_f32_16x16x32_bf16 v[72:75], v[128:131], a[4:7], 0
  ds_read_b64_tr_b16 a[140:141], v8 offset:4096
  v_mfma_f32_16x16x32_bf16 v[76:79], v[132:135], a[4:7], 0
  s_waitcnt vmcnt(16)
  ds_read_b64_tr_b16 a[142:143], v8 offset:6144
  v_mfma_f32_16x16x32_bf16 v[80:83], v[152:155], a[16:19], v[80:83]
  ds_read_b64_tr_b16 a[144:145], v5 offset:8192
  buffer_load_dwordx4 v[224:227], v9, s[8:11], s42 offen offset:0 sc1
  v_mfma_f32_16x16x32_bf16 v[84:87], v[156:159], a[16:19], v[84:87]
  s_nop 0
  ds_read_b64_tr_b16 a[146:147], v5 offset:10240
  v_mfma_f32_16x16x32_bf16 v[88:91], v[152:155], a[20:23], v[88:91]
  ds_read_b64_tr_b16 a[148:149], v6 offset:8192
  v_mfma_f32_16x16x32_bf16 v[92:95], v[156:159], a[20:23], v[92:95]
  ds_read_b64_tr_b16 a[150:151], v6 offset:10240
  v_mfma_f32_16x16x32_bf16 v[96:99], v[144:147], a[24:27], v[96:99]
  ds_read_b64_tr_b16 a[152:153], v7 offset:8192
  buffer_load_dwordx4 v[228:231], v9, s[8:11], s42 offen offset:1024 sc1
  v_mfma_f32_16x16x32_bf16 v[100:103], v[148:151], a[24:27], v[100:103]
  ds_read_b64_tr_b16 a[154:155], v7 offset:10240
  v_mfma_f32_16x16x32_bf16 v[104:107], v[144:147], a[28:31], v[104:107]
  ds_read_b64_tr_b16 a[156:157], v8 offset:8192
  v_mfma_f32_16x16x32_bf16 v[108:111], v[148:151], a[28:31], v[108:111]
  ds_read_b64_tr_b16 a[158:159], v8 offset:10240
  v_mfma_f32_16x16x32_bf16 v[112:115], v[152:155], a[24:27], v[112:115]
  ds_read_b64_tr_b16 a[160:161], v5 offset:12288
  buffer_load_dwordx4 v[232:235], v10, s[8:11], s42 offen offset:0 sc1
  v_mfma_f32_16x16x32_bf16 v[116:119], v[156:159], a[24:27], v[116:119]
  ds_read_b64_tr_b16 a[162:163], v5 offset:14336
  v_mfma_f32_16x16x32_bf16 v[120:123], v[152:155], a[28:31], v[120:123]
  ds_read_b64_tr_b16 a[164:165], v6 offset:12288
  v_mfma_f32_16x16x32_bf16 v[124:127], v[156:159], a[28:31], v[124:127]
  ds_read_b64_tr_b16 a[166:167], v6 offset:14336
  v_mfma_f32_16x16x32_bf16 v[64:67], v[144:147], a[16:19], v[64:67]
  ds_read_b64_tr_b16 a[168:169], v7 offset:12288
  buffer_load_dwordx4 v[236:239], v10, s[8:11], s42 offen offset:1024 sc1
  v_mfma_f32_16x16x32_bf16 v[68:71], v[148:151], a[16:19], v[68:71]
  ds_read_b64_tr_b16 a[170:171], v7 offset:14336
  s_add_u32 s42, s42, 28672
  v_mfma_f32_16x16x32_bf16 v[72:75], v[144:147], a[20:23], v[72:75]
  ds_read_b64_tr_b16 a[172:173], v8 offset:12288
  v_mfma_f32_16x16x32_bf16 v[76:79], v[148:151], a[20:23], v[76:79]
  s_waitcnt vmcnt(12)
  ds_read_b64_tr_b16 a[174:175], v8 offset:14336
  v_mfma_f32_16x16x32_bf16 v[80:83], v[168:171], a[32:35], v[80:83]
  ds_read_b64_tr_b16 a[176:177], v5 offset:16384
  buffer_load_dwordx4 v[240:243], v9, s[8:11], s42 offen offset:0 sc1
  v_mfma_f32_16x16x32_bf16 v[80:83], v[184:187], a[48:51], v[80:83]
  s_nop 0
  ds_read_b64_tr_b16 a[178:179], v5 offset:18432
  v_mfma_f32_16x16x32_bf16 v[84:87], v[172:175], a[32:35], v[84:87]
  ds_read_b64_tr_b16 a[180:181], v6 offset:16384
  v_mfma_f32_16x16x32_bf16 v[84:87], v[188:191], a[48:51], v[84:87]
  ds_read_b64_tr_b16 a[182:183], v6 offset:18432
  v_mfma_f32_16x16x32_bf16 v[88:91], v[168:171], a[36:39], v[88:91]
  ds_read_b64_tr_b16 a[184:185], v7 offset:16384
  buffer_load_dwordx4 v[244:247], v9, s[8:11], s42 offen offset:1024 sc1
  v_mfma_f32_16x16x32_bf16 v[88:91], v[184:187], a[52:55], v[88:91]
  ds_read_b64_tr_b16 a[186:187], v7 offset:18432
  v_mfma_f32_16x16x32_bf16 v[92:95], v[172:175], a[36:39], v[92:95]
  ds_read_b64_tr_b16 a[188:189], v8 offset:16384
  v_mfma_f32_16x16x32_bf16 v[92:95], v[188:191], a[52:55], v[92:95]
  ds_read_b64_tr_b16 a[190:191], v8 offset:18432
  v_mfma_f32_16x16x32_bf16 v[96:99], v[160:163], a[40:43], v[96:99]
  ds_read_b64_tr_b16 a[192:193], v5 offset:20480
  buffer_load_dwordx4 v[248:251], v10, s[8:11], s42 offen offset:0 sc1
  v_mfma_f32_16x16x32_bf16 v[96:99], v[176:179], a[56:59], v[96:99]
  ds_read_b64_tr_b16 a[194:195], v5 offset:22528
  v_mfma_f32_16x16x32_bf16 v[100:103], v[164:167], a[40:43], v[100:103]
  ds_read_b64_tr_b16 a[196:197], v6 offset:20480
  v_mfma_f32_16x16x32_bf16 v[100:103], v[180:183], a[56:59], v[100:103]
  ds_read_b64_tr_b16 a[198:199], v6 offset:22528
  v_mfma_f32_16x16x32_bf16 v[104:107], v[160:163], a[44:47], v[104:107]
  ds_read_b64_tr_b16 a[200:201], v7 offset:20480
  buffer_load_dwordx4 v[252:255], v10, s[8:11], s42 offen offset:1024 sc1
  v_mfma_f32_16x16x32_bf16 v[104:107], v[176:179], a[60:63], v[104:107]
  ds_read_b64_tr_b16 a[202:203], v7 offset:22528
  s_add_u32 s42, s42, 28672
  v_mfma_f32_16x16x32_bf16 v[108:111], v[164:167], a[44:47], v[108:111]
  ds_read_b64_tr_b16 a[204:205], v8 offset:20480
  v_mfma_f32_16x16x32_bf16 v[108:111], v[180:183], a[60:63], v[108:111]
  ds_read_b64_tr_b16 a[206:207], v8 offset:22528
  v_mfma_f32_16x16x32_bf16 v[112:115], v[168:171], a[40:43], v[112:115]
  ds_read_b64_tr_b16 a[208:209], v5 offset:24576
  buffer_load_dwordx4 v[128:131], v9, s[8:11], s42 offen offset:0 sc1
  v_mfma_f32_16x16x32_bf16 v[112:115], v[184:187], a[56:59], v[112:115]
  ds_read_b64_tr_b16 a[210:211], v5 offset:26624
  v_mfma_f32_16x16x32_bf16 v[116:119], v[172:175], a[40:43], v[116:119]
  ds_read_b64_tr_b16 a[212:213], v6 offset:24576
  v_mfma_f32_16x16x32_bf16 v[116:119], v[188:191], a[56:59], v[116:119]
  ds_read_b64_tr_b16 a[214:215], v6 offset:26624
  v_mfma_f32_16x16x32_bf16 v[120:123], v[168:171], a[44:47], v[120:123]
  ds_read_b64_tr_b16 a[216:217], v7 offset:24576
  buffer_load_dwordx4 v[132:135], v9, s[8:11], s42 offen offset:1024 sc1
  v_mfma_f32_16x16x32_bf16 v[120:123], v[184:187], a[60:63], v[120:123]
  ds_read_b64_tr_b16 a[218:219], v7 offset:26624
  v_mfma_f32_16x16x32_bf16 v[124:127], v[172:175], a[44:47], v[124:127]
  ds_read_b64_tr_b16 a[220:221], v8 offset:24576
  v_mfma_f32_16x16x32_bf16 v[124:127], v[188:191], a[60:63], v[124:127]
  ds_read_b64_tr_b16 a[222:223], v8 offset:26624
  v_mfma_f32_16x16x32_bf16 v[64:67], v[160:163], a[32:35], v[64:67]
  buffer_load_dwordx4 v[136:139], v10, s[8:11], s42 offen offset:0 sc1
  v_mfma_f32_16x16x32_bf16 v[64:67], v[176:179], a[48:51], v[64:67]
  v_mfma_f32_16x16x32_bf16 v[68:71], v[164:167], a[32:35], v[68:71]
  v_mfma_f32_16x16x32_bf16 v[68:71], v[180:183], a[48:51], v[68:71]
  v_mfma_f32_16x16x32_bf16 v[72:75], v[160:163], a[36:39], v[72:75]
  buffer_load_dwordx4 v[140:143], v10, s[8:11], s42 offen offset:1024 sc1
  s_add_u32 s42, s42, 28672
  v_mfma_f32_16x16x32_bf16 v[72:75], v[176:179], a[52:55], v[72:75]
  v_mfma_f32_16x16x32_bf16 v[76:79], v[164:167], a[36:39], v[76:79]
  v_mfma_f32_16x16x32_bf16 v[76:79], v[180:183], a[52:55], v[76:79]
  s_waitcnt vmcnt(12)
  s_nop 0
  v_mfma_f32_16x16x32_bf16 v[80:83], v[200:203], a[64:67], v[80:83]
  buffer_load_dwordx4 v[144:147], v9, s[8:11], s42 offen offset:0 sc1
  v_mfma_f32_16x16x32_bf16 v[80:83], v[216:219], a[80:83], v[80:83]
  v_mfma_f32_16x16x32_bf16 v[84:87], v[204:207], a[64:67], v[84:87]
  v_mfma_f32_16x16x32_bf16 v[84:87], v[220:223], a[80:83], v[84:87]
  v_mfma_f32_16x16x32_bf16 v[88:91], v[200:203], a[68:71], v[88:91]
  buffer_load_dwordx4 v[148:151], v9, s[8:11], s42 offen offset:1024 sc1
  v_mfma_f32_16x16x32_bf16 v[88:91], v[216:219], a[84:87], v[88:91]
  v_mfma_f32_16x16x32_bf16 v[92:95], v[204:207], a[68:71], v[92:95]
  v_mfma_f32_16x16x32_bf16 v[92:95], v[220:223], a[84:87], v[92:95]
  v_mfma_f32_16x16x32_bf16 v[96:99], v[192:195], a[72:75], v[96:99]
  buffer_load_dwordx4 v[152:155], v10, s[8:11], s42 offen offset:0 sc1
  v_mfma_f32_16x16x32_bf16 v[96:99], v[208:211], a[88:91], v[96:99]
  v_mfma_f32_16x16x32_bf16 v[100:103], v[196:199], a[72:75], v[100:103]
  v_mfma_f32_16x16x32_bf16 v[100:103], v[212:215], a[88:91], v[100:103]
  v_mfma_f32_16x16x32_bf16 v[104:107], v[192:195], a[76:79], v[104:107]
  buffer_load_dwordx4 v[156:159], v10, s[8:11], s42 offen offset:1024 sc1
  s_add_u32 s42, s42, 28672
  v_mfma_f32_16x16x32_bf16 v[104:107], v[208:211], a[92:95], v[104:107]
  v_mfma_f32_16x16x32_bf16 v[108:111], v[196:199], a[76:79], v[108:111]
  v_mfma_f32_16x16x32_bf16 v[108:111], v[212:215], a[92:95], v[108:111]
  v_mfma_f32_16x16x32_bf16 v[112:115], v[200:203], a[72:75], v[112:115]
  buffer_load_dwordx4 v[160:163], v9, s[8:11], s42 offen offset:0 sc1
  v_mfma_f32_16x16x32_bf16 v[112:115], v[216:219], a[88:91], v[112:115]
  v_mfma_f32_16x16x32_bf16 v[116:119], v[204:207], a[72:75], v[116:119]
  v_mfma_f32_16x16x32_bf16 v[116:119], v[220:223], a[88:91], v[116:119]
  v_mfma_f32_16x16x32_bf16 v[120:123], v[200:203], a[76:79], v[120:123]
  buffer_load_dwordx4 v[164:167], v9, s[8:11], s42 offen offset:1024 sc1
  v_mfma_f32_16x16x32_bf16 v[120:123], v[216:219], a[92:95], v[120:123]
  v_mfma_f32_16x16x32_bf16 v[124:127], v[204:207], a[76:79], v[124:127]
  v_mfma_f32_16x16x32_bf16 v[124:127], v[220:223], a[92:95], v[124:127]
  v_mfma_f32_16x16x32_bf16 v[64:67], v[192:195], a[64:67], v[64:67]
  buffer_load_dwordx4 v[168:171], v10, s[8:11], s42 offen offset:0 sc1
  v_mfma_f32_16x16x32_bf16 v[64:67], v[208:211], a[80:83], v[64:67]
  v_mfma_f32_16x16x32_bf16 v[68:71], v[196:199], a[64:67], v[68:71]
  v_mfma_f32_16x16x32_bf16 v[68:71], v[212:215], a[80:83], v[68:71]
  v_mfma_f32_16x16x32_bf16 v[72:75], v[192:195], a[68:71], v[72:75]
  buffer_load_dwordx4 v[172:175], v10, s[8:11], s42 offen offset:1024 sc1
  s_add_u32 s42, s42, 28672
  v_mfma_f32_16x16x32_bf16 v[72:75], v[208:211], a[84:87], v[72:75]
  v_mfma_f32_16x16x32_bf16 v[76:79], v[196:199], a[68:71], v[76:79]
  v_mfma_f32_16x16x32_bf16 v[76:79], v[212:215], a[84:87], v[76:79]
  s_waitcnt vmcnt(12)
  s_waitcnt lgkmcnt(0)
  v_mfma_f32_16x16x32_bf16 v[80:83], v[232:235], a[96:99], v[80:83]
  buffer_load_dwordx4 v[176:179], v9, s[8:11], s42 offen offset:0 sc1
  v_mfma_f32_16x16x32_bf16 v[80:83], v[248:251], a[112:115], v[80:83]
  v_mfma_f32_16x16x32_bf16 v[84:87], v[236:239], a[96:99], v[84:87]
  v_mfma_f32_16x16x32_bf16 v[84:87], v[252:255], a[112:115], v[84:87]
  v_mfma_f32_16x16x32_bf16 v[88:91], v[232:235], a[100:103], v[88:91]
  buffer_load_dwordx4 v[180:183], v9, s[8:11], s42 offen offset:1024 sc1
  s_lshl_b32 s5, s44, 13
  v_mfma_f32_16x16x32_bf16 v[88:91], v[248:251], a[116:119], v[88:91]
  s_nop 0
  s_add_u32 s5, s5, 131072
  v_mfma_f32_16x16x32_bf16 v[92:95], v[236:239], a[100:103], v[92:95]
  v_add_u32_e64 v20, s5, v0
  v_mfma_f32_16x16x32_bf16 v[92:95], v[252:255], a[116:119], v[92:95]
  s_add_u32 s5, s64, 28672
  v_mfma_f32_16x16x32_bf16 v[96:99], v[224:227], a[104:107], v[96:99]
  buffer_load_dwordx4 v[184:187], v10, s[8:11], s42 offen offset:0 sc1
  v_add_u32_e64 v21, s5, v0
  v_mfma_f32_16x16x32_bf16 v[96:99], v[240:243], a[120:123], v[96:99]
  v_xor_b32 v22, 0x2000, v20
  v_mfma_f32_16x16x32_bf16 v[100:103], v[228:231], a[104:107], v[100:103]
  v_xor_b32 v23, 0x4000, v20
  v_mfma_f32_16x16x32_bf16 v[100:103], v[244:247], a[120:123], v[100:103]
  v_xor_b32 v24, 0x18000, v21
  v_mfma_f32_16x16x32_bf16 v[104:107], v[224:227], a[108:111], v[104:107]
  buffer_load_dwordx4 v[188:191], v10, s[8:11], s42 offen offset:1024 sc1
  s_add_u32 s42, s42, 28672
  v_mfma_f32_16x16x32_bf16 v[104:107], v[240:243], a[124:127], v[104:107]
  v_mfma_f32_16x16x32_bf16 v[108:111], v[228:231], a[108:111], v[108:111]
  v_mfma_f32_16x16x32_bf16 v[108:111], v[244:247], a[124:127], v[108:111]
  v_mfma_f32_16x16x32_bf16 v[112:115], v[232:235], a[104:107], v[112:115]
  buffer_load_dwordx4 v[192:195], v9, s[8:11], s42 offen offset:0 sc1
  v_mfma_f32_16x16x32_bf16 v[112:115], v[248:251], a[120:123], v[112:115]
  v_mfma_f32_16x16x32_bf16 v[116:119], v[236:239], a[104:107], v[116:119]
  v_mfma_f32_16x16x32_bf16 v[116:119], v[252:255], a[120:123], v[116:119]
  v_mfma_f32_16x16x32_bf16 v[120:123], v[232:235], a[108:111], v[120:123]
  buffer_load_dwordx4 v[196:199], v9, s[8:11], s42 offen offset:1024 sc1
  v_mfma_f32_16x16x32_bf16 v[120:123], v[248:251], a[124:127], v[120:123]
  v_mfma_f32_16x16x32_bf16 v[124:127], v[236:239], a[108:111], v[124:127]
  v_mfma_f32_16x16x32_bf16 v[124:127], v[252:255], a[124:127], v[124:127]
  v_mfma_f32_16x16x32_bf16 v[64:67], v[224:227], a[96:99], v[64:67]
  buffer_load_dwordx4 v[200:203], v10, s[8:11], s42 offen offset:0 sc1
  v_mfma_f32_16x16x32_bf16 v[64:67], v[240:243], a[112:115], v[64:67]
  v_mfma_f32_16x16x32_bf16 v[68:71], v[228:231], a[96:99], v[68:71]
  v_mfma_f32_16x16x32_bf16 v[68:71], v[244:247], a[112:115], v[68:71]
  v_mfma_f32_16x16x32_bf16 v[72:75], v[224:227], a[100:103], v[72:75]
  buffer_load_dwordx4 v[204:207], v10, s[8:11], s42 offen offset:1024 sc1
  s_add_u32 s42, s42, 28672
  v_mfma_f32_16x16x32_bf16 v[72:75], v[240:243], a[116:119], v[72:75]
  v_mfma_f32_16x16x32_bf16 v[76:79], v[228:231], a[100:103], v[76:79]
  v_mfma_f32_16x16x32_bf16 v[76:79], v[244:247], a[116:119], v[76:79]
  s_waitcnt vmcnt(12)
  s_nop 0
  v_mfma_f32_16x16x32_bf16 v[80:83], v[136:139], a[128:131], v[80:83]
  buffer_load_dwordx4 v[208:211], v9, s[8:11], s42 offen offset:0 sc1
  v_mfma_f32_16x16x32_bf16 v[80:83], v[152:155], a[144:147], v[80:83]
  v_mfma_f32_16x16x32_bf16 v[84:87], v[140:143], a[128:131], v[84:87]
  v_mfma_f32_16x16x32_bf16 v[84:87], v[156:159], a[144:147], v[84:87]
  v_mfma_f32_16x16x32_bf16 v[88:91], v[136:139], a[132:135], v[88:91]
  buffer_load_dwordx4 v[212:215], v9, s[8:11], s42 offen offset:1024 sc1
  v_mfma_f32_16x16x32_bf16 v[88:91], v[152:155], a[148:151], v[88:91]
  v_mfma_f32_16x16x32_bf16 v[92:95], v[140:143], a[132:135], v[92:95]
  v_mfma_f32_16x16x32_bf16 v[92:95], v[156:159], a[148:151], v[92:95]
  v_mfma_f32_16x16x32_bf16 v[96:99], v[128:131], a[136:139], v[96:99]
  buffer_load_dwordx4 v[216:219], v10, s[8:11], s42 offen offset:0 sc1
  v_mfma_f32_16x16x32_bf16 v[96:99], v[144:147], a[152:155], v[96:99]
  v_mfma_f32_16x16x32_bf16 v[100:103], v[132:135], a[136:139], v[100:103]
  v_mfma_f32_16x16x32_bf16 v[100:103], v[148:151], a[152:155], v[100:103]
  v_mfma_f32_16x16x32_bf16 v[104:107], v[128:131], a[140:143], v[104:107]
  buffer_load_dwordx4 v[220:223], v10, s[8:11], s42 offen offset:1024 sc1
  s_add_u32 s42, s42, 28672
  v_mfma_f32_16x16x32_bf16 v[104:107], v[144:147], a[156:159], v[104:107]
  v_mfma_f32_16x16x32_bf16 v[108:111], v[132:135], a[140:143], v[108:111]
  v_mfma_f32_16x16x32_bf16 v[108:111], v[148:151], a[156:159], v[108:111]
  v_mfma_f32_16x16x32_bf16 v[112:115], v[136:139], a[136:139], v[112:115]
  buffer_load_dwordx4 v[36:39], v9, s[8:11], s22 offen offset:0 sc1
  v_mfma_f32_16x16x32_bf16 v[112:115], v[152:155], a[152:155], v[112:115]
  v_mfma_f32_16x16x32_bf16 v[116:119], v[140:143], a[136:139], v[116:119]
  v_mfma_f32_16x16x32_bf16 v[116:119], v[156:159], a[152:155], v[116:119]
  v_mfma_f32_16x16x32_bf16 v[120:123], v[136:139], a[140:143], v[120:123]
  buffer_load_dwordx4 v[40:43], v9, s[8:11], s22 offen offset:1024 sc1
  v_mfma_f32_16x16x32_bf16 v[120:123], v[152:155], a[156:159], v[120:123]
  v_mfma_f32_16x16x32_bf16 v[124:127], v[140:143], a[140:143], v[124:127]
  v_mfma_f32_16x16x32_bf16 v[124:127], v[156:159], a[156:159], v[124:127]
  v_mfma_f32_16x16x32_bf16 v[64:67], v[128:131], a[128:131], v[64:67]
  buffer_load_dwordx4 v[44:47], v9, s[8:11], s23 offen offset:0 sc1
  v_mfma_f32_16x16x32_bf16 v[64:67], v[144:147], a[144:147], v[64:67]
  v_mfma_f32_16x16x32_bf16 v[68:71], v[132:135], a[128:131], v[68:71]
  v_mfma_f32_16x16x32_bf16 v[68:71], v[148:151], a[144:147], v[68:71]
  v_mfma_f32_16x16x32_bf16 v[72:75], v[128:131], a[132:135], v[72:75]
  buffer_load_dwordx4 v[48:51], v9, s[8:11], s23 offen offset:1024 sc1
  v_mfma_f32_16x16x32_bf16 v[72:75], v[144:147], a[148:151], v[72:75]
  v_mfma_f32_16x16x32_bf16 v[76:79], v[132:135], a[132:135], v[76:79]
  v_mfma_f32_16x16x32_bf16 v[76:79], v[148:151], a[148:151], v[76:79]
  s_waitcnt vmcnt(12)
  s_nop 0
  v_mfma_f32_16x16x32_bf16 v[80:83], v[168:171], a[160:163], v[80:83]
  v_mfma_f32_16x16x32_bf16 v[80:83], v[184:187], a[176:179], v[80:83]
  v_mfma_f32_16x16x32_bf16 v[84:87], v[172:175], a[160:163], v[84:87]
  v_mfma_f32_16x16x32_bf16 v[84:87], v[188:191], a[176:179], v[84:87]
  v_mfma_f32_16x16x32_bf16 v[88:91], v[168:171], a[164:167], v[88:91]
  v_mfma_f32_16x16x32_bf16 v[88:91], v[184:187], a[180:183], v[88:91]
  v_mfma_f32_16x16x32_bf16 v[92:95], v[172:175], a[164:167], v[92:95]
  v_mfma_f32_16x16x32_bf16 v[92:95], v[188:191], a[180:183], v[92:95]
  v_mfma_f32_16x16x32_bf16 v[96:99], v[160:163], a[168:171], v[96:99]
  v_mfma_f32_16x16x32_bf16 v[96:99], v[176:179], a[184:187], v[96:99]
  v_mfma_f32_16x16x32_bf16 v[100:103], v[164:167], a[168:171], v[100:103]
  v_mfma_f32_16x16x32_bf16 v[100:103], v[180:183], a[184:187], v[100:103]
  v_mfma_f32_16x16x32_bf16 v[104:107], v[160:163], a[172:175], v[104:107]
  v_mfma_f32_16x16x32_bf16 v[104:107], v[176:179], a[188:191], v[104:107]
  v_mfma_f32_16x16x32_bf16 v[108:111], v[164:167], a[172:175], v[108:111]
  v_mfma_f32_16x16x32_bf16 v[108:111], v[180:183], a[188:191], v[108:111]
  v_mfma_f32_16x16x32_bf16 v[112:115], v[168:171], a[168:171], v[112:115]
  v_mfma_f32_16x16x32_bf16 v[112:115], v[184:187], a[184:187], v[112:115]
  v_mfma_f32_16x16x32_bf16 v[116:119], v[172:175], a[168:171], v[116:119]
  v_mfma_f32_16x16x32_bf16 v[116:119], v[188:191], a[184:187], v[116:119]
  v_mfma_f32_16x16x32_bf16 v[120:123], v[168:171], a[172:175], v[120:123]
  v_mfma_f32_16x16x32_bf16 v[120:123], v[184:187], a[188:191], v[120:123]
  v_mfma_f32_16x16x32_bf16 v[124:127], v[172:175], a[172:175], v[124:127]
  v_mfma_f32_16x16x32_bf16 v[124:127], v[188:191], a[188:191], v[124:127]
  v_mfma_f32_16x16x32_bf16 v[64:67], v[160:163], a[160:163], v[64:67]
  v_mfma_f32_16x16x32_bf16 v[64:67], v[176:179], a[176:179], v[64:67]
  v_mfma_f32_16x16x32_bf16 v[68:71], v[164:167], a[160:163], v[68:71]
  v_mfma_f32_16x16x32_bf16 v[68:71], v[180:183], a[176:179], v[68:71]
  v_mfma_f32_16x16x32_bf16 v[72:75], v[160:163], a[164:167], v[72:75]
  v_mfma_f32_16x16x32_bf16 v[72:75], v[176:179], a[180:183], v[72:75]
  v_mfma_f32_16x16x32_bf16 v[76:79], v[164:167], a[164:167], v[76:79]
  v_mfma_f32_16x16x32_bf16 v[76:79], v[180:183], a[180:183], v[76:79]
  s_waitcnt vmcnt(8)
  s_nop 0
  v_mfma_f32_16x16x32_bf16 v[80:83], v[200:203], a[192:195], v[80:83]
  v_mfma_f32_16x16x32_bf16 v[84:87], v[204:207], a[192:195], v[84:87]
  v_mfma_f32_16x16x32_bf16 v[88:91], v[200:203], a[196:199], v[88:91]
  v_mfma_f32_16x16x32_bf16 v[92:95], v[204:207], a[196:199], v[92:95]
  v_mfma_f32_16x16x32_bf16 v[96:99], v[192:195], a[200:203], v[96:99]
  v_mfma_f32_16x16x32_bf16 v[100:103], v[196:199], a[200:203], v[100:103]
  v_mfma_f32_16x16x32_bf16 v[104:107], v[192:195], a[204:207], v[104:107]
  v_mfma_f32_16x16x32_bf16 v[108:111], v[196:199], a[204:207], v[108:111]
  v_mfma_f32_16x16x32_bf16 v[112:115], v[200:203], a[200:203], v[112:115]
  v_mfma_f32_16x16x32_bf16 v[116:119], v[204:207], a[200:203], v[116:119]
  v_mfma_f32_16x16x32_bf16 v[120:123], v[200:203], a[204:207], v[120:123]
  v_mfma_f32_16x16x32_bf16 v[124:127], v[204:207], a[204:207], v[124:127]
  v_mfma_f32_16x16x32_bf16 v[64:67], v[192:195], a[192:195], v[64:67]
  v_mfma_f32_16x16x32_bf16 v[68:71], v[196:199], a[192:195], v[68:71]
  v_mfma_f32_16x16x32_bf16 v[72:75], v[192:195], a[196:199], v[72:75]
  v_mfma_f32_16x16x32_bf16 v[76:79], v[196:199], a[196:199], v[76:79]
  s_waitcnt vmcnt(4)
  s_nop 0
  v_mfma_f32_16x16x32_bf16 v[80:83], v[216:219], a[208:211], v[80:83]
  v_mfma_f32_16x16x32_bf16 v[84:87], v[220:223], a[208:211], v[84:87]
  v_mfma_f32_16x16x32_bf16 v[88:91], v[216:219], a[212:215], v[88:91]
  v_mfma_f32_16x16x32_bf16 v[92:95], v[220:223], a[212:215], v[92:95]
  v_mfma_f32_16x16x32_bf16 v[96:99], v[208:211], a[216:219], v[96:99]
  v_mfma_f32_16x16x32_bf16 v[100:103], v[212:215], a[216:219], v[100:103]
  v_mfma_f32_16x16x32_bf16 v[104:107], v[208:211], a[220:223], v[104:107]
  v_mfma_f32_16x16x32_bf16 v[108:111], v[212:215], a[220:223], v[108:111]
  v_mfma_f32_16x16x32_bf16 v[112:115], v[216:219], a[216:219], v[112:115]
  ds_write_b128 v20, v[80:83] offset:0
  v_mfma_f32_16x16x32_bf16 v[116:119], v[220:223], a[216:219], v[116:119]
  ds_write_b128 v20, v[84:87] offset:1024
  v_mfma_f32_16x16x32_bf16 v[120:123], v[216:219], a[220:223], v[120:123]
  ds_write_b128 v20, v[88:91] offset:2048
  v_mfma_f32_16x16x32_bf16 v[124:127], v[220:223], a[220:223], v[124:127]
  ds_write_b128 v20, v[92:95] offset:3072
  v_mfma_f32_16x16x32_bf16 v[64:67], v[208:211], a[208:211], v[64:67]
  ds_write_b128 v20, v[96:99] offset:4096
  v_mfma_f32_16x16x32_bf16 v[68:71], v[212:215], a[208:211], v[68:71]
  ds_write_b128 v20, v[100:103] offset:5120
  v_mfma_f32_16x16x32_bf16 v[72:75], v[208:211], a[212:215], v[72:75]
  ds_write_b128 v20, v[104:107] offset:6144
  v_mfma_f32_16x16x32_bf16 v[76:79], v[212:215], a[212:215], v[76:79]
  ds_write_b128 v20, v[108:111] offset:7168
  ds_write_b128 v21, v[112:115] offset:0
  ds_write_b128 v21, v[116:119] offset:1024
  ds_write_b128 v21, v[120:123] offset:2048
  ds_write_b128 v21, v[124:127] offset:3072
  s_waitcnt vmcnt(0)
  v_mfma_f32_16x16x32_bf16 v[64:67], v[36:39], v[32:35], v[64:67]
  s_nop 0
  v_mfma_f32_16x16x32_bf16 v[68:71], v[40:43], v[32:35], v[68:71]
  v_mfma_f32_16x16x32_bf16 v[72:75], v[44:47], v[32:35], v[72:75]
  v_mfma_f32_16x16x32_bf16 v[76:79], v[48:51], v[32:35], v[76:79]
  s_waitcnt lgkmcnt(0)
  s_barrier
  ds_read_b128 v[80:83], v22 offset:0
  ds_read_b128 v[84:87], v22 offset:1024
  ds_read_b128 v[88:91], v22 offset:2048
  ds_read_b128 v[92:95], v22 offset:3072
  ds_read_b128 v[96:99], v23 offset:4096
  ds_read_b128 v[100:103], v23 offset:5120
  ds_read_b128 v[104:107], v23 offset:6144
  ds_read_b128 v[108:111], v23 offset:7168
  ds_read_b128 v[112:115], v24 offset:0
  ds_read_b128 v[116:119], v24 offset:1024
  ds_read_b128 v[120:123], v24 offset:2048
  ds_read_b128 v[124:127], v24 offset:3072
  s_waitcnt lgkmcnt(8)
  v_pk_add_f32 v[64:65], v[64:65], v[80:81]
  v_pk_add_f32 v[66:67], v[66:67], v[82:83]
  v_pk_add_f32 v[68:69], v[68:69], v[84:85]
  v_pk_add_f32 v[70:71], v[70:71], v[86:87]
  v_pk_add_f32 v[72:73], v[72:73], v[88:89]
  v_pk_add_f32 v[74:75], v[74:75], v[90:91]
  v_pk_add_f32 v[76:77], v[76:77], v[92:93]
  v_pk_add_f32 v[78:79], v[78:79], v[94:95]
  s_waitcnt lgkmcnt(4)
  v_pk_add_f32 v[64:65], v[64:65], v[96:97]
  v_pk_add_f32 v[66:67], v[66:67], v[98:99]
  v_pk_add_f32 v[68:69], v[68:69], v[100:101]
  v_pk_add_f32 v[70:71], v[70:71], v[102:103]
  v_pk_add_f32 v[72:73], v[72:73], v[104:105]
  v_pk_add_f32 v[74:75], v[74:75], v[106:107]
  v_pk_add_f32 v[76:77], v[76:77], v[108:109]
  v_pk_add_f32 v[78:79], v[78:79], v[110:111]
  s_waitcnt lgkmcnt(0)
  v_pk_add_f32 v[64:65], v[64:65], v[112:113]
  v_pk_add_f32 v[66:67], v[66:67], v[114:115]
  v_pk_add_f32 v[68:69], v[68:69], v[116:117]
  v_pk_add_f32 v[70:71], v[70:71], v[118:119]
  v_pk_add_f32 v[72:73], v[72:73], v[120:121]
  v_pk_add_f32 v[74:75], v[74:75], v[122:123]
  v_pk_add_f32 v[76:77], v[76:77], v[124:125]
  v_pk_add_f32 v[78:79], v[78:79], v[126:127]
  v_add_f32 v64, v64, v28
  v_add_f32 v65, v65, v28
  v_add_f32 v66, v66, v28
  v_add_f32 v67, v67, v28
  v_add_f32 v68, v68, v28
  v_add_f32 v69, v69, v28
  v_add_f32 v70, v70, v28
  v_add_f32_e64 v71, v71, v28
  v_cvt_pk_bf16_f32 v64, v64, v65
  v_cvt_pk_bf16_f32 v65, v66, v67
  v_cvt_pk_bf16_f32 v66, v68, v69
  v_cvt_pk_bf16_f32 v67, v70, v71
  buffer_store_dwordx4 v[64:67], v30, s[52:55], s20 offen sc1
  v_add_f32 v72, v72, v29
  v_add_f32 v73, v73, v29
  v_add_f32 v74, v74, v29
  v_add_f32 v75, v75, v29
  v_add_f32 v76, v76, v29
  v_add_f32 v77, v77, v29
  v_add_f32 v78, v78, v29
  v_add_f32 v79, v79, v29
  v_cvt_pk_bf16_f32 v72, v72, v73
  v_cvt_pk_bf16_f32 v73, v74, v75
  v_cvt_pk_bf16_f32 v74, v76, v77
  v_cvt_pk_bf16_f32 v75, v78, v79
  buffer_store_dwordx4 v[72:75], v30, s[52:55], s21 offen sc1
L_k6_end:
L_k2_end:
  s_endpgm
L_k6_p0s:
  s_mov_b32 s43, 0
L_k6_p0:
  s_mov_b64 exec, vcc
  buffer_load_dword v23, v22, s[8:11], s6 offen sc0 sc1
  s_add_u32 s43, s43, 1
  s_cmp_ge_u32 s43, 0x40000
  s_waitcnt vmcnt(0)
  s_cbranch_scc1 L_k6_p0e
  v_cmp_ne_u32 vcc, 1, v23
  s_nop 0
  s_cbranch_vccnz L_k6_p0
L_k6_p0e:
  s_mov_b64 exec, -1
  s_branch L_k6_p0x
L_k6_p1s:
  s_mov_b32 s43, 0
L_k6_p1:
  s_mov_b64 exec, vcc
  buffer_load_dword v23, v22, s[8:11], s6 offen sc0 sc1
  s_add_u32 s43, s43, 1
  s_cmp_ge_u32 s43, 0x40000
  s_waitcnt vmcnt(0)
  s_cbranch_scc1 L_k6_p1e
  v_cmp_ne_u32 vcc, 1, v23
  s_nop 0
  s_cbranch_vccnz L_k6_p1
L_k6_p1e:
  s_mov_b64 exec, -1
  s_branch L_k6_p1x
L_k6_p2s:
  s_mov_b32 s43, 0
L_k6_p2:
  s_mov_b64 exec, vcc
  buffer_load_dword v23, v22, s[8:11], s6 offen sc0 sc1
  s_add_u32 s43, s43, 1
  s_cmp_ge_u32 s43, 0x40000
  s_waitcnt vmcnt(0)
  s_cbranch_scc1 L_k6_p2e
  v_cmp_ne_u32 vcc, 1, v23
  s_nop 0
  s_cbranch_vccnz L_k6_p2
L_k6_p2e:
  s_mov_b64 exec, -1
  s_branch L_k6_p2x
L_k2_codeend:
L_k2_fix0:
  s_nop 7
  v_max3_f32 v24, v32, v33, v34
  v_max3_f32 v26, v48, v49, v50
  v_max3_f32 v24, v24, v35, v36
  v_max3_f32 v26, v26, v51, v52
  v_max3_f32 v24, v24, v37, v38
  v_max3_f32 v26, v26, v53, v54
  v_max3_f32 v24, v24, v39, v40
  v_max3_f32 v26, v26, v55, v56
  v_max3_f32 v24, v24, v41, v42
  v_max3_f32 v26, v26, v57, v58
  v_max3_f32 v24, v24, v43, v44
  v_max3_f32 v26, v26, v59, v60
  v_max3_f32 v24, v24, v45, v46
  v_max3_f32 v26, v26, v61, v62
  v_max_f32 v24, v24, v47
  v_max_f32 v26, v26, v63
  v_mov_b32 v25, v24
  v_mov_b32 v27, v26
  s_nop 0
  v_permlane16_swap_b32 v24, v25
  v_permlane16_swap_b32 v26, v27
  v_max_f32 v24, v24, v25
  v_max_f32 v26, v26, v27
  v_mov_b32 v25, v24
  v_mov_b32 v27, v26
  s_nop 0
  v_permlane32_swap_b32 v24, v25
  v_permlane32_swap_b32 v26, v27
  v_max_f32 v24, v24, v25
  v_max_f32 v26, v26, v27
  v_sub_f32 v24, 0xc1800000, v24
  v_sub_f32 v26, 0xc1800000, v26
  v_min_f32 v24, 0, v24
  v_min_f32 v26, 0, v26
  v_mov_b32 v25, v24
  v_mov_b32 v27, v26
  v_add_f32 v6, v6, v24
  v_add_f32 v7, v7, v26
  v_pk_add_f32 v[16:17], v[32:33], v[24:25]
  v_pk_add_f32 v[18:19], v[34:35], v[24:25]
  v_pk_add_f32 v[20:21], v[36:37], v[24:25]
  v_pk_add_f32 v[22:23], v[38:39], v[24:25]
  v_exp_f32 v16, v16
  v_exp_f32 v17, v17
  v_exp_f32 v18, v18
  v_exp_f32 v19, v19
  v_exp_f32 v20, v20
  v_exp_f32 v21, v21
  v_exp_f32 v22, v22
  v_exp_f32 v23, v23
  v_cvt_pk_bf16_f32 v96, v16, v17
  v_cvt_pk_bf16_f32 v97, v18, v19
  v_cvt_pk_bf16_f32 v98, v20, v21
  v_cvt_pk_bf16_f32 v99, v22, v23
  v_pk_add_f32 v[16:17], v[40:41], v[24:25]
  v_pk_add_f32 v[18:19], v[42:43], v[24:25]
  v_pk_add_f32 v[20:21], v[44:45], v[24:25]
  v_pk_add_f32 v[22:23], v[46:47], v[24:25]
  v_exp_f32 v16, v16
  v_exp_f32 v17, v17
  v_exp_f32 v18, v18
  v_exp_f32 v19, v19
  v_exp_f32 v20, v20
  v_exp_f32 v21, v21
  v_exp_f32 v22, v22
  v_exp_f32 v23, v23
  v_cvt_pk_bf16_f32 v100, v16, v17
  v_cvt_pk_bf16_f32 v101, v18, v19
  v_cvt_pk_bf16_f32 v102, v20, v21
  v_cvt_pk_bf16_f32 v103, v22, v23
  v_pk_add_f32 v[16:17], v[48:49], v[26:27]
  v_pk_add_f32 v[18:19], v[50:51], v[26:27]
  v_pk_add_f32 v[20:21], v[52:53], v[26:27]
  v_pk_add_f32 v[22:23], v[54:55], v[26:27]
  v_exp_f32 v16, v16
  v_exp_f32 v17, v17
  v_exp_f32 v18, v18
  v_exp_f32 v19, v19
  v_exp_f32 v20, v20
  v_exp_f32 v21, v21
  v_exp_f32 v22, v22
  v_exp_f32 v23, v23
  v_cvt_pk_bf16_f32 v104, v16, v17
  v_cvt_pk_bf16_f32 v105, v18, v19
  v_cvt_pk_bf16_f32 v106, v20, v21
  v_cvt_pk_bf16_f32 v107, v22, v23
  v_pk_add_f32 v[16:17], v[56:57], v[26:27]
  v_pk_add_f32 v[18:19], v[58:59], v[26:27]
  v_pk_add_f32 v[20:21], v[60:61], v[26:27]
  v_pk_add_f32 v[22:23], v[62:63], v[26:27]
  v_exp_f32 v16, v16
  v_exp_f32 v17, v17
  v_exp_f32 v18, v18
  v_exp_f32 v19, v19
  v_exp_f32 v20, v20
  v_exp_f32 v21, v21
  v_exp_f32 v22, v22
  v_exp_f32 v23, v23
  v_cvt_pk_bf16_f32 v108, v16, v17
  v_cvt_pk_bf16_f32 v109, v18, v19
  v_cvt_pk_bf16_f32 v110, v20, v21
  v_cvt_pk_bf16_f32 v111, v22, v23
  v_mov_b32 v64, v6
  v_mov_b32 v65, v6
  v_mov_b32 v66, v6
  v_mov_b32 v67, v6
  v_mov_b32 v68, v6
  v_mov_b32 v69, v6
  v_mov_b32 v70, v6
  v_mov_b32 v71, v6
  v_mov_b32 v72, v6
  v_mov_b32 v73, v6
  v_mov_b32 v74, v6
  v_mov_b32 v75, v6
  v_mov_b32 v76, v6
  v_mov_b32 v77, v6
  v_mov_b32 v78, v6
  v_mov_b32 v79, v6
  v_mov_b32 v80, v7
  v_mov_b32 v81, v7
  v_mov_b32 v82, v7
  v_mov_b32 v83, v7
  v_mov_b32 v84, v7
  v_mov_b32 v85, v7
  v_mov_b32 v86, v7
  v_mov_b32 v87, v7
  v_mov_b32 v88, v7
  v_mov_b32 v89, v7
  v_mov_b32 v90, v7
  v_mov_b32 v91, v7
  v_mov_b32 v92, v7
  v_mov_b32 v93, v7
  v_mov_b32 v94, v7
  v_mov_b32 v95, v7
  v_exp_f32 v24, v24
  v_exp_f32 v26, v26
  v_accvgpr_read_b32 v16, a192
  v_accvgpr_read_b32 v17, a193
  v_accvgpr_read_b32 v18, a194
  v_accvgpr_read_b32 v19, a195
  v_mul_f32 v16, v16, v24
  v_mul_f32 v17, v17, v24
  v_mul_f32 v18, v18, v24
  v_mul_f32 v19, v19, v24
  v_accvgpr_write_b32 a192, v16
  v_accvgpr_write_b32 a193, v17
  v_accvgpr_write_b32 a194, v18
  v_accvgpr_write_b32 a195, v19
  v_mul_f32 v128, v128, v24
  v_mul_f32 v129, v129, v24
  v_mul_f32 v130, v130, v24
  v_mul_f32 v131, v131, v24
  v_mul_f32 v132, v132, v24
  v_mul_f32 v133, v133, v24
  v_mul_f32 v134, v134, v24
  v_mul_f32 v135, v135, v24
  v_mul_f32 v136, v136, v24
  v_mul_f32 v137, v137, v24
  v_mul_f32 v138, v138, v24
  v_mul_f32 v139, v139, v24
  v_mul_f32 v140, v140, v24
  v_mul_f32 v141, v141, v24
  v_mul_f32 v142, v142, v24
  v_mul_f32 v143, v143, v24
  v_mul_f32 v144, v144, v24
  v_mul_f32 v145, v145, v24
  v_mul_f32 v146, v146, v24
  v_mul_f32 v147, v147, v24
  v_mul_f32 v148, v148, v24
  v_mul_f32 v149, v149, v24
  v_mul_f32 v150, v150, v24
  v_mul_f32 v151, v151, v24
  v_mul_f32 v152, v152, v24
  v_mul_f32 v153, v153, v24
  v_mul_f32 v154, v154, v24
  v_mul_f32 v155, v155, v24
  v_mul_f32 v156, v156, v24
  v_mul_f32 v157, v157, v24
  v_mul_f32 v158, v158, v24
  v_mul_f32 v159, v159, v24
  v_mul_f32 v160, v160, v24
  v_mul_f32 v161, v161, v24
  v_mul_f32 v162, v162, v24
  v_mul_f32 v163, v163, v24
  v_mul_f32 v164, v164, v24
  v_mul_f32 v165, v165, v24
  v_mul_f32 v166, v166, v24
  v_mul_f32 v167, v167, v24
  v_mul_f32 v168, v168, v24
  v_mul_f32 v169, v169, v24
  v_mul_f32 v170, v170, v24
  v_mul_f32 v171, v171, v24
  v_mul_f32 v172, v172, v24
  v_mul_f32 v173, v173, v24
  v_mul_f32 v174, v174, v24
  v_mul_f32 v175, v175, v24
  v_mul_f32 v176, v176, v24
  v_mul_f32 v177, v177, v24
  v_mul_f32 v178, v178, v24
  v_mul_f32 v179, v179, v24
  v_mul_f32 v180, v180, v24
  v_mul_f32 v181, v181, v24
  v_mul_f32 v182, v182, v24
  v_mul_f32 v183, v183, v24
  v_mul_f32 v184, v184, v24
  v_mul_f32 v185, v185, v24
  v_mul_f32 v186, v186, v24
  v_mul_f32 v187, v187, v24
  v_mul_f32 v188, v188, v24
  v_mul_f32 v189, v189, v24
  v_mul_f32 v190, v190, v24
  v_mul_f32 v191, v191, v24
  v_accvgpr_read_b32 v16, a196
  v_accvgpr_read_b32 v17, a197
  v_accvgpr_read_b32 v18, a198
  v_accvgpr_read_b32 v19, a199
  v_mul_f32 v16, v16, v26
  v_mul_f32 v17, v17, v26
  v_mul_f32 v18, v18, v26
  v_mul_f32 v19, v19, v26
  v_accvgpr_write_b32 a196, v16
  v_accvgpr_write_b32 a197, v17
  v_accvgpr_write_b32 a198, v18
  v_accvgpr_write_b32 a199, v19
  v_mul_f32 v192, v192, v26
  v_mul_f32 v193, v193, v26
  v_mul_f32 v194, v194, v26
  v_mul_f32 v195, v195, v26
  v_mul_f32 v196, v196, v26
  v_mul_f32 v197, v197, v26
  v_mul_f32 v198, v198, v26
  v_mul_f32 v199, v199, v26
  v_mul_f32 v200, v200, v26
  v_mul_f32 v201, v201, v26
  v_mul_f32 v202, v202, v26
  v_mul_f32 v203, v203, v26
  v_mul_f32 v204, v204, v26
  v_mul_f32 v205, v205, v26
  v_mul_f32 v206, v206, v26
  v_mul_f32 v207, v207, v26
  v_mul_f32 v208, v208, v26
  v_mul_f32 v209, v209, v26
  v_mul_f32 v210, v210, v26
  v_mul_f32 v211, v211, v26
  v_mul_f32 v212, v212, v26
  v_mul_f32 v213, v213, v26
  v_mul_f32 v214, v214, v26
  v_mul_f32 v215, v215, v26
  v_mul_f32 v216, v216, v26
  v_mul_f32 v217, v217, v26
  v_mul_f32 v218, v218, v26
  v_mul_f32 v219, v219, v26
  v_mul_f32 v220, v220, v26
  v_mul_f32 v221, v221, v26
  v_mul_f32 v222, v222, v26
  v_mul_f32 v223, v223, v26
  v_mul_f32 v224, v224, v26
  v_mul_f32 v225, v225, v26
  v_mul_f32 v226, v226, v26
  v_mul_f32 v227, v227, v26
  v_mul_f32 v228, v228, v26
  v_mul_f32 v229, v229, v26
  v_mul_f32 v230, v230, v26
  v_mul_f32 v231, v231, v26
  v_mul_f32 v232, v232, v26
  v_mul_f32 v233, v233, v26
  v_mul_f32 v234, v234, v26
  v_mul_f32 v235, v235, v26
  v_mul_f32 v236, v236, v26
  v_mul_f32 v237, v237, v26
  v_mul_f32 v238, v238, v26
  v_mul_f32 v239, v239, v26
  v_mul_f32 v240, v240, v26
  v_mul_f32 v241, v241, v26
  v_mul_f32 v242, v242, v26
  v_mul_f32 v243, v243, v26
  v_mul_f32 v244, v244, v26
  v_mul_f32 v245, v245, v26
  v_mul_f32 v246, v246, v26
  v_mul_f32 v247, v247, v26
  v_mul_f32 v248, v248, v26
  v_mul_f32 v249, v249, v26
  v_mul_f32 v250, v250, v26
  v_mul_f32 v251, v251, v26
  v_mul_f32 v252, v252, v26
  v_mul_f32 v253, v253, v26
  v_mul_f32 v254, v254, v26
  v_mul_f32 v255, v255, v26
  s_nop 1
  s_branch L_k2_fixret0
L_k2_fix1:
  s_nop 7
  v_max3_f32 v24, v32, v33, v34
  v_max3_f32 v26, v48, v49, v50
  v_max3_f32 v24, v24, v35, v36
  v_max3_f32 v26, v26, v51, v52
  v_max3_f32 v24, v24, v37, v38
  v_max3_f32 v26, v26, v53, v54
  v_max3_f32 v24, v24, v39, v40
  v_max3_f32 v26, v26, v55, v56
  v_max3_f32 v24, v24, v41, v42
  v_max3_f32 v26, v26, v57, v58
  v_max3_f32 v24, v24, v43, v44
  v_max3_f32 v26, v26, v59, v60
  v_max3_f32 v24, v24, v45, v46
  v_max3_f32 v26, v26, v61, v62
  v_max_f32 v24, v24, v47
  v_max_f32 v26, v26, v63
  v_mov_b32 v25, v24
  v_mov_b32 v27, v26
  s_nop 0
  v_permlane16_swap_b32 v24, v25
  v_permlane16_swap_b32 v26, v27
  v_max_f32 v24, v24, v25
  v_max_f32 v26, v26, v27
  v_mov_b32 v25, v24
  v_mov_b32 v27, v26
  s_nop 0
  v_permlane32_swap_b32 v24, v25
  v_permlane32_swap_b32 v26, v27
  v_max_f32 v24, v24, v25
  v_max_f32_e64 v26, v26, v27
  v_sub_f32 v24, 0xc1800000, v24
  v_sub_f32 v26, 0xc1800000, v26
  v_min_f32 v24, 0, v24
  v_min_f32 v26, 0, v26
  v_mov_b32 v25, v24
  v_mov_b32 v27, v26
  v_add_f32 v6, v6, v24
  v_add_f32 v7, v7, v26
  v_pk_add_f32 v[16:17], v[32:33], v[24:25]
  v_pk_add_f32 v[18:19], v[34:35], v[24:25]
  v_pk_add_f32 v[20:21], v[36:37], v[24:25]
  v_pk_add_f32 v[22:23], v[38:39], v[24:25]
  v_exp_f32 v16, v16
  v_exp_f32 v17, v17
  v_exp_f32 v18, v18
  v_exp_f32 v19, v19
  v_exp_f32 v20, v20
  v_exp_f32 v21, v21
  v_exp_f32 v22, v22
  v_exp_f32 v23, v23
  v_cvt_pk_bf16_f32 v112, v16, v17
  v_cvt_pk_bf16_f32 v113, v18, v19
  v_cvt_pk_bf16_f32 v114, v20, v21
  v_cvt_pk_bf16_f32 v115, v22, v23
  v_pk_add_f32 v[16:17], v[40:41], v[24:25]
  v_pk_add_f32 v[18:19], v[42:43], v[24:25]
  v_pk_add_f32 v[20:21], v[44:45], v[24:25]
  v_pk_add_f32 v[22:23], v[46:47], v[24:25]
  v_exp_f32 v16, v16
  v_exp_f32 v17, v17
  v_exp_f32 v18, v18
  v_exp_f32 v19, v19
  v_exp_f32 v20, v20
  v_exp_f32 v21, v21
  v_exp_f32 v22, v22
  v_exp_f32 v23, v23
  v_cvt_pk_bf16_f32 v116, v16, v17
  v_cvt_pk_bf16_f32 v117, v18, v19
  v_cvt_pk_bf16_f32 v118, v20, v21
  v_cvt_pk_bf16_f32 v119, v22, v23
  v_pk_add_f32 v[16:17], v[48:49], v[26:27]
  v_pk_add_f32 v[18:19], v[50:51], v[26:27]
  v_pk_add_f32 v[20:21], v[52:53], v[26:27]
  v_pk_add_f32 v[22:23], v[54:55], v[26:27]
  v_exp_f32 v16, v16
  v_exp_f32 v17, v17
  v_exp_f32 v18, v18
  v_exp_f32 v19, v19
  v_exp_f32 v20, v20
  v_exp_f32 v21, v21
  v_exp_f32 v22, v22
  v_exp_f32 v23, v23
  v_cvt_pk_bf16_f32 v120, v16, v17
  v_cvt_pk_bf16_f32 v121, v18, v19
  v_cvt_pk_bf16_f32 v122, v20, v21
  v_cvt_pk_bf16_f32 v123, v22, v23
  v_pk_add_f32 v[16:17], v[56:57], v[26:27]
  v_pk_add_f32 v[18:19], v[58:59], v[26:27]
  v_pk_add_f32 v[20:21], v[60:61], v[26:27]
  v_pk_add_f32 v[22:23], v[62:63], v[26:27]
  v_exp_f32 v16, v16
  v_exp_f32 v17, v17
  v_exp_f32 v18, v18
  v_exp_f32 v19, v19
  v_exp_f32 v20, v20
  v_exp_f32 v21, v21
  v_exp_f32 v22, v22
  v_exp_f32 v23, v23
  v_cvt_pk_bf16_f32 v124, v16, v17
  v_cvt_pk_bf16_f32 v125, v18, v19
  v_cvt_pk_bf16_f32 v126, v20, v21
  v_cvt_pk_bf16_f32 v127, v22, v23
  v_mov_b32 v64, v6
  v_mov_b32 v65, v6
  v_mov_b32 v66, v6
  v_mov_b32 v67, v6
  v_mov_b32 v68, v6
  v_mov_b32 v69, v6
  v_mov_b32 v70, v6
  v_mov_b32 v71, v6
  v_mov_b32 v72, v6
  v_mov_b32 v73, v6
  v_mov_b32 v74, v6
  v_mov_b32 v75, v6
  v_mov_b32 v76, v6
  v_mov_b32 v77, v6
  v_mov_b32 v78, v6
  v_mov_b32 v79, v6
  v_mov_b32 v80, v7
  v_mov_b32 v81, v7
  v_mov_b32 v82, v7
  v_mov_b32 v83, v7
  v_mov_b32 v84, v7
  v_mov_b32 v85, v7
  v_mov_b32 v86, v7
  v_mov_b32 v87, v7
  v_mov_b32 v88, v7
  v_mov_b32 v89, v7
  v_mov_b32 v90, v7
  v_mov_b32 v91, v7
  v_mov_b32 v92, v7
  v_mov_b32 v93, v7
  v_mov_b32 v94, v7
  v_mov_b32 v95, v7
  v_exp_f32 v24, v24
  v_exp_f32 v26, v26
  v_accvgpr_read_b32 v16, a192
  v_accvgpr_read_b32 v17, a193
  v_accvgpr_read_b32 v18, a194
  v_accvgpr_read_b32 v19, a195
  v_mul_f32 v16, v16, v24
  v_mul_f32 v17, v17, v24
  v_mul_f32 v18, v18, v24
  v_mul_f32 v19, v19, v24
  v_accvgpr_write_b32 a192, v16
  v_accvgpr_write_b32 a193, v17
  v_accvgpr_write_b32 a194, v18
  v_accvgpr_write_b32 a195, v19
  v_mul_f32 v128, v128, v24
  v_mul_f32 v129, v129, v24
  v_mul_f32 v130, v130, v24
  v_mul_f32 v131, v131, v24
  v_mul_f32 v132, v132, v24
  v_mul_f32 v133, v133, v24
  v_mul_f32 v134, v134, v24
  v_mul_f32 v135, v135, v24
  v_mul_f32 v136, v136, v24
  v_mul_f32 v137, v137, v24
  v_mul_f32 v138, v138, v24
  v_mul_f32 v139, v139, v24
  v_mul_f32 v140, v140, v24
  v_mul_f32 v141, v141, v24
  v_mul_f32 v142, v142, v24
  v_mul_f32 v143, v143, v24
  v_mul_f32 v144, v144, v24
  v_mul_f32 v145, v145, v24
  v_mul_f32 v146, v146, v24
  v_mul_f32 v147, v147, v24
  v_mul_f32 v148, v148, v24
  v_mul_f32 v149, v149, v24
  v_mul_f32 v150, v150, v24
  v_mul_f32 v151, v151, v24
  v_mul_f32 v152, v152, v24
  v_mul_f32 v153, v153, v24
  v_mul_f32 v154, v154, v24
  v_mul_f32 v155, v155, v24
  v_mul_f32 v156, v156, v24
  v_mul_f32 v157, v157, v24
  v_mul_f32 v158, v158, v24
  v_mul_f32 v159, v159, v24
  v_mul_f32 v160, v160, v24
  v_mul_f32 v161, v161, v24
  v_mul_f32 v162, v162, v24
  v_mul_f32 v163, v163, v24
  v_mul_f32 v164, v164, v24
  v_mul_f32 v165, v165, v24
  v_mul_f32 v166, v166, v24
  v_mul_f32 v167, v167, v24
  v_mul_f32 v168, v168, v24
  v_mul_f32 v169, v169, v24
  v_mul_f32 v170, v170, v24
  v_mul_f32 v171, v171, v24
  v_mul_f32 v172, v172, v24
  v_mul_f32 v173, v173, v24
  v_mul_f32 v174, v174, v24
  v_mul_f32 v175, v175, v24
  v_mul_f32 v176, v176, v24
  v_mul_f32 v177, v177, v24
  v_mul_f32 v178, v178, v24
  v_mul_f32 v179, v179, v24
  v_mul_f32 v180, v180, v24
  v_mul_f32 v181, v181, v24
  v_mul_f32 v182, v182, v24
  v_mul_f32 v183, v183, v24
  v_mul_f32 v184, v184, v24
  v_mul_f32 v185, v185, v24
  v_mul_f32 v186, v186, v24
  v_mul_f32 v187, v187, v24
  v_mul_f32 v188, v188, v24
  v_mul_f32 v189, v189, v24
  v_mul_f32 v190, v190, v24
  v_mul_f32 v191, v191, v24
  v_accvgpr_read_b32 v16, a196
  v_accvgpr_read_b32 v17, a197
  v_accvgpr_read_b32 v18, a198
  v_accvgpr_read_b32 v19, a199
  v_mul_f32 v16, v16, v26
  v_mul_f32 v17, v17, v26
  v_mul_f32 v18, v18, v26
  v_mul_f32 v19, v19, v26
  v_accvgpr_write_b32 a196, v16
  v_accvgpr_write_b32 a197, v17
  v_accvgpr_write_b32 a198, v18
  v_accvgpr_write_b32 a199, v19
  v_mul_f32 v192, v192, v26
  v_mul_f32 v193, v193, v26
  v_mul_f32 v194, v194, v26
  v_mul_f32 v195, v195, v26
  v_mul_f32 v196, v196, v26
  v_mul_f32 v197, v197, v26
  v_mul_f32 v198, v198, v26
  v_mul_f32 v199, v199, v26
  v_mul_f32 v200, v200, v26
  v_mul_f32 v201, v201, v26
  v_mul_f32 v202, v202, v26
  v_mul_f32 v203, v203, v26
  v_mul_f32 v204, v204, v26
  v_mul_f32 v205, v205, v26
  v_mul_f32 v206, v206, v26
  v_mul_f32 v207, v207, v26
  v_mul_f32 v208, v208, v26
  v_mul_f32 v209, v209, v26
  v_mul_f32 v210, v210, v26
  v_mul_f32 v211, v211, v26
  v_mul_f32 v212, v212, v26
  v_mul_f32 v213, v213, v26
  v_mul_f32 v214, v214, v26
  v_mul_f32 v215, v215, v26
  v_mul_f32 v216, v216, v26
  v_mul_f32 v217, v217, v26
  v_mul_f32 v218, v218, v26
  v_mul_f32 v219, v219, v26
  v_mul_f32 v220, v220, v26
  v_mul_f32 v221, v221, v26
  v_mul_f32 v222, v222, v26
  v_mul_f32 v223, v223, v26
  v_mul_f32 v224, v224, v26
  v_mul_f32 v225, v225, v26
  v_mul_f32 v226, v226, v26
  v_mul_f32 v227, v227, v26
  v_mul_f32 v228, v228, v26
  v_mul_f32 v229, v229, v26
  v_mul_f32 v230, v230, v26
  v_mul_f32 v231, v231, v26
  v_mul_f32 v232, v232, v26
  v_mul_f32 v233, v233, v26
  v_mul_f32 v234, v234, v26
  v_mul_f32 v235, v235, v26
  v_mul_f32 v236, v236, v26
  v_mul_f32 v237, v237, v26
  v_mul_f32 v238, v238, v26
  v_mul_f32 v239, v239, v26
  v_mul_f32 v240, v240, v26
  v_mul_f32 v241, v241, v26
  v_mul_f32 v242, v242, v26
  v_mul_f32 v243, v243, v26
  v_mul_f32 v244, v244, v26
  v_mul_f32 v245, v245, v26
  v_mul_f32 v246, v246, v26
  v_mul_f32 v247, v247, v26
  v_mul_f32 v248, v248, v26
  v_mul_f32 v249, v249, v26
  v_mul_f32 v250, v250, v26
  v_mul_f32 v251, v251, v26
  v_mul_f32 v252, v252, v26
  v_mul_f32 v253, v253, v26
  v_mul_f32 v254, v254, v26
  v_mul_f32 v255, v255, v26
  s_nop 1
  s_branch L_k2_fixret1
L_k2_fixh:
  s_nop 7
  v_max3_f32 v26, v48, v49, v50
  v_max3_f32 v26, v26, v51, v52
  v_max3_f32 v26, v26, v53, v54
  v_max3_f32 v26, v26, v55, v56
  v_max3_f32 v26, v26, v57, v58
  v_max3_f32 v26, v26, v59, v60
  v_max3_f32 v26, v26, v61, v62
  v_max_f32 v26, v26, v63
  v_mov_b32 v27, v26
  s_nop 1
  v_permlane16_swap_b32 v26, v27
  v_max_f32 v26, v26, v27
  v_mov_b32 v27, v26
  s_nop 1
  v_permlane32_swap_b32 v26, v27
  v_max_f32 v26, v26, v27
  v_sub_f32 v26, 0xc1800000, v26
  v_min_f32 v26, 0, v26
  v_mov_b32 v27, v26
  v_add_f32_e64 v7, v7, v26
  v_pk_add_f32 v[16:17], v[48:49], v[26:27]
  v_pk_add_f32 v[18:19], v[50:51], v[26:27]
  v_pk_add_f32 v[20:21], v[52:53], v[26:27]
  v_pk_add_f32 v[22:23], v[54:55], v[26:27]
  v_exp_f32 v16, v16
  v_exp_f32 v17, v17
  v_exp_f32 v18, v18
  v_exp_f32 v19, v19
  v_exp_f32 v20, v20
  v_exp_f32 v21, v21
  v_exp_f32 v22, v22
  v_exp_f32 v23, v23
  v_cvt_pk_bf16_f32 v120, v16, v17
  v_cvt_pk_bf16_f32 v121, v18, v19
  v_cvt_pk_bf16_f32 v122, v20, v21
  v_cvt_pk_bf16_f32 v123, v22, v23
  v_pk_add_f32 v[16:17], v[56:57], v[26:27]
  v_pk_add_f32 v[18:19], v[58:59], v[26:27]
  v_pk_add_f32 v[20:21], v[60:61], v[26:27]
  v_pk_add_f32 v[22:23], v[62:63], v[26:27]
  v_exp_f32 v16, v16
  v_exp_f32 v17, v17
  v_exp_f32 v18, v18
  v_exp_f32 v19, v19
  v_exp_f32 v20, v20
  v_exp_f32 v21, v21
  v_exp_f32 v22, v22
  v_exp_f32 v23, v23
  v_cvt_pk_bf16_f32 v124, v16, v17
  v_cvt_pk_bf16_f32 v125, v18, v19
  v_cvt_pk_bf16_f32 v126, v20, v21
  v_cvt_pk_bf16_f32 v127, v22, v23
  v_exp_f32_e64 v26, v26
  v_accvgpr_read_b32 v16, a196
  v_accvgpr_read_b32 v17, a197
  v_accvgpr_read_b32 v18, a198
  v_accvgpr_read_b32 v19, a199
  v_mul_f32 v16, v16, v26
  v_mul_f32 v17, v17, v26
  v_mul_f32 v18, v18, v26
  v_mul_f32 v19, v19, v26
  v_accvgpr_write_b32 a196, v16
  v_accvgpr_write_b32 a197, v17
  v_accvgpr_write_b32 a198, v18
  v_accvgpr_write_b32 a199, v19
  v_mul_f32 v192, v192, v26
  v_mul_f32 v193, v193, v26
  v_mul_f32 v194, v194, v26
  v_mul_f32 v195, v195, v26
  v_mul_f32 v196, v196, v26
  v_mul_f32 v197, v197, v26
  v_mul_f32 v198, v198, v26
  v_mul_f32 v199, v199, v26
  v_mul_f32 v200, v200, v26
  v_mul_f32 v201, v201, v26
  v_mul_f32 v202, v202, v26
  v_mul_f32 v203, v203, v26
  v_mul_f32 v204, v204, v26
  v_mul_f32 v205, v205, v26
  v_mul_f32 v206, v206, v26
  v_mul_f32 v207, v207, v26
  v_mul_f32 v208, v208, v26
  v_mul_f32 v209, v209, v26
  v_mul_f32 v210, v210, v26
  v_mul_f32 v211, v211, v26
  v_mul_f32 v212, v212, v26
  v_mul_f32 v213, v213, v26
  v_mul_f32 v214, v214, v26
  v_mul_f32 v215, v215, v26
  v_mul_f32 v216, v216, v26
  v_mul_f32 v217, v217, v26
  v_mul_f32 v218, v218, v26
  v_mul_f32 v219, v219, v26
  v_mul_f32 v220, v220, v26
  v_mul_f32 v221, v221, v26
  v_mul_f32 v222, v222, v26
  v_mul_f32 v223, v223, v26
  v_mul_f32 v224, v224, v26
  v_mul_f32 v225, v225, v26
  v_mul_f32 v226, v226, v26
  v_mul_f32 v227, v227, v26
  v_mul_f32 v228, v228, v26
  v_mul_f32 v229, v229, v26
  v_mul_f32 v230, v230, v26
  v_mul_f32 v231, v231, v26
  v_mul_f32 v232, v232, v26
  v_mul_f32 v233, v233, v26
  v_mul_f32 v234, v234, v26
  v_mul_f32 v235, v235, v26
  v_mul_f32 v236, v236, v26
  v_mul_f32 v237, v237, v26
  v_mul_f32 v238, v238, v26
  v_mul_f32 v239, v239, v26
  v_mul_f32 v240, v240, v26
  v_mul_f32 v241, v241, v26
  v_mul_f32 v242, v242, v26
  v_mul_f32 v243, v243, v26
  v_mul_f32 v244, v244, v26
  v_mul_f32 v245, v245, v26
  v_mul_f32 v246, v246, v26
  v_mul_f32 v247, v247, v26
  v_mul_f32 v248, v248, v26
  v_mul_f32 v249, v249, v26
  v_mul_f32 v250, v250, v26
  v_mul_f32 v251, v251, v26
  v_mul_f32 v252, v252, v26
  v_mul_f32 v253, v253, v26
  v_mul_f32 v254, v254, v26
  v_mul_f32 v255, v255, v26
  s_cmp_eq_u32 s59, 2
  s_cbranch_scc1 L_k2_fixhret1
  s_branch L_k2_fixhret0
.section .rodata,"a"
.p2align 6
.amdhsa_kernel fused_kernel
  .amdhsa_next_free_vgpr 512
  .amdhsa_next_free_sgpr 102
  .amdhsa_accum_offset 256
  .amdhsa_group_segment_fixed_size 0
  .amdhsa_kernarg_size 112
  .amdhsa_user_sgpr_count 2
  .amdhsa_user_sgpr_kernarg_segment_ptr 1
  .amdhsa_system_sgpr_workgroup_id_x 1
.end_amdhsa_kernel
.text
L_allend:
```
